```python
import torch

def _softmax(x, axis=-1):
    return torch.softmax(x, dim=axis)
def _gelu(x):
    return torch.nn.functional.gelu(x, approximate="tanh")
def _silu(x):
    return torch.nn.functional.silu(x)
def _sigmoid(x):
    return torch.sigmoid(x)
def _layernorm(x, axis=-1, eps=1e-5):
    m = x.mean(dim=axis, keepdim=True)
    v = x.var(dim=axis, keepdim=True, unbiased=False)
    return (x - m) / torch.sqrt(v + eps)
def _scatter_add(tgt, idx, src, axis=0):
    return tgt.clone().index_add_(axis, idx, src)
def _segment_sum(src, seg, n):
    out = torch.zeros((n,) + src.shape[1:], dtype=src.dtype)
    return out.index_add_(0, seg, src)
def _pad(x, pw):
    flat = tuple(v for pair in reversed(pw) for v in pair)
    return torch.nn.functional.pad(x, flat)

kernel_name = 'interleave_layers__spectral_gfnet__glu_gated_reglu__prompt'

def setup_inputs():

    _w = (lambda a: (lambda t: t.to(torch.bfloat16) if t.is_floating_point() else t)(torch.as_tensor(a)))
    def _A_setup():
        B, S, D = 1, 2048, 512
        Df = D // 2 + 1
        return {
            "x": _w((lambda *s: torch.randn(*s, dtype=torch.bfloat16) * 0.05)(B, S, D)),
            "w_r": _w((lambda *s: torch.randn(*s, dtype=torch.bfloat16) * 0.4)(S, Df) * 0.02),
            "w_i": _w((lambda *s: torch.randn(*s, dtype=torch.bfloat16) * 0.4)(S, Df) * 0.02),
        }
    _A_in = _A_setup()

    def _B_setup():
        B, S, D, F = 1, 2048, 512, 1792
        return {
            "x": _w((lambda *s: torch.randn(*s, dtype=torch.bfloat16) * 0.05)(B, S, D)),
            "W_gate": _w((lambda *s: torch.randn(*s, dtype=torch.bfloat16) * 0.2)(D, F) * (2.0 / D) ** 0.5),
            "W_up": _w((lambda *s: torch.randn(*s, dtype=torch.bfloat16) * 0.2)(D, F) * (2.0 / D) ** 0.5),
            "W_down": _w((lambda *s: torch.randn(*s, dtype=torch.bfloat16) * 0.2)(F, D) * (1.0 / F) ** 0.5),
        }
    _B_in = _B_setup()

    return {
        "A_x": _A_in["x"],
        "A_w_r": _A_in["w_r"],
        "A_w_i": _A_in["w_i"],
        "B_x": _B_in["x"],
        "B_W_gate": _B_in["W_gate"],
        "B_W_up": _B_in["W_up"],
        "B_W_down": _B_in["W_down"],
    }

def reference(A_x, A_w_r, A_w_i, B_x, B_W_gate, B_W_up, B_W_down):
    def _A_ref(x, w_r, w_i):
        B, S, D = x.shape
        X = (lambda x, axes=(-2,-1): torch.fft.rfft2(x.float(), dim=axes))(x, axes=(-2, -1))
        W = w_r + 1j * w_i
        X = X * W
        y = (lambda x, s, axes=(-2,-1): torch.fft.irfft2(x, s=s, dim=axes).to(torch.bfloat16))(X, (S, D), axes=(-2, -1))
        return y

    def _B_ref(x, W_gate, W_up, W_down):
        gate = torch.einsum("bsd,df->bsf", x, W_gate)
        up = torch.einsum("bsd,df->bsf", x, W_up)
        gate = gate * (lambda x, dt: x.to(dt))(gate > 0, gate.dtype)
        h = gate * up
        return torch.einsum("bsf,fd->bsd", h, W_down)

    x = A_x
    x = x + _A_ref(_layernorm(x, axis=-1), A_w_r, A_w_i)
    x = x + _B_ref(_layernorm(x, axis=-1), B_W_gate, B_W_up, B_W_down)
    x = x + _A_ref(_layernorm(x, axis=-1), A_w_r, A_w_i)
    x = x + _B_ref(_layernorm(x, axis=-1), B_W_gate, B_W_up, B_W_down)
    return x
```

```asm
; @launch grid=(256,1,1) block=(256,1,1) lds=163840
.amdgcn_target "amdgcn-amd-amdhsa--gfx950"
.text
.globl interleave_layers__spectral_gfnet__glu_gated_reglu__prompt_kernel
.p2align 8
.type interleave_layers__spectral_gfnet__glu_gated_reglu__prompt_kernel,@function
interleave_layers__spectral_gfnet__glu_gated_reglu__prompt_kernel:
    s_cmp_ge_u32 s2, 256
    s_cbranch_scc1 Lexit
    s_load_dwordx16 s[4:19], s[0:1], 0
    s_load_dwordx4 s[20:23], s[0:1], 64
    s_getpc_b64 s[32:33]
Lpc:
    s_mov_b32 s34, Ltab+36864-Lpc
    s_mov_b32 s35, 0x20000
    s_lshr_b32 s36, s2, 3
    s_and_b32 s36, s36, 7
    s_lshl_b32 s36, s36, 14
    v_lshlrev_b32 v1, 6, v0
    buffer_load_dword v44, v1, s[32:35], s36 offen
    v_lshrrev_b32 v1, 6, v0
    s_nop 0
    v_readfirstlane_b32 s3, v1
    v_and_b32 v1, 63, v0
    v_lshlrev_b32 v2, 4, v1
    v_and_b32 v3, 31, v1
    v_lshrrev_b32 v4, 5, v1
    v_and_b32 v5, 0xfffffff3, v3
    v_and_b32 v6, 4, v3
    v_lshl_or_b32 v5, v6, 1, v5
    v_and_b32 v6, 8, v3
    v_lshrrev_b32 v6, 1, v6
    v_or_b32 v5, v5, v6
    s_and_b32 s52, s2, 7
    s_lshr_b32 s56, s2, 5
    s_lshl_b32 s56, s56, 3
    s_add_u32 s52, s52, s56
    s_lshr_b32 s53, s2, 1
    s_and_b32 s53, s53, 12
    s_add_u32 s53, s53, s3
    s_and_b32 s67, s3, 1
    s_lshr_b32 s68, s3, 1
    s_lshl_b32 s56, s67, 7
    v_xor_b32 v56, s56, v2
    v_xor_b32 v57, 16, v56
    v_xor_b32 v58, 32, v56
    v_xor_b32 v59, 48, v56
    v_xor_b32 v60, 64, v56
    v_xor_b32 v61, 80, v56
    v_xor_b32 v62, 96, v56
    v_xor_b32 v63, 112, v56
    s_and_b32 s63, s2, 7
    s_lshl_b32 s63, s63, 1
    s_bfe_u32 s56, s2, 0x10005
    s_add_u32 s63, s63, s56
    s_lshr_b32 s56, s2, 6
    s_lshl_b32 s56, s56, 4
    s_add_u32 s63, s63, s56
    s_lshr_b32 s56, s63, 2
    s_lshl_b32 s56, s56, 7
    s_and_b32 s57, s63, 3
    s_lshl_b32 s57, s57, 2
    s_add_u32 s56, s56, s57
    s_lshl_b32 s57, s67, 4
    s_add_u32 s56, s56, s57
    s_lshl_b32 s57, s68, 1
    s_add_u32 s56, s56, s57
    s_lshl_b32 s56, s56, 10
    s_lshl_b32 s69, s3, 13
    s_lshl_b32 s54, s2, 2
    s_add_u32 s54, s54, s3
    s_lshl_b32 s65, s54, 1
    s_and_b32 s60, s65, 0x780
    s_and_b32 s57, s65, 3
    s_lshl_b32 s57, s57, 5
    s_or_b32 s60, s60, s57
    s_and_b32 s57, s65, 4
    s_lshl_b32 s57, s57, 2
    s_or_b32 s60, s60, s57
    s_lshr_b32 s57, s65, 3
    s_and_b32 s57, s57, 15
    s_or_b32 s60, s60, s57
    s_lshl_b32 s60, s60, 10
    s_add_u32 s61, s60, 32768
    s_mov_b32 s30, 0x200000
    s_mov_b32 s31, 0x20000
    s_mov_b32 s26, 0x4000000
    s_mov_b32 s27, 0x20000
    s_mov_b32 s58, 0x2190000
    s_cmp_eq_u32 s54, 1023
    s_cselect_b32 s58, s58, 0x4000000
    s_cselect_b32 s65, 0, 256
    s_add_u32 s59, s58, 0x4000
    v_mov_b32 v6, 0
    v_lshlrev_b32 v7, 8, v1
    v_mov_b32 v8, 1
    s_and_b32 s62, s2, 3
    s_lshl_b32 s62, s62, 6
    s_lshl_b32 s57, s3, 4
    s_add_u32 s62, s62, s57
    v_and_b32 v10, 15, v1
    v_add_u32 v10, s62, v10
    v_mov_b32 v11, 256
    v_cmp_eq_u32 vcc, 0, v10
    v_lshrrev_b32 v13, 4, v1
    v_mul_u32_u24 v12, 514, v13
    v_cndmask_b32 v11, v10, v11, vcc
    v_lshl_add_u32 v11, v11, 1, v12
    v_mul_u32_u24 v45, 8448, v10
    v_lshl_add_u32 v45, v13, 4, v45
    v_lshrrev_b32 v40, 3, v1
    v_mul_u32_u24 v40, 3584, v40
    v_and_b32 v41, 7, v1
    v_lshrrev_b32 v42, 2, v1
    v_and_b32 v42, 4, v42
    v_xor_b32 v41, v41, v42
    v_lshl_add_u32 v47, v41, 4, v40
    s_waitcnt lgkmcnt(0)
    s_mov_b32 s28, s4
    s_mov_b32 s29, s5
    s_add_u32 m0, s69, 0
    s_add_u32 s57, s56, 0
    buffer_load_dwordx4 v56, s[28:31], s57 offen lds
    s_add_u32 m0, s69, 1024
    s_add_u32 s57, s56, 32768
    buffer_load_dwordx4 v57, s[28:31], s57 offen lds
    s_add_u32 m0, s69, 2048
    s_add_u32 s57, s56, 65536
    buffer_load_dwordx4 v58, s[28:31], s57 offen lds
    s_add_u32 m0, s69, 3072
    s_add_u32 s57, s56, 98304
    buffer_load_dwordx4 v59, s[28:31], s57 offen lds
    s_add_u32 m0, s69, 4096
    s_add_u32 s57, s56, 1024
    buffer_load_dwordx4 v60, s[28:31], s57 offen lds
    s_add_u32 m0, s69, 5120
    s_add_u32 s57, s56, 33792
    buffer_load_dwordx4 v61, s[28:31], s57 offen lds
    s_add_u32 m0, s69, 6144
    s_add_u32 s57, s56, 66560
    buffer_load_dwordx4 v62, s[28:31], s57 offen lds
    s_add_u32 m0, s69, 7168
    s_add_u32 s57, s56, 99328
    buffer_load_dwordx4 v63, s[28:31], s57 offen lds
    buffer_load_dwordx4 v[16:19], v2, s[28:31], s60 offen
    buffer_load_dwordx4 v[20:23], v2, s[28:31], s61 offen
    s_mov_b32 s24, s22
    s_mov_b32 s25, s23
    buffer_store_dword v6, v7, s[24:27], s58 offen offset:0 sc1
    buffer_store_dword v6, v7, s[24:27], s58 offen offset:128 sc1
    buffer_store_dword v6, v7, s[24:27], s59 offen offset:0 sc1
    buffer_store_dword v6, v7, s[24:27], s59 offen offset:128 sc1
    s_mov_b32 s32, s6
    s_mov_b32 s33, s7
    s_mov_b32 s34, 0x101000
    s_mov_b32 s35, 0x20000
    s_mov_b32 s36, s8
    s_mov_b32 s37, s9
    s_mov_b32 s38, 0x101000
    s_mov_b32 s39, 0x20000
    s_mov_b32 s48, s20
    s_mov_b32 s49, s21
    s_mov_b32 s50, 0x100
    s_mov_b32 s51, 0x20000
    s_getpc_b64 s[20:21]
Lpc2:
    s_add_u32 s20, s20, Ltab-Lpc2
    s_addc_u32 s21, s21, 0
    s_mov_b32 s22, 36864
    s_mov_b32 s23, 0x20000
    s_cmp_lt_u32 s52, 56
    s_cselect_b32 s42, 1835008, 0
    s_cselect_b32 s46, 1835008, 0
    s_cmp_ge_u32 s52, 28
    s_cselect_b32 s40, s14, s12
    s_cselect_b32 s41, s15, s13
    s_cselect_b32 s66, 1, 0
    s_mov_b32 s43, 0x20000
    s_mov_b32 s47, 0x20000
    s_mov_b32 s44, s16
    s_mov_b32 s45, s17
    s_mul_i32 s56, s66, 28
    s_sub_u32 s55, s52, s56
    s_lshr_b32 s60, s2, 2
    s_and_b32 s60, s60, 7
    s_lshr_b32 s61, s2, 5
    s_lshl_b32 s64, s61, 8
    s_lshl_b32 s57, s60, 3
    s_add_u32 s64, s64, s57
    s_mul_i32 s64, s64, 514
    s_lshr_b32 s62, s60, 1
    s_lshl_b32 s62, s62, 11
    s_lshl_b32 s57, s61, 8
    s_add_u32 s62, s62, s57
    s_and_b32 s57, s60, 1
    s_lshl_b32 s57, s57, 7
    s_add_u32 s62, s62, s57
    s_add_u32 s62, s62, 0x2400000
    s_mul_i32 s4, s3, 458752
    s_lshl_b32 s57, s55, 7
    s_add_u32 s4, s4, s57
    s_lshl_b32 s5, s3, 14
    s_lshl_b32 s6, s52, 5
    s_lshl_b32 s57, s68, 4
    s_add_u32 s6, s6, s57
    s_lshl_b32 s57, s67, 2
    s_add_u32 s6, s6, s57
    s_lshl_b32 s6, s6, 10
    s_mov_b32 s17, s69
    v_mov_b32 v88, -1
    v_mov_b32 v89, -1
    v_mov_b32 v90, -1
    v_mov_b32 v91, -1
    v_mov_b32 v92, 0
    v_mov_b32 v93, 0
    v_mov_b32 v94, 0
    v_mov_b32 v95, 0
    s_lshl_b32 s56, s53, 5
    v_add_u32 v40, s56, v5
    v_lshrrev_b32 v41, 1, v40
    v_and_b32 v42, 1, v40
    v_cvt_f32_u32 v43, v41
    v_mul_f32 v43, 0x3b000000, v43
    v_cvt_f32_u32 v48, v42
    v_mul_f32 v48, 0x3e800000, v48
    s_sub_u32 s7, s54, 920
    s_lshl_b32 s15, s7, 13
    s_add_u32 s15, s15, 0x2110000
    s_cmp_lt_u32 s7, 28
    s_cselect_b32 s15, s15, 0x4000000
    s_mov_b32 exec_hi, 0
    buffer_store_dword v6, v7, s[24:27], s15 offen sc1
    s_mov_b32 exec_hi, -1
    v_mov_b32 v49, 0x3e000000
    v_cmp_eq_u32 vcc, 0, v41
    s_nop 1
    v_cndmask_b32 v48, v48, v49, vcc
    v_mov_b32 v49, 0.5
    v_cmp_eq_u32 vcc, 0, v40
    s_nop 1
    v_cndmask_b32 v43, v43, v49, vcc
    v_lshlrev_b32 v49, 31, v41
    v_or_b32 v46, 1.0, v49
    s_sub_u32 s7, s54, 896
    s_lshl_b32 s15, s7, 10
    s_add_u32 s15, s15, 0x2002000
    s_cmp_lt_u32 s7, 24
    s_cselect_b32 s15, s15, 0x4000000
    s_sub_u32 s7, s54, 960
    s_lshl_b32 s16, s7, 10
    s_add_u32 s16, s16, 0x2180000
    s_cmp_lt_u32 s7, 64
    s_cselect_b32 s15, s16, s15
    buffer_store_dwordx4 v[92:95], v2, s[24:27], s15 offen sc1
    v_lshlrev_b32 v49, 3, v4
    v_cvt_f32_u32 v49, v49
    v_fma_f32 v48, v43, v49, v48
    v_mul_f32 v50, 0x41800000, v43
    v_cos_f32 v50, v50
    v_fmamk_f32 v96, v43, 0x00000000, v48
    v_fmamk_f32 v97, v43, 0x3f800000, v48
    v_fmamk_f32 v98, v43, 0x40000000, v48
    buffer_load_ushort v24, v11, s[32:35], s64 offen
    v_fmamk_f32 v99, v43, 0x40400000, v48
    v_fmamk_f32 v100, v43, 0x40800000, v48
    v_fmamk_f32 v101, v43, 0x40a00000, v48
    v_fmamk_f32 v102, v43, 0x40c00000, v48
    v_fmamk_f32 v103, v43, 0x40e00000, v48
    v_fmamk_f32 v104, v43, 0x41800000, v48
    v_fmamk_f32 v105, v43, 0x41880000, v48
    v_fmamk_f32 v106, v43, 0x41900000, v48
    buffer_load_ushort v28, v11, s[36:39], s64 offen
    v_fmamk_f32 v107, v43, 0x41980000, v48
    v_fmamk_f32 v108, v43, 0x41a00000, v48
    v_fmamk_f32 v109, v43, 0x41a80000, v48
    v_fmamk_f32 v110, v43, 0x41b00000, v48
    v_fmamk_f32 v111, v43, 0x41b80000, v48
    v_add_f32 v50, v50, v50
    v_cos_f32 v96, v96
    v_cos_f32 v97, v97
    buffer_load_ushort v32, v11, s[32:35], s64 offen offset:2056
    v_cos_f32 v98, v98
    v_cos_f32 v99, v99
    v_cos_f32 v100, v100
    v_cos_f32 v101, v101
    v_cos_f32 v102, v102
    v_cos_f32 v103, v103
    v_cos_f32 v104, v104
    v_cos_f32 v105, v105
    buffer_load_ushort v36, v11, s[36:39], s64 offen offset:2056
    s_add_u32 s64, s64, 32896
    v_cos_f32 v106, v106
    v_cos_f32 v107, v107
    v_cos_f32 v108, v108
    v_cos_f32 v109, v109
    v_cos_f32 v110, v110
    v_cos_f32 v111, v111
    s_mov_b32 s56, 0x3d800000
    v_pk_mul_f32 v[96:97], v[96:97], s[56:57] op_sel_hi:[1,0]
    buffer_load_ushort v25, v11, s[32:35], s64 offen
    v_pk_mul_f32 v[98:99], v[98:99], s[56:57] op_sel_hi:[1,0]
    v_pk_mul_f32 v[100:101], v[100:101], s[56:57] op_sel_hi:[1,0]
    v_pk_mul_f32 v[102:103], v[102:103], s[56:57] op_sel_hi:[1,0]
    v_pk_mul_f32 v[104:105], v[104:105], s[56:57] op_sel_hi:[1,0]
    v_pk_mul_f32 v[106:107], v[106:107], s[56:57] op_sel_hi:[1,0]
    v_pk_mul_f32 v[108:109], v[108:109], s[56:57] op_sel_hi:[1,0]
    v_pk_mul_f32 v[110:111], v[110:111], s[56:57] op_sel_hi:[1,0]
    v_cvt_pk_bf16_f32 v120, v96, v97
    buffer_load_ushort v29, v11, s[36:39], s64 offen
    v_cvt_pk_bf16_f32 v121, v98, v99
    v_cvt_pk_bf16_f32 v122, v100, v101
    v_cvt_pk_bf16_f32 v123, v102, v103
    v_accvgpr_write_b32 a192, v120
    v_accvgpr_write_b32 a193, v121
    v_accvgpr_write_b32 a194, v122
    v_accvgpr_write_b32 a195, v123
    v_cvt_pk_bf16_f32 v120, v104, v105
    buffer_load_ushort v33, v11, s[32:35], s64 offen offset:2056
    v_cvt_pk_bf16_f32 v121, v106, v107
    v_cvt_pk_bf16_f32 v122, v108, v109
    v_cvt_pk_bf16_f32 v123, v110, v111
    v_accvgpr_write_b32 a196, v120
    v_accvgpr_write_b32 a197, v121
    v_accvgpr_write_b32 a198, v122
    v_accvgpr_write_b32 a199, v123
    v_pk_fma_f32 v[112:113], v[104:105], v[50:51], v[96:97] op_sel_hi:[1,0,1] neg_lo:[0,0,1] neg_hi:[0,0,1]
    buffer_load_ushort v37, v11, s[36:39], s64 offen offset:2056
    s_add_u32 s64, s64, 32896
    v_pk_fma_f32 v[114:115], v[106:107], v[50:51], v[98:99] op_sel_hi:[1,0,1] neg_lo:[0,0,1] neg_hi:[0,0,1]
    v_pk_fma_f32 v[116:117], v[108:109], v[50:51], v[100:101] op_sel_hi:[1,0,1] neg_lo:[0,0,1] neg_hi:[0,0,1]
    v_pk_fma_f32 v[118:119], v[110:111], v[50:51], v[102:103] op_sel_hi:[1,0,1] neg_lo:[0,0,1] neg_hi:[0,0,1]
    v_cvt_pk_bf16_f32 v120, v112, v113
    v_cvt_pk_bf16_f32 v121, v114, v115
    v_cvt_pk_bf16_f32 v122, v116, v117
    v_cvt_pk_bf16_f32 v123, v118, v119
    v_accvgpr_write_b32 a200, v120
    buffer_load_ushort v26, v11, s[32:35], s64 offen
    v_accvgpr_write_b32 a201, v121
    v_accvgpr_write_b32 a202, v122
    v_accvgpr_write_b32 a203, v123
    v_pk_fma_f32 v[96:97], v[112:113], v[50:51], v[104:105] op_sel_hi:[1,0,1] neg_lo:[0,0,1] neg_hi:[0,0,1]
    v_pk_fma_f32 v[98:99], v[114:115], v[50:51], v[106:107] op_sel_hi:[1,0,1] neg_lo:[0,0,1] neg_hi:[0,0,1]
    v_pk_fma_f32 v[100:101], v[116:117], v[50:51], v[108:109] op_sel_hi:[1,0,1] neg_lo:[0,0,1] neg_hi:[0,0,1]
    v_pk_fma_f32 v[102:103], v[118:119], v[50:51], v[110:111] op_sel_hi:[1,0,1] neg_lo:[0,0,1] neg_hi:[0,0,1]
    v_cvt_pk_bf16_f32 v120, v96, v97
    buffer_load_ushort v30, v11, s[36:39], s64 offen
    v_cvt_pk_bf16_f32 v121, v98, v99
    v_cvt_pk_bf16_f32 v122, v100, v101
    v_cvt_pk_bf16_f32 v123, v102, v103
    v_accvgpr_write_b32 a204, v120
    v_accvgpr_write_b32 a205, v121
    v_accvgpr_write_b32 a206, v122
    v_accvgpr_write_b32 a207, v123
    v_pk_fma_f32 v[104:105], v[96:97], v[50:51], v[112:113] op_sel_hi:[1,0,1] neg_lo:[0,0,1] neg_hi:[0,0,1]
    buffer_load_ushort v34, v11, s[32:35], s64 offen offset:2056
    v_pk_fma_f32 v[106:107], v[98:99], v[50:51], v[114:115] op_sel_hi:[1,0,1] neg_lo:[0,0,1] neg_hi:[0,0,1]
    v_pk_fma_f32 v[108:109], v[100:101], v[50:51], v[116:117] op_sel_hi:[1,0,1] neg_lo:[0,0,1] neg_hi:[0,0,1]
    v_pk_fma_f32 v[110:111], v[102:103], v[50:51], v[118:119] op_sel_hi:[1,0,1] neg_lo:[0,0,1] neg_hi:[0,0,1]
    v_cvt_pk_bf16_f32 v120, v104, v105
    v_cvt_pk_bf16_f32 v121, v106, v107
    v_cvt_pk_bf16_f32 v122, v108, v109
    v_cvt_pk_bf16_f32 v123, v110, v111
    v_accvgpr_write_b32 a208, v120
    buffer_load_ushort v38, v11, s[36:39], s64 offen offset:2056
    s_add_u32 s64, s64, 32896
    v_accvgpr_write_b32 a209, v121
    v_accvgpr_write_b32 a210, v122
    v_accvgpr_write_b32 a211, v123
    v_pk_fma_f32 v[112:113], v[104:105], v[50:51], v[96:97] op_sel_hi:[1,0,1] neg_lo:[0,0,1] neg_hi:[0,0,1]
    v_pk_fma_f32 v[114:115], v[106:107], v[50:51], v[98:99] op_sel_hi:[1,0,1] neg_lo:[0,0,1] neg_hi:[0,0,1]
    v_pk_fma_f32 v[116:117], v[108:109], v[50:51], v[100:101] op_sel_hi:[1,0,1] neg_lo:[0,0,1] neg_hi:[0,0,1]
    v_pk_fma_f32 v[118:119], v[110:111], v[50:51], v[102:103] op_sel_hi:[1,0,1] neg_lo:[0,0,1] neg_hi:[0,0,1]
    v_cvt_pk_bf16_f32 v120, v112, v113
    buffer_load_ushort v27, v11, s[32:35], s64 offen
    v_cvt_pk_bf16_f32 v121, v114, v115
    v_cvt_pk_bf16_f32 v122, v116, v117
    v_cvt_pk_bf16_f32 v123, v118, v119
    v_accvgpr_write_b32 a212, v120
    v_accvgpr_write_b32 a213, v121
    v_accvgpr_write_b32 a214, v122
    v_accvgpr_write_b32 a215, v123
    v_pk_fma_f32 v[96:97], v[112:113], v[50:51], v[104:105] op_sel_hi:[1,0,1] neg_lo:[0,0,1] neg_hi:[0,0,1]
    buffer_load_ushort v31, v11, s[36:39], s64 offen
    v_pk_fma_f32 v[98:99], v[114:115], v[50:51], v[106:107] op_sel_hi:[1,0,1] neg_lo:[0,0,1] neg_hi:[0,0,1]
    v_pk_fma_f32 v[100:101], v[116:117], v[50:51], v[108:109] op_sel_hi:[1,0,1] neg_lo:[0,0,1] neg_hi:[0,0,1]
    v_pk_fma_f32 v[102:103], v[118:119], v[50:51], v[110:111] op_sel_hi:[1,0,1] neg_lo:[0,0,1] neg_hi:[0,0,1]
    v_cvt_pk_bf16_f32 v120, v96, v97
    v_cvt_pk_bf16_f32 v121, v98, v99
    v_cvt_pk_bf16_f32 v122, v100, v101
    v_cvt_pk_bf16_f32 v123, v102, v103
    v_accvgpr_write_b32 a216, v120
    buffer_load_ushort v35, v11, s[32:35], s64 offen offset:2056
    v_accvgpr_write_b32 a217, v121
    v_accvgpr_write_b32 a218, v122
    v_accvgpr_write_b32 a219, v123
    v_pk_fma_f32 v[104:105], v[96:97], v[50:51], v[112:113] op_sel_hi:[1,0,1] neg_lo:[0,0,1] neg_hi:[0,0,1]
    v_pk_fma_f32 v[106:107], v[98:99], v[50:51], v[114:115] op_sel_hi:[1,0,1] neg_lo:[0,0,1] neg_hi:[0,0,1]
    v_pk_fma_f32 v[108:109], v[100:101], v[50:51], v[116:117] op_sel_hi:[1,0,1] neg_lo:[0,0,1] neg_hi:[0,0,1]
    v_pk_fma_f32 v[110:111], v[102:103], v[50:51], v[118:119] op_sel_hi:[1,0,1] neg_lo:[0,0,1] neg_hi:[0,0,1]
    v_cvt_pk_bf16_f32 v120, v104, v105
    buffer_load_ushort v39, v11, s[36:39], s64 offen offset:2056
    v_cvt_pk_bf16_f32 v121, v106, v107
    v_cvt_pk_bf16_f32 v122, v108, v109
    v_cvt_pk_bf16_f32 v123, v110, v111
    v_accvgpr_write_b32 a220, v120
    v_accvgpr_write_b32 a221, v121
    v_accvgpr_write_b32 a222, v122
    v_accvgpr_write_b32 a223, v123
    v_pk_fma_f32 v[112:113], v[104:105], v[50:51], v[96:97] op_sel_hi:[1,0,1] neg_lo:[0,0,1] neg_hi:[0,0,1]
    s_add_u32 m0, s5, 65536
    s_add_u32 s7, s4, 0
    buffer_load_dwordx4 v47, s[40:43], s7 offen lds
    v_pk_fma_f32 v[114:115], v[106:107], v[50:51], v[98:99] op_sel_hi:[1,0,1] neg_lo:[0,0,1] neg_hi:[0,0,1]
    v_pk_fma_f32 v[116:117], v[108:109], v[50:51], v[100:101] op_sel_hi:[1,0,1] neg_lo:[0,0,1] neg_hi:[0,0,1]
    v_pk_fma_f32 v[118:119], v[110:111], v[50:51], v[102:103] op_sel_hi:[1,0,1] neg_lo:[0,0,1] neg_hi:[0,0,1]
    v_cvt_pk_bf16_f32 v120, v112, v113
    v_cvt_pk_bf16_f32 v121, v114, v115
    v_cvt_pk_bf16_f32 v122, v116, v117
    v_cvt_pk_bf16_f32 v123, v118, v119
    v_accvgpr_write_b32 a224, v120
    s_add_u32 m0, s5, 66560
    s_add_u32 s7, s4, 28672
    buffer_load_dwordx4 v47, s[40:43], s7 offen lds
    v_accvgpr_write_b32 a225, v121
    v_accvgpr_write_b32 a226, v122
    v_accvgpr_write_b32 a227, v123
    v_pk_fma_f32 v[96:97], v[112:113], v[50:51], v[104:105] op_sel_hi:[1,0,1] neg_lo:[0,0,1] neg_hi:[0,0,1]
    v_pk_fma_f32 v[98:99], v[114:115], v[50:51], v[106:107] op_sel_hi:[1,0,1] neg_lo:[0,0,1] neg_hi:[0,0,1]
    v_pk_fma_f32 v[100:101], v[116:117], v[50:51], v[108:109] op_sel_hi:[1,0,1] neg_lo:[0,0,1] neg_hi:[0,0,1]
    v_pk_fma_f32 v[102:103], v[118:119], v[50:51], v[110:111] op_sel_hi:[1,0,1] neg_lo:[0,0,1] neg_hi:[0,0,1]
    v_cvt_pk_bf16_f32 v120, v96, v97
    s_add_u32 m0, s5, 67584
    s_add_u32 s7, s4, 57344
    buffer_load_dwordx4 v47, s[40:43], s7 offen lds
    v_cvt_pk_bf16_f32 v121, v98, v99
    v_cvt_pk_bf16_f32 v122, v100, v101
    v_cvt_pk_bf16_f32 v123, v102, v103
    v_accvgpr_write_b32 a228, v120
    v_accvgpr_write_b32 a229, v121
    v_accvgpr_write_b32 a230, v122
    v_accvgpr_write_b32 a231, v123
    v_pk_fma_f32 v[104:105], v[96:97], v[50:51], v[112:113] op_sel_hi:[1,0,1] neg_lo:[0,0,1] neg_hi:[0,0,1]
    s_add_u32 m0, s5, 68608
    s_add_u32 s7, s4, 86016
    buffer_load_dwordx4 v47, s[40:43], s7 offen lds
    v_pk_fma_f32 v[106:107], v[98:99], v[50:51], v[114:115] op_sel_hi:[1,0,1] neg_lo:[0,0,1] neg_hi:[0,0,1]
    v_pk_fma_f32 v[108:109], v[100:101], v[50:51], v[116:117] op_sel_hi:[1,0,1] neg_lo:[0,0,1] neg_hi:[0,0,1]
    v_pk_fma_f32 v[110:111], v[102:103], v[50:51], v[118:119] op_sel_hi:[1,0,1] neg_lo:[0,0,1] neg_hi:[0,0,1]
    v_cvt_pk_bf16_f32 v120, v104, v105
    v_cvt_pk_bf16_f32 v121, v106, v107
    v_cvt_pk_bf16_f32 v122, v108, v109
    v_cvt_pk_bf16_f32 v123, v110, v111
    v_accvgpr_write_b32 a232, v120
    s_waitcnt vmcnt(22)
    s_mov_b64 exec, 1
    buffer_store_dword v8, v6, s[48:51], s65 offen sc1
    s_mov_b64 exec, -1
    v_accvgpr_write_b32 a233, v121
    v_accvgpr_write_b32 a234, v122
    v_accvgpr_write_b32 a235, v123
    v_pk_fma_f32 v[112:113], v[104:105], v[50:51], v[96:97] op_sel_hi:[1,0,1] neg_lo:[0,0,1] neg_hi:[0,0,1]
    v_pk_fma_f32 v[114:115], v[106:107], v[50:51], v[98:99] op_sel_hi:[1,0,1] neg_lo:[0,0,1] neg_hi:[0,0,1]
    v_pk_fma_f32 v[116:117], v[108:109], v[50:51], v[100:101] op_sel_hi:[1,0,1] neg_lo:[0,0,1] neg_hi:[0,0,1]
    v_pk_fma_f32 v[118:119], v[110:111], v[50:51], v[102:103] op_sel_hi:[1,0,1] neg_lo:[0,0,1] neg_hi:[0,0,1]
    v_cvt_pk_bf16_f32 v120, v112, v113
    v_cvt_pk_bf16_f32 v121, v114, v115
    v_cvt_pk_bf16_f32 v122, v116, v117
    v_cvt_pk_bf16_f32 v123, v118, v119
    v_accvgpr_write_b32 a236, v120
    v_accvgpr_write_b32 a237, v121
    v_accvgpr_write_b32 a238, v122
    v_accvgpr_write_b32 a239, v123
    v_pk_fma_f32 v[96:97], v[112:113], v[50:51], v[104:105] op_sel_hi:[1,0,1] neg_lo:[0,0,1] neg_hi:[0,0,1]
    v_pk_fma_f32 v[98:99], v[114:115], v[50:51], v[106:107] op_sel_hi:[1,0,1] neg_lo:[0,0,1] neg_hi:[0,0,1]
    v_pk_fma_f32 v[100:101], v[116:117], v[50:51], v[108:109] op_sel_hi:[1,0,1] neg_lo:[0,0,1] neg_hi:[0,0,1]
    v_pk_fma_f32 v[102:103], v[118:119], v[50:51], v[110:111] op_sel_hi:[1,0,1] neg_lo:[0,0,1] neg_hi:[0,0,1]
    v_cvt_pk_bf16_f32 v120, v96, v97
    v_cvt_pk_bf16_f32 v121, v98, v99
    v_cvt_pk_bf16_f32 v122, v100, v101
    v_cvt_pk_bf16_f32 v123, v102, v103
    v_accvgpr_write_b32 a240, v120
    v_accvgpr_write_b32 a241, v121
    v_accvgpr_write_b32 a242, v122
    v_accvgpr_write_b32 a243, v123
    v_pk_fma_f32 v[104:105], v[96:97], v[50:51], v[112:113] op_sel_hi:[1,0,1] neg_lo:[0,0,1] neg_hi:[0,0,1]
    v_pk_fma_f32 v[106:107], v[98:99], v[50:51], v[114:115] op_sel_hi:[1,0,1] neg_lo:[0,0,1] neg_hi:[0,0,1]
    v_pk_fma_f32 v[108:109], v[100:101], v[50:51], v[116:117] op_sel_hi:[1,0,1] neg_lo:[0,0,1] neg_hi:[0,0,1]
    v_pk_fma_f32 v[110:111], v[102:103], v[50:51], v[118:119] op_sel_hi:[1,0,1] neg_lo:[0,0,1] neg_hi:[0,0,1]
    v_cvt_pk_bf16_f32 v120, v104, v105
    v_cvt_pk_bf16_f32 v121, v106, v107
    v_cvt_pk_bf16_f32 v122, v108, v109
    v_cvt_pk_bf16_f32 v123, v110, v111
    v_accvgpr_write_b32 a244, v120
    v_accvgpr_write_b32 a245, v121
    v_accvgpr_write_b32 a246, v122
    v_accvgpr_write_b32 a247, v123
    v_pk_fma_f32 v[112:113], v[104:105], v[50:51], v[96:97] op_sel_hi:[1,0,1] neg_lo:[0,0,1] neg_hi:[0,0,1]
    v_pk_fma_f32 v[114:115], v[106:107], v[50:51], v[98:99] op_sel_hi:[1,0,1] neg_lo:[0,0,1] neg_hi:[0,0,1]
    v_pk_fma_f32 v[116:117], v[108:109], v[50:51], v[100:101] op_sel_hi:[1,0,1] neg_lo:[0,0,1] neg_hi:[0,0,1]
    v_pk_fma_f32 v[118:119], v[110:111], v[50:51], v[102:103] op_sel_hi:[1,0,1] neg_lo:[0,0,1] neg_hi:[0,0,1]
    v_cvt_pk_bf16_f32 v120, v112, v113
    v_cvt_pk_bf16_f32 v121, v114, v115
    v_cvt_pk_bf16_f32 v122, v116, v117
    v_cvt_pk_bf16_f32 v123, v118, v119
    v_accvgpr_write_b32 a248, v120
    v_accvgpr_write_b32 a249, v121
    v_accvgpr_write_b32 a250, v122
    v_accvgpr_write_b32 a251, v123
    v_pk_fma_f32 v[96:97], v[112:113], v[50:51], v[104:105] op_sel_hi:[1,0,1] neg_lo:[0,0,1] neg_hi:[0,0,1]
    v_pk_fma_f32 v[98:99], v[114:115], v[50:51], v[106:107] op_sel_hi:[1,0,1] neg_lo:[0,0,1] neg_hi:[0,0,1]
    v_pk_fma_f32 v[100:101], v[116:117], v[50:51], v[108:109] op_sel_hi:[1,0,1] neg_lo:[0,0,1] neg_hi:[0,0,1]
    v_pk_fma_f32 v[102:103], v[118:119], v[50:51], v[110:111] op_sel_hi:[1,0,1] neg_lo:[0,0,1] neg_hi:[0,0,1]
    v_cvt_pk_bf16_f32 v120, v96, v97
    v_cvt_pk_bf16_f32 v121, v98, v99
    v_cvt_pk_bf16_f32 v122, v100, v101
    v_cvt_pk_bf16_f32 v123, v102, v103
    v_accvgpr_write_b32 a252, v120
    v_accvgpr_write_b32 a253, v121
    v_accvgpr_write_b32 a254, v122
    v_accvgpr_write_b32 a255, v123
    v_and_b32 v40, 15, v3
    v_xor_b32 v40, v40, v4
    v_lshlrev_b32 v40, 4, v40
    v_lshl_add_u32 v48, v3, 10, v40
    v_xor_b32 v49, 32, v48
    v_xor_b32 v50, 64, v48
    v_xor_b32 v51, 96, v48
    v_xor_b32 v52, 128, v48
    v_xor_b32 v53, 160, v48
    v_xor_b32 v54, 192, v48
    v_xor_b32 v55, 224, v48
    v_and_b32 v3, 7, v1
    v_lshlrev_b32 v3, 4, v3
    v_and_b32 v40, 48, v1
    v_lshl_or_b32 v3, v40, 3, v3
    v_and_b32 v40, 8, v1
    v_lshl_or_b32 v3, v40, 7, v3
    s_barrier
    ds_read_b128 v[96:99], v48 offset:0
    ds_read_b128 v[100:103], v48 offset:512
    ds_read_b128 v[104:107], v49 offset:0
    ds_read_b128 v[108:111], v49 offset:512
    ds_read_b128 v[112:115], v50 offset:0
    ds_read_b128 v[116:119], v50 offset:512
    ds_read_b128 v[120:123], v51 offset:0
    ds_read_b128 v[124:127], v51 offset:512
    s_waitcnt lgkmcnt(7)
    v_mfma_f32_32x32x16_bf16 v[192:207], v[96:99], a[192:195], 0
    v_readfirstlane_b32 s56, v16
    v_readfirstlane_b32 s57, v20
    v_lshlrev_b32 v64, 16, v16
    v_and_b32 v65, 0xffff0000, v16
    ds_read_b128 v[96:99], v52 offset:0
    s_waitcnt lgkmcnt(7)
    v_mfma_f32_32x32x16_bf16 v[208:223], v[100:103], a[192:195], 0
    v_lshlrev_b32 v66, 16, v17
    s_add_u32 m0, s5, 69632
    s_add_u32 s7, s4, 114688
    buffer_load_dwordx4 v47, s[40:43], s7 offen lds
    ds_read_b128 v[100:103], v52 offset:512
    s_waitcnt lgkmcnt(7)
    v_mfma_f32_32x32x16_bf16 v[192:207], v[104:107], a[196:199], v[192:207]
    v_and_b32 v67, 0xffff0000, v17
    v_lshlrev_b32 v68, 16, v18
    v_and_b32 v69, 0xffff0000, v18
    v_lshlrev_b32 v70, 16, v19
    ds_read_b128 v[104:107], v53 offset:0
    s_waitcnt lgkmcnt(7)
    v_mfma_f32_32x32x16_bf16 v[208:223], v[108:111], a[196:199], v[208:223]
    v_and_b32 v71, 0xffff0000, v19
    s_add_u32 m0, s5, 70656
    s_add_u32 s7, s4, 143360
    buffer_load_dwordx4 v47, s[40:43], s7 offen lds
    v_lshlrev_b32 v72, 16, v20
    ds_read_b128 v[108:111], v53 offset:512
    s_waitcnt lgkmcnt(7)
    v_mfma_f32_32x32x16_bf16 v[192:207], v[112:115], a[200:203], v[192:207]
    v_and_b32 v73, 0xffff0000, v20
    v_lshlrev_b32 v74, 16, v21
    v_and_b32 v75, 0xffff0000, v21
    v_lshlrev_b32 v76, 16, v22
    ds_read_b128 v[112:115], v54 offset:0
    s_waitcnt lgkmcnt(7)
    v_mfma_f32_32x32x16_bf16 v[208:223], v[116:119], a[200:203], v[208:223]
    s_add_u32 m0, s5, 71680
    s_add_u32 s7, s4, 172032
    buffer_load_dwordx4 v47, s[40:43], s7 offen lds
    v_and_b32 v77, 0xffff0000, v22
    ds_read_b128 v[116:119], v54 offset:512
    s_waitcnt lgkmcnt(7)
    v_mfma_f32_32x32x16_bf16 v[192:207], v[120:123], a[204:207], v[192:207]
    v_lshlrev_b32 v78, 16, v23
    v_and_b32 v79, 0xffff0000, v23
    s_lshl_b32 s56, s56, 16
    s_lshl_b32 s57, s57, 16
    ds_read_b128 v[120:123], v55 offset:0
    s_waitcnt lgkmcnt(7)
    v_mfma_f32_32x32x16_bf16 v[208:223], v[124:127], a[204:207], v[208:223]
    s_add_u32 m0, s5, 72704
    s_add_u32 s7, s4, 200704
    buffer_load_dwordx4 v47, s[40:43], s7 offen lds
    v_subrev_f32 v64, s56, v64
    v_subrev_f32 v72, s57, v72
    ds_read_b128 v[124:127], v55 offset:512
    s_waitcnt lgkmcnt(7)
    v_mfma_f32_32x32x16_bf16 v[192:207], v[96:99], a[208:211], v[192:207]
    v_subrev_f32 v65, s56, v65
    v_subrev_f32 v73, s57, v73
    v_subrev_f32 v66, s56, v66
    s_add_u32 m0, s5, 73728
    ds_read_b128 v[96:99], v48 offset:256
    s_waitcnt lgkmcnt(7)
    v_mfma_f32_32x32x16_bf16 v[208:223], v[100:103], a[208:211], v[208:223]
    s_add_u32 s7, s4, 229376
    buffer_load_dwordx4 v47, s[40:43], s7 offen lds
    v_subrev_f32 v74, s57, v74
    v_subrev_f32 v67, s56, v67
    ds_read_b128 v[100:103], v48 offset:768
    s_waitcnt lgkmcnt(7)
    v_mfma_f32_32x32x16_bf16 v[192:207], v[104:107], a[212:215], v[192:207]
    v_subrev_f32 v75, s57, v75
    v_subrev_f32 v68, s56, v68
    v_subrev_f32 v76, s57, v76
    s_add_u32 m0, s5, 74752
    ds_read_b128 v[104:107], v49 offset:256
    s_waitcnt lgkmcnt(7)
    v_mfma_f32_32x32x16_bf16 v[208:223], v[108:111], a[212:215], v[208:223]
    s_add_u32 s7, s4, 258048
    buffer_load_dwordx4 v47, s[40:43], s7 offen lds
    v_subrev_f32 v69, s56, v69
    v_subrev_f32 v77, s57, v77
    v_subrev_f32 v70, s56, v70
    ds_read_b128 v[108:111], v49 offset:768
    s_waitcnt lgkmcnt(7)
    v_mfma_f32_32x32x16_bf16 v[192:207], v[112:115], a[216:219], v[192:207]
    v_subrev_f32 v78, s57, v78
    v_subrev_f32 v71, s56, v71
    s_add_u32 m0, s5, 75776
    s_add_u32 s7, s4, 286720
    ds_read_b128 v[112:115], v50 offset:256
    s_waitcnt lgkmcnt(7)
    v_mfma_f32_32x32x16_bf16 v[208:223], v[116:119], a[216:219], v[208:223]
    buffer_load_dwordx4 v47, s[40:43], s7 offen lds
    v_subrev_f32 v79, s57, v79
    v_add_f32 v80, v64, v65
    v_mul_f32 v82, v64, v64
    ds_read_b128 v[116:119], v50 offset:768
    s_waitcnt lgkmcnt(7)
    v_mfma_f32_32x32x16_bf16 v[192:207], v[120:123], a[220:223], v[192:207]
    v_add_f32 v81, v72, v73
    v_mul_f32 v83, v72, v72
    s_add_u32 m0, s5, 76800
    s_add_u32 s7, s4, 315392
    ds_read_b128 v[120:123], v51 offset:256
    s_waitcnt lgkmcnt(7)
    v_mfma_f32_32x32x16_bf16 v[208:223], v[124:127], a[220:223], v[208:223]
    buffer_load_dwordx4 v47, s[40:43], s7 offen lds
    v_fmac_f32 v82, v65, v65
    v_fmac_f32 v83, v73, v73
    v_add_f32 v80, v80, v66
    v_fmac_f32 v82, v66, v66
    ds_read_b128 v[124:127], v51 offset:768
    s_waitcnt lgkmcnt(7)
    v_mfma_f32_32x32x16_bf16 v[192:207], v[96:99], a[224:227], v[192:207]
    v_add_f32 v81, v81, v74
    s_add_u32 m0, s5, 77824
    s_add_u32 s7, s4, 344064
    buffer_load_dwordx4 v47, s[40:43], s7 offen lds
    ds_read_b128 v[96:99], v52 offset:256
    s_waitcnt lgkmcnt(7)
    v_mfma_f32_32x32x16_bf16 v[208:223], v[100:103], a[224:227], v[208:223]
    v_fmac_f32 v83, v74, v74
    v_add_f32 v80, v80, v67
    v_fmac_f32 v82, v67, v67
    v_add_f32 v81, v81, v75
    ds_read_b128 v[100:103], v52 offset:768
    s_waitcnt lgkmcnt(7)
    v_mfma_f32_32x32x16_bf16 v[192:207], v[104:107], a[228:231], v[192:207]
    v_fmac_f32 v83, v75, v75
    s_add_u32 m0, s5, 78848
    s_add_u32 s7, s4, 372736
    buffer_load_dwordx4 v47, s[40:43], s7 offen lds
    ds_read_b128 v[104:107], v53 offset:256
    s_waitcnt lgkmcnt(7)
    v_mfma_f32_32x32x16_bf16 v[208:223], v[108:111], a[228:231], v[208:223]
    v_add_f32 v80, v80, v68
    v_fmac_f32 v82, v68, v68
    v_add_f32 v81, v81, v76
    v_fmac_f32 v83, v76, v76
    v_add_f32 v80, v80, v69
    ds_read_b128 v[108:111], v53 offset:768
    s_waitcnt lgkmcnt(7)
    v_mfma_f32_32x32x16_bf16 v[192:207], v[112:115], a[232:235], v[192:207]
    s_add_u32 m0, s5, 79872
    s_add_u32 s7, s4, 401408
    buffer_load_dwordx4 v47, s[40:43], s7 offen lds
    v_fmac_f32 v82, v69, v69
    ds_read_b128 v[112:115], v54 offset:256
    s_waitcnt lgkmcnt(7)
    v_mfma_f32_32x32x16_bf16 v[208:223], v[116:119], a[232:235], v[208:223]
    v_add_f32 v81, v81, v77
    v_fmac_f32 v83, v77, v77
    v_add_f32 v80, v80, v70
    v_fmac_f32 v82, v70, v70
    ds_read_b128 v[116:119], v54 offset:768
    s_waitcnt lgkmcnt(7)
    v_mfma_f32_32x32x16_bf16 v[192:207], v[120:123], a[236:239], v[192:207]
    s_add_u32 m0, s5, 80896
    s_add_u32 s7, s4, 430080
    buffer_load_dwordx4 v47, s[40:43], s7 offen lds
    v_add_f32 v81, v81, v78
    ds_read_b128 v[120:123], v55 offset:256
    s_waitcnt lgkmcnt(7)
    v_mfma_f32_32x32x16_bf16 v[208:223], v[124:127], a[236:239], v[208:223]
    v_fmac_f32 v83, v78, v78
    v_add_f32 v80, v80, v71
    v_fmac_f32 v82, v71, v71
    v_add_f32 v81, v81, v79
    v_fmac_f32 v83, v79, v79
    ds_read_b128 v[124:127], v55 offset:768
    s_waitcnt lgkmcnt(7)
    v_mfma_f32_32x32x16_bf16 v[192:207], v[96:99], a[240:243], v[192:207]
    v_permlane32_swap_b32 v80, v82
    v_permlane32_swap_b32 v81, v83
    v_add_f32 v80, v80, v82
    v_add_f32 v81, v81, v83
    s_waitcnt lgkmcnt(6)
    v_mfma_f32_32x32x16_bf16 v[208:223], v[100:103], a[240:243], v[208:223]
    s_lshl_b32 s60, s53, 17
    s_lshl_b32 s57, s63, 6
    v_permlane16_swap_b32 v80, v81
    v_add_f32 v80, v80, v81
    s_waitcnt lgkmcnt(5)
    v_mfma_f32_32x32x16_bf16 v[192:207], v[104:107], a[244:247], v[192:207]
    s_add_u32 s60, s60, s57
    s_add_u32 s61, s60, 65536
    v_add_f32_dpp v80, v80, v80 row_ror:8 row_mask:0xf bank_mask:0xf
    v_and_b32 v40, 15, v5
    s_waitcnt lgkmcnt(4)
    v_mfma_f32_32x32x16_bf16 v[208:223], v[108:111], a[244:247], v[208:223]
    v_lshlrev_b32 v40, 12, v40
    v_add_f32_dpp v80, v80, v80 row_ror:4 row_mask:0xf bank_mask:0xf
    v_lshl_add_u32 v40, v4, 4, v40
    v_and_b32 v41, 16, v1
    v_add_f32_dpp v80, v80, v80 row_ror:2 row_mask:0xf bank_mask:0xf
    s_waitcnt lgkmcnt(3)
    v_mfma_f32_32x32x16_bf16 v[192:207], v[112:115], a[248:251], v[192:207]
    v_lshl_add_u32 v14, v41, 1, v40
    v_lshrrev_b32 v83, 2, v1
    v_add_f32_dpp v80, v80, v80 row_ror:1 row_mask:0xf bank_mask:0xf
    v_mov_b32 v81, v80
    s_waitcnt lgkmcnt(2)
    v_mfma_f32_32x32x16_bf16 v[208:223], v[116:119], a[248:251], v[208:223]
    s_lshl_b32 s56, s3, 3
    s_add_u32 s56, s56, 131072
    v_permlane32_swap_b32 v80, v81
    v_mul_f32 v82, 0xbb000000, v80
    s_waitcnt lgkmcnt(1)
    v_mfma_f32_32x32x16_bf16 v[192:207], v[120:123], a[252:255], v[192:207]
    v_fmac_f32 v81, v82, v80
    v_max_f32 v81, 0, v81
    v_add_u32 v82, s56, v83
    s_mov_b64 exec, 0x10001
    ds_write_b32 v82, v81
    s_mov_b64 exec, -1
    s_waitcnt lgkmcnt(1)
    v_mfma_f32_32x32x16_bf16 v[208:223], v[124:127], a[252:255], v[208:223]
    v_and_b32 v83, 7, v1
    v_lshlrev_b32 v83, 2, v83
    v_add_u32 v83, 131072, v83
    v_lshlrev_b32 v84, 2, v1
    s_lshl_b32 s64, s2, 6
    s_add_u32 s64, s64, 0x2010000
    s_cmp_lg_u32 s3, 0
    s_cselect_b32 s64, 0x4000000, s64
    s_nop 3
    v_pk_fma_f32 v[192:193], v[208:209], v[46:47], v[192:193] op_sel_hi:[1,0,1]
    v_pk_fma_f32 v[194:195], v[210:211], v[46:47], v[194:195] op_sel_hi:[1,0,1]
    v_pk_fma_f32 v[196:197], v[212:213], v[46:47], v[196:197] op_sel_hi:[1,0,1]
    v_pk_fma_f32 v[198:199], v[214:215], v[46:47], v[198:199] op_sel_hi:[1,0,1]
    v_pk_fma_f32 v[200:201], v[216:217], v[46:47], v[200:201] op_sel_hi:[1,0,1]
    v_pk_fma_f32 v[202:203], v[218:219], v[46:47], v[202:203] op_sel_hi:[1,0,1]
    v_pk_fma_f32 v[204:205], v[220:221], v[46:47], v[204:205] op_sel_hi:[1,0,1]
    v_pk_fma_f32 v[206:207], v[222:223], v[46:47], v[206:207] op_sel_hi:[1,0,1]
    v_cvt_pk_bf16_f32 v56, v192, v193
    v_cvt_pk_bf16_f32 v57, v194, v195
    v_cvt_pk_bf16_f32 v58, v196, v197
    v_cvt_pk_bf16_f32 v59, v198, v199
    v_cvt_pk_bf16_f32 v60, v200, v201
    v_cvt_pk_bf16_f32 v61, v202, v203
    v_cvt_pk_bf16_f32 v62, v204, v205
    v_cvt_pk_bf16_f32 v63, v206, v207
    v_permlane16_swap_b32 v56, v60
    v_permlane16_swap_b32 v57, v61
    v_permlane16_swap_b32 v58, v62
    v_permlane16_swap_b32 v59, v63
    buffer_store_dwordx4 v[56:59], v14, s[24:27], s60 offen sc1
    buffer_store_dwordx4 v[60:63], v14, s[24:27], s61 offen sc1
    s_waitcnt vmcnt(2)
    s_waitcnt lgkmcnt(0)
    s_barrier
    ds_read_b32 v81, v83
    v_lshl_or_b32 v24, v28, 16, v24
    v_lshl_or_b32 v32, v36, 16, v32
    v_lshl_or_b32 v25, v29, 16, v25
    v_lshl_or_b32 v33, v37, 16, v33
    v_lshl_or_b32 v26, v30, 16, v26
    v_lshl_or_b32 v34, v38, 16, v34
    v_lshl_or_b32 v27, v31, 16, v27
    v_lshl_or_b32 v35, v39, 16, v35
    buffer_store_dwordx4 v[24:27], v45, s[24:27], s62 offen sc1
    buffer_store_dwordx4 v[32:35], v45, s[24:27], s62 offen offset:64 sc1
    s_waitcnt lgkmcnt(0)
    s_mov_b64 exec, 0xffff
    buffer_store_dword v81, v84, s[24:27], s64 offen sc1
    s_mov_b64 exec, -1
    buffer_load_dword v44, v6, s[48:51], 0 offen sc1
    s_cmp_lt_u32 s52, 56
    s_cbranch_scc1 Lmn1
    s_waitcnt vmcnt(0)
    v_cmp_gt_u32 vcc, 1, v44
    s_cbranch_vccnz Lzc4
Lzd5:
    s_barrier
    s_lshl_b32 s56, s2, 7
    s_add_u32 s56, s56, 0x2190000
    s_cmp_lg_u32 s3, 0
    s_cselect_b32 s56, 0x4000000, s56
    v_mov_b32 v7, 1
    s_mov_b64 exec, 0xffff
    buffer_store_dword v7, v84, s[24:27], s56 offen sc1
    s_mov_b64 exec, -1
    v_lshlrev_b32 v6, 7, v0
    s_mov_b32 s12, 0x2190000
    s_branch Lalt2
Lmn1:
    v_lshrrev_b32 v42, 2, v1
    v_and_b32 v42, 3, v42
    v_lshl_add_u32 v43, v4, 3, v42
    v_lshlrev_b32 v43, 7, v43
    v_and_b32 v41, 16, v1
    v_lshl_or_b32 v43, v41, 1, v43
    v_and_b32 v41, 1, v1
    v_lshl_or_b32 v43, v41, 4, v43
    v_and_b32 v41, 2, v1
    v_lshl_or_b32 v43, v41, 2, v43
    v_lshrrev_b32 v41, 1, v42
    v_lshl_or_b32 v43, v41, 6, v43
    v_add_u32 v40, 65536, v43
    v_xor_b32 v41, 64, v40
    ds_read_b64_tr_b16 v[96:97], v40 offset:0
    ds_read_b64_tr_b16 v[98:99], v40 offset:512
    ds_read_b64_tr_b16 v[100:101], v40 offset:32768
    ds_read_b64_tr_b16 v[102:103], v40 offset:33280
    ds_read_b64_tr_b16 v[104:105], v40 offset:2048
    ds_read_b64_tr_b16 v[106:107], v40 offset:2560
    ds_read_b64_tr_b16 v[108:109], v40 offset:34816
    ds_read_b64_tr_b16 v[110:111], v40 offset:35328
    ds_read_b64_tr_b16 v[112:113], v40 offset:4096
    ds_read_b64_tr_b16 v[114:115], v40 offset:4608
    ds_read_b64_tr_b16 v[116:117], v40 offset:36864
    ds_read_b64_tr_b16 v[118:119], v40 offset:37376
    ds_read_b64_tr_b16 v[120:121], v40 offset:6144
    ds_read_b64_tr_b16 v[122:123], v40 offset:6656
    s_waitcnt lgkmcnt(10)
    v_mfma_f32_32x32x16_bf16 v[192:207], a[192:195], v[96:99], 0
    s_lshr_b32 s8, s53, 1
    s_mul_i32 s8, s8, 229376
    s_lshl_b32 s57, s52, 12
    s_add_u32 s8, s8, s57
    s_lshl_b32 s57, s67, 10
    s_add_u32 s8, s8, s57
    s_add_u32 s9, s8, 0x1200000
    s_add_u32 s8, s8, 0x1000000
    s_lshl_b32 s10, s55, 17
    s_lshl_b32 s57, s53, 12
    s_add_u32 s10, s10, s57
    s_lshl_b32 s57, s66, 11
    s_add_u32 s10, s10, s57
    s_add_u32 s10, s10, 0xc00000
    s_add_u32 s11, s10, 65536
    s_and_b32 s12, s2, 7
    s_lshl_b32 s12, s12, 8
    s_add_u32 s12, s12, 0x210c000
    ds_read_b64_tr_b16 v[124:125], v40 offset:38912
    ds_read_b64_tr_b16 v[126:127], v40 offset:39424
    v_mfma_f32_32x32x16_bf16 v[208:223], a[192:195], v[100:103], 0
    s_mul_i32 s13, s52, 37
    s_lshr_b32 s13, s13, 9
    s_and_b32 s57, s53, 12
    s_add_u32 s13, s13, s57
    s_lshl_b32 s13, s13, 8
    s_add_u32 s13, s13, 0x213c000
    s_cmp_lg_u32 s3, 0
    s_cselect_b32 s13, 0x4000000, s13
    s_mov_b32 s14, s53
    s_lshl_b32 s57, s67, 7
    v_xor_b32 v47, s57, v2
    ds_read_b64_tr_b16 v[96:97], v40 offset:8192
    ds_read_b64_tr_b16 v[98:99], v40 offset:8704
    s_waitcnt lgkmcnt(10)
    v_mfma_f32_32x32x16_bf16 v[192:207], a[196:199], v[104:107], v[192:207]
    ds_read_b64_tr_b16 v[100:101], v40 offset:40960
    ds_read_b64_tr_b16 v[102:103], v40 offset:41472
    v_mfma_f32_32x32x16_bf16 v[208:223], a[196:199], v[108:111], v[208:223]
    ds_read_b64_tr_b16 v[104:105], v40 offset:10240
    ds_read_b64_tr_b16 v[106:107], v40 offset:10752
    s_waitcnt lgkmcnt(10)
    v_mfma_f32_32x32x16_bf16 v[192:207], a[200:203], v[112:115], v[192:207]
    ds_read_b64_tr_b16 v[108:109], v40 offset:43008
    ds_read_b64_tr_b16 v[110:111], v40 offset:43520
    v_mfma_f32_32x32x16_bf16 v[208:223], a[200:203], v[116:119], v[208:223]
    ds_read_b64_tr_b16 v[112:113], v40 offset:12288
    ds_read_b64_tr_b16 v[114:115], v40 offset:12800
    s_waitcnt lgkmcnt(10)
    v_mfma_f32_32x32x16_bf16 v[192:207], a[204:207], v[120:123], v[192:207]
    ds_read_b64_tr_b16 v[116:117], v40 offset:45056
    ds_read_b64_tr_b16 v[118:119], v40 offset:45568
    v_mfma_f32_32x32x16_bf16 v[208:223], a[204:207], v[124:127], v[208:223]
    ds_read_b64_tr_b16 v[120:121], v40 offset:14336
    ds_read_b64_tr_b16 v[122:123], v40 offset:14848
    s_waitcnt lgkmcnt(10)
    v_mfma_f32_32x32x16_bf16 v[192:207], a[208:211], v[96:99], v[192:207]
    ds_read_b64_tr_b16 v[124:125], v40 offset:47104
    ds_read_b64_tr_b16 v[126:127], v40 offset:47616
    v_mfma_f32_32x32x16_bf16 v[208:223], a[208:211], v[100:103], v[208:223]
    ds_read_b64_tr_b16 v[96:97], v40 offset:16384
    ds_read_b64_tr_b16 v[98:99], v40 offset:16896
    s_waitcnt lgkmcnt(10)
    v_mfma_f32_32x32x16_bf16 v[192:207], a[212:215], v[104:107], v[192:207]
    ds_read_b64_tr_b16 v[100:101], v40 offset:49152
    ds_read_b64_tr_b16 v[102:103], v40 offset:49664
    v_mfma_f32_32x32x16_bf16 v[208:223], a[212:215], v[108:111], v[208:223]
    ds_read_b64_tr_b16 v[104:105], v40 offset:18432
    ds_read_b64_tr_b16 v[106:107], v40 offset:18944
    s_waitcnt lgkmcnt(10)
    v_mfma_f32_32x32x16_bf16 v[192:207], a[216:219], v[112:115], v[192:207]
    s_waitcnt vmcnt(0)
    v_cmp_gt_u32 vcc, 1, v44
    s_cbranch_vccnz Lzc6
Lzd7:
    s_barrier
    s_lshl_b32 s56, s2, 7
    s_add_u32 s56, s56, 0x2190000
    s_cmp_lg_u32 s3, 0
    s_cselect_b32 s56, 0x4000000, s56
    v_mov_b32 v7, 1
    s_mov_b64 exec, 0xffff
    buffer_store_dword v7, v84, s[24:27], s56 offen sc1
    s_mov_b64 exec, -1
    v_lshlrev_b32 v6, 7, v0
    s_mov_b32 s12, 0x2190000
    ds_read_b64_tr_b16 v[108:109], v40 offset:51200
    ds_read_b64_tr_b16 v[110:111], v40 offset:51712
    v_mfma_f32_32x32x16_bf16 v[208:223], a[216:219], v[116:119], v[208:223]
    s_lshl_b32 s15, s3, 13
    buffer_load_dwordx4 v[128:131], v2, s[20:23], s15 offen offset:0
    ds_read_b64_tr_b16 v[112:113], v40 offset:20480
    ds_read_b64_tr_b16 v[114:115], v40 offset:20992
    s_waitcnt lgkmcnt(10)
    v_mfma_f32_32x32x16_bf16 v[192:207], a[220:223], v[120:123], v[192:207]
    buffer_load_dwordx4 v[132:135], v2, s[20:23], s15 offen offset:1024
    buffer_load_dwordx4 v[136:139], v2, s[20:23], s15 offen offset:2048
    ds_read_b64_tr_b16 v[116:117], v40 offset:53248
    ds_read_b64_tr_b16 v[118:119], v40 offset:53760
    v_mfma_f32_32x32x16_bf16 v[208:223], a[220:223], v[124:127], v[208:223]
    buffer_load_dwordx4 v[140:143], v2, s[20:23], s15 offen offset:3072
    s_add_u32 s15, s15, 4096
    ds_read_b64_tr_b16 v[120:121], v40 offset:22528
    ds_read_b64_tr_b16 v[122:123], v40 offset:23040
    s_waitcnt lgkmcnt(10)
    v_mfma_f32_32x32x16_bf16 v[192:207], a[224:227], v[96:99], v[192:207]
    buffer_load_dwordx4 v[176:179], v2, s[20:23], s15 offen offset:0
    buffer_load_dwordx4 v[180:183], v2, s[20:23], s15 offen offset:1024
    ds_read_b64_tr_b16 v[124:125], v40 offset:55296
    ds_read_b64_tr_b16 v[126:127], v40 offset:55808
    v_mfma_f32_32x32x16_bf16 v[208:223], a[224:227], v[100:103], v[208:223]
    buffer_load_dwordx4 v[184:187], v2, s[20:23], s15 offen offset:2048
    buffer_load_dwordx4 v[188:191], v2, s[20:23], s15 offen offset:3072
    ds_read_b64_tr_b16 v[96:97], v40 offset:24576
    ds_read_b64_tr_b16 v[98:99], v40 offset:25088
    s_waitcnt lgkmcnt(10)
    v_mfma_f32_32x32x16_bf16 v[192:207], a[228:231], v[104:107], v[192:207]
    s_mov_b32 s15, 32768
    buffer_load_dwordx4 v[152:155], v2, s[20:23], s15 offen offset:0
    ds_read_b64_tr_b16 v[100:101], v40 offset:57344
    ds_read_b64_tr_b16 v[102:103], v40 offset:57856
    v_mfma_f32_32x32x16_bf16 v[208:223], a[228:231], v[108:111], v[208:223]
    buffer_load_dwordx4 v[156:159], v2, s[20:23], s15 offen offset:1024
    buffer_load_dwordx4 v[160:163], v2, s[20:23], s15 offen offset:2048
    ds_read_b64_tr_b16 v[104:105], v40 offset:26624
    ds_read_b64_tr_b16 v[106:107], v40 offset:27136
    s_waitcnt lgkmcnt(10)
    v_mfma_f32_32x32x16_bf16 v[192:207], a[232:235], v[112:115], v[192:207]
    buffer_load_dwordx4 v[164:167], v2, s[20:23], s15 offen offset:3072
    v_and_b32 v8, 15, v1
    ds_read_b64_tr_b16 v[108:109], v40 offset:59392
    ds_read_b64_tr_b16 v[110:111], v40 offset:59904
    v_mfma_f32_32x32x16_bf16 v[208:223], a[232:235], v[116:119], v[208:223]
    v_lshrrev_b32 v9, 4, v1
    s_lshr_b32 s56, s3, 1
    s_lshl_b32 s56, s56, 10
    s_and_b32 s57, s3, 1
    s_lshl_b32 s57, s57, 3
    s_add_u32 s56, s56, s57
    s_add_u32 s56, s56, 131072
    v_add_u32 v10, s56, v2
    ds_read_b64_tr_b16 v[112:113], v40 offset:28672
    ds_read_b64_tr_b16 v[114:115], v40 offset:29184
    s_waitcnt lgkmcnt(10)
    v_mfma_f32_32x32x16_bf16 v[192:207], a[236:239], v[120:123], v[192:207]
    v_lshlrev_b32 v11, 5, v8
    v_lshl_add_u32 v11, v9, 3, v11
    ds_read_b64_tr_b16 v[116:117], v40 offset:61440
    ds_read_b64_tr_b16 v[118:119], v40 offset:61952
    v_mfma_f32_32x32x16_bf16 v[208:223], a[236:239], v[124:127], v[208:223]
    s_lshl_b32 s56, s3, 11
    s_add_u32 s56, s56, 139264
    v_add_u32 v11, s56, v11
    v_lshlrev_b32 v12, 3, v1
    ds_read_b64_tr_b16 v[120:121], v40 offset:30720
    ds_read_b64_tr_b16 v[122:123], v40 offset:31232
    s_waitcnt lgkmcnt(10)
    v_mfma_f32_32x32x16_bf16 v[192:207], a[240:243], v[96:99], v[192:207]
    v_add_u32 v12, 139264, v12
    v_add_u32 v13, 131072, v2
    ds_read_b64_tr_b16 v[124:125], v40 offset:63488
    ds_read_b64_tr_b16 v[126:127], v40 offset:64000
    v_mfma_f32_32x32x16_bf16 v[208:223], a[240:243], v[100:103], v[208:223]
    v_lshlrev_b32 v15, 5, v1
    s_lshl_b32 s58, s2, 13
    s_lshl_b32 s59, s3, 10
    s_add_u32 s58, s58, s59
    s_lshl_b32 s59, s3, 11
    ds_read_b64_tr_b16 v[96:97], v41 offset:0
    ds_read_b64_tr_b16 v[98:99], v41 offset:512
    s_waitcnt lgkmcnt(10)
    v_mfma_f32_32x32x16_bf16 v[192:207], a[244:247], v[104:107], v[192:207]
    ds_read_b64_tr_b16 v[100:101], v41 offset:32768
    ds_read_b64_tr_b16 v[102:103], v41 offset:33280
    v_mfma_f32_32x32x16_bf16 v[208:223], a[244:247], v[108:111], v[208:223]
    ds_read_b64_tr_b16 v[104:105], v41 offset:2048
    ds_read_b64_tr_b16 v[106:107], v41 offset:2560
    s_waitcnt lgkmcnt(10)
    v_mfma_f32_32x32x16_bf16 v[192:207], a[248:251], v[112:115], v[192:207]
    ds_read_b64_tr_b16 v[108:109], v41 offset:34816
    ds_read_b64_tr_b16 v[110:111], v41 offset:35328
    v_mfma_f32_32x32x16_bf16 v[208:223], a[248:251], v[116:119], v[208:223]
    ds_read_b64_tr_b16 v[112:113], v41 offset:4096
    ds_read_b64_tr_b16 v[114:115], v41 offset:4608
    s_waitcnt lgkmcnt(10)
    v_mfma_f32_32x32x16_bf16 v[192:207], a[252:255], v[120:123], v[192:207]
    ds_read_b64_tr_b16 v[116:117], v41 offset:36864
    ds_read_b64_tr_b16 v[118:119], v41 offset:37376
    v_mfma_f32_32x32x16_bf16 v[208:223], a[252:255], v[124:127], v[208:223]
    ds_read_b64_tr_b16 v[120:121], v41 offset:6144
    ds_read_b64_tr_b16 v[122:123], v41 offset:6656
    s_waitcnt lgkmcnt(10)
    v_mfma_f32_32x32x16_bf16 v[224:239], a[192:195], v[96:99], 0
    ds_read_b64_tr_b16 v[124:125], v41 offset:38912
    ds_read_b64_tr_b16 v[126:127], v41 offset:39424
    v_mfma_f32_32x32x16_bf16 v[240:255], a[192:195], v[100:103], 0
    ds_read_b64_tr_b16 v[96:97], v41 offset:8192
    ds_read_b64_tr_b16 v[98:99], v41 offset:8704
    s_waitcnt lgkmcnt(10)
    v_mfma_f32_32x32x16_bf16 v[224:239], a[196:199], v[104:107], v[224:239]
    ds_read_b64_tr_b16 v[100:101], v41 offset:40960
    ds_read_b64_tr_b16 v[102:103], v41 offset:41472
    v_mfma_f32_32x32x16_bf16 v[240:255], a[196:199], v[108:111], v[240:255]
    ds_read_b64_tr_b16 v[104:105], v41 offset:10240
    ds_read_b64_tr_b16 v[106:107], v41 offset:10752
    s_waitcnt lgkmcnt(10)
    v_mfma_f32_32x32x16_bf16 v[224:239], a[200:203], v[112:115], v[224:239]
    v_add_f32 v192, v192, v208
    v_add_f32 v193, v193, v209
    ds_read_b64_tr_b16 v[108:109], v41 offset:43008
    ds_read_b64_tr_b16 v[110:111], v41 offset:43520
    v_mfma_f32_32x32x16_bf16 v[240:255], a[200:203], v[116:119], v[240:255]
    v_cvt_pk_bf16_f32 v24, v192, v193
    v_sub_f32 v194, v194, v210
    ds_read_b64_tr_b16 v[112:113], v41 offset:12288
    ds_read_b64_tr_b16 v[114:115], v41 offset:12800
    s_waitcnt lgkmcnt(10)
    v_mfma_f32_32x32x16_bf16 v[224:239], a[204:207], v[120:123], v[224:239]
    v_sub_f32 v195, v195, v211
    v_cvt_pk_bf16_f32 v25, v194, v195
    ds_read_b64_tr_b16 v[116:117], v41 offset:45056
    ds_read_b64_tr_b16 v[118:119], v41 offset:45568
    v_mfma_f32_32x32x16_bf16 v[240:255], a[204:207], v[124:127], v[240:255]
    v_add_f32 v196, v196, v212
    v_add_f32 v197, v197, v213
    ds_read_b64_tr_b16 v[120:121], v41 offset:14336
    ds_read_b64_tr_b16 v[122:123], v41 offset:14848
    s_waitcnt lgkmcnt(10)
    v_mfma_f32_32x32x16_bf16 v[224:239], a[208:211], v[96:99], v[224:239]
    v_cvt_pk_bf16_f32 v26, v196, v197
    v_sub_f32 v198, v198, v214
    ds_read_b64_tr_b16 v[124:125], v41 offset:47104
    ds_read_b64_tr_b16 v[126:127], v41 offset:47616
    v_mfma_f32_32x32x16_bf16 v[240:255], a[208:211], v[100:103], v[240:255]
    v_sub_f32 v199, v199, v215
    v_cvt_pk_bf16_f32 v27, v198, v199
    ds_read_b64_tr_b16 v[96:97], v41 offset:16384
    ds_read_b64_tr_b16 v[98:99], v41 offset:16896
    s_waitcnt lgkmcnt(10)
    v_mfma_f32_32x32x16_bf16 v[224:239], a[212:215], v[104:107], v[224:239]
    v_add_f32 v200, v200, v216
    v_add_f32 v201, v201, v217
    ds_read_b64_tr_b16 v[100:101], v41 offset:49152
    ds_read_b64_tr_b16 v[102:103], v41 offset:49664
    v_mfma_f32_32x32x16_bf16 v[240:255], a[212:215], v[108:111], v[240:255]
    v_cvt_pk_bf16_f32 v28, v200, v201
    v_sub_f32 v202, v202, v218
    ds_read_b64_tr_b16 v[104:105], v41 offset:18432
    ds_read_b64_tr_b16 v[106:107], v41 offset:18944
    s_waitcnt lgkmcnt(10)
    v_mfma_f32_32x32x16_bf16 v[224:239], a[216:219], v[112:115], v[224:239]
    buffer_load_dword v7, v6, s[24:27], s12 offen sc1
    v_sub_f32 v203, v203, v219
    v_cvt_pk_bf16_f32 v29, v202, v203
    ds_read_b64_tr_b16 v[108:109], v41 offset:51200
    ds_read_b64_tr_b16 v[110:111], v41 offset:51712
    v_mfma_f32_32x32x16_bf16 v[240:255], a[216:219], v[116:119], v[240:255]
    v_add_f32 v204, v204, v220
    v_add_f32 v205, v205, v221
    ds_read_b64_tr_b16 v[112:113], v41 offset:20480
    ds_read_b64_tr_b16 v[114:115], v41 offset:20992
    s_waitcnt lgkmcnt(10)
    v_mfma_f32_32x32x16_bf16 v[224:239], a[220:223], v[120:123], v[224:239]
    v_cvt_pk_bf16_f32 v30, v204, v205
    v_sub_f32 v206, v206, v222
    ds_read_b64_tr_b16 v[116:117], v41 offset:53248
    ds_read_b64_tr_b16 v[118:119], v41 offset:53760
    v_mfma_f32_32x32x16_bf16 v[240:255], a[220:223], v[124:127], v[240:255]
    v_sub_f32 v207, v207, v223
    v_cvt_pk_bf16_f32 v31, v206, v207
    ds_read_b64_tr_b16 v[120:121], v41 offset:22528
    ds_read_b64_tr_b16 v[122:123], v41 offset:23040
    s_waitcnt lgkmcnt(10)
    v_mfma_f32_32x32x16_bf16 v[224:239], a[224:227], v[96:99], v[224:239]
    buffer_store_dwordx4 v[24:27], v3, s[24:27], s10 offen sc1
    buffer_store_dwordx4 v[28:31], v3, s[24:27], s10 offen offset:512 sc1
    ds_read_b64_tr_b16 v[124:125], v41 offset:55296
    ds_read_b64_tr_b16 v[126:127], v41 offset:55808
    v_mfma_f32_32x32x16_bf16 v[240:255], a[224:227], v[100:103], v[240:255]
    ds_read_b64_tr_b16 v[96:97], v41 offset:24576
    ds_read_b64_tr_b16 v[98:99], v41 offset:25088
    s_waitcnt lgkmcnt(10)
    v_mfma_f32_32x32x16_bf16 v[224:239], a[228:231], v[104:107], v[224:239]
    ds_read_b64_tr_b16 v[100:101], v41 offset:57344
    ds_read_b64_tr_b16 v[102:103], v41 offset:57856
    v_mfma_f32_32x32x16_bf16 v[240:255], a[228:231], v[108:111], v[240:255]
    ds_read_b64_tr_b16 v[104:105], v41 offset:26624
    ds_read_b64_tr_b16 v[106:107], v41 offset:27136
    s_waitcnt lgkmcnt(10)
    v_mfma_f32_32x32x16_bf16 v[224:239], a[232:235], v[112:115], v[224:239]
    ds_read_b64_tr_b16 v[108:109], v41 offset:59392
    ds_read_b64_tr_b16 v[110:111], v41 offset:59904
    v_mfma_f32_32x32x16_bf16 v[240:255], a[232:235], v[116:119], v[240:255]
    ds_read_b64_tr_b16 v[112:113], v41 offset:28672
    ds_read_b64_tr_b16 v[114:115], v41 offset:29184
    s_waitcnt lgkmcnt(10)
    v_mfma_f32_32x32x16_bf16 v[224:239], a[236:239], v[120:123], v[224:239]
    ds_read_b64_tr_b16 v[116:117], v41 offset:61440
    ds_read_b64_tr_b16 v[118:119], v41 offset:61952
    v_mfma_f32_32x32x16_bf16 v[240:255], a[236:239], v[124:127], v[240:255]
    ds_read_b64_tr_b16 v[120:121], v41 offset:30720
    ds_read_b64_tr_b16 v[122:123], v41 offset:31232
    s_waitcnt lgkmcnt(10)
    v_mfma_f32_32x32x16_bf16 v[224:239], a[240:243], v[96:99], v[224:239]
    s_waitcnt vmcnt(2)
    v_cmp_eq_u32 vcc, 0, v7
    s_cbranch_vccz Lfo8
    v_lshlrev_b32 v6, 7, v0
    s_mov_b32 s56, 0x2190000
    s_mov_b32 m0, 0
Lfp9:
    buffer_load_dword v7, v6, s[24:27], s56 offen sc1
    s_waitcnt vmcnt(0)
    v_cmp_eq_u32 vcc, 0, v7
    s_cbranch_vccz Lfx10
    s_nop 0
    s_mov_b64 exec, vcc
    s_sleep 1
    s_add_u32 m0, m0, 1
    s_cmp_lt_u32 m0, 400000
    s_cbranch_scc1 Lfp9
Lfx10:
    s_mov_b64 exec, -1
Lfo8:
    s_barrier
    s_lshl_b32 s56, s59, 1
    s_add_u32 s56, s56, 0x2010000
    v_lshlrev_b32 v15, 6, v1
    buffer_load_dwordx4 v[88:91], v15, s[24:27], s56 offen sc1
    buffer_load_dwordx4 v[92:95], v15, s[24:27], s56 offen offset:16 sc1
    s_mul_i32 s61, s2, 8448
    s_lshl_b32 s60, s3, 11
    s_add_u32 s61, s61, s60
    s_add_u32 s61, s61, 0x2400000
    s_lshr_b32 s60, s60, 1
    s_lshl_b32 s57, s2, 13
    s_add_u32 s60, s60, s57
    buffer_load_dwordx4 v[64:67], v2, s[24:27], s60 offen sc1
    s_add_u32 s60, s60, 4096
    s_cmp_eq_u32 s2, 0
    s_cselect_b32 s60, 0x4000000, s60
    buffer_load_dwordx4 v[68:71], v2, s[24:27], s60 offen sc1
    buffer_load_dwordx4 v[72:75], v2, s[24:27], s61 offen sc1
    buffer_load_dwordx4 v[76:79], v2, s[24:27], s61 offen offset:1024 sc1
    ds_read_b64_tr_b16 v[124:125], v41 offset:63488
    ds_read_b64_tr_b16 v[126:127], v41 offset:64000
    v_mfma_f32_32x32x16_bf16 v[240:255], a[240:243], v[100:103], v[240:255]
    s_waitcnt lgkmcnt(8)
    v_mfma_f32_32x32x16_bf16 v[224:239], a[244:247], v[104:107], v[224:239]
    v_mfma_f32_32x32x16_bf16 v[240:255], a[244:247], v[108:111], v[240:255]
    s_waitcnt lgkmcnt(4)
    v_mfma_f32_32x32x16_bf16 v[224:239], a[248:251], v[112:115], v[224:239]
    v_mfma_f32_32x32x16_bf16 v[240:255], a[248:251], v[116:119], v[240:255]
    s_waitcnt lgkmcnt(0)
    v_mfma_f32_32x32x16_bf16 v[224:239], a[252:255], v[120:123], v[224:239]
    v_mfma_f32_32x32x16_bf16 v[240:255], a[252:255], v[124:127], v[240:255]
    s_nop 11
    v_add_f32 v224, v224, v240
    v_add_f32 v225, v225, v241
    v_cvt_pk_bf16_f32 v32, v224, v225
    v_sub_f32 v226, v226, v242
    v_sub_f32 v227, v227, v243
    v_cvt_pk_bf16_f32 v33, v226, v227
    v_add_f32 v228, v228, v244
    v_add_f32 v229, v229, v245
    v_cvt_pk_bf16_f32 v34, v228, v229
    v_sub_f32 v230, v230, v246
    v_sub_f32 v231, v231, v247
    v_cvt_pk_bf16_f32 v35, v230, v231
    v_add_f32 v232, v232, v248
    v_add_f32 v233, v233, v249
    v_cvt_pk_bf16_f32 v36, v232, v233
    v_sub_f32 v234, v234, v250
    v_sub_f32 v235, v235, v251
    v_cvt_pk_bf16_f32 v37, v234, v235
    v_add_f32 v236, v236, v252
    v_add_f32 v237, v237, v253
    v_cvt_pk_bf16_f32 v38, v236, v237
    v_sub_f32 v238, v238, v254
    v_sub_f32 v239, v239, v255
    v_cvt_pk_bf16_f32 v39, v238, v239
    buffer_store_dwordx4 v[32:35], v3, s[24:27], s11 offen sc1
    buffer_store_dwordx4 v[36:39], v3, s[24:27], s11 offen offset:512 sc1
    s_add_u32 m0, s17, 32768
    s_add_u32 s7, s6, 0
    v_xor_b32 v45, 0, v47
    buffer_load_dwordx4 v45, s[44:47], s7 offen lds
    s_add_u32 m0, s17, 33792
    s_add_u32 s7, s6, 1024
    v_xor_b32 v45, 16, v47
    buffer_load_dwordx4 v45, s[44:47], s7 offen lds
    s_add_u32 m0, s17, 34816
    s_add_u32 s7, s6, 2048
    v_xor_b32 v45, 32, v47
    buffer_load_dwordx4 v45, s[44:47], s7 offen lds
    s_add_u32 m0, s17, 35840
    s_add_u32 s7, s6, 3072
    v_xor_b32 v45, 48, v47
    buffer_load_dwordx4 v45, s[44:47], s7 offen lds
    s_add_u32 m0, s17, 36864
    s_add_u32 s7, s6, 8192
    v_xor_b32 v45, 64, v47
    buffer_load_dwordx4 v45, s[44:47], s7 offen lds
    s_add_u32 m0, s17, 37888
    s_add_u32 s7, s6, 9216
    v_xor_b32 v45, 80, v47
    buffer_load_dwordx4 v45, s[44:47], s7 offen lds
    s_add_u32 m0, s17, 38912
    s_add_u32 s7, s6, 10240
    v_xor_b32 v45, 96, v47
    buffer_load_dwordx4 v45, s[44:47], s7 offen lds
    s_add_u32 m0, s17, 39936
    s_add_u32 s7, s6, 11264
    v_xor_b32 v45, 112, v47
    buffer_load_dwordx4 v45, s[44:47], s7 offen lds
Lp1d3:
    s_mov_b32 s56, 0x46000000
    v_mov_b32 v240, 0x4227c5ac
    s_cmp_eq_u32 s2, 0
    s_cselect_b32 s66, 0, 1.0
    s_add_u32 s68, s58, 0x200000
    s_add_u32 s69, s68, 4096
    s_add_u32 s60, s58, 0x400000
    s_add_u32 s61, s60, 4096
    s_waitcnt vmcnt(10)
    v_fma_f32 v88, v88, s56, v240
    v_fma_f32 v89, v89, s56, v240
    v_fma_f32 v90, v90, s56, v240
    v_fma_f32 v91, v91, s56, v240
    v_fma_f32 v92, v92, s56, v240
    v_fma_f32 v93, v93, s56, v240
    v_fma_f32 v94, v94, s56, v240
    v_fma_f32 v95, v95, s56, v240
    v_rsq_f32 v88, v88
    v_rsq_f32 v89, v89
    v_rsq_f32 v90, v90
    v_rsq_f32 v91, v91
    v_rsq_f32 v92, v92
    v_rsq_f32 v93, v93
    v_rsq_f32 v94, v94
    v_rsq_f32 v95, v95
    v_lshlrev_b32 v96, 16, v64
    v_and_b32 v97, 0xffff0000, v64
    v_lshlrev_b32 v98, 16, v65
    v_and_b32 v99, 0xffff0000, v65
    v_lshlrev_b32 v100, 16, v66
    v_and_b32 v101, 0xffff0000, v66
    v_lshlrev_b32 v102, 16, v67
    v_and_b32 v103, 0xffff0000, v67
    v_lshlrev_b32 v104, 16, v68
    v_and_b32 v105, 0xffff0000, v68
    v_lshlrev_b32 v106, 16, v69
    v_and_b32 v107, 0xffff0000, v69
    v_lshlrev_b32 v108, 16, v70
    v_and_b32 v109, 0xffff0000, v70
    v_lshlrev_b32 v110, 16, v71
    v_and_b32 v111, 0xffff0000, v71
    v_pk_mul_f32 v[224:225], v[96:97], v[88:89]
    v_pk_mul_f32 v[226:227], v[98:99], v[90:91]
    v_cvt_pk_bf16_f32 v32, v224, v225
    v_cvt_pk_bf16_f32 v33, v226, v227
    ds_write_b64 v10, v[32:33] offset:0
    v_pk_mul_f32 v[228:229], v[100:101], v[92:93]
    v_pk_mul_f32 v[230:231], v[102:103], v[94:95]
    v_cvt_pk_bf16_f32 v34, v228, v229
    v_cvt_pk_bf16_f32 v35, v230, v231
    ds_write_b64 v10, v[34:35] offset:2048
    v_pk_mul_f32 v[232:233], v[104:105], v[88:89]
    v_pk_mul_f32 v[234:235], v[106:107], v[90:91]
    v_cvt_pk_bf16_f32 v36, v232, v233
    v_cvt_pk_bf16_f32 v37, v234, v235
    ds_write_b64 v10, v[36:37] offset:4096
    v_pk_mul_f32 v[236:237], v[108:109], v[92:93]
    v_pk_mul_f32 v[238:239], v[110:111], v[94:95]
    v_cvt_pk_bf16_f32 v38, v236, v237
    v_cvt_pk_bf16_f32 v39, v238, v239
    ds_write_b64 v10, v[38:39] offset:6144
    v_lshlrev_b32 v16, 16, v72
    v_and_b32 v24, 0xffff0000, v72
    v_lshlrev_b32 v17, 16, v73
    v_and_b32 v25, 0xffff0000, v73
    v_lshlrev_b32 v18, 16, v74
    v_and_b32 v26, 0xffff0000, v74
    v_lshlrev_b32 v19, 16, v75
    v_and_b32 v27, 0xffff0000, v75
    v_lshlrev_b32 v20, 16, v76
    v_and_b32 v28, 0xffff0000, v76
    v_lshlrev_b32 v21, 16, v77
    v_and_b32 v29, 0xffff0000, v77
    v_lshlrev_b32 v22, 16, v78
    v_and_b32 v30, 0xffff0000, v78
    v_lshlrev_b32 v23, 16, v79
    v_and_b32 v31, 0xffff0000, v79
    v_xor_b32 v144, 0x80008000, v136
    v_xor_b32 v168, 0x80008000, v160
    v_xor_b32 v145, 0x80008000, v137
    v_xor_b32 v169, 0x80008000, v161
    v_xor_b32 v146, 0x80008000, v138
    v_xor_b32 v170, 0x80008000, v162
    v_xor_b32 v147, 0x80008000, v139
    v_xor_b32 v171, 0x80008000, v163
    v_xor_b32 v148, 0x80008000, v140
    v_xor_b32 v172, 0x80008000, v164
    v_xor_b32 v149, 0x80008000, v141
    v_xor_b32 v173, 0x80008000, v165
    v_xor_b32 v150, 0x80008000, v142
    v_xor_b32 v174, 0x80008000, v166
    v_xor_b32 v151, 0x80008000, v143
    v_xor_b32 v175, 0x80008000, v167
    s_lshl_b32 s57, s3, 12
    s_add_u32 s57, s57, 147456
    v_add_u32 v44, s57, v2
    ds_write_b128 v44, v[64:67] offset:0
    ds_write_b128 v44, v[68:71] offset:1024
    ds_write_b128 v44, v[72:75] offset:2048
    ds_write_b128 v44, v[76:79] offset:3072
    s_waitcnt vmcnt(8)
    s_waitcnt lgkmcnt(0)
    s_barrier
    ds_read_b128 v[192:195], v13 offset:0
    ds_read_b128 v[208:211], v13 offset:4096
    ds_read_b128 v[196:199], v13 offset:1024
    ds_read_b128 v[212:215], v13 offset:5120
    ds_read_b128 v[200:203], v13 offset:2048
    ds_read_b128 v[216:219], v13 offset:6144
    ds_read_b128 v[204:207], v13 offset:3072
    ds_read_b128 v[220:223], v13 offset:7168
    s_lshl_b32 s57, s55, 8
    s_add_u32 s57, s57, 0x2138000
    s_cmp_lg_u32 s3, 0
    s_cselect_b32 s57, 0x4000000, s57
    s_cmp_ge_u32 s52, 56
    s_cselect_b32 s57, 0x4000000, s57
    v_mov_b32 v41, 0
    v_mov_b32 v40, 1
    s_mov_b64 exec, 1
    buffer_atomic_add v40, v41, s[24:27], s57 offen sc1
    s_mov_b64 exec, -1
    s_waitcnt lgkmcnt(6)
    v_mfma_f32_16x16x32_bf16 v[224:227], v[192:195], v[128:131], 0
    v_mfma_f32_16x16x32_bf16 v[232:235], v[192:195], v[136:139], 0
    v_mfma_f32_16x16x32_bf16 v[224:227], v[208:211], v[144:147], v[224:227]
    v_mfma_f32_16x16x32_bf16 v[232:235], v[208:211], v[128:131], v[232:235]
    s_waitcnt lgkmcnt(4)
    v_mov_b32 v248, -1
    v_mov_b32 v249, -1
    v_mov_b32 v250, -1
    v_mov_b32 v251, -1
    v_mfma_f32_16x16x32_bf16 v[224:227], v[196:199], v[132:135], v[224:227]
    v_mfma_f32_16x16x32_bf16 v[232:235], v[196:199], v[140:143], v[232:235]
    v_mfma_f32_16x16x32_bf16 v[224:227], v[212:215], v[148:151], v[224:227]
    v_mfma_f32_16x16x32_bf16 v[232:235], v[212:215], v[132:135], v[232:235]
    s_waitcnt lgkmcnt(2)
    v_mfma_f32_16x16x32_bf16 v[228:231], v[200:203], v[128:131], 0
    s_add_u32 s7, s58, 0x2200000
    s_cmp_lt_u32 s2, 128
    s_cselect_b32 s7, s7, 0x4000000
    s_add_u32 s15, s7, 4096
    s_mov_b32 exec_lo, 0x00ff00ff
    s_mov_b32 exec_hi, 0x00ff00ff
    buffer_store_dwordx4 v[248:251], v2, s[24:27], s7 offen sc1
    buffer_store_dwordx4 v[248:251], v2, s[24:27], s15 offen sc1
    s_mov_b64 exec, -1
    v_mfma_f32_16x16x32_bf16 v[236:239], v[200:203], v[136:139], 0
    v_mfma_f32_16x16x32_bf16 v[228:231], v[216:219], v[144:147], v[228:231]
    v_mfma_f32_16x16x32_bf16 v[236:239], v[216:219], v[128:131], v[236:239]
    s_waitcnt lgkmcnt(0)
    v_mfma_f32_16x16x32_bf16 v[228:231], v[204:207], v[132:135], v[228:231]
    v_mfma_f32_16x16x32_bf16 v[236:239], v[204:207], v[140:143], v[236:239]
    s_add_u32 s7, s58, 0x800000
    s_cmp_lt_u32 s2, 128
    s_cselect_b32 s7, s7, 0x4000000
    s_add_u32 s15, s7, 4096
    s_mov_b32 exec_lo, 0x00ff00ff
    s_mov_b32 exec_hi, 0x00ff00ff
    buffer_store_dwordx4 v[248:251], v2, s[24:27], s7 offen sc1
    buffer_store_dwordx4 v[248:251], v2, s[24:27], s15 offen sc1
    s_mov_b64 exec, -1
    v_mfma_f32_16x16x32_bf16 v[228:231], v[220:223], v[148:151], v[228:231]
    v_mfma_f32_16x16x32_bf16 v[236:239], v[220:223], v[132:135], v[236:239]
    v_pk_mul_f32 v[240:241], v[232:233], v[184:185]
    v_pk_mul_f32 v[242:243], v[224:225], v[184:185]
    v_pk_fma_f32 v[224:225], v[224:225], v[176:177], v[240:241] neg_lo:[0,0,1] neg_hi:[0,0,1]
    v_pk_fma_f32 v[232:233], v[232:233], v[176:177], v[242:243]
    v_pk_mul_f32 v[240:241], v[234:235], v[186:187]
    v_pk_mul_f32 v[242:243], v[226:227], v[186:187]
    v_pk_fma_f32 v[226:227], v[226:227], v[178:179], v[240:241] neg_lo:[0,0,1] neg_hi:[0,0,1]
    v_pk_fma_f32 v[234:235], v[234:235], v[178:179], v[242:243]
    v_cvt_pk_bf16_f32 v32, v224, v225
    v_cvt_pk_bf16_f32 v33, v226, v227
    v_cvt_pk_bf16_f32 v36, v232, v233
    v_cvt_pk_bf16_f32 v37, v234, v235
    v_pk_mul_f32 v[240:241], v[236:237], v[188:189]
    v_pk_mul_f32 v[242:243], v[228:229], v[188:189]
    v_pk_fma_f32 v[228:229], v[228:229], v[180:181], v[240:241] neg_lo:[0,0,1] neg_hi:[0,0,1]
    v_pk_fma_f32 v[236:237], v[236:237], v[180:181], v[242:243]
    v_pk_mul_f32 v[240:241], v[238:239], v[190:191]
    v_pk_mul_f32 v[242:243], v[230:231], v[190:191]
    v_pk_fma_f32 v[230:231], v[230:231], v[182:183], v[240:241] neg_lo:[0,0,1] neg_hi:[0,0,1]
    v_pk_fma_f32 v[238:239], v[238:239], v[182:183], v[242:243]
    v_cvt_pk_bf16_f32 v34, v228, v229
    v_cvt_pk_bf16_f32 v35, v230, v231
    v_cvt_pk_bf16_f32 v38, v236, v237
    v_cvt_pk_bf16_f32 v39, v238, v239
    v_mfma_f32_16x16x32_bf16 v[224:227], v[152:155], v[32:35], 0
    v_mfma_f32_16x16x32_bf16 v[232:235], v[160:163], v[32:35], 0
    v_mfma_f32_16x16x32_bf16 v[224:227], v[168:171], v[36:39], v[224:227]
    v_mfma_f32_16x16x32_bf16 v[232:235], v[152:155], v[36:39], v[232:235]
    v_mfma_f32_16x16x32_bf16 v[228:231], v[156:159], v[32:35], 0
    v_mfma_f32_16x16x32_bf16 v[236:239], v[164:167], v[32:35], 0
    v_mfma_f32_16x16x32_bf16 v[228:231], v[172:175], v[36:39], v[228:231]
    v_mfma_f32_16x16x32_bf16 v[236:239], v[156:159], v[36:39], v[236:239]
    s_nop 3
    v_pk_mul_f32 v[240:241], v[232:233], v[24:25]
    v_pk_mul_f32 v[242:243], v[224:225], v[24:25]
    v_pk_fma_f32 v[224:225], v[224:225], v[16:17], v[240:241] neg_lo:[0,0,1] neg_hi:[0,0,1]
    v_pk_fma_f32 v[232:233], v[232:233], v[16:17], v[242:243]
    v_pk_mul_f32 v[240:241], v[234:235], v[26:27]
    v_pk_mul_f32 v[242:243], v[226:227], v[26:27]
    v_pk_fma_f32 v[226:227], v[226:227], v[18:19], v[240:241] neg_lo:[0,0,1] neg_hi:[0,0,1]
    v_pk_fma_f32 v[234:235], v[234:235], v[18:19], v[242:243]
    v_cvt_pk_bf16_f32 v32, v224, v225
    v_cvt_pk_bf16_f32 v33, v226, v227
    v_cvt_pk_bf16_f32 v36, v232, v233
    v_cvt_pk_bf16_f32 v37, v234, v235
    v_pk_mul_f32 v[240:241], v[236:237], v[28:29]
    v_pk_mul_f32 v[242:243], v[228:229], v[28:29]
    v_pk_fma_f32 v[228:229], v[228:229], v[20:21], v[240:241] neg_lo:[0,0,1] neg_hi:[0,0,1]
    v_pk_fma_f32 v[236:237], v[236:237], v[20:21], v[242:243]
    v_pk_mul_f32 v[240:241], v[238:239], v[30:31]
    v_pk_mul_f32 v[242:243], v[230:231], v[30:31]
    v_pk_fma_f32 v[230:231], v[230:231], v[22:23], v[240:241] neg_lo:[0,0,1] neg_hi:[0,0,1]
    v_pk_fma_f32 v[238:239], v[238:239], v[22:23], v[242:243]
    v_cvt_pk_bf16_f32 v34, v228, v229
    v_cvt_pk_bf16_f32 v35, v230, v231
    v_cvt_pk_bf16_f32 v38, v236, v237
    v_cvt_pk_bf16_f32 v39, v238, v239
    v_mfma_f32_16x16x32_bf16 v[224:227], v[152:155], v[32:35], 0
    v_mfma_f32_16x16x32_bf16 v[232:235], v[168:171], v[32:35], 0
    v_mfma_f32_16x16x32_bf16 v[224:227], v[160:163], v[36:39], v[224:227]
    v_mfma_f32_16x16x32_bf16 v[232:235], v[152:155], v[36:39], v[232:235]
    v_mfma_f32_16x16x32_bf16 v[228:231], v[156:159], v[32:35], 0
    v_mfma_f32_16x16x32_bf16 v[236:239], v[172:175], v[32:35], 0
    v_mfma_f32_16x16x32_bf16 v[228:231], v[164:167], v[36:39], v[228:231]
    v_mfma_f32_16x16x32_bf16 v[236:239], v[156:159], v[36:39], v[236:239]
    s_nop 3
    v_pk_mul_f32 v[240:241], v[232:233], v[184:185]
    v_pk_mul_f32 v[242:243], v[224:225], v[184:185]
    v_pk_fma_f32 v[224:225], v[224:225], v[176:177], v[240:241]
    v_pk_fma_f32 v[232:233], v[232:233], v[176:177], v[242:243] neg_lo:[0,0,1] neg_hi:[0,0,1]
    v_pk_mul_f32 v[240:241], v[234:235], v[186:187]
    v_pk_mul_f32 v[242:243], v[226:227], v[186:187]
    v_pk_fma_f32 v[226:227], v[226:227], v[178:179], v[240:241]
    v_pk_fma_f32 v[234:235], v[234:235], v[178:179], v[242:243] neg_lo:[0,0,1] neg_hi:[0,0,1]
    v_cvt_pk_bf16_f32 v32, v224, v225
    v_cvt_pk_bf16_f32 v33, v226, v227
    v_cvt_pk_bf16_f32 v36, v232, v233
    v_cvt_pk_bf16_f32 v37, v234, v235
    ds_write_b64 v11, v[32:33] offset:0
    ds_write_b64 v11, v[36:37] offset:512
    v_pk_mul_f32 v[240:241], v[236:237], v[188:189]
    v_pk_mul_f32 v[242:243], v[228:229], v[188:189]
    v_pk_fma_f32 v[228:229], v[228:229], v[180:181], v[240:241]
    v_pk_fma_f32 v[236:237], v[236:237], v[180:181], v[242:243] neg_lo:[0,0,1] neg_hi:[0,0,1]
    v_pk_mul_f32 v[240:241], v[238:239], v[190:191]
    v_pk_mul_f32 v[242:243], v[230:231], v[190:191]
    v_pk_fma_f32 v[230:231], v[230:231], v[182:183], v[240:241]
    v_pk_fma_f32 v[238:239], v[238:239], v[182:183], v[242:243] neg_lo:[0,0,1] neg_hi:[0,0,1]
    v_cvt_pk_bf16_f32 v34, v228, v229
    v_cvt_pk_bf16_f32 v35, v230, v231
    v_cvt_pk_bf16_f32 v38, v236, v237
    v_cvt_pk_bf16_f32 v39, v238, v239
    ds_write_b64 v11, v[34:35] offset:1024
    ds_write_b64 v11, v[38:39] offset:1536
    s_waitcnt lgkmcnt(0)
    s_barrier
    ds_read_b64_tr_b16 v[192:193], v12 offset:0
    ds_read_b64_tr_b16 v[194:195], v12 offset:2048
    ds_read_b64_tr_b16 v[208:209], v12 offset:512
    ds_read_b64_tr_b16 v[210:211], v12 offset:2560
    ds_read_b64_tr_b16 v[196:197], v12 offset:4096
    ds_read_b64_tr_b16 v[198:199], v12 offset:6144
    ds_read_b64_tr_b16 v[212:213], v12 offset:4608
    ds_read_b64_tr_b16 v[214:215], v12 offset:6656
    ds_read_b64_tr_b16 v[200:201], v12 offset:1024
    ds_read_b64_tr_b16 v[202:203], v12 offset:3072
    ds_read_b64_tr_b16 v[216:217], v12 offset:1536
    ds_read_b64_tr_b16 v[218:219], v12 offset:3584
    ds_read_b64_tr_b16 v[204:205], v12 offset:5120
    ds_read_b64_tr_b16 v[206:207], v12 offset:7168
    ds_read_b64_tr_b16 v[220:221], v12 offset:5632
    ds_read_b64_tr_b16 v[222:223], v12 offset:7680
    s_lshr_b32 s56, s2, 3
    s_mul_i32 s57, s56, 43
    s_lshr_b32 s57, s57, 7
    s_mul_i32 s52, s57, 3
    s_sub_u32 s52, s56, s52
    s_and_b32 s54, s2, 3
    s_mul_i32 s55, s54, 3
    s_add_u32 s52, s52, s55
    s_and_b32 s55, s56, 4
    s_lshr_b32 s55, s55, 1
    s_lshr_b32 s54, s54, 1
    s_add_u32 s55, s55, s54
    s_add_u32 s55, s55, 12
    s_and_b32 s54, s2, 1
    s_lshl_b32 s54, s54, 2
    s_and_b32 s53, s56, 3
    s_add_u32 s54, s54, s53
    s_cmp_lt_u32 s56, 24
    s_cselect_b32 s52, s52, s55
    s_cselect_b32 s53, s57, s54
    s_and_b32 s54, s2, 4
    s_lshl_b32 s54, s54, 1
    s_add_u32 s53, s53, s54
    s_and_b32 s55, s2, 7
    s_lshl_b32 s55, s55, 2
    s_lshr_b32 s56, s2, 3
    s_and_b32 s56, s56, 3
    s_add_u32 s55, s55, s56
    s_lshr_b32 s54, s2, 5
    s_lshl_b32 s57, s52, 1
    s_lshr_b32 s56, s3, 1
    s_add_u32 s57, s57, s56
    s_lshl_b32 s57, s57, 8
    s_add_u32 s64, s57, 0x2138000
    s_lshl_b32 s62, s52, 2
    s_add_u32 s62, s62, s3
    s_lshl_b32 s62, s62, 16
    s_add_u32 s62, s62, 0xc00000
    s_cmp_ge_u32 s52, 14
    s_cselect_b32 s65, 0, 8
    s_cselect_b32 s62, 0x4000000, s62
    buffer_load_dword v40, v41, s[24:27], s64 offen sc1
    s_waitcnt lgkmcnt(12)
    v_mfma_f32_16x16x32_bf16 v[224:227], v[128:131], v[192:195], 0
    v_mfma_f32_16x16x32_bf16 v[232:235], v[144:147], v[192:195], 0
    v_mfma_f32_16x16x32_bf16 v[224:227], v[136:139], v[208:211], v[224:227]
    v_mfma_f32_16x16x32_bf16 v[232:235], v[128:131], v[208:211], v[232:235]
    s_waitcnt lgkmcnt(8)
    v_mfma_f32_16x16x32_bf16 v[224:227], v[132:135], v[196:199], v[224:227]
    v_mfma_f32_16x16x32_bf16 v[232:235], v[148:151], v[196:199], v[232:235]
    v_mfma_f32_16x16x32_bf16 v[224:227], v[140:143], v[212:215], v[224:227]
    v_mfma_f32_16x16x32_bf16 v[232:235], v[132:135], v[212:215], v[232:235]
    s_waitcnt lgkmcnt(4)
    v_mfma_f32_16x16x32_bf16 v[228:231], v[128:131], v[200:203], 0
    v_mfma_f32_16x16x32_bf16 v[236:239], v[144:147], v[200:203], 0
    v_mfma_f32_16x16x32_bf16 v[228:231], v[136:139], v[216:219], v[228:231]
    v_mfma_f32_16x16x32_bf16 v[236:239], v[128:131], v[216:219], v[236:239]
    s_waitcnt lgkmcnt(0)
    v_mfma_f32_16x16x32_bf16 v[228:231], v[132:135], v[204:207], v[228:231]
    v_mfma_f32_16x16x32_bf16 v[236:239], v[148:151], v[204:207], v[236:239]
    v_mfma_f32_16x16x32_bf16 v[228:231], v[140:143], v[220:223], v[228:231]
    v_mfma_f32_16x16x32_bf16 v[236:239], v[132:135], v[220:223], v[236:239]
    v_pk_add_f32 v[96:97], v[96:97], v[224:225]
    v_pk_fma_f32 v[104:105], v[232:233], s[66:67], v[104:105] op_sel_hi:[1,0,1]
    v_pk_add_f32 v[98:99], v[98:99], v[226:227]
    v_pk_fma_f32 v[106:107], v[234:235], s[66:67], v[106:107] op_sel_hi:[1,0,1]
    v_cvt_pk_bf16_f32 v64, v96, v97
    v_cvt_pk_bf16_f32 v65, v98, v99
    v_cvt_pk_bf16_f32 v68, v104, v105
    v_cvt_pk_bf16_f32 v69, v106, v107
    v_pk_add_f32 v[100:101], v[100:101], v[228:229]
    v_pk_fma_f32 v[108:109], v[236:237], s[66:67], v[108:109] op_sel_hi:[1,0,1]
    v_pk_add_f32 v[102:103], v[102:103], v[230:231]
    v_pk_fma_f32 v[110:111], v[238:239], s[66:67], v[110:111] op_sel_hi:[1,0,1]
    v_cvt_pk_bf16_f32 v66, v100, v101
    v_cvt_pk_bf16_f32 v67, v102, v103
    v_cvt_pk_bf16_f32 v70, v108, v109
    v_cvt_pk_bf16_f32 v71, v110, v111
    buffer_store_dwordx4 v[64:67], v2, s[24:27], s68 offen sc1
    buffer_store_dwordx4 v[68:71], v2, s[24:27], s69 offen sc1
    v_pk_mul_f32 v[232:233], v[232:233], s[66:67] op_sel_hi:[1,0]
    v_pk_mul_f32 v[234:235], v[234:235], s[66:67] op_sel_hi:[1,0]
    v_pk_mul_f32 v[236:237], v[236:237], s[66:67] op_sel_hi:[1,0]
    v_pk_mul_f32 v[238:239], v[238:239], s[66:67] op_sel_hi:[1,0]
    v_cvt_pk_bf16_f32 v80, v224, v225
    v_cvt_pk_bf16_f32 v81, v226, v227
    v_cvt_pk_bf16_f32 v82, v228, v229
    v_cvt_pk_bf16_f32 v83, v230, v231
    v_cvt_pk_bf16_f32 v84, v232, v233
    v_cvt_pk_bf16_f32 v85, v234, v235
    v_cvt_pk_bf16_f32 v86, v236, v237
    v_cvt_pk_bf16_f32 v87, v238, v239
    buffer_store_dwordx4 v[80:83], v2, s[24:27], s60 offen sc1
    buffer_store_dwordx4 v[84:87], v2, s[24:27], s61 offen sc1
    s_waitcnt vmcnt(4)
    v_cmp_gt_u32 vcc, s65, v40
    s_cbranch_vccz Lcb13
    s_mov_b32 m0, 0
Lcp14:
    s_sleep 3
    buffer_load_dword v40, v41, s[24:27], s64 offen sc1
    s_add_u32 m0, m0, 1
    s_cmp_gt_u32 m0, 400000
    s_cbranch_scc1 Lcb13
    s_waitcnt vmcnt(0)
    v_cmp_gt_u32 vcc, s65, v40
    s_cbranch_vccnz Lcp14
Lcb13:
    s_add_u32 s47, s62, 0
    buffer_load_dwordx4 a[0:3], v2, s[24:27], s47 offen offset:0 sc1
    buffer_load_dwordx4 a[4:7], v2, s[24:27], s47 offen offset:1024 sc1
    buffer_load_dwordx4 a[8:11], v2, s[24:27], s47 offen offset:2048 sc1
    buffer_load_dwordx4 a[12:15], v2, s[24:27], s47 offen offset:3072 sc1
    s_add_u32 s47, s62, 4096
    buffer_load_dwordx4 a[16:19], v2, s[24:27], s47 offen offset:0 sc1
    buffer_load_dwordx4 a[20:23], v2, s[24:27], s47 offen offset:1024 sc1
    buffer_load_dwordx4 a[24:27], v2, s[24:27], s47 offen offset:2048 sc1
    buffer_load_dwordx4 a[28:31], v2, s[24:27], s47 offen offset:3072 sc1
    s_add_u32 s47, s62, 8192
    buffer_load_dwordx4 a[32:35], v2, s[24:27], s47 offen offset:0 sc1
    buffer_load_dwordx4 a[36:39], v2, s[24:27], s47 offen offset:1024 sc1
    s_waitcnt vmcnt(10)
    s_barrier
    s_cmp_lg_u32 s3, 0
    s_cbranch_scc1 Lar15
    v_mov_b32 v6, 0
    v_mov_b32 v7, 1
    s_mov_b64 exec, 1
    s_and_b32 s56, s2, 15
    s_lshl_b32 s56, s56, 8
    s_add_u32 s56, s56, 0x2110000
    buffer_atomic_add v7, v6, s[24:27], s56 offen sc1
    s_mov_b64 exec, -1
Lar15:
Lj712:
    s_lshl_b32 s56, s2, 2
    s_add_u32 s56, s56, s3
    s_cmp_lg_u32 s56, 1020
    s_cbranch_scc1 Lnm16
    v_lshlrev_b32 v6, 8, v1
    s_mov_b32 s56, 0x2110000
    s_mov_b64 exec, 0xffff
    s_mov_b32 m0, 0
Lpl17:
    buffer_load_dword v7, v6, s[24:27], s56 offen sc1
    s_waitcnt vmcnt(0)
    v_cmp_gt_u32 vcc, 16, v7
    s_cbranch_vccz Lpx18
    s_add_u32 m0, m0, 1
    s_cmp_lt_u32 m0, 400000
    s_cbranch_scc1 Lpl17
Lpx18:
    s_mov_b64 exec, 0xff
    v_mov_b32 v7, 1
    s_mov_b32 s56, 0x2114000
    buffer_store_dword v7, v6, s[24:27], s56 offen sc1
    s_mov_b64 exec, -1
Lnm16:
    s_cmp_ge_u32 s52, 14
    s_cbranch_scc1 Lpt20
    v_lshrrev_b32 v42, 2, v1
    v_and_b32 v42, 3, v42
    v_lshl_add_u32 v43, v4, 2, v42
    v_lshrrev_b32 v40, 3, v1
    v_and_b32 v40, 2, v40
    v_and_b32 v41, 1, v1
    v_or_b32 v40, v40, v41
    s_lshl_b32 s56, s14, 2
    v_or_b32 v40, s56, v40
    v_xor_b32 v40, v40, v43
    v_lshlrev_b32 v40, 4, v40
    v_lshl_add_u32 v40, v43, 10, v40
    v_and_b32 v41, 2, v1
    v_lshl_or_b32 v40, v41, 2, v40
    v_xor_b32 v41, 128, v40
    ds_read_b64_tr_b16 v[16:17], v40 offset:32768
    ds_read_b64_tr_b16 v[18:19], v41 offset:40960
    ds_read_b64_tr_b16 v[20:21], v40 offset:49152
    ds_read_b64_tr_b16 v[22:23], v41 offset:57344
    ds_read_b128 v[96:99], v48 offset:32768
    ds_read_b128 v[100:103], v48 offset:33280
    ds_read_b128 v[104:107], v49 offset:32768
    ds_read_b128 v[108:111], v49 offset:33280
    ds_read_b128 v[112:115], v50 offset:32768
    ds_read_b128 v[116:119], v50 offset:33280
    ds_read_b128 v[120:123], v51 offset:32768
    ds_read_b128 v[124:127], v51 offset:33280
    s_waitcnt lgkmcnt(7)
    v_mfma_f32_32x32x16_bf16 v[192:207], v[96:99], a[192:195], 0
    ds_read_b128 v[96:99], v52 offset:32768
    s_waitcnt lgkmcnt(7)
    v_mfma_f32_32x32x16_bf16 v[208:223], v[100:103], a[192:195], 0
    buffer_load_dwordx4 a[40:43], v2, s[24:27], s47 offen offset:2048 sc1
    ds_read_b128 v[100:103], v52 offset:33280
    s_waitcnt lgkmcnt(7)
    v_mfma_f32_32x32x16_bf16 v[192:207], v[104:107], a[196:199], v[192:207]
    buffer_load_dwordx4 a[44:47], v2, s[24:27], s47 offen offset:3072 sc1
    ds_read_b128 v[104:107], v53 offset:32768
    s_waitcnt lgkmcnt(7)
    v_mfma_f32_32x32x16_bf16 v[208:223], v[108:111], a[196:199], v[208:223]
    s_add_u32 s47, s62, 12288
    ds_read_b128 v[108:111], v53 offset:33280
    s_waitcnt lgkmcnt(7)
    v_mfma_f32_32x32x16_bf16 v[192:207], v[112:115], a[200:203], v[192:207]
    buffer_load_dwordx4 a[48:51], v2, s[24:27], s47 offen offset:0 sc1
    ds_read_b128 v[112:115], v54 offset:32768
    s_waitcnt lgkmcnt(7)
    v_mfma_f32_32x32x16_bf16 v[208:223], v[116:119], a[200:203], v[208:223]
    buffer_load_dwordx4 a[52:55], v2, s[24:27], s47 offen offset:1024 sc1
    ds_read_b128 v[116:119], v54 offset:33280
    s_waitcnt lgkmcnt(7)
    v_mfma_f32_32x32x16_bf16 v[192:207], v[120:123], a[204:207], v[192:207]
    ds_read_b128 v[120:123], v55 offset:32768
    s_waitcnt lgkmcnt(7)
    v_mfma_f32_32x32x16_bf16 v[208:223], v[124:127], a[204:207], v[208:223]
    buffer_load_dwordx4 a[56:59], v2, s[24:27], s47 offen offset:2048 sc1
    ds_read_b128 v[124:127], v55 offset:33280
    s_waitcnt lgkmcnt(7)
    v_mfma_f32_32x32x16_bf16 v[192:207], v[96:99], a[208:211], v[192:207]
    buffer_load_dwordx4 a[60:63], v2, s[24:27], s47 offen offset:3072 sc1
    ds_read_b128 v[96:99], v48 offset:33024
    s_waitcnt lgkmcnt(7)
    v_mfma_f32_32x32x16_bf16 v[208:223], v[100:103], a[208:211], v[208:223]
    s_add_u32 s47, s62, 16384
    ds_read_b128 v[100:103], v48 offset:33536
    s_waitcnt lgkmcnt(7)
    v_mfma_f32_32x32x16_bf16 v[192:207], v[104:107], a[212:215], v[192:207]
    buffer_load_dwordx4 a[64:67], v2, s[24:27], s47 offen offset:0 sc1
    ds_read_b128 v[104:107], v49 offset:33024
    s_waitcnt lgkmcnt(7)
    v_mfma_f32_32x32x16_bf16 v[208:223], v[108:111], a[212:215], v[208:223]
    buffer_load_dwordx4 a[68:71], v2, s[24:27], s47 offen offset:1024 sc1
    ds_read_b128 v[108:111], v49 offset:33536
    s_waitcnt lgkmcnt(7)
    v_mfma_f32_32x32x16_bf16 v[192:207], v[112:115], a[216:219], v[192:207]
    ds_read_b128 v[112:115], v50 offset:33024
    s_waitcnt lgkmcnt(7)
    v_mfma_f32_32x32x16_bf16 v[208:223], v[116:119], a[216:219], v[208:223]
    buffer_load_dwordx4 a[72:75], v2, s[24:27], s47 offen offset:2048 sc1
    ds_read_b128 v[116:119], v50 offset:33536
    s_waitcnt lgkmcnt(7)
    v_mfma_f32_32x32x16_bf16 v[192:207], v[120:123], a[220:223], v[192:207]
    buffer_load_dwordx4 a[76:79], v2, s[24:27], s47 offen offset:3072 sc1
    ds_read_b128 v[120:123], v51 offset:33024
    s_waitcnt lgkmcnt(7)
    v_mfma_f32_32x32x16_bf16 v[208:223], v[124:127], a[220:223], v[208:223]
    s_add_u32 s47, s62, 20480
    ds_read_b128 v[124:127], v51 offset:33536
    s_waitcnt lgkmcnt(7)
    v_mfma_f32_32x32x16_bf16 v[192:207], v[96:99], a[224:227], v[192:207]
    buffer_load_dwordx4 a[80:83], v2, s[24:27], s47 offen offset:0 sc1
    ds_read_b128 v[96:99], v52 offset:33024
    s_waitcnt lgkmcnt(7)
    v_mfma_f32_32x32x16_bf16 v[208:223], v[100:103], a[224:227], v[208:223]
    buffer_load_dwordx4 a[84:87], v2, s[24:27], s47 offen offset:1024 sc1
    ds_read_b128 v[100:103], v52 offset:33536
    s_waitcnt lgkmcnt(7)
    v_mfma_f32_32x32x16_bf16 v[192:207], v[104:107], a[228:231], v[192:207]
    buffer_load_dwordx4 a[88:91], v2, s[24:27], s47 offen offset:2048 sc1
    ds_read_b128 v[104:107], v53 offset:33024
    s_waitcnt lgkmcnt(7)
    v_mfma_f32_32x32x16_bf16 v[208:223], v[108:111], a[228:231], v[208:223]
    ds_read_b128 v[108:111], v53 offset:33536
    s_waitcnt lgkmcnt(7)
    v_mfma_f32_32x32x16_bf16 v[192:207], v[112:115], a[232:235], v[192:207]
    buffer_load_dwordx4 a[92:95], v2, s[24:27], s47 offen offset:3072 sc1
    ds_read_b128 v[112:115], v54 offset:33024
    s_waitcnt lgkmcnt(7)
    v_mfma_f32_32x32x16_bf16 v[208:223], v[116:119], a[232:235], v[208:223]
    s_add_u32 s47, s62, 24576
    ds_read_b128 v[116:119], v54 offset:33536
    s_waitcnt lgkmcnt(7)
    v_mfma_f32_32x32x16_bf16 v[192:207], v[120:123], a[236:239], v[192:207]
    buffer_load_dwordx4 a[96:99], v2, s[24:27], s47 offen offset:0 sc1
    ds_read_b128 v[120:123], v55 offset:33024
    s_waitcnt lgkmcnt(7)
    v_mfma_f32_32x32x16_bf16 v[208:223], v[124:127], a[236:239], v[208:223]
    buffer_load_dwordx4 a[100:103], v2, s[24:27], s47 offen offset:1024 sc1
    ds_read_b128 v[124:127], v55 offset:33536
    s_waitcnt lgkmcnt(7)
    v_mfma_f32_32x32x16_bf16 v[192:207], v[96:99], a[240:243], v[192:207]
    buffer_load_dwordx4 a[104:107], v2, s[24:27], s47 offen offset:2048 sc1
    s_waitcnt lgkmcnt(6)
    v_mfma_f32_32x32x16_bf16 v[208:223], v[100:103], a[240:243], v[208:223]
    s_waitcnt lgkmcnt(5)
    v_mfma_f32_32x32x16_bf16 v[192:207], v[104:107], a[244:247], v[192:207]
    buffer_load_dwordx4 a[108:111], v2, s[24:27], s47 offen offset:3072 sc1
    s_waitcnt lgkmcnt(4)
    v_mfma_f32_32x32x16_bf16 v[208:223], v[108:111], a[244:247], v[208:223]
    s_add_u32 s47, s62, 28672
    s_waitcnt lgkmcnt(3)
    v_mfma_f32_32x32x16_bf16 v[192:207], v[112:115], a[248:251], v[192:207]
    buffer_load_dwordx4 a[112:115], v2, s[24:27], s47 offen offset:0 sc1
    s_waitcnt lgkmcnt(2)
    v_mfma_f32_32x32x16_bf16 v[208:223], v[116:119], a[248:251], v[208:223]
    buffer_load_dwordx4 a[116:119], v2, s[24:27], s47 offen offset:1024 sc1
    s_waitcnt lgkmcnt(1)
    v_mfma_f32_32x32x16_bf16 v[192:207], v[120:123], a[252:255], v[192:207]
    buffer_load_dwordx4 a[120:123], v2, s[24:27], s47 offen offset:2048 sc1
    s_waitcnt lgkmcnt(0)
    v_mfma_f32_32x32x16_bf16 v[208:223], v[124:127], a[252:255], v[208:223]
    buffer_load_dwordx4 a[124:127], v2, s[24:27], s47 offen offset:3072 sc1
    s_nop 10
    v_pk_fma_f32 v[192:193], v[208:209], v[46:47], v[192:193] op_sel_hi:[1,0,1]
    v_pk_fma_f32 v[194:195], v[210:211], v[46:47], v[194:195] op_sel_hi:[1,0,1]
    v_pk_fma_f32 v[196:197], v[212:213], v[46:47], v[196:197] op_sel_hi:[1,0,1]
    v_pk_fma_f32 v[198:199], v[214:215], v[46:47], v[198:199] op_sel_hi:[1,0,1]
    v_pk_fma_f32 v[200:201], v[216:217], v[46:47], v[200:201] op_sel_hi:[1,0,1]
    v_pk_fma_f32 v[202:203], v[218:219], v[46:47], v[202:203] op_sel_hi:[1,0,1]
    v_pk_fma_f32 v[204:205], v[220:221], v[46:47], v[204:205] op_sel_hi:[1,0,1]
    v_pk_fma_f32 v[206:207], v[222:223], v[46:47], v[206:207] op_sel_hi:[1,0,1]
    v_cvt_pk_bf16_f32 v56, v192, v193
    v_cvt_pk_bf16_f32 v57, v194, v195
    v_cvt_pk_bf16_f32 v58, v196, v197
    v_cvt_pk_bf16_f32 v59, v198, v199
    v_cvt_pk_bf16_f32 v60, v200, v201
    v_cvt_pk_bf16_f32 v61, v202, v203
    v_cvt_pk_bf16_f32 v62, v204, v205
    v_cvt_pk_bf16_f32 v63, v206, v207
    buffer_store_dwordx4 v[56:59], v2, s[24:27], s8 offen sc1
    buffer_store_dwordx4 v[60:63], v2, s[24:27], s8 offen offset:2048 sc1
    buffer_store_dwordx4 v[16:19], v2, s[24:27], s9 offen sc1
    buffer_store_dwordx4 v[20:23], v2, s[24:27], s9 offen offset:2048 sc1
Lsk19:
    v_lshrrev_b32 v40, 3, v1
    v_and_b32 v41, 7, v1
    v_lshrrev_b32 v42, 2, v1
    v_and_b32 v42, 4, v42
    v_xor_b32 v41, v41, v42
    v_lshlrev_b32 v41, 4, v41
    v_lshl_add_u32 v13, v40, 12, v41
    v_xor_b32 v51, 32, v13
    v_lshrrev_b32 v40, 2, v1
    v_and_b32 v40, 3, v40
    v_and_b32 v42, 1, v1
    v_lshlrev_b32 v41, 4, v42
    v_and_b32 v42, 2, v1
    v_lshl_or_b32 v41, v42, 2, v41
    v_lshl_or_b32 v41, v40, 7, v41
    v_lshrrev_b32 v42, 1, v40
    v_lshl_or_b32 v41, v42, 6, v41
    v_and_b32 v42, 16, v1
    v_lshl_or_b32 v41, v42, 1, v41
    v_and_b32 v42, 48, v1
    v_lshl_or_b32 v8, v42, 6, v41
    v_xor_b32 v9, 32, v8
    v_xor_b32 v10, 64, v8
    v_xor_b32 v11, 96, v8
    s_lshr_b32 s66, s3, 1
    s_and_b32 s67, s3, 1
    v_lshl_or_b32 v12, v4, 10, v41
    v_lshlrev_b32 v42, 5, v4
    v_xor_b32 v12, v12, v42
    s_lshl_b32 s56, s67, 6
    v_xor_b32 v12, s56, v12
    s_lshl_b32 s56, s66, 16
    s_lshl_b32 s57, s52, 11
    s_add_u32 s56, s56, s57
    v_add_u32 v12, s56, v12
    v_and_b32 v50, 15, v1
    v_lshlrev_b32 v50, 4, v50
    v_and_b32 v42, 48, v1
    v_lshl_or_b32 v50, v42, 5, v50
    v_mov_b32 v14, 0
    v_mov_b32 v15, 1
    s_mul_i32 s56, s3, 57344
    s_mul_i32 s64, s54, 229376
    s_add_u32 s64, s64, s56
    s_add_u32 s64, s64, 0x1000000
    s_mul_i32 s65, s55, 229376
    s_add_u32 s65, s65, s56
    s_lshr_b32 s65, s65, 1
    s_add_u32 s65, s65, 0x1400000
    s_lshl_b32 s58, s3, 16
    s_lshl_b32 s59, s53, 8
    s_add_u32 s58, s58, s59
    s_add_u32 s58, s58, 0x200000
    s_lshl_b32 s59, s3, 11
    s_mov_b32 s15, 0x2110000
    s_lshl_b32 s60, s52, 2
    s_add_u32 s60, s60, s3
    s_lshl_b32 s60, s60, 12
    s_mul_i32 s32, s53, 458752
    s_add_u32 s32, s32, s60
    s_lshr_b32 s32, s32, 1
    s_add_u32 s32, s32, 0x1400000
    s_add_u32 s33, s32, 114688
    s_add_u32 s34, s32, 3670016
    s_add_u32 s35, s33, 3670016
    s_lshl_b32 s40, s53, 8
    s_add_u32 s40, s40, 0x2118000
    s_add_u32 s41, s40, 0x4000
    s_cmp_lg_u32 s3, 0
    s_cselect_b32 s41, 0x4000000, s41
    s_cselect_b32 s40, 0x4000000, s40
    s_lshr_b32 s42, s55, 1
    s_lshl_b32 s42, s42, 8
    s_add_u32 s42, s42, 0x2118000
    s_add_u32 s43, s42, 0x4000
    s_lshr_b32 s39, s54, 1
    s_lshl_b32 s39, s39, 2
    s_add_u32 s39, s39, s3
    s_lshl_b32 s39, s39, 8
    s_add_u32 s39, s39, 0x213c000
    s_lshr_b32 s36, s60, 12
    s_mul_i32 s36, s36, 37
    s_lshr_b32 s36, s36, 9
    s_lshl_b32 s57, s53, 2
    s_add_u32 s36, s36, s57
    s_lshl_b32 s36, s36, 8
    s_add_u32 s36, s36, 0x2140000
    s_lshr_b32 s37, s55, 1
    s_lshl_b32 s37, s37, 2
    s_add_u32 s37, s37, s3
    s_lshl_b32 s37, s37, 8
    s_add_u32 s37, s37, 0x2140000
    s_lshl_b32 s44, s53, 9
    s_lshl_b32 s57, s3, 7
    s_add_u32 s44, s44, s57
    s_add_u32 s44, s44, 0x2002000
    s_cmp_lg_u32 s3, 0
    s_cbranch_scc1 Lwt21
    s_cmp_eq_u32 s2, 255
    s_cbranch_scc1 Lwt21
    v_mov_b32 v6, 0
    s_and_b32 s56, s2, 7
    s_lshl_b32 s56, s56, 8
    s_add_u32 s56, s56, 0x2114000
    s_mov_b64 exec, 0x1
    s_mov_b32 m0, 0
Lpl22:
    buffer_load_dword v7, v6, s[24:27], s56 offen sc1
    s_waitcnt vmcnt(0)
    v_cmp_gt_u32 vcc, 1, v7
    s_cbranch_vccz Lpx23
    s_sleep 1
    s_add_u32 m0, m0, 1
    s_cmp_lt_u32 m0, 400000
    s_cbranch_scc1 Lpl22
Lpx23:
    s_mov_b64 exec, -1
Lwt21:
    s_barrier
    s_cmp_ge_u32 s52, 14
    s_cbranch_scc1 Lalt24
    s_add_u32 m0, s59, 0
    s_add_u32 s60, s58, 0
    buffer_load_dwordx4 v13, s[24:27], s60 offen sc1 lds
    s_add_u32 m0, s59, 1024
    s_add_u32 s60, s58, 32768
    buffer_load_dwordx4 v51, s[24:27], s60 offen sc1 lds
    s_add_u32 m0, s59, 8192
    s_add_u32 s60, s58, 262144
    buffer_load_dwordx4 v13, s[24:27], s60 offen sc1 lds
    s_add_u32 m0, s59, 9216
    s_add_u32 s60, s58, 294912
    buffer_load_dwordx4 v51, s[24:27], s60 offen sc1 lds
    s_add_u32 m0, s59, 16384
    s_add_u32 s60, s58, 524288
    buffer_load_dwordx4 v13, s[24:27], s60 offen sc1 lds
    s_add_u32 m0, s59, 17408
    s_add_u32 s60, s58, 557056
    buffer_load_dwordx4 v51, s[24:27], s60 offen sc1 lds
    s_add_u32 m0, s59, 24576
    s_add_u32 s60, s58, 786432
    buffer_load_dwordx4 v13, s[24:27], s60 offen sc1 lds
    s_add_u32 m0, s59, 25600
    s_add_u32 s60, s58, 819200
    buffer_load_dwordx4 v51, s[24:27], s60 offen sc1 lds
    s_waitcnt vmcnt(6)
    s_barrier
    s_mov_b64 exec, 1
    buffer_atomic_add v15, v14, s[24:27], s13 offen sc1
    s_mov_b64 exec, -1
    ds_read_b64_tr_b16 v[64:65], v8 offset:0
    ds_read_b64_tr_b16 v[66:67], v8 offset:512
    ds_read_b64_tr_b16 v[68:69], v9 offset:0
    ds_read_b64_tr_b16 v[70:71], v9 offset:512
    ds_read_b64_tr_b16 v[72:73], v10 offset:0
    ds_read_b64_tr_b16 v[74:75], v10 offset:512
    ds_read_b64_tr_b16 v[76:77], v11 offset:0
    ds_read_b64_tr_b16 v[78:79], v11 offset:512
    s_waitcnt lgkmcnt(6)
    v_mfma_f32_16x16x32_bf16 v[128:131], a[0:3], v[64:67], 0
    ds_read_b64_tr_b16 v[80:81], v8 offset:4096
    s_add_u32 m0, s59, 32768
    v_mfma_f32_16x16x32_bf16 v[132:135], a[4:7], v[64:67], 0
    ds_read_b64_tr_b16 v[82:83], v8 offset:4608
    s_add_u32 s60, s58, 1048576
    v_mfma_f32_16x16x32_bf16 v[160:163], a[8:11], v[64:67], 0
    buffer_load_dwordx4 v13, s[24:27], s60 offen sc1 lds
    v_mfma_f32_16x16x32_bf16 v[164:167], a[12:15], v[64:67], 0
    s_waitcnt lgkmcnt(6)
    v_mfma_f32_16x16x32_bf16 v[136:139], a[0:3], v[68:71], 0
    ds_read_b64_tr_b16 v[84:85], v9 offset:4096
    s_add_u32 m0, s59, 33792
    v_mfma_f32_16x16x32_bf16 v[140:143], a[4:7], v[68:71], 0
    ds_read_b64_tr_b16 v[86:87], v9 offset:4608
    s_add_u32 s60, s58, 1081344
    v_mfma_f32_16x16x32_bf16 v[168:171], a[8:11], v[68:71], 0
    buffer_load_dwordx4 v51, s[24:27], s60 offen sc1 lds
    v_mfma_f32_16x16x32_bf16 v[172:175], a[12:15], v[68:71], 0
    s_waitcnt lgkmcnt(6)
    v_mfma_f32_16x16x32_bf16 v[144:147], a[0:3], v[72:75], 0
    ds_read_b64_tr_b16 v[88:89], v10 offset:4096
    s_add_u32 m0, s59, 40960
    v_mfma_f32_16x16x32_bf16 v[148:151], a[4:7], v[72:75], 0
    ds_read_b64_tr_b16 v[90:91], v10 offset:4608
    s_add_u32 s60, s58, 1310720
    v_mfma_f32_16x16x32_bf16 v[176:179], a[8:11], v[72:75], 0
    buffer_load_dwordx4 v13, s[24:27], s60 offen sc1 lds
    v_mfma_f32_16x16x32_bf16 v[180:183], a[12:15], v[72:75], 0
    s_waitcnt lgkmcnt(6)
    v_mfma_f32_16x16x32_bf16 v[152:155], a[0:3], v[76:79], 0
    ds_read_b64_tr_b16 v[92:93], v11 offset:4096
    s_add_u32 m0, s59, 41984
    v_mfma_f32_16x16x32_bf16 v[156:159], a[4:7], v[76:79], 0
    ds_read_b64_tr_b16 v[94:95], v11 offset:4608
    s_add_u32 s60, s58, 1343488
    v_mfma_f32_16x16x32_bf16 v[184:187], a[8:11], v[76:79], 0
    buffer_load_dwordx4 v51, s[24:27], s60 offen sc1 lds
    v_mfma_f32_16x16x32_bf16 v[188:191], a[12:15], v[76:79], 0
    s_waitcnt vmcnt(9)
    s_barrier
    s_waitcnt lgkmcnt(6)
    v_mfma_f32_16x16x32_bf16 v[128:131], a[16:19], v[80:83], v[128:131]
    ds_read_b64_tr_b16 v[64:65], v8 offset:8192
    s_add_u32 m0, s59, 49152
    v_mfma_f32_16x16x32_bf16 v[132:135], a[20:23], v[80:83], v[132:135]
    ds_read_b64_tr_b16 v[66:67], v8 offset:8704
    s_add_u32 s60, s58, 1572864
    v_mfma_f32_16x16x32_bf16 v[160:163], a[24:27], v[80:83], v[160:163]
    buffer_load_dwordx4 v13, s[24:27], s60 offen sc1 lds
    v_mfma_f32_16x16x32_bf16 v[164:167], a[28:31], v[80:83], v[164:167]
    s_waitcnt lgkmcnt(6)
    v_mfma_f32_16x16x32_bf16 v[136:139], a[16:19], v[84:87], v[136:139]
    ds_read_b64_tr_b16 v[68:69], v9 offset:8192
    s_add_u32 m0, s59, 50176
    v_mfma_f32_16x16x32_bf16 v[140:143], a[20:23], v[84:87], v[140:143]
    ds_read_b64_tr_b16 v[70:71], v9 offset:8704
    s_add_u32 s60, s58, 1605632
    v_mfma_f32_16x16x32_bf16 v[168:171], a[24:27], v[84:87], v[168:171]
    buffer_load_dwordx4 v51, s[24:27], s60 offen sc1 lds
    v_mfma_f32_16x16x32_bf16 v[172:175], a[28:31], v[84:87], v[172:175]
    s_waitcnt lgkmcnt(6)
    v_mfma_f32_16x16x32_bf16 v[144:147], a[16:19], v[88:91], v[144:147]
    ds_read_b64_tr_b16 v[72:73], v10 offset:8192
    s_add_u32 m0, s59, 57344
    v_mfma_f32_16x16x32_bf16 v[148:151], a[20:23], v[88:91], v[148:151]
    ds_read_b64_tr_b16 v[74:75], v10 offset:8704
    s_add_u32 s60, s58, 1835008
    v_mfma_f32_16x16x32_bf16 v[176:179], a[24:27], v[88:91], v[176:179]
    buffer_load_dwordx4 v13, s[24:27], s60 offen sc1 lds
    v_mfma_f32_16x16x32_bf16 v[180:183], a[28:31], v[88:91], v[180:183]
    s_waitcnt lgkmcnt(6)
    v_mfma_f32_16x16x32_bf16 v[152:155], a[16:19], v[92:95], v[152:155]
    ds_read_b64_tr_b16 v[76:77], v11 offset:8192
    s_add_u32 m0, s59, 58368
    v_mfma_f32_16x16x32_bf16 v[156:159], a[20:23], v[92:95], v[156:159]
    ds_read_b64_tr_b16 v[78:79], v11 offset:8704
    s_add_u32 s60, s58, 1867776
    v_mfma_f32_16x16x32_bf16 v[184:187], a[24:27], v[92:95], v[184:187]
    buffer_load_dwordx4 v51, s[24:27], s60 offen sc1 lds
    v_mfma_f32_16x16x32_bf16 v[188:191], a[28:31], v[92:95], v[188:191]
    s_waitcnt lgkmcnt(6)
    v_mfma_f32_16x16x32_bf16 v[128:131], a[32:35], v[64:67], v[128:131]
    ds_read_b64_tr_b16 v[80:81], v8 offset:12288
    s_add_u32 s47, s62, 32768
    v_mfma_f32_16x16x32_bf16 v[132:135], a[36:39], v[64:67], v[132:135]
    ds_read_b64_tr_b16 v[82:83], v8 offset:12800
    buffer_load_dwordx4 a[128:131], v2, s[24:27], s47 offen offset:0 sc1
    v_mfma_f32_16x16x32_bf16 v[160:163], a[40:43], v[64:67], v[160:163]
    v_mfma_f32_16x16x32_bf16 v[164:167], a[44:47], v[64:67], v[164:167]
    s_waitcnt lgkmcnt(6)
    v_mfma_f32_16x16x32_bf16 v[136:139], a[32:35], v[68:71], v[136:139]
    ds_read_b64_tr_b16 v[84:85], v9 offset:12288
    buffer_load_dwordx4 a[132:135], v2, s[24:27], s47 offen offset:1024 sc1
    v_mfma_f32_16x16x32_bf16 v[140:143], a[36:39], v[68:71], v[140:143]
    ds_read_b64_tr_b16 v[86:87], v9 offset:12800
    v_mfma_f32_16x16x32_bf16 v[168:171], a[40:43], v[68:71], v[168:171]
    v_mfma_f32_16x16x32_bf16 v[172:175], a[44:47], v[68:71], v[172:175]
    s_waitcnt lgkmcnt(6)
    v_mfma_f32_16x16x32_bf16 v[144:147], a[32:35], v[72:75], v[144:147]
    ds_read_b64_tr_b16 v[88:89], v10 offset:12288
    buffer_load_dwordx4 a[136:139], v2, s[24:27], s47 offen offset:2048 sc1
    v_mfma_f32_16x16x32_bf16 v[148:151], a[36:39], v[72:75], v[148:151]
    ds_read_b64_tr_b16 v[90:91], v10 offset:12800
    v_mfma_f32_16x16x32_bf16 v[176:179], a[40:43], v[72:75], v[176:179]
    v_mfma_f32_16x16x32_bf16 v[180:183], a[44:47], v[72:75], v[180:183]
    s_waitcnt lgkmcnt(6)
    v_mfma_f32_16x16x32_bf16 v[152:155], a[32:35], v[76:79], v[152:155]
    ds_read_b64_tr_b16 v[92:93], v11 offset:12288
    buffer_load_dwordx4 a[140:143], v2, s[24:27], s47 offen offset:3072 sc1
    v_mfma_f32_16x16x32_bf16 v[156:159], a[36:39], v[76:79], v[156:159]
    ds_read_b64_tr_b16 v[94:95], v11 offset:12800
    v_mfma_f32_16x16x32_bf16 v[184:187], a[40:43], v[76:79], v[184:187]
    v_mfma_f32_16x16x32_bf16 v[188:191], a[44:47], v[76:79], v[188:191]
    s_waitcnt vmcnt(13)
    s_barrier
    s_waitcnt lgkmcnt(6)
    v_mfma_f32_16x16x32_bf16 v[128:131], a[48:51], v[80:83], v[128:131]
    ds_read_b64_tr_b16 v[64:65], v8 offset:16384
    s_add_u32 s47, s62, 36864
    v_mfma_f32_16x16x32_bf16 v[132:135], a[52:55], v[80:83], v[132:135]
    ds_read_b64_tr_b16 v[66:67], v8 offset:16896
    buffer_load_dwordx4 a[144:147], v2, s[24:27], s47 offen offset:0 sc1
    v_mfma_f32_16x16x32_bf16 v[160:163], a[56:59], v[80:83], v[160:163]
    v_mfma_f32_16x16x32_bf16 v[164:167], a[60:63], v[80:83], v[164:167]
    s_waitcnt lgkmcnt(6)
    v_mfma_f32_16x16x32_bf16 v[136:139], a[48:51], v[84:87], v[136:139]
    ds_read_b64_tr_b16 v[68:69], v9 offset:16384
    buffer_load_dwordx4 a[148:151], v2, s[24:27], s47 offen offset:1024 sc1
    v_mfma_f32_16x16x32_bf16 v[140:143], a[52:55], v[84:87], v[140:143]
    ds_read_b64_tr_b16 v[70:71], v9 offset:16896
    v_mfma_f32_16x16x32_bf16 v[168:171], a[56:59], v[84:87], v[168:171]
    v_mfma_f32_16x16x32_bf16 v[172:175], a[60:63], v[84:87], v[172:175]
    s_waitcnt lgkmcnt(6)
    v_mfma_f32_16x16x32_bf16 v[144:147], a[48:51], v[88:91], v[144:147]
    ds_read_b64_tr_b16 v[72:73], v10 offset:16384
    buffer_load_dwordx4 a[152:155], v2, s[24:27], s47 offen offset:2048 sc1
    v_mfma_f32_16x16x32_bf16 v[148:151], a[52:55], v[88:91], v[148:151]
    ds_read_b64_tr_b16 v[74:75], v10 offset:16896
    v_mfma_f32_16x16x32_bf16 v[176:179], a[56:59], v[88:91], v[176:179]
    v_mfma_f32_16x16x32_bf16 v[180:183], a[60:63], v[88:91], v[180:183]
    s_waitcnt lgkmcnt(6)
    v_mfma_f32_16x16x32_bf16 v[152:155], a[48:51], v[92:95], v[152:155]
    ds_read_b64_tr_b16 v[76:77], v11 offset:16384
    buffer_load_dwordx4 a[156:159], v2, s[24:27], s47 offen offset:3072 sc1
    v_mfma_f32_16x16x32_bf16 v[156:159], a[52:55], v[92:95], v[156:159]
    ds_read_b64_tr_b16 v[78:79], v11 offset:16896
    v_mfma_f32_16x16x32_bf16 v[184:187], a[56:59], v[92:95], v[184:187]
    v_mfma_f32_16x16x32_bf16 v[188:191], a[60:63], v[92:95], v[188:191]
    s_waitcnt lgkmcnt(6)
    v_mfma_f32_16x16x32_bf16 v[128:131], a[64:67], v[64:67], v[128:131]
    ds_read_b64_tr_b16 v[80:81], v8 offset:20480
    s_add_u32 s47, s62, 40960
    v_mfma_f32_16x16x32_bf16 v[132:135], a[68:71], v[64:67], v[132:135]
    ds_read_b64_tr_b16 v[82:83], v8 offset:20992
    buffer_load_dwordx4 a[160:163], v2, s[24:27], s47 offen offset:0 sc1
    v_mfma_f32_16x16x32_bf16 v[160:163], a[72:75], v[64:67], v[160:163]
    v_mfma_f32_16x16x32_bf16 v[164:167], a[76:79], v[64:67], v[164:167]
    s_waitcnt lgkmcnt(6)
    v_mfma_f32_16x16x32_bf16 v[136:139], a[64:67], v[68:71], v[136:139]
    ds_read_b64_tr_b16 v[84:85], v9 offset:20480
    buffer_load_dwordx4 a[164:167], v2, s[24:27], s47 offen offset:1024 sc1
    v_mfma_f32_16x16x32_bf16 v[140:143], a[68:71], v[68:71], v[140:143]
    ds_read_b64_tr_b16 v[86:87], v9 offset:20992
    v_mfma_f32_16x16x32_bf16 v[168:171], a[72:75], v[68:71], v[168:171]
    v_mfma_f32_16x16x32_bf16 v[172:175], a[76:79], v[68:71], v[172:175]
    s_waitcnt lgkmcnt(6)
    v_mfma_f32_16x16x32_bf16 v[144:147], a[64:67], v[72:75], v[144:147]
    ds_read_b64_tr_b16 v[88:89], v10 offset:20480
    buffer_load_dwordx4 a[168:171], v2, s[24:27], s47 offen offset:2048 sc1
    v_mfma_f32_16x16x32_bf16 v[148:151], a[68:71], v[72:75], v[148:151]
    ds_read_b64_tr_b16 v[90:91], v10 offset:20992
    v_mfma_f32_16x16x32_bf16 v[176:179], a[72:75], v[72:75], v[176:179]
    v_mfma_f32_16x16x32_bf16 v[180:183], a[76:79], v[72:75], v[180:183]
    s_waitcnt lgkmcnt(6)
    v_mfma_f32_16x16x32_bf16 v[152:155], a[64:67], v[76:79], v[152:155]
    ds_read_b64_tr_b16 v[92:93], v11 offset:20480
    buffer_load_dwordx4 a[172:175], v2, s[24:27], s47 offen offset:3072 sc1
    v_mfma_f32_16x16x32_bf16 v[156:159], a[68:71], v[76:79], v[156:159]
    ds_read_b64_tr_b16 v[94:95], v11 offset:20992
    v_mfma_f32_16x16x32_bf16 v[184:187], a[72:75], v[76:79], v[184:187]
    v_mfma_f32_16x16x32_bf16 v[188:191], a[76:79], v[76:79], v[188:191]
    s_waitcnt lgkmcnt(6)
    v_mfma_f32_16x16x32_bf16 v[128:131], a[80:83], v[80:83], v[128:131]
    ds_read_b64_tr_b16 v[64:65], v8 offset:24576
    s_add_u32 s47, s62, 45056
    v_mfma_f32_16x16x32_bf16 v[132:135], a[84:87], v[80:83], v[132:135]
    ds_read_b64_tr_b16 v[66:67], v8 offset:25088
    buffer_load_dwordx4 a[176:179], v2, s[24:27], s47 offen offset:0 sc1
    v_mfma_f32_16x16x32_bf16 v[160:163], a[88:91], v[80:83], v[160:163]
    v_mfma_f32_16x16x32_bf16 v[164:167], a[92:95], v[80:83], v[164:167]
    s_waitcnt lgkmcnt(6)
    v_mfma_f32_16x16x32_bf16 v[136:139], a[80:83], v[84:87], v[136:139]
    ds_read_b64_tr_b16 v[68:69], v9 offset:24576
    buffer_load_dwordx4 a[180:183], v2, s[24:27], s47 offen offset:1024 sc1
    v_mfma_f32_16x16x32_bf16 v[140:143], a[84:87], v[84:87], v[140:143]
    ds_read_b64_tr_b16 v[70:71], v9 offset:25088
    v_mfma_f32_16x16x32_bf16 v[168:171], a[88:91], v[84:87], v[168:171]
    v_mfma_f32_16x16x32_bf16 v[172:175], a[92:95], v[84:87], v[172:175]
    s_waitcnt lgkmcnt(6)
    v_mfma_f32_16x16x32_bf16 v[144:147], a[80:83], v[88:91], v[144:147]
    ds_read_b64_tr_b16 v[72:73], v10 offset:24576
    buffer_load_dwordx4 a[184:187], v2, s[24:27], s47 offen offset:2048 sc1
    v_mfma_f32_16x16x32_bf16 v[148:151], a[84:87], v[88:91], v[148:151]
    ds_read_b64_tr_b16 v[74:75], v10 offset:25088
    v_mfma_f32_16x16x32_bf16 v[176:179], a[88:91], v[88:91], v[176:179]
    v_mfma_f32_16x16x32_bf16 v[180:183], a[92:95], v[88:91], v[180:183]
    s_waitcnt lgkmcnt(6)
    v_mfma_f32_16x16x32_bf16 v[152:155], a[80:83], v[92:95], v[152:155]
    ds_read_b64_tr_b16 v[76:77], v11 offset:24576
    buffer_load_dwordx4 a[188:191], v2, s[24:27], s47 offen offset:3072 sc1
    v_mfma_f32_16x16x32_bf16 v[156:159], a[84:87], v[92:95], v[156:159]
    ds_read_b64_tr_b16 v[78:79], v11 offset:25088
    v_mfma_f32_16x16x32_bf16 v[184:187], a[88:91], v[92:95], v[184:187]
    v_mfma_f32_16x16x32_bf16 v[188:191], a[92:95], v[92:95], v[188:191]
    s_waitcnt lgkmcnt(6)
    v_mfma_f32_16x16x32_bf16 v[128:131], a[96:99], v[64:67], v[128:131]
    ds_read_b64_tr_b16 v[80:81], v8 offset:28672
    s_add_u32 s47, s62, 49152
    v_mfma_f32_16x16x32_bf16 v[132:135], a[100:103], v[64:67], v[132:135]
    ds_read_b64_tr_b16 v[82:83], v8 offset:29184
    buffer_load_dwordx4 a[192:195], v2, s[24:27], s47 offen offset:0 sc1
    v_mfma_f32_16x16x32_bf16 v[160:163], a[104:107], v[64:67], v[160:163]
    v_mfma_f32_16x16x32_bf16 v[164:167], a[108:111], v[64:67], v[164:167]
    s_waitcnt lgkmcnt(6)
    v_mfma_f32_16x16x32_bf16 v[136:139], a[96:99], v[68:71], v[136:139]
    ds_read_b64_tr_b16 v[84:85], v9 offset:28672
    buffer_load_dwordx4 a[196:199], v2, s[24:27], s47 offen offset:1024 sc1
    v_mfma_f32_16x16x32_bf16 v[140:143], a[100:103], v[68:71], v[140:143]
    ds_read_b64_tr_b16 v[86:87], v9 offset:29184
    v_mfma_f32_16x16x32_bf16 v[168:171], a[104:107], v[68:71], v[168:171]
    v_mfma_f32_16x16x32_bf16 v[172:175], a[108:111], v[68:71], v[172:175]
    s_waitcnt lgkmcnt(6)
    v_mfma_f32_16x16x32_bf16 v[144:147], a[96:99], v[72:75], v[144:147]
    ds_read_b64_tr_b16 v[88:89], v10 offset:28672
    buffer_load_dwordx4 a[200:203], v2, s[24:27], s47 offen offset:2048 sc1
    v_mfma_f32_16x16x32_bf16 v[148:151], a[100:103], v[72:75], v[148:151]
    ds_read_b64_tr_b16 v[90:91], v10 offset:29184
    v_mfma_f32_16x16x32_bf16 v[176:179], a[104:107], v[72:75], v[176:179]
    v_mfma_f32_16x16x32_bf16 v[180:183], a[108:111], v[72:75], v[180:183]
    s_waitcnt lgkmcnt(6)
    v_mfma_f32_16x16x32_bf16 v[152:155], a[96:99], v[76:79], v[152:155]
    ds_read_b64_tr_b16 v[92:93], v11 offset:28672
    buffer_load_dwordx4 a[204:207], v2, s[24:27], s47 offen offset:3072 sc1
    v_mfma_f32_16x16x32_bf16 v[156:159], a[100:103], v[76:79], v[156:159]
    ds_read_b64_tr_b16 v[94:95], v11 offset:29184
    v_mfma_f32_16x16x32_bf16 v[184:187], a[104:107], v[76:79], v[184:187]
    v_mfma_f32_16x16x32_bf16 v[188:191], a[108:111], v[76:79], v[188:191]
    s_waitcnt vmcnt(24)
    s_barrier
    s_waitcnt lgkmcnt(6)
    v_mfma_f32_16x16x32_bf16 v[128:131], a[112:115], v[80:83], v[128:131]
    ds_read_b64_tr_b16 v[64:65], v8 offset:32768
    s_add_u32 s47, s62, 53248
    v_mfma_f32_16x16x32_bf16 v[132:135], a[116:119], v[80:83], v[132:135]
    ds_read_b64_tr_b16 v[66:67], v8 offset:33280
    buffer_load_dwordx4 a[208:211], v2, s[24:27], s47 offen offset:0 sc1
    v_mfma_f32_16x16x32_bf16 v[160:163], a[120:123], v[80:83], v[160:163]
    v_mfma_f32_16x16x32_bf16 v[164:167], a[124:127], v[80:83], v[164:167]
    s_waitcnt lgkmcnt(6)
    v_mfma_f32_16x16x32_bf16 v[136:139], a[112:115], v[84:87], v[136:139]
    ds_read_b64_tr_b16 v[68:69], v9 offset:32768
    buffer_load_dwordx4 a[212:215], v2, s[24:27], s47 offen offset:1024 sc1
    v_mfma_f32_16x16x32_bf16 v[140:143], a[116:119], v[84:87], v[140:143]
    ds_read_b64_tr_b16 v[70:71], v9 offset:33280
    v_mfma_f32_16x16x32_bf16 v[168:171], a[120:123], v[84:87], v[168:171]
    v_mfma_f32_16x16x32_bf16 v[172:175], a[124:127], v[84:87], v[172:175]
    s_waitcnt lgkmcnt(6)
    v_mfma_f32_16x16x32_bf16 v[144:147], a[112:115], v[88:91], v[144:147]
    ds_read_b64_tr_b16 v[72:73], v10 offset:32768
    buffer_load_dwordx4 a[216:219], v2, s[24:27], s47 offen offset:2048 sc1
    v_mfma_f32_16x16x32_bf16 v[148:151], a[116:119], v[88:91], v[148:151]
    ds_read_b64_tr_b16 v[74:75], v10 offset:33280
    v_mfma_f32_16x16x32_bf16 v[176:179], a[120:123], v[88:91], v[176:179]
    v_mfma_f32_16x16x32_bf16 v[180:183], a[124:127], v[88:91], v[180:183]
    s_waitcnt lgkmcnt(6)
    v_mfma_f32_16x16x32_bf16 v[152:155], a[112:115], v[92:95], v[152:155]
    ds_read_b64_tr_b16 v[76:77], v11 offset:32768
    buffer_load_dwordx4 a[220:223], v2, s[24:27], s47 offen offset:3072 sc1
    v_mfma_f32_16x16x32_bf16 v[156:159], a[116:119], v[92:95], v[156:159]
    ds_read_b64_tr_b16 v[78:79], v11 offset:33280
    v_mfma_f32_16x16x32_bf16 v[184:187], a[120:123], v[92:95], v[184:187]
    v_mfma_f32_16x16x32_bf16 v[188:191], a[124:127], v[92:95], v[188:191]
    s_waitcnt vmcnt(16)
    s_waitcnt lgkmcnt(6)
    v_mfma_f32_16x16x32_bf16 v[128:131], a[128:131], v[64:67], v[128:131]
    ds_read_b64_tr_b16 v[80:81], v8 offset:36864
    s_add_u32 s47, s62, 57344
    v_mfma_f32_16x16x32_bf16 v[132:135], a[132:135], v[64:67], v[132:135]
    ds_read_b64_tr_b16 v[82:83], v8 offset:37376
    buffer_load_dwordx4 a[224:227], v2, s[24:27], s47 offen offset:0 sc1
    v_mfma_f32_16x16x32_bf16 v[160:163], a[136:139], v[64:67], v[160:163]
    v_mfma_f32_16x16x32_bf16 v[164:167], a[140:143], v[64:67], v[164:167]
    s_waitcnt lgkmcnt(6)
    v_mfma_f32_16x16x32_bf16 v[136:139], a[128:131], v[68:71], v[136:139]
    ds_read_b64_tr_b16 v[84:85], v9 offset:36864
    buffer_load_dwordx4 a[228:231], v2, s[24:27], s47 offen offset:1024 sc1
    v_mfma_f32_16x16x32_bf16 v[140:143], a[132:135], v[68:71], v[140:143]
    ds_read_b64_tr_b16 v[86:87], v9 offset:37376
    v_mfma_f32_16x16x32_bf16 v[168:171], a[136:139], v[68:71], v[168:171]
    v_mfma_f32_16x16x32_bf16 v[172:175], a[140:143], v[68:71], v[172:175]
    s_waitcnt lgkmcnt(6)
    v_mfma_f32_16x16x32_bf16 v[144:147], a[128:131], v[72:75], v[144:147]
    ds_read_b64_tr_b16 v[88:89], v10 offset:36864
    buffer_load_dwordx4 a[232:235], v2, s[24:27], s47 offen offset:2048 sc1
    v_mfma_f32_16x16x32_bf16 v[148:151], a[132:135], v[72:75], v[148:151]
    ds_read_b64_tr_b16 v[90:91], v10 offset:37376
    v_mfma_f32_16x16x32_bf16 v[176:179], a[136:139], v[72:75], v[176:179]
    v_mfma_f32_16x16x32_bf16 v[180:183], a[140:143], v[72:75], v[180:183]
    s_waitcnt lgkmcnt(6)
    v_mfma_f32_16x16x32_bf16 v[152:155], a[128:131], v[76:79], v[152:155]
    ds_read_b64_tr_b16 v[92:93], v11 offset:36864
    buffer_load_dwordx4 a[236:239], v2, s[24:27], s47 offen offset:3072 sc1
    v_mfma_f32_16x16x32_bf16 v[156:159], a[132:135], v[76:79], v[156:159]
    ds_read_b64_tr_b16 v[94:95], v11 offset:37376
    v_mfma_f32_16x16x32_bf16 v[184:187], a[136:139], v[76:79], v[184:187]
    v_mfma_f32_16x16x32_bf16 v[188:191], a[140:143], v[76:79], v[188:191]
    s_waitcnt lgkmcnt(6)
    v_mfma_f32_16x16x32_bf16 v[128:131], a[144:147], v[80:83], v[128:131]
    ds_read_b64_tr_b16 v[64:65], v8 offset:40960
    s_add_u32 s47, s62, 61440
    v_mfma_f32_16x16x32_bf16 v[132:135], a[148:151], v[80:83], v[132:135]
    ds_read_b64_tr_b16 v[66:67], v8 offset:41472
    buffer_load_dwordx4 a[240:243], v2, s[24:27], s47 offen offset:0 sc1
    v_mfma_f32_16x16x32_bf16 v[160:163], a[152:155], v[80:83], v[160:163]
    v_mfma_f32_16x16x32_bf16 v[164:167], a[156:159], v[80:83], v[164:167]
    s_waitcnt lgkmcnt(6)
    v_mfma_f32_16x16x32_bf16 v[136:139], a[144:147], v[84:87], v[136:139]
    ds_read_b64_tr_b16 v[68:69], v9 offset:40960
    buffer_load_dwordx4 a[244:247], v2, s[24:27], s47 offen offset:1024 sc1
    v_mfma_f32_16x16x32_bf16 v[140:143], a[148:151], v[84:87], v[140:143]
    ds_read_b64_tr_b16 v[70:71], v9 offset:41472
    v_mfma_f32_16x16x32_bf16 v[168:171], a[152:155], v[84:87], v[168:171]
    v_mfma_f32_16x16x32_bf16 v[172:175], a[156:159], v[84:87], v[172:175]
    s_waitcnt lgkmcnt(6)
    v_mfma_f32_16x16x32_bf16 v[144:147], a[144:147], v[88:91], v[144:147]
    ds_read_b64_tr_b16 v[72:73], v10 offset:40960
    buffer_load_dwordx4 a[248:251], v2, s[24:27], s47 offen offset:2048 sc1
    v_mfma_f32_16x16x32_bf16 v[148:151], a[148:151], v[88:91], v[148:151]
    ds_read_b64_tr_b16 v[74:75], v10 offset:41472
    v_mfma_f32_16x16x32_bf16 v[176:179], a[152:155], v[88:91], v[176:179]
    v_mfma_f32_16x16x32_bf16 v[180:183], a[156:159], v[88:91], v[180:183]
    s_waitcnt lgkmcnt(6)
    v_mfma_f32_16x16x32_bf16 v[152:155], a[144:147], v[92:95], v[152:155]
    ds_read_b64_tr_b16 v[76:77], v11 offset:40960
    buffer_load_dwordx4 a[252:255], v2, s[24:27], s47 offen offset:3072 sc1
    v_mfma_f32_16x16x32_bf16 v[156:159], a[148:151], v[92:95], v[156:159]
    ds_read_b64_tr_b16 v[78:79], v11 offset:41472
    v_mfma_f32_16x16x32_bf16 v[184:187], a[152:155], v[92:95], v[184:187]
    v_mfma_f32_16x16x32_bf16 v[188:191], a[156:159], v[92:95], v[188:191]
    buffer_load_dword v57, v14, s[24:27], s39 offen sc1
    s_waitcnt vmcnt(17)
    s_waitcnt lgkmcnt(6)
    v_mfma_f32_16x16x32_bf16 v[128:131], a[160:163], v[64:67], v[128:131]
    ds_read_b64_tr_b16 v[80:81], v8 offset:45056
    s_add_u32 m0, s59, 65536
    v_mfma_f32_16x16x32_bf16 v[132:135], a[164:167], v[64:67], v[132:135]
    ds_read_b64_tr_b16 v[82:83], v8 offset:45568
    s_add_u32 s60, s58, 128
    v_mfma_f32_16x16x32_bf16 v[160:163], a[168:171], v[64:67], v[160:163]
    buffer_load_dwordx4 v13, s[24:27], s60 offen sc1 lds
    v_mfma_f32_16x16x32_bf16 v[164:167], a[172:175], v[64:67], v[164:167]
    s_waitcnt lgkmcnt(6)
    v_mfma_f32_16x16x32_bf16 v[136:139], a[160:163], v[68:71], v[136:139]
    ds_read_b64_tr_b16 v[84:85], v9 offset:45056
    s_add_u32 m0, s59, 66560
    v_mfma_f32_16x16x32_bf16 v[140:143], a[164:167], v[68:71], v[140:143]
    ds_read_b64_tr_b16 v[86:87], v9 offset:45568
    s_add_u32 s60, s58, 32896
    v_mfma_f32_16x16x32_bf16 v[168:171], a[168:171], v[68:71], v[168:171]
    buffer_load_dwordx4 v51, s[24:27], s60 offen sc1 lds
    v_mfma_f32_16x16x32_bf16 v[172:175], a[172:175], v[68:71], v[172:175]
    s_waitcnt lgkmcnt(6)
    v_mfma_f32_16x16x32_bf16 v[144:147], a[160:163], v[72:75], v[144:147]
    ds_read_b64_tr_b16 v[88:89], v10 offset:45056
    s_add_u32 m0, s59, 73728
    v_mfma_f32_16x16x32_bf16 v[148:151], a[164:167], v[72:75], v[148:151]
    ds_read_b64_tr_b16 v[90:91], v10 offset:45568
    s_add_u32 s60, s58, 262272
    v_mfma_f32_16x16x32_bf16 v[176:179], a[168:171], v[72:75], v[176:179]
    buffer_load_dwordx4 v13, s[24:27], s60 offen sc1 lds
    v_mfma_f32_16x16x32_bf16 v[180:183], a[172:175], v[72:75], v[180:183]
    s_waitcnt lgkmcnt(6)
    v_mfma_f32_16x16x32_bf16 v[152:155], a[160:163], v[76:79], v[152:155]
    ds_read_b64_tr_b16 v[92:93], v11 offset:45056
    s_add_u32 m0, s59, 74752
    v_mfma_f32_16x16x32_bf16 v[156:159], a[164:167], v[76:79], v[156:159]
    ds_read_b64_tr_b16 v[94:95], v11 offset:45568
    s_add_u32 s60, s58, 295040
    v_mfma_f32_16x16x32_bf16 v[184:187], a[168:171], v[76:79], v[184:187]
    buffer_load_dwordx4 v51, s[24:27], s60 offen sc1 lds
    v_mfma_f32_16x16x32_bf16 v[188:191], a[172:175], v[76:79], v[188:191]
    s_barrier
    s_waitcnt lgkmcnt(6)
    v_mfma_f32_16x16x32_bf16 v[128:131], a[176:179], v[80:83], v[128:131]
    ds_read_b64_tr_b16 v[64:65], v8 offset:49152
    s_add_u32 m0, s59, 81920
    v_mfma_f32_16x16x32_bf16 v[132:135], a[180:183], v[80:83], v[132:135]
    ds_read_b64_tr_b16 v[66:67], v8 offset:49664
    s_add_u32 s60, s58, 524416
    v_mfma_f32_16x16x32_bf16 v[160:163], a[184:187], v[80:83], v[160:163]
    buffer_load_dwordx4 v13, s[24:27], s60 offen sc1 lds
    v_mfma_f32_16x16x32_bf16 v[164:167], a[188:191], v[80:83], v[164:167]
    s_waitcnt lgkmcnt(6)
    v_mfma_f32_16x16x32_bf16 v[136:139], a[176:179], v[84:87], v[136:139]
    ds_read_b64_tr_b16 v[68:69], v8 offset:53248
    s_add_u32 m0, s59, 82944
    v_mfma_f32_16x16x32_bf16 v[140:143], a[180:183], v[84:87], v[140:143]
    ds_read_b64_tr_b16 v[70:71], v8 offset:53760
    s_add_u32 s60, s58, 557184
    v_mfma_f32_16x16x32_bf16 v[168:171], a[184:187], v[84:87], v[168:171]
    buffer_load_dwordx4 v51, s[24:27], s60 offen sc1 lds
    v_mfma_f32_16x16x32_bf16 v[172:175], a[188:191], v[84:87], v[172:175]
    s_waitcnt lgkmcnt(6)
    v_mfma_f32_16x16x32_bf16 v[144:147], a[176:179], v[88:91], v[144:147]
    ds_read_b64_tr_b16 v[72:73], v8 offset:57344
    s_add_u32 m0, s59, 90112
    v_mfma_f32_16x16x32_bf16 v[148:151], a[180:183], v[88:91], v[148:151]
    ds_read_b64_tr_b16 v[74:75], v8 offset:57856
    s_add_u32 s60, s58, 786560
    v_mfma_f32_16x16x32_bf16 v[176:179], a[184:187], v[88:91], v[176:179]
    buffer_load_dwordx4 v13, s[24:27], s60 offen sc1 lds
    v_mfma_f32_16x16x32_bf16 v[180:183], a[188:191], v[88:91], v[180:183]
    s_waitcnt lgkmcnt(6)
    v_mfma_f32_16x16x32_bf16 v[152:155], a[176:179], v[92:95], v[152:155]
    ds_read_b64_tr_b16 v[76:77], v8 offset:61440
    s_add_u32 m0, s59, 91136
    v_mfma_f32_16x16x32_bf16 v[156:159], a[180:183], v[92:95], v[156:159]
    ds_read_b64_tr_b16 v[78:79], v8 offset:61952
    s_add_u32 s60, s58, 819328
    v_mfma_f32_16x16x32_bf16 v[184:187], a[184:187], v[92:95], v[184:187]
    buffer_load_dwordx4 v51, s[24:27], s60 offen sc1 lds
    v_mfma_f32_16x16x32_bf16 v[188:191], a[188:191], v[92:95], v[188:191]
    s_waitcnt vmcnt(17)
    s_waitcnt lgkmcnt(6)
    v_mfma_f32_16x16x32_bf16 v[128:131], a[192:195], v[64:67], v[128:131]
    ds_read_b64_tr_b16 v[80:81], v9 offset:49152
    s_add_u32 m0, s59, 98304
    v_mfma_f32_16x16x32_bf16 v[132:135], a[196:199], v[64:67], v[132:135]
    ds_read_b64_tr_b16 v[82:83], v9 offset:49664
    s_add_u32 s60, s58, 1048704
    v_mfma_f32_16x16x32_bf16 v[160:163], a[200:203], v[64:67], v[160:163]
    buffer_load_dwordx4 v13, s[24:27], s60 offen sc1 lds
    v_mfma_f32_16x16x32_bf16 v[164:167], a[204:207], v[64:67], v[164:167]
    s_waitcnt lgkmcnt(6)
    v_mfma_f32_16x16x32_bf16 v[128:131], a[208:211], v[68:71], v[128:131]
    ds_read_b64_tr_b16 v[84:85], v9 offset:53248
    s_add_u32 m0, s59, 99328
    v_mfma_f32_16x16x32_bf16 v[132:135], a[212:215], v[68:71], v[132:135]
    ds_read_b64_tr_b16 v[86:87], v9 offset:53760
    s_add_u32 s60, s58, 1081472
    v_mfma_f32_16x16x32_bf16 v[160:163], a[216:219], v[68:71], v[160:163]
    buffer_load_dwordx4 v51, s[24:27], s60 offen sc1 lds
    v_mfma_f32_16x16x32_bf16 v[164:167], a[220:223], v[68:71], v[164:167]
    s_waitcnt vmcnt(11)
    s_waitcnt lgkmcnt(6)
    v_mfma_f32_16x16x32_bf16 v[128:131], a[224:227], v[72:75], v[128:131]
    ds_read_b64_tr_b16 v[88:89], v9 offset:57344
    s_add_u32 m0, s59, 106496
    v_mfma_f32_16x16x32_bf16 v[132:135], a[228:231], v[72:75], v[132:135]
    ds_read_b64_tr_b16 v[90:91], v9 offset:57856
    s_add_u32 s60, s58, 1310848
    v_mfma_f32_16x16x32_bf16 v[160:163], a[232:235], v[72:75], v[160:163]
    buffer_load_dwordx4 v13, s[24:27], s60 offen sc1 lds
    v_mfma_f32_16x16x32_bf16 v[164:167], a[236:239], v[72:75], v[164:167]
    s_waitcnt lgkmcnt(6)
    v_mfma_f32_16x16x32_bf16 v[128:131], a[240:243], v[76:79], v[128:131]
    ds_read_b64_tr_b16 v[92:93], v9 offset:61440
    s_add_u32 m0, s59, 107520
    v_mfma_f32_16x16x32_bf16 v[132:135], a[244:247], v[76:79], v[132:135]
    ds_read_b64_tr_b16 v[94:95], v9 offset:61952
    s_add_u32 s60, s58, 1343616
    v_mfma_f32_16x16x32_bf16 v[160:163], a[248:251], v[76:79], v[160:163]
    buffer_load_dwordx4 v51, s[24:27], s60 offen sc1 lds
    v_mfma_f32_16x16x32_bf16 v[164:167], a[252:255], v[76:79], v[164:167]
    s_waitcnt lgkmcnt(6)
    v_mfma_f32_16x16x32_bf16 v[136:139], a[192:195], v[80:83], v[136:139]
    ds_read_b64_tr_b16 v[64:65], v10 offset:49152
    s_add_u32 m0, s59, 114688
    v_mfma_f32_16x16x32_bf16 v[140:143], a[196:199], v[80:83], v[140:143]
    ds_read_b64_tr_b16 v[66:67], v10 offset:49664
    s_add_u32 s60, s58, 1572992
    v_mfma_f32_16x16x32_bf16 v[168:171], a[200:203], v[80:83], v[168:171]
    buffer_load_dwordx4 v13, s[24:27], s60 offen sc1 lds
    v_mfma_f32_16x16x32_bf16 v[172:175], a[204:207], v[80:83], v[172:175]
    s_waitcnt lgkmcnt(6)
    v_mfma_f32_16x16x32_bf16 v[136:139], a[208:211], v[84:87], v[136:139]
    ds_read_b64_tr_b16 v[68:69], v10 offset:53248
    s_add_u32 m0, s59, 115712
    v_mfma_f32_16x16x32_bf16 v[140:143], a[212:215], v[84:87], v[140:143]
    ds_read_b64_tr_b16 v[70:71], v10 offset:53760
    s_add_u32 s60, s58, 1605760
    v_mfma_f32_16x16x32_bf16 v[168:171], a[216:219], v[84:87], v[168:171]
    buffer_load_dwordx4 v51, s[24:27], s60 offen sc1 lds
    v_max_f32 v128, 0, v128
    v_max_f32 v129, 0, v129
    v_mfma_f32_16x16x32_bf16 v[172:175], a[220:223], v[84:87], v[172:175]
    v_mul_f32 v128, v160, v128
    s_waitcnt lgkmcnt(6)
    v_mfma_f32_16x16x32_bf16 v[136:139], a[224:227], v[88:91], v[136:139]
    ds_read_b64_tr_b16 v[72:73], v10 offset:57344
    s_add_u32 m0, s59, 122880
    v_mfma_f32_16x16x32_bf16 v[140:143], a[228:231], v[88:91], v[140:143]
    ds_read_b64_tr_b16 v[74:75], v10 offset:57856
    s_add_u32 s60, s58, 1835136
    v_mfma_f32_16x16x32_bf16 v[168:171], a[232:235], v[88:91], v[168:171]
    buffer_load_dwordx4 v13, s[24:27], s60 offen sc1 lds
    v_mul_f32 v129, v161, v129
    v_cvt_pk_bf16_f32 v32, v128, v129
    v_mfma_f32_16x16x32_bf16 v[172:175], a[236:239], v[88:91], v[172:175]
    v_max_f32 v130, 0, v130
    s_waitcnt lgkmcnt(6)
    v_mfma_f32_16x16x32_bf16 v[136:139], a[240:243], v[92:95], v[136:139]
    ds_read_b64_tr_b16 v[76:77], v10 offset:61440
    s_add_u32 m0, s59, 123904
    v_mfma_f32_16x16x32_bf16 v[140:143], a[244:247], v[92:95], v[140:143]
    ds_read_b64_tr_b16 v[78:79], v10 offset:61952
    s_add_u32 s60, s58, 1867904
    v_mfma_f32_16x16x32_bf16 v[168:171], a[248:251], v[92:95], v[168:171]
    buffer_load_dwordx4 v51, s[24:27], s60 offen sc1 lds
    v_max_f32 v131, 0, v131
    v_mul_f32 v130, v162, v130
    v_mfma_f32_16x16x32_bf16 v[172:175], a[252:255], v[92:95], v[172:175]
    v_mul_f32 v131, v163, v131
    s_waitcnt vmcnt(16)
    v_cmp_gt_u32 vcc, 14, v57
    s_cbranch_vccnz Lck26
Lcb27:
    s_waitcnt lgkmcnt(6)
    v_mfma_f32_16x16x32_bf16 v[144:147], a[192:195], v[64:67], v[144:147]
    ds_read_b64_tr_b16 v[80:81], v11 offset:49152
    s_add_u32 s63, s64, 0
    v_mfma_f32_16x16x32_bf16 v[148:151], a[196:199], v[64:67], v[148:151]
    ds_read_b64_tr_b16 v[82:83], v11 offset:49664
    buffer_load_dwordx4 v[96:99], v2, s[24:27], s63 offen offset:0 sc1
    v_mfma_f32_16x16x32_bf16 v[176:179], a[200:203], v[64:67], v[176:179]
    v_cvt_pk_bf16_f32 v33, v130, v131
    v_max_f32 v132, 0, v132
    v_max_f32 v133, 0, v133
    v_mfma_f32_16x16x32_bf16 v[180:183], a[204:207], v[64:67], v[180:183]
    v_mul_f32 v132, v164, v132
    s_waitcnt lgkmcnt(6)
    v_mfma_f32_16x16x32_bf16 v[144:147], a[208:211], v[68:71], v[144:147]
    ds_read_b64_tr_b16 v[84:85], v11 offset:53248
    buffer_load_dwordx4 v[100:103], v2, s[24:27], s63 offen offset:1024 sc1
    v_mfma_f32_16x16x32_bf16 v[148:151], a[212:215], v[68:71], v[148:151]
    ds_read_b64_tr_b16 v[86:87], v11 offset:53760
    v_mul_f32 v133, v165, v133
    v_mfma_f32_16x16x32_bf16 v[176:179], a[216:219], v[68:71], v[176:179]
    v_cvt_pk_bf16_f32 v34, v132, v133
    v_max_f32 v134, 0, v134
    v_max_f32 v135, 0, v135
    v_mfma_f32_16x16x32_bf16 v[180:183], a[220:223], v[68:71], v[180:183]
    v_mul_f32 v134, v166, v134
    s_waitcnt lgkmcnt(6)
    v_mfma_f32_16x16x32_bf16 v[144:147], a[224:227], v[72:75], v[144:147]
    ds_read_b64_tr_b16 v[88:89], v11 offset:57344
    buffer_load_dwordx4 v[104:107], v2, s[24:27], s63 offen offset:2048 sc1
    v_mfma_f32_16x16x32_bf16 v[148:151], a[228:231], v[72:75], v[148:151]
    ds_read_b64_tr_b16 v[90:91], v11 offset:57856
    v_mul_f32 v135, v167, v135
    v_mfma_f32_16x16x32_bf16 v[176:179], a[232:235], v[72:75], v[176:179]
    v_cvt_pk_bf16_f32 v35, v134, v135
    buffer_store_dwordx4 v[32:35], v50, s[24:27], s32 offen offset:0 sc1
    v_max_f32 v136, 0, v136
    v_mfma_f32_16x16x32_bf16 v[180:183], a[236:239], v[72:75], v[180:183]
    v_max_f32 v137, 0, v137
    s_waitcnt lgkmcnt(6)
    v_mfma_f32_16x16x32_bf16 v[144:147], a[240:243], v[76:79], v[144:147]
    ds_read_b64_tr_b16 v[92:93], v11 offset:61440
    buffer_load_dwordx4 v[108:111], v2, s[24:27], s63 offen offset:3072 sc1
    v_mfma_f32_16x16x32_bf16 v[148:151], a[244:247], v[76:79], v[148:151]
    ds_read_b64_tr_b16 v[94:95], v11 offset:61952
    v_mul_f32 v136, v168, v136
    v_mfma_f32_16x16x32_bf16 v[176:179], a[248:251], v[76:79], v[176:179]
    v_mul_f32 v137, v169, v137
    v_cvt_pk_bf16_f32 v36, v136, v137
    v_max_f32 v138, 0, v138
    v_mfma_f32_16x16x32_bf16 v[180:183], a[252:255], v[76:79], v[180:183]
    v_max_f32 v139, 0, v139
    s_waitcnt vmcnt(17)
    s_barrier
    s_waitcnt lgkmcnt(6)
    v_mfma_f32_16x16x32_bf16 v[152:155], a[192:195], v[80:83], v[152:155]
    v_add_u32 v8, 0x10000, v8
    ds_read_b64_tr_b16 v[64:65], v8 offset:0
    s_add_u32 s63, s64, 4096
    v_mfma_f32_16x16x32_bf16 v[156:159], a[196:199], v[80:83], v[156:159]
    ds_read_b64_tr_b16 v[66:67], v8 offset:512
    buffer_load_dwordx4 v[112:115], v2, s[24:27], s63 offen offset:0 sc1
    v_mfma_f32_16x16x32_bf16 v[184:187], a[200:203], v[80:83], v[184:187]
    v_mul_f32 v138, v170, v138
    v_mul_f32 v139, v171, v139
    v_cvt_pk_bf16_f32 v37, v138, v139
    v_mfma_f32_16x16x32_bf16 v[188:191], a[204:207], v[80:83], v[188:191]
    v_max_f32 v140, 0, v140
    s_waitcnt lgkmcnt(6)
    v_mfma_f32_16x16x32_bf16 v[152:155], a[208:211], v[84:87], v[152:155]
    v_add_u32 v9, 0x10000, v9
    ds_read_b64_tr_b16 v[68:69], v9 offset:0
    buffer_load_dwordx4 v[116:119], v2, s[24:27], s63 offen offset:1024 sc1
    v_mfma_f32_16x16x32_bf16 v[156:159], a[212:215], v[84:87], v[156:159]
    ds_read_b64_tr_b16 v[70:71], v9 offset:512
    v_max_f32 v141, 0, v141
    v_mfma_f32_16x16x32_bf16 v[184:187], a[216:219], v[84:87], v[184:187]
    v_mul_f32 v140, v172, v140
    v_mul_f32 v141, v173, v141
    v_cvt_pk_bf16_f32 v38, v140, v141
    v_mfma_f32_16x16x32_bf16 v[188:191], a[220:223], v[84:87], v[188:191]
    v_max_f32 v142, 0, v142
    s_waitcnt lgkmcnt(6)
    v_mfma_f32_16x16x32_bf16 v[152:155], a[224:227], v[88:91], v[152:155]
    v_add_u32 v10, 0x10000, v10
    ds_read_b64_tr_b16 v[72:73], v10 offset:0
    buffer_load_dwordx4 v[120:123], v2, s[24:27], s63 offen offset:2048 sc1
    v_mfma_f32_16x16x32_bf16 v[156:159], a[228:231], v[88:91], v[156:159]
    ds_read_b64_tr_b16 v[74:75], v10 offset:512
    v_max_f32 v143, 0, v143
    v_mfma_f32_16x16x32_bf16 v[184:187], a[232:235], v[88:91], v[184:187]
    v_mul_f32 v142, v174, v142
    v_mul_f32 v143, v175, v143
    v_cvt_pk_bf16_f32 v39, v142, v143
    v_mfma_f32_16x16x32_bf16 v[188:191], a[236:239], v[88:91], v[188:191]
    buffer_store_dwordx4 v[36:39], v50, s[24:27], s32 offen offset:256 sc1
    s_waitcnt lgkmcnt(6)
    v_mfma_f32_16x16x32_bf16 v[152:155], a[240:243], v[92:95], v[152:155]
    v_add_u32 v11, 0x10000, v11
    ds_read_b64_tr_b16 v[76:77], v11 offset:0
    buffer_load_dwordx4 v[124:127], v2, s[24:27], s63 offen offset:3072 sc1
    v_mfma_f32_16x16x32_bf16 v[156:159], a[244:247], v[92:95], v[156:159]
    ds_read_b64_tr_b16 v[78:79], v11 offset:512
    v_max_f32 v144, 0, v144
    v_mfma_f32_16x16x32_bf16 v[184:187], a[248:251], v[92:95], v[184:187]
    v_max_f32 v145, 0, v145
    v_mul_f32 v144, v176, v144
    v_mul_f32 v145, v177, v145
    v_mfma_f32_16x16x32_bf16 v[188:191], a[252:255], v[92:95], v[188:191]
    v_cvt_pk_bf16_f32 v40, v144, v145
    s_waitcnt lgkmcnt(6)
    v_mfma_f32_16x16x32_bf16 v[192:195], a[0:3], v[64:67], 0
    ds_read_b64_tr_b16 v[80:81], v8 offset:4096
    v_max_f32 v146, 0, v146
    v_mfma_f32_16x16x32_bf16 v[196:199], a[4:7], v[64:67], 0
    ds_read_b64_tr_b16 v[82:83], v8 offset:4608
    v_max_f32 v147, 0, v147
    v_mfma_f32_16x16x32_bf16 v[224:227], a[8:11], v[64:67], 0
    v_mul_f32 v146, v178, v146
    v_mul_f32 v147, v179, v147
    v_cvt_pk_bf16_f32 v41, v146, v147
    v_mfma_f32_16x16x32_bf16 v[228:231], a[12:15], v[64:67], 0
    v_max_f32 v148, 0, v148
    s_waitcnt lgkmcnt(6)
    v_mfma_f32_16x16x32_bf16 v[200:203], a[0:3], v[68:71], 0
    ds_read_b64_tr_b16 v[84:85], v9 offset:4096
    v_max_f32 v149, 0, v149
    v_mfma_f32_16x16x32_bf16 v[204:207], a[4:7], v[68:71], 0
    ds_read_b64_tr_b16 v[86:87], v9 offset:4608
    v_mul_f32 v148, v180, v148
    v_mfma_f32_16x16x32_bf16 v[232:235], a[8:11], v[68:71], 0
    v_mul_f32 v149, v181, v149
    v_cvt_pk_bf16_f32 v42, v148, v149
    v_max_f32 v150, 0, v150
    v_mfma_f32_16x16x32_bf16 v[236:239], a[12:15], v[68:71], 0
    v_max_f32 v151, 0, v151
    s_waitcnt lgkmcnt(6)
    v_mfma_f32_16x16x32_bf16 v[208:211], a[0:3], v[72:75], 0
    ds_read_b64_tr_b16 v[88:89], v10 offset:4096
    v_mul_f32 v150, v182, v150
    v_mfma_f32_16x16x32_bf16 v[212:215], a[4:7], v[72:75], 0
    ds_read_b64_tr_b16 v[90:91], v10 offset:4608
    v_mul_f32 v151, v183, v151
    v_mfma_f32_16x16x32_bf16 v[240:243], a[8:11], v[72:75], 0
    v_cvt_pk_bf16_f32 v43, v150, v151
    buffer_store_dwordx4 v[40:43], v50, s[24:27], s33 offen offset:0 sc1
    v_max_f32 v152, 0, v152
    v_mfma_f32_16x16x32_bf16 v[244:247], a[12:15], v[72:75], 0
    v_max_f32 v153, 0, v153
    s_waitcnt lgkmcnt(6)
    v_mfma_f32_16x16x32_bf16 v[216:219], a[0:3], v[76:79], 0
    ds_read_b64_tr_b16 v[92:93], v11 offset:4096
    v_mul_f32 v152, v184, v152
    v_mfma_f32_16x16x32_bf16 v[220:223], a[4:7], v[76:79], 0
    ds_read_b64_tr_b16 v[94:95], v11 offset:4608
    v_mul_f32 v153, v185, v153
    v_mfma_f32_16x16x32_bf16 v[248:251], a[8:11], v[76:79], 0
    v_cvt_pk_bf16_f32 v44, v152, v153
    v_max_f32 v154, 0, v154
    v_max_f32 v155, 0, v155
    v_mfma_f32_16x16x32_bf16 v[252:255], a[12:15], v[76:79], 0
    v_mul_f32 v154, v186, v154
    s_waitcnt lgkmcnt(6)
    v_mfma_f32_16x16x32_bf16 v[192:195], a[16:19], v[80:83], v[192:195]
    ds_read_b64_tr_b16 v[64:65], v8 offset:8192
    v_mul_f32 v155, v187, v155
    v_mfma_f32_16x16x32_bf16 v[196:199], a[20:23], v[80:83], v[196:199]
    ds_read_b64_tr_b16 v[66:67], v8 offset:8704
    v_cvt_pk_bf16_f32 v45, v154, v155
    v_mfma_f32_16x16x32_bf16 v[224:227], a[24:27], v[80:83], v[224:227]
    v_max_f32 v156, 0, v156
    v_max_f32 v157, 0, v157
    v_mul_f32 v156, v188, v156
    v_mfma_f32_16x16x32_bf16 v[228:231], a[28:31], v[80:83], v[228:231]
    v_mul_f32 v157, v189, v157
    s_waitcnt lgkmcnt(6)
    v_mfma_f32_16x16x32_bf16 v[200:203], a[16:19], v[84:87], v[200:203]
    ds_read_b64_tr_b16 v[68:69], v9 offset:8192
    v_cvt_pk_bf16_f32 v46, v156, v157
    v_mfma_f32_16x16x32_bf16 v[204:207], a[20:23], v[84:87], v[204:207]
    ds_read_b64_tr_b16 v[70:71], v9 offset:8704
    v_max_f32 v158, 0, v158
    v_mfma_f32_16x16x32_bf16 v[232:235], a[24:27], v[84:87], v[232:235]
    v_max_f32 v159, 0, v159
    v_mul_f32 v158, v190, v158
    v_mul_f32 v159, v191, v159
    v_mfma_f32_16x16x32_bf16 v[236:239], a[28:31], v[84:87], v[236:239]
    v_cvt_pk_bf16_f32 v47, v158, v159
    s_waitcnt lgkmcnt(6)
    v_mfma_f32_16x16x32_bf16 v[208:211], a[16:19], v[88:91], v[208:211]
    ds_read_b64_tr_b16 v[72:73], v10 offset:8192
    buffer_store_dwordx4 v[44:47], v50, s[24:27], s33 offen offset:256 sc1
    v_mfma_f32_16x16x32_bf16 v[212:215], a[20:23], v[88:91], v[212:215]
    ds_read_b64_tr_b16 v[74:75], v10 offset:8704
    v_mfma_f32_16x16x32_bf16 v[240:243], a[24:27], v[88:91], v[240:243]
    v_mfma_f32_16x16x32_bf16 v[244:247], a[28:31], v[88:91], v[244:247]
    s_waitcnt lgkmcnt(6)
    v_mfma_f32_16x16x32_bf16 v[216:219], a[16:19], v[92:95], v[216:219]
    ds_read_b64_tr_b16 v[76:77], v11 offset:8192
    v_mfma_f32_16x16x32_bf16 v[220:223], a[20:23], v[92:95], v[220:223]
    ds_read_b64_tr_b16 v[78:79], v11 offset:8704
    v_mfma_f32_16x16x32_bf16 v[248:251], a[24:27], v[92:95], v[248:251]
    v_mfma_f32_16x16x32_bf16 v[252:255], a[28:31], v[92:95], v[252:255]
    s_waitcnt lgkmcnt(6)
    v_mfma_f32_16x16x32_bf16 v[192:195], a[32:35], v[64:67], v[192:195]
    ds_read_b64_tr_b16 v[80:81], v8 offset:12288
    s_add_u32 s63, s64, 8192
    v_mfma_f32_16x16x32_bf16 v[196:199], a[36:39], v[64:67], v[196:199]
    ds_read_b64_tr_b16 v[82:83], v8 offset:12800
    buffer_load_dwordx4 a[0:3], v2, s[24:27], s63 offen offset:0 sc1
    v_mfma_f32_16x16x32_bf16 v[224:227], a[40:43], v[64:67], v[224:227]
    v_mfma_f32_16x16x32_bf16 v[228:231], a[44:47], v[64:67], v[228:231]
    s_waitcnt lgkmcnt(6)
    v_mfma_f32_16x16x32_bf16 v[200:203], a[32:35], v[68:71], v[200:203]
    ds_read_b64_tr_b16 v[84:85], v9 offset:12288
    buffer_load_dwordx4 a[4:7], v2, s[24:27], s63 offen offset:1024 sc1
    v_mfma_f32_16x16x32_bf16 v[204:207], a[36:39], v[68:71], v[204:207]
    ds_read_b64_tr_b16 v[86:87], v9 offset:12800
    v_mfma_f32_16x16x32_bf16 v[232:235], a[40:43], v[68:71], v[232:235]
    v_mfma_f32_16x16x32_bf16 v[236:239], a[44:47], v[68:71], v[236:239]
    s_waitcnt lgkmcnt(6)
    v_mfma_f32_16x16x32_bf16 v[208:211], a[32:35], v[72:75], v[208:211]
    ds_read_b64_tr_b16 v[88:89], v10 offset:12288
    buffer_load_dwordx4 a[8:11], v2, s[24:27], s63 offen offset:2048 sc1
    v_mfma_f32_16x16x32_bf16 v[212:215], a[36:39], v[72:75], v[212:215]
    ds_read_b64_tr_b16 v[90:91], v10 offset:12800
    v_mfma_f32_16x16x32_bf16 v[240:243], a[40:43], v[72:75], v[240:243]
    v_mfma_f32_16x16x32_bf16 v[244:247], a[44:47], v[72:75], v[244:247]
    s_waitcnt lgkmcnt(6)
    v_mfma_f32_16x16x32_bf16 v[216:219], a[32:35], v[76:79], v[216:219]
    ds_read_b64_tr_b16 v[92:93], v11 offset:12288
    buffer_load_dwordx4 a[12:15], v2, s[24:27], s63 offen offset:3072 sc1
    v_mfma_f32_16x16x32_bf16 v[220:223], a[36:39], v[76:79], v[220:223]
    ds_read_b64_tr_b16 v[94:95], v11 offset:12800
    v_mfma_f32_16x16x32_bf16 v[248:251], a[40:43], v[76:79], v[248:251]
    v_mfma_f32_16x16x32_bf16 v[252:255], a[44:47], v[76:79], v[252:255]
    s_waitcnt vmcnt(16)
    s_barrier
    s_waitcnt lgkmcnt(6)
    v_mfma_f32_16x16x32_bf16 v[192:195], a[48:51], v[80:83], v[192:195]
    ds_read_b64_tr_b16 v[64:65], v8 offset:16384
    s_add_u32 s63, s64, 12288
    v_mfma_f32_16x16x32_bf16 v[196:199], a[52:55], v[80:83], v[196:199]
    ds_read_b64_tr_b16 v[66:67], v8 offset:16896
    buffer_load_dwordx4 a[16:19], v2, s[24:27], s63 offen offset:0 sc1
    v_mfma_f32_16x16x32_bf16 v[224:227], a[56:59], v[80:83], v[224:227]
    v_mfma_f32_16x16x32_bf16 v[228:231], a[60:63], v[80:83], v[228:231]
    s_waitcnt lgkmcnt(6)
    v_mfma_f32_16x16x32_bf16 v[200:203], a[48:51], v[84:87], v[200:203]
    ds_read_b64_tr_b16 v[68:69], v9 offset:16384
    buffer_load_dwordx4 a[20:23], v2, s[24:27], s63 offen offset:1024 sc1
    v_mfma_f32_16x16x32_bf16 v[204:207], a[52:55], v[84:87], v[204:207]
    ds_read_b64_tr_b16 v[70:71], v9 offset:16896
    v_mfma_f32_16x16x32_bf16 v[232:235], a[56:59], v[84:87], v[232:235]
    v_mfma_f32_16x16x32_bf16 v[236:239], a[60:63], v[84:87], v[236:239]
    s_waitcnt lgkmcnt(6)
    v_mfma_f32_16x16x32_bf16 v[208:211], a[48:51], v[88:91], v[208:211]
    ds_read_b64_tr_b16 v[72:73], v10 offset:16384
    buffer_load_dwordx4 a[24:27], v2, s[24:27], s63 offen offset:2048 sc1
    v_mfma_f32_16x16x32_bf16 v[212:215], a[52:55], v[88:91], v[212:215]
    ds_read_b64_tr_b16 v[74:75], v10 offset:16896
    v_mfma_f32_16x16x32_bf16 v[240:243], a[56:59], v[88:91], v[240:243]
    v_mfma_f32_16x16x32_bf16 v[244:247], a[60:63], v[88:91], v[244:247]
    s_waitcnt lgkmcnt(6)
    v_mfma_f32_16x16x32_bf16 v[216:219], a[48:51], v[92:95], v[216:219]
    ds_read_b64_tr_b16 v[76:77], v11 offset:16384
    buffer_load_dwordx4 a[28:31], v2, s[24:27], s63 offen offset:3072 sc1
    v_mfma_f32_16x16x32_bf16 v[220:223], a[52:55], v[92:95], v[220:223]
    ds_read_b64_tr_b16 v[78:79], v11 offset:16896
    v_mfma_f32_16x16x32_bf16 v[248:251], a[56:59], v[92:95], v[248:251]
    v_mfma_f32_16x16x32_bf16 v[252:255], a[60:63], v[92:95], v[252:255]
    s_waitcnt lgkmcnt(6)
    v_mfma_f32_16x16x32_bf16 v[192:195], a[64:67], v[64:67], v[192:195]
    ds_read_b64_tr_b16 v[80:81], v8 offset:20480
    s_add_u32 s63, s64, 16384
    v_mfma_f32_16x16x32_bf16 v[196:199], a[68:71], v[64:67], v[196:199]
    ds_read_b64_tr_b16 v[82:83], v8 offset:20992
    buffer_load_dwordx4 v[128:131], v2, s[24:27], s63 offen offset:0 sc1
    v_mfma_f32_16x16x32_bf16 v[224:227], a[72:75], v[64:67], v[224:227]
    s_cmp_lt_u32 s52, 4
    s_cselect_b32 s57, -1, 0
    ds_read_b64_tr_b16 v[16:17], v12 offset:0
    ds_read_b64_tr_b16 v[18:19], v12 offset:512
    v_mfma_f32_16x16x32_bf16 v[228:231], a[76:79], v[64:67], v[228:231]
    ds_read_b64_tr_b16 v[20:21], v12 offset:28672
    s_waitcnt lgkmcnt(9)
    v_mfma_f32_16x16x32_bf16 v[200:203], a[64:67], v[68:71], v[200:203]
    ds_read_b64_tr_b16 v[84:85], v9 offset:20480
    buffer_load_dwordx4 v[132:135], v2, s[24:27], s63 offen offset:1024 sc1
    v_mfma_f32_16x16x32_bf16 v[204:207], a[68:71], v[68:71], v[204:207]
    ds_read_b64_tr_b16 v[86:87], v9 offset:20992
    ds_read_b64_tr_b16 v[22:23], v12 offset:29184
    v_mfma_f32_16x16x32_bf16 v[232:235], a[72:75], v[68:71], v[232:235]
    ds_read_b64_tr_b16 v[24:25], v12 offset:57344
    ds_read_b64_tr_b16 v[26:27], v12 offset:57856
    v_lshlrev_b32 v48, 2, v5
    v_mfma_f32_16x16x32_bf16 v[236:239], a[76:79], v[68:71], v[236:239]
    s_nop 0
    s_waitcnt lgkmcnt(12)
    v_mfma_f32_16x16x32_bf16 v[208:211], a[64:67], v[72:75], v[208:211]
    ds_read_b64_tr_b16 v[88:89], v10 offset:20480
    buffer_load_dwordx4 v[136:139], v2, s[24:27], s63 offen offset:2048 sc1
    v_mfma_f32_16x16x32_bf16 v[212:215], a[68:71], v[72:75], v[212:215]
    ds_read_b64_tr_b16 v[90:91], v10 offset:20992
    s_nop 0
    v_mfma_f32_16x16x32_bf16 v[240:243], a[72:75], v[72:75], v[240:243]
    s_waitcnt lgkmcnt(2)
    v_lshlrev_b32 v28, 16, v16
    v_and_b32 v29, 0xffff0000, v16
    v_mfma_f32_16x16x32_bf16 v[244:247], a[76:79], v[72:75], v[244:247]
    v_mul_f32 v30, v28, v28
    v_mfma_f32_16x16x32_bf16 v[216:219], a[64:67], v[76:79], v[216:219]
    ds_read_b64_tr_b16 v[92:93], v11 offset:20480
    buffer_load_dwordx4 v[140:143], v2, s[24:27], s63 offen offset:3072 sc1
    v_mfma_f32_16x16x32_bf16 v[220:223], a[68:71], v[76:79], v[220:223]
    ds_read_b64_tr_b16 v[94:95], v11 offset:20992
    v_mul_f32 v31, v29, v29
    v_mfma_f32_16x16x32_bf16 v[248:251], a[72:75], v[76:79], v[248:251]
    v_lshlrev_b32 v28, 16, v17
    v_and_b32 v29, 0xffff0000, v17
    v_fmac_f32 v30, v28, v28
    v_mfma_f32_16x16x32_bf16 v[252:255], a[76:79], v[76:79], v[252:255]
    v_fmac_f32 v31, v29, v29
    v_mfma_f32_16x16x32_bf16 v[192:195], a[80:83], v[80:83], v[192:195]
    ds_read_b64_tr_b16 v[64:65], v8 offset:24576
    s_add_u32 s63, s64, 20480
    v_mfma_f32_16x16x32_bf16 v[196:199], a[84:87], v[80:83], v[196:199]
    ds_read_b64_tr_b16 v[66:67], v8 offset:25088
    buffer_load_dwordx4 v[144:147], v2, s[24:27], s63 offen offset:0 sc1
    v_mfma_f32_16x16x32_bf16 v[224:227], a[88:91], v[80:83], v[224:227]
    v_lshlrev_b32 v28, 16, v18
    v_and_b32 v29, 0xffff0000, v18
    v_fmac_f32 v30, v28, v28
    v_mfma_f32_16x16x32_bf16 v[228:231], a[92:95], v[80:83], v[228:231]
    v_fmac_f32 v31, v29, v29
    v_mfma_f32_16x16x32_bf16 v[200:203], a[80:83], v[84:87], v[200:203]
    ds_read_b64_tr_b16 v[68:69], v9 offset:24576
    buffer_load_dwordx4 v[148:151], v2, s[24:27], s63 offen offset:1024 sc1
    v_mfma_f32_16x16x32_bf16 v[204:207], a[84:87], v[84:87], v[204:207]
    ds_read_b64_tr_b16 v[70:71], v9 offset:25088
    v_lshlrev_b32 v28, 16, v19
    v_mfma_f32_16x16x32_bf16 v[232:235], a[88:91], v[84:87], v[232:235]
    v_and_b32 v29, 0xffff0000, v19
    v_fmac_f32 v30, v28, v28
    v_fmac_f32 v31, v29, v29
    v_mfma_f32_16x16x32_bf16 v[236:239], a[92:95], v[84:87], v[236:239]
    v_lshlrev_b32 v28, 16, v20
    s_waitcnt vmcnt(14)
    s_barrier
    s_mov_b64 exec, 1
    buffer_atomic_add v15, v14, s[24:27], s40 offen sc1
    s_mov_b64 exec, -1
    s_lshl_b32 s56, s3, 14
    v_add_u32 v49, s56, v2
    s_waitcnt lgkmcnt(6)
    v_mfma_f32_16x16x32_bf16 v[208:211], a[80:83], v[88:91], v[208:211]
    ds_read_b64_tr_b16 v[72:73], v10 offset:24576
    buffer_load_dwordx4 v[152:155], v2, s[24:27], s63 offen offset:2048 sc1
    v_mfma_f32_16x16x32_bf16 v[212:215], a[84:87], v[88:91], v[212:215]
    ds_read_b64_tr_b16 v[74:75], v10 offset:25088
    v_and_b32 v29, 0xffff0000, v20
    v_mfma_f32_16x16x32_bf16 v[240:243], a[88:91], v[88:91], v[240:243]
    v_fmac_f32 v30, v28, v28
    v_fmac_f32 v31, v29, v29
    v_lshlrev_b32 v28, 16, v21
    v_mfma_f32_16x16x32_bf16 v[244:247], a[92:95], v[88:91], v[244:247]
    ds_write_b128 v49, a[128:131] offset:0
    s_waitcnt lgkmcnt(7)
    v_mfma_f32_16x16x32_bf16 v[216:219], a[80:83], v[92:95], v[216:219]
    ds_read_b64_tr_b16 v[76:77], v11 offset:24576
    buffer_load_dwordx4 v[156:159], v2, s[24:27], s63 offen offset:3072 sc1
    v_mfma_f32_16x16x32_bf16 v[220:223], a[84:87], v[92:95], v[220:223]
    ds_read_b64_tr_b16 v[78:79], v11 offset:25088
    v_and_b32 v29, 0xffff0000, v21
    v_mfma_f32_16x16x32_bf16 v[248:251], a[88:91], v[92:95], v[248:251]
    v_fmac_f32 v30, v28, v28
    v_fmac_f32 v31, v29, v29
    v_lshlrev_b32 v28, 16, v22
    v_mfma_f32_16x16x32_bf16 v[252:255], a[92:95], v[92:95], v[252:255]
    ds_write_b128 v49, a[132:135] offset:1024
    s_waitcnt lgkmcnt(8)
    v_mfma_f32_16x16x32_bf16 v[192:195], a[96:99], v[64:67], v[192:195]
    ds_read_b64_tr_b16 v[80:81], v8 offset:28672
    s_add_u32 s63, s64, 24576
    v_mfma_f32_16x16x32_bf16 v[196:199], a[100:103], v[64:67], v[196:199]
    ds_read_b64_tr_b16 v[82:83], v8 offset:29184
    buffer_load_dwordx4 v[160:163], v2, s[24:27], s63 offen offset:0 sc1
    v_mfma_f32_16x16x32_bf16 v[224:227], a[104:107], v[64:67], v[224:227]
    v_and_b32 v29, 0xffff0000, v22
    v_fmac_f32 v30, v28, v28
    v_fmac_f32 v31, v29, v29
    v_mfma_f32_16x16x32_bf16 v[228:231], a[108:111], v[64:67], v[228:231]
    ds_write_b128 v49, a[136:139] offset:2048
    s_waitcnt lgkmcnt(9)
    v_mfma_f32_16x16x32_bf16 v[200:203], a[96:99], v[68:71], v[200:203]
    ds_read_b64_tr_b16 v[84:85], v9 offset:28672
    buffer_load_dwordx4 v[164:167], v2, s[24:27], s63 offen offset:1024 sc1
    v_mfma_f32_16x16x32_bf16 v[204:207], a[100:103], v[68:71], v[204:207]
    ds_read_b64_tr_b16 v[86:87], v9 offset:29184
    v_lshlrev_b32 v28, 16, v23
    v_mfma_f32_16x16x32_bf16 v[232:235], a[104:107], v[68:71], v[232:235]
    v_and_b32 v29, 0xffff0000, v23
    v_fmac_f32 v30, v28, v28
    v_fmac_f32 v31, v29, v29
    v_mfma_f32_16x16x32_bf16 v[236:239], a[108:111], v[68:71], v[236:239]
    ds_write_b128 v49, a[140:143] offset:3072
    s_waitcnt lgkmcnt(10)
    v_mfma_f32_16x16x32_bf16 v[208:211], a[96:99], v[72:75], v[208:211]
    ds_read_b64_tr_b16 v[88:89], v10 offset:28672
    buffer_load_dwordx4 v[168:171], v2, s[24:27], s63 offen offset:2048 sc1
    v_mfma_f32_16x16x32_bf16 v[212:215], a[100:103], v[72:75], v[212:215]
    ds_read_b64_tr_b16 v[90:91], v10 offset:29184
    v_and_b32 v24, s57, v24
    v_mfma_f32_16x16x32_bf16 v[240:243], a[104:107], v[72:75], v[240:243]
    v_lshlrev_b32 v28, 16, v24
    v_and_b32 v29, 0xffff0000, v24
    v_fmac_f32 v30, v28, v28
    v_mfma_f32_16x16x32_bf16 v[244:247], a[108:111], v[72:75], v[244:247]
    ds_write_b128 v49, a[144:147] offset:4096
    s_waitcnt lgkmcnt(10)
    v_mfma_f32_16x16x32_bf16 v[216:219], a[96:99], v[76:79], v[216:219]
    ds_read_b64_tr_b16 v[92:93], v11 offset:28672
    buffer_load_dwordx4 v[172:175], v2, s[24:27], s63 offen offset:3072 sc1
    v_mfma_f32_16x16x32_bf16 v[220:223], a[100:103], v[76:79], v[220:223]
    ds_read_b64_tr_b16 v[94:95], v11 offset:29184
    v_fmac_f32 v31, v29, v29
    v_mfma_f32_16x16x32_bf16 v[248:251], a[104:107], v[76:79], v[248:251]
    v_and_b32 v25, s57, v25
    v_lshlrev_b32 v28, 16, v25
    v_and_b32 v29, 0xffff0000, v25
    v_mfma_f32_16x16x32_bf16 v[252:255], a[108:111], v[76:79], v[252:255]
    ds_write_b128 v49, a[148:151] offset:5120
    s_waitcnt lgkmcnt(10)
    v_mfma_f32_16x16x32_bf16 v[192:195], a[112:115], v[80:83], v[192:195]
    ds_read_b64_tr_b16 v[64:65], v8 offset:32768
    s_add_u32 s63, s64, 28672
    v_mfma_f32_16x16x32_bf16 v[196:199], a[116:119], v[80:83], v[196:199]
    ds_read_b64_tr_b16 v[66:67], v8 offset:33280
    buffer_load_dwordx4 v[176:179], v2, s[24:27], s63 offen offset:0 sc1
    v_mfma_f32_16x16x32_bf16 v[224:227], a[120:123], v[80:83], v[224:227]
    v_fmac_f32 v30, v28, v28
    v_fmac_f32 v31, v29, v29
    v_and_b32 v26, s57, v26
    v_mfma_f32_16x16x32_bf16 v[228:231], a[124:127], v[80:83], v[228:231]
    ds_write_b128 v49, a[152:155] offset:6144
    s_waitcnt lgkmcnt(10)
    v_mfma_f32_16x16x32_bf16 v[200:203], a[112:115], v[84:87], v[200:203]
    ds_read_b64_tr_b16 v[68:69], v9 offset:32768
    buffer_load_dwordx4 v[180:183], v2, s[24:27], s63 offen offset:1024 sc1
    v_mfma_f32_16x16x32_bf16 v[204:207], a[116:119], v[84:87], v[204:207]
    ds_read_b64_tr_b16 v[70:71], v9 offset:33280
    v_lshlrev_b32 v28, 16, v26
    v_mfma_f32_16x16x32_bf16 v[232:235], a[120:123], v[84:87], v[232:235]
    v_and_b32 v29, 0xffff0000, v26
    v_fmac_f32 v30, v28, v28
    v_fmac_f32 v31, v29, v29
    v_mfma_f32_16x16x32_bf16 v[236:239], a[124:127], v[84:87], v[236:239]
    ds_write_b128 v49, a[156:159] offset:7168
    s_waitcnt lgkmcnt(10)
    v_mfma_f32_16x16x32_bf16 v[208:211], a[112:115], v[88:91], v[208:211]
    ds_read_b64_tr_b16 v[72:73], v10 offset:32768
    buffer_load_dwordx4 v[184:187], v2, s[24:27], s63 offen offset:2048 sc1
    v_mfma_f32_16x16x32_bf16 v[212:215], a[116:119], v[88:91], v[212:215]
    ds_read_b64_tr_b16 v[74:75], v10 offset:33280
    v_and_b32 v27, s57, v27
    v_mfma_f32_16x16x32_bf16 v[240:243], a[120:123], v[88:91], v[240:243]
    v_lshlrev_b32 v28, 16, v27
    v_and_b32 v29, 0xffff0000, v27
    v_fmac_f32 v30, v28, v28
    v_mfma_f32_16x16x32_bf16 v[244:247], a[124:127], v[88:91], v[244:247]
    ds_write_b128 v49, a[160:163] offset:8192
    s_waitcnt lgkmcnt(10)
    v_mfma_f32_16x16x32_bf16 v[216:219], a[112:115], v[92:95], v[216:219]
    ds_read_b64_tr_b16 v[76:77], v11 offset:32768
    buffer_load_dwordx4 v[188:191], v2, s[24:27], s63 offen offset:3072 sc1
    v_mfma_f32_16x16x32_bf16 v[220:223], a[116:119], v[92:95], v[220:223]
    ds_read_b64_tr_b16 v[78:79], v11 offset:33280
    v_fmac_f32 v31, v29, v29
    v_mfma_f32_16x16x32_bf16 v[248:251], a[120:123], v[92:95], v[248:251]
    v_add_f32 v30, v30, v31
    v_mov_b32 v31, v30
    s_nop 0
    v_mfma_f32_16x16x32_bf16 v[252:255], a[124:127], v[92:95], v[252:255]
    ds_write_b128 v49, a[164:167] offset:9216
    s_waitcnt lgkmcnt(10)
    v_mfma_f32_16x16x32_bf16 v[192:195], a[128:131], v[64:67], v[192:195]
    ds_read_b64_tr_b16 v[80:81], v8 offset:36864
    s_add_u32 s63, s64, 32768
    v_mfma_f32_16x16x32_bf16 v[196:199], a[132:135], v[64:67], v[196:199]
    ds_read_b64_tr_b16 v[82:83], v8 offset:37376
    buffer_load_dwordx4 a[32:35], v2, s[24:27], s63 offen offset:0 sc1
    v_mfma_f32_16x16x32_bf16 v[224:227], a[136:139], v[64:67], v[224:227]
    v_permlane32_swap_b32 v30, v31
    v_add_f32 v30, v30, v31
    s_mov_b32 exec_hi, 0
    buffer_atomic_add_f32 v30, v48, s[24:27], s44 offen sc1
    s_mov_b32 exec_hi, -1
    v_mfma_f32_16x16x32_bf16 v[228:231], a[140:143], v[64:67], v[228:231]
    ds_write_b128 v49, a[168:171] offset:10240
    s_waitcnt lgkmcnt(10)
    v_mfma_f32_16x16x32_bf16 v[200:203], a[128:131], v[68:71], v[200:203]
    ds_read_b64_tr_b16 v[84:85], v9 offset:36864
    buffer_load_dwordx4 a[36:39], v2, s[24:27], s63 offen offset:1024 sc1
    v_mfma_f32_16x16x32_bf16 v[204:207], a[132:135], v[68:71], v[204:207]
    ds_read_b64_tr_b16 v[86:87], v9 offset:37376
    v_mfma_f32_16x16x32_bf16 v[232:235], a[136:139], v[68:71], v[232:235]
    v_mfma_f32_16x16x32_bf16 v[236:239], a[140:143], v[68:71], v[236:239]
    ds_write_b128 v49, a[172:175] offset:11264
    s_waitcnt lgkmcnt(10)
    v_mfma_f32_16x16x32_bf16 v[208:211], a[128:131], v[72:75], v[208:211]
    ds_read_b64_tr_b16 v[88:89], v10 offset:36864
    buffer_load_dwordx4 a[40:43], v2, s[24:27], s63 offen offset:2048 sc1
    v_mfma_f32_16x16x32_bf16 v[212:215], a[132:135], v[72:75], v[212:215]
    ds_read_b64_tr_b16 v[90:91], v10 offset:37376
    v_mfma_f32_16x16x32_bf16 v[240:243], a[136:139], v[72:75], v[240:243]
    v_mfma_f32_16x16x32_bf16 v[244:247], a[140:143], v[72:75], v[244:247]
    ds_write_b128 v49, a[176:179] offset:12288
    s_waitcnt lgkmcnt(10)
    v_mfma_f32_16x16x32_bf16 v[216:219], a[128:131], v[76:79], v[216:219]
    ds_read_b64_tr_b16 v[92:93], v11 offset:36864
    buffer_load_dwordx4 a[44:47], v2, s[24:27], s63 offen offset:3072 sc1
    v_mfma_f32_16x16x32_bf16 v[220:223], a[132:135], v[76:79], v[220:223]
    ds_read_b64_tr_b16 v[94:95], v11 offset:37376
    v_mfma_f32_16x16x32_bf16 v[248:251], a[136:139], v[76:79], v[248:251]
    v_mfma_f32_16x16x32_bf16 v[252:255], a[140:143], v[76:79], v[252:255]
    ds_write_b128 v49, a[180:183] offset:13312
    s_waitcnt lgkmcnt(10)
    v_mfma_f32_16x16x32_bf16 v[192:195], a[144:147], v[80:83], v[192:195]
    ds_read_b64_tr_b16 v[64:65], v8 offset:40960
    s_add_u32 s63, s64, 36864
    v_mfma_f32_16x16x32_bf16 v[196:199], a[148:151], v[80:83], v[196:199]
    ds_read_b64_tr_b16 v[66:67], v8 offset:41472
    buffer_load_dwordx4 a[48:51], v2, s[24:27], s63 offen offset:0 sc1
    v_mfma_f32_16x16x32_bf16 v[224:227], a[152:155], v[80:83], v[224:227]
    v_mfma_f32_16x16x32_bf16 v[228:231], a[156:159], v[80:83], v[228:231]
    ds_write_b128 v49, a[184:187] offset:14336
    s_waitcnt lgkmcnt(10)
    v_mfma_f32_16x16x32_bf16 v[200:203], a[144:147], v[84:87], v[200:203]
    ds_read_b64_tr_b16 v[68:69], v9 offset:40960
    buffer_load_dwordx4 a[52:55], v2, s[24:27], s63 offen offset:1024 sc1
    v_mfma_f32_16x16x32_bf16 v[204:207], a[148:151], v[84:87], v[204:207]
    ds_read_b64_tr_b16 v[70:71], v9 offset:41472
    v_mfma_f32_16x16x32_bf16 v[232:235], a[152:155], v[84:87], v[232:235]
    v_mfma_f32_16x16x32_bf16 v[236:239], a[156:159], v[84:87], v[236:239]
    ds_write_b128 v49, a[188:191] offset:15360
    s_waitcnt lgkmcnt(10)
    v_mfma_f32_16x16x32_bf16 v[208:211], a[144:147], v[88:91], v[208:211]
    ds_read_b64_tr_b16 v[72:73], v10 offset:40960
    buffer_load_dwordx4 a[56:59], v2, s[24:27], s63 offen offset:2048 sc1
    v_mfma_f32_16x16x32_bf16 v[212:215], a[148:151], v[88:91], v[212:215]
    ds_read_b64_tr_b16 v[74:75], v10 offset:41472
    v_mfma_f32_16x16x32_bf16 v[240:243], a[152:155], v[88:91], v[240:243]
    v_mfma_f32_16x16x32_bf16 v[244:247], a[156:159], v[88:91], v[244:247]
    s_waitcnt lgkmcnt(9)
    v_mfma_f32_16x16x32_bf16 v[216:219], a[144:147], v[92:95], v[216:219]
    ds_read_b64_tr_b16 v[76:77], v11 offset:40960
    buffer_load_dwordx4 a[60:63], v2, s[24:27], s63 offen offset:3072 sc1
    v_mfma_f32_16x16x32_bf16 v[220:223], a[148:151], v[92:95], v[220:223]
    ds_read_b64_tr_b16 v[78:79], v11 offset:41472
    v_mfma_f32_16x16x32_bf16 v[248:251], a[152:155], v[92:95], v[248:251]
    v_mfma_f32_16x16x32_bf16 v[252:255], a[156:159], v[92:95], v[252:255]
    buffer_load_dword v57, v14, s[24:27], s42 offen sc1
    s_waitcnt lgkmcnt(8)
    v_mfma_f32_16x16x32_bf16 v[192:195], a[160:163], v[64:67], v[192:195]
    ds_read_b64_tr_b16 v[80:81], v8 offset:45056
    s_add_u32 s63, s64, 40960
    v_mfma_f32_16x16x32_bf16 v[196:199], a[164:167], v[64:67], v[196:199]
    ds_read_b64_tr_b16 v[82:83], v8 offset:45568
    buffer_load_dwordx4 a[64:67], v2, s[24:27], s63 offen offset:0 sc1
    v_mfma_f32_16x16x32_bf16 v[224:227], a[168:171], v[64:67], v[224:227]
    v_mfma_f32_16x16x32_bf16 v[228:231], a[172:175], v[64:67], v[228:231]
    s_waitcnt lgkmcnt(7)
    v_mfma_f32_16x16x32_bf16 v[200:203], a[160:163], v[68:71], v[200:203]
    ds_read_b64_tr_b16 v[84:85], v9 offset:45056
    buffer_load_dwordx4 a[68:71], v2, s[24:27], s63 offen offset:1024 sc1
    v_mfma_f32_16x16x32_bf16 v[204:207], a[164:167], v[68:71], v[204:207]
    ds_read_b64_tr_b16 v[86:87], v9 offset:45568
    v_mfma_f32_16x16x32_bf16 v[232:235], a[168:171], v[68:71], v[232:235]
    v_mfma_f32_16x16x32_bf16 v[236:239], a[172:175], v[68:71], v[236:239]
    s_waitcnt lgkmcnt(6)
    v_mfma_f32_16x16x32_bf16 v[208:211], a[160:163], v[72:75], v[208:211]
    ds_read_b64_tr_b16 v[88:89], v10 offset:45056
    buffer_load_dwordx4 a[72:75], v2, s[24:27], s63 offen offset:2048 sc1
    v_mfma_f32_16x16x32_bf16 v[212:215], a[164:167], v[72:75], v[212:215]
    ds_read_b64_tr_b16 v[90:91], v10 offset:45568
    v_mfma_f32_16x16x32_bf16 v[240:243], a[168:171], v[72:75], v[240:243]
    v_mfma_f32_16x16x32_bf16 v[244:247], a[172:175], v[72:75], v[244:247]
    s_waitcnt lgkmcnt(6)
    v_mfma_f32_16x16x32_bf16 v[216:219], a[160:163], v[76:79], v[216:219]
    ds_read_b64_tr_b16 v[92:93], v11 offset:45056
    buffer_load_dwordx4 a[76:79], v2, s[24:27], s63 offen offset:3072 sc1
    v_mfma_f32_16x16x32_bf16 v[220:223], a[164:167], v[76:79], v[220:223]
    ds_read_b64_tr_b16 v[94:95], v11 offset:45568
    v_mfma_f32_16x16x32_bf16 v[248:251], a[168:171], v[76:79], v[248:251]
    v_mfma_f32_16x16x32_bf16 v[252:255], a[172:175], v[76:79], v[252:255]
    s_waitcnt lgkmcnt(6)
    v_mfma_f32_16x16x32_bf16 v[192:195], a[176:179], v[80:83], v[192:195]
    ds_read_b64_tr_b16 v[64:65], v8 offset:49152
    s_add_u32 s63, s64, 45056
    v_mfma_f32_16x16x32_bf16 v[196:199], a[180:183], v[80:83], v[196:199]
    ds_read_b64_tr_b16 v[66:67], v8 offset:49664
    buffer_load_dwordx4 a[80:83], v2, s[24:27], s63 offen offset:0 sc1
    v_mfma_f32_16x16x32_bf16 v[224:227], a[184:187], v[80:83], v[224:227]
    v_mfma_f32_16x16x32_bf16 v[228:231], a[188:191], v[80:83], v[228:231]
    s_waitcnt lgkmcnt(6)
    v_mfma_f32_16x16x32_bf16 v[200:203], a[176:179], v[84:87], v[200:203]
    ds_read_b64_tr_b16 v[68:69], v8 offset:53248
    buffer_load_dwordx4 a[84:87], v2, s[24:27], s63 offen offset:1024 sc1
    v_mfma_f32_16x16x32_bf16 v[204:207], a[180:183], v[84:87], v[204:207]
    ds_read_b64_tr_b16 v[70:71], v8 offset:53760
    v_mfma_f32_16x16x32_bf16 v[232:235], a[184:187], v[84:87], v[232:235]
    v_mfma_f32_16x16x32_bf16 v[236:239], a[188:191], v[84:87], v[236:239]
    s_waitcnt lgkmcnt(6)
    v_mfma_f32_16x16x32_bf16 v[208:211], a[176:179], v[88:91], v[208:211]
    ds_read_b64_tr_b16 v[72:73], v8 offset:57344
    buffer_load_dwordx4 a[88:91], v2, s[24:27], s63 offen offset:2048 sc1
    v_mfma_f32_16x16x32_bf16 v[212:215], a[180:183], v[88:91], v[212:215]
    ds_read_b64_tr_b16 v[74:75], v8 offset:57856
    v_mfma_f32_16x16x32_bf16 v[240:243], a[184:187], v[88:91], v[240:243]
    v_mfma_f32_16x16x32_bf16 v[244:247], a[188:191], v[88:91], v[244:247]
    s_waitcnt lgkmcnt(6)
    v_mfma_f32_16x16x32_bf16 v[216:219], a[176:179], v[92:95], v[216:219]
    ds_read_b64_tr_b16 v[76:77], v8 offset:61440
    buffer_load_dwordx4 a[92:95], v2, s[24:27], s63 offen offset:3072 sc1
    v_mfma_f32_16x16x32_bf16 v[220:223], a[180:183], v[92:95], v[220:223]
    ds_read_b64_tr_b16 v[78:79], v8 offset:61952
    v_mfma_f32_16x16x32_bf16 v[248:251], a[184:187], v[92:95], v[248:251]
    v_mfma_f32_16x16x32_bf16 v[252:255], a[188:191], v[92:95], v[252:255]
    s_waitcnt lgkmcnt(6)
    v_mfma_f32_16x16x32_bf16 v[192:195], a[192:195], v[64:67], v[192:195]
    ds_read_b64_tr_b16 v[80:81], v9 offset:49152
    v_mfma_f32_16x16x32_bf16 v[196:199], a[196:199], v[64:67], v[196:199]
    ds_read_b64_tr_b16 v[82:83], v9 offset:49664
    v_mfma_f32_16x16x32_bf16 v[224:227], a[200:203], v[64:67], v[224:227]
    v_mfma_f32_16x16x32_bf16 v[228:231], a[204:207], v[64:67], v[228:231]
    s_waitcnt lgkmcnt(6)
    v_mfma_f32_16x16x32_bf16 v[192:195], a[208:211], v[68:71], v[192:195]
    ds_read_b64_tr_b16 v[84:85], v9 offset:53248
    v_mfma_f32_16x16x32_bf16 v[196:199], a[212:215], v[68:71], v[196:199]
    ds_read_b64_tr_b16 v[86:87], v9 offset:53760
    v_mfma_f32_16x16x32_bf16 v[224:227], a[216:219], v[68:71], v[224:227]
    v_mfma_f32_16x16x32_bf16 v[228:231], a[220:223], v[68:71], v[228:231]
    s_waitcnt vmcnt(8)
    v_cmp_gt_u32 vcc, 14, v57
    s_cbranch_vccnz Lck28
Lcb29:
    s_waitcnt lgkmcnt(6)
    v_mfma_f32_16x16x32_bf16 v[192:195], a[224:227], v[72:75], v[192:195]
    ds_read_b64_tr_b16 v[88:89], v9 offset:57344
    s_add_u32 s47, s65, 0
    v_mfma_f32_16x16x32_bf16 v[196:199], a[228:231], v[72:75], v[196:199]
    ds_read_b64_tr_b16 v[90:91], v9 offset:57856
    buffer_load_dwordx4 a[96:99], v2, s[24:27], s47 offen offset:0 sc1
    v_mfma_f32_16x16x32_bf16 v[224:227], a[232:235], v[72:75], v[224:227]
    v_mfma_f32_16x16x32_bf16 v[228:231], a[236:239], v[72:75], v[228:231]
    s_waitcnt lgkmcnt(6)
    v_mfma_f32_16x16x32_bf16 v[192:195], a[240:243], v[76:79], v[192:195]
    ds_read_b64_tr_b16 v[92:93], v9 offset:61440
    buffer_load_dwordx4 a[100:103], v2, s[24:27], s47 offen offset:1024 sc1
    v_mfma_f32_16x16x32_bf16 v[196:199], a[244:247], v[76:79], v[196:199]
    ds_read_b64_tr_b16 v[94:95], v9 offset:61952
    v_mfma_f32_16x16x32_bf16 v[224:227], a[248:251], v[76:79], v[224:227]
    v_mfma_f32_16x16x32_bf16 v[228:231], a[252:255], v[76:79], v[228:231]
    s_waitcnt lgkmcnt(6)
    v_mfma_f32_16x16x32_bf16 v[200:203], a[192:195], v[80:83], v[200:203]
    ds_read_b64_tr_b16 v[64:65], v10 offset:49152
    s_add_u32 s63, s64, 49152
    v_mfma_f32_16x16x32_bf16 v[204:207], a[196:199], v[80:83], v[204:207]
    ds_read_b64_tr_b16 v[66:67], v10 offset:49664
    buffer_load_dwordx4 a[104:107], v2, s[24:27], s63 offen offset:0 sc1
    v_mfma_f32_16x16x32_bf16 v[232:235], a[200:203], v[80:83], v[232:235]
    v_mfma_f32_16x16x32_bf16 v[236:239], a[204:207], v[80:83], v[236:239]
    s_waitcnt lgkmcnt(6)
    v_mfma_f32_16x16x32_bf16 v[200:203], a[208:211], v[84:87], v[200:203]
    ds_read_b64_tr_b16 v[68:69], v10 offset:53248
    buffer_load_dwordx4 a[108:111], v2, s[24:27], s63 offen offset:1024 sc1
    v_mfma_f32_16x16x32_bf16 v[204:207], a[212:215], v[84:87], v[204:207]
    ds_read_b64_tr_b16 v[70:71], v10 offset:53760
    v_max_f32 v192, 0, v192
    v_mfma_f32_16x16x32_bf16 v[232:235], a[216:219], v[84:87], v[232:235]
    v_max_f32 v193, 0, v193
    v_mul_f32 v192, v224, v192
    v_mul_f32 v193, v225, v193
    v_mfma_f32_16x16x32_bf16 v[236:239], a[220:223], v[84:87], v[236:239]
    v_cvt_pk_bf16_f32 v32, v192, v193
    s_waitcnt lgkmcnt(6)
    v_mfma_f32_16x16x32_bf16 v[200:203], a[224:227], v[88:91], v[200:203]
    ds_read_b64_tr_b16 v[72:73], v10 offset:57344
    buffer_load_dwordx4 a[112:115], v2, s[24:27], s47 offen offset:2048 sc1
    v_mfma_f32_16x16x32_bf16 v[204:207], a[228:231], v[88:91], v[204:207]
    ds_read_b64_tr_b16 v[74:75], v10 offset:57856
    v_max_f32 v194, 0, v194
    v_mfma_f32_16x16x32_bf16 v[232:235], a[232:235], v[88:91], v[232:235]
    v_max_f32 v195, 0, v195
    v_mul_f32 v194, v226, v194
    v_mul_f32 v195, v227, v195
    v_mfma_f32_16x16x32_bf16 v[236:239], a[236:239], v[88:91], v[236:239]
    v_cvt_pk_bf16_f32 v33, v194, v195
    s_waitcnt lgkmcnt(6)
    v_mfma_f32_16x16x32_bf16 v[200:203], a[240:243], v[92:95], v[200:203]
    ds_read_b64_tr_b16 v[76:77], v10 offset:61440
    buffer_load_dwordx4 a[116:119], v2, s[24:27], s47 offen offset:3072 sc1
    v_mfma_f32_16x16x32_bf16 v[204:207], a[244:247], v[92:95], v[204:207]
    ds_read_b64_tr_b16 v[78:79], v10 offset:61952
    v_max_f32 v196, 0, v196
    v_mfma_f32_16x16x32_bf16 v[232:235], a[248:251], v[92:95], v[232:235]
    v_max_f32 v197, 0, v197
    v_mul_f32 v196, v228, v196
    v_mul_f32 v197, v229, v197
    v_mfma_f32_16x16x32_bf16 v[236:239], a[252:255], v[92:95], v[236:239]
    v_cvt_pk_bf16_f32 v34, v196, v197
    s_waitcnt lgkmcnt(6)
    v_mfma_f32_16x16x32_bf16 v[208:211], a[192:195], v[64:67], v[208:211]
    ds_read_b64_tr_b16 v[80:81], v11 offset:49152
    s_add_u32 s63, s64, 49152
    v_mfma_f32_16x16x32_bf16 v[212:215], a[196:199], v[64:67], v[212:215]
    ds_read_b64_tr_b16 v[82:83], v11 offset:49664
    buffer_load_dwordx4 a[120:123], v2, s[24:27], s63 offen offset:2048 sc1
    v_mfma_f32_16x16x32_bf16 v[240:243], a[200:203], v[64:67], v[240:243]
    v_max_f32 v198, 0, v198
    v_max_f32 v199, 0, v199
    v_mul_f32 v198, v230, v198
    v_mfma_f32_16x16x32_bf16 v[244:247], a[204:207], v[64:67], v[244:247]
    v_mul_f32 v199, v231, v199
    s_waitcnt lgkmcnt(6)
    v_mfma_f32_16x16x32_bf16 v[208:211], a[208:211], v[68:71], v[208:211]
    ds_read_b64_tr_b16 v[84:85], v11 offset:53248
    buffer_load_dwordx4 a[124:127], v2, s[24:27], s63 offen offset:3072 sc1
    v_mfma_f32_16x16x32_bf16 v[212:215], a[212:215], v[68:71], v[212:215]
    ds_read_b64_tr_b16 v[86:87], v11 offset:53760
    v_cvt_pk_bf16_f32 v35, v198, v199
    v_mfma_f32_16x16x32_bf16 v[240:243], a[216:219], v[68:71], v[240:243]
    buffer_store_dwordx4 v[32:35], v50, s[24:27], s34 offen offset:0 sc1
    v_max_f32 v200, 0, v200
    v_max_f32 v201, 0, v201
    v_mfma_f32_16x16x32_bf16 v[244:247], a[220:223], v[68:71], v[244:247]
    v_mul_f32 v200, v232, v200
    s_waitcnt lgkmcnt(6)
    v_mfma_f32_16x16x32_bf16 v[208:211], a[224:227], v[72:75], v[208:211]
    ds_read_b64_tr_b16 v[88:89], v11 offset:57344
    s_add_u32 s47, s65, 4096
    v_mfma_f32_16x16x32_bf16 v[212:215], a[228:231], v[72:75], v[212:215]
    ds_read_b64_tr_b16 v[90:91], v11 offset:57856
    buffer_load_dwordx4 a[128:131], v2, s[24:27], s47 offen offset:0 sc1
    v_mfma_f32_16x16x32_bf16 v[240:243], a[232:235], v[72:75], v[240:243]
    v_mul_f32 v201, v233, v201
    v_cvt_pk_bf16_f32 v36, v200, v201
    v_max_f32 v202, 0, v202
    v_mfma_f32_16x16x32_bf16 v[244:247], a[236:239], v[72:75], v[244:247]
    v_max_f32 v203, 0, v203
    s_waitcnt lgkmcnt(6)
    v_mfma_f32_16x16x32_bf16 v[208:211], a[240:243], v[76:79], v[208:211]
    ds_read_b64_tr_b16 v[92:93], v11 offset:61440
    buffer_load_dwordx4 a[132:135], v2, s[24:27], s47 offen offset:1024 sc1
    v_mfma_f32_16x16x32_bf16 v[212:215], a[244:247], v[76:79], v[212:215]
    ds_read_b64_tr_b16 v[94:95], v11 offset:61952
    v_mul_f32 v202, v234, v202
    v_mfma_f32_16x16x32_bf16 v[240:243], a[248:251], v[76:79], v[240:243]
    v_mul_f32 v203, v235, v203
    v_cvt_pk_bf16_f32 v37, v202, v203
    v_max_f32 v204, 0, v204
    v_mfma_f32_16x16x32_bf16 v[244:247], a[252:255], v[76:79], v[244:247]
    v_max_f32 v205, 0, v205
    s_waitcnt lgkmcnt(6)
    v_mfma_f32_16x16x32_bf16 v[216:219], a[192:195], v[80:83], v[216:219]
    s_add_u32 s63, s64, 53248
    buffer_load_dwordx4 a[136:139], v2, s[24:27], s63 offen offset:0 sc1
    v_mfma_f32_16x16x32_bf16 v[220:223], a[196:199], v[80:83], v[220:223]
    v_mul_f32 v204, v236, v204
    v_mul_f32 v205, v237, v205
    v_mfma_f32_16x16x32_bf16 v[248:251], a[200:203], v[80:83], v[248:251]
    v_cvt_pk_bf16_f32 v38, v204, v205
    v_max_f32 v206, 0, v206
    v_max_f32 v207, 0, v207
    v_mfma_f32_16x16x32_bf16 v[252:255], a[204:207], v[80:83], v[252:255]
    v_mul_f32 v206, v238, v206
    s_waitcnt lgkmcnt(4)
    v_mfma_f32_16x16x32_bf16 v[216:219], a[208:211], v[84:87], v[216:219]
    buffer_load_dwordx4 a[140:143], v2, s[24:27], s63 offen offset:1024 sc1
    v_mul_f32 v207, v239, v207
    v_mfma_f32_16x16x32_bf16 v[220:223], a[212:215], v[84:87], v[220:223]
    v_cvt_pk_bf16_f32 v39, v206, v207
    buffer_store_dwordx4 v[36:39], v50, s[24:27], s34 offen offset:256 sc1
    v_mfma_f32_16x16x32_bf16 v[248:251], a[216:219], v[84:87], v[248:251]
    v_max_f32 v208, 0, v208
    v_max_f32 v209, 0, v209
    v_mul_f32 v208, v240, v208
    v_mfma_f32_16x16x32_bf16 v[252:255], a[220:223], v[84:87], v[252:255]
    v_mul_f32 v209, v241, v209
    s_waitcnt lgkmcnt(2)
    v_mfma_f32_16x16x32_bf16 v[216:219], a[224:227], v[88:91], v[216:219]
    buffer_load_dwordx4 a[144:147], v2, s[24:27], s47 offen offset:2048 sc1
    v_cvt_pk_bf16_f32 v40, v208, v209
    v_mfma_f32_16x16x32_bf16 v[220:223], a[228:231], v[88:91], v[220:223]
    v_max_f32 v210, 0, v210
    v_max_f32 v211, 0, v211
    v_mfma_f32_16x16x32_bf16 v[248:251], a[232:235], v[88:91], v[248:251]
    v_mul_f32 v210, v242, v210
    v_mul_f32 v211, v243, v211
    v_cvt_pk_bf16_f32 v41, v210, v211
    v_mfma_f32_16x16x32_bf16 v[252:255], a[236:239], v[88:91], v[252:255]
    v_max_f32 v212, 0, v212
    s_waitcnt lgkmcnt(0)
    v_mfma_f32_16x16x32_bf16 v[216:219], a[240:243], v[92:95], v[216:219]
    buffer_load_dwordx4 a[148:151], v2, s[24:27], s47 offen offset:3072 sc1
    v_max_f32 v213, 0, v213
    v_mfma_f32_16x16x32_bf16 v[220:223], a[244:247], v[92:95], v[220:223]
    v_mul_f32 v212, v244, v212
    v_mul_f32 v213, v245, v213
    v_mfma_f32_16x16x32_bf16 v[248:251], a[248:251], v[92:95], v[248:251]
    v_cvt_pk_bf16_f32 v42, v212, v213
    v_max_f32 v214, 0, v214
    v_max_f32 v215, 0, v215
    v_mfma_f32_16x16x32_bf16 v[252:255], a[252:255], v[92:95], v[252:255]
    v_mul_f32 v214, v246, v214
    v_mul_f32 v215, v247, v215
    v_cvt_pk_bf16_f32 v43, v214, v215
    buffer_store_dwordx4 v[40:43], v50, s[24:27], s35 offen offset:0 sc1
    v_max_f32 v216, 0, v216
    v_max_f32 v217, 0, v217
    v_mul_f32 v216, v248, v216
    v_mul_f32 v217, v249, v217
    v_cvt_pk_bf16_f32 v44, v216, v217
    v_max_f32 v218, 0, v218
    v_max_f32 v219, 0, v219
    v_mul_f32 v218, v250, v218
    v_mul_f32 v219, v251, v219
    v_cvt_pk_bf16_f32 v45, v218, v219
    v_max_f32 v220, 0, v220
    v_max_f32 v221, 0, v221
    v_mul_f32 v220, v252, v220
    v_mul_f32 v221, v253, v221
    v_cvt_pk_bf16_f32 v46, v220, v221
    v_max_f32 v222, 0, v222
    v_max_f32 v223, 0, v223
    v_mul_f32 v222, v254, v222
    v_mul_f32 v223, v255, v223
    v_cvt_pk_bf16_f32 v47, v222, v223
    buffer_store_dwordx4 v[44:47], v50, s[24:27], s35 offen offset:256 sc1
    s_add_u32 s63, s64, 53248
    buffer_load_dwordx4 a[152:155], v2, s[24:27], s63 offen offset:2048 sc1
    buffer_load_dwordx4 a[156:159], v2, s[24:27], s63 offen offset:3072 sc1
    s_add_u32 s47, s65, 8192
    buffer_load_dwordx4 a[160:163], v2, s[24:27], s47 offen offset:0 sc1
    buffer_load_dwordx4 a[164:167], v2, s[24:27], s47 offen offset:1024 sc1
    buffer_load_dwordx4 a[168:171], v2, s[24:27], s47 offen offset:2048 sc1
    buffer_load_dwordx4 a[172:175], v2, s[24:27], s47 offen offset:3072 sc1
    s_add_u32 s47, s65, 12288
    buffer_load_dwordx4 a[176:179], v2, s[24:27], s47 offen offset:0 sc1
    buffer_load_dwordx4 a[180:183], v2, s[24:27], s47 offen offset:1024 sc1
    s_waitcnt vmcnt(8)
    s_mov_b64 exec, 1
    buffer_atomic_add v15, v14, s[24:27], s36 offen sc1
    s_mov_b64 exec, -1
    s_barrier
    s_mov_b64 exec, 1
    buffer_atomic_add v15, v14, s[24:27], s41 offen sc1
    s_mov_b64 exec, -1
Lg1j25:
    s_waitcnt vmcnt(10)
    v_mfma_f32_32x32x16_bf16 v[192:207], a[96:99], v[96:99], 0
    buffer_load_dwordx4 a[184:187], v2, s[24:27], s47 offen offset:2048 sc1
    v_and_b32 v48, 15, v5
    v_and_b32 v49, 16, v1
    v_mfma_f32_32x32x16_bf16 v[208:223], a[96:99], v[100:103], 0
    buffer_load_dwordx4 a[188:191], v2, s[24:27], s47 offen offset:3072 sc1
    v_lshlrev_b32 v49, 1, v49
    v_lshl_or_b32 v49, v4, 4, v49
    v_mfma_f32_32x32x16_bf16 v[192:207], a[100:103], v[104:107], v[192:207]
    s_add_u32 s47, s65, 16384
    buffer_load_dwordx4 a[96:99], v2, s[24:27], s47 offen offset:0 sc1
    s_lshr_b32 s68, s55, 1
    v_mfma_f32_32x32x16_bf16 v[208:223], a[100:103], v[108:111], v[208:223]
    buffer_load_dwordx4 a[100:103], v2, s[24:27], s47 offen offset:1024 sc1
    s_lshl_b32 s68, s68, 2
    s_and_b32 s56, s55, 1
    v_mfma_f32_32x32x16_bf16 v[192:207], a[112:115], v[112:115], v[192:207]
    s_add_u32 s68, s68, s56
    s_lshl_b32 s56, s3, 13
    s_add_u32 s56, s56, 65536
    v_mfma_f32_32x32x16_bf16 v[208:223], a[112:115], v[116:119], v[208:223]
    buffer_load_dwordx4 a[112:115], v2, s[24:27], s47 offen offset:2048 sc1
    v_add_u32 v50, s56, v2
    v_and_b32 v52, 0x2f0, v2
    v_mfma_f32_32x32x16_bf16 v[192:207], a[116:119], v[120:123], v[192:207]
    v_and_b32 v53, 16, v1
    v_lshl_or_b32 v54, v53, 6, v52
    v_lshl_or_b32 v52, v53, 7, v52
    v_mfma_f32_32x32x16_bf16 v[208:223], a[116:119], v[124:127], v[208:223]
    buffer_load_dwordx4 a[116:119], v2, s[24:27], s47 offen offset:3072 sc1
    s_lshl_b32 s56, s67, 12
    s_lshl_b32 s57, s66, 8
    v_mfma_f32_32x32x16_bf16 v[192:207], a[128:131], a[0:3], v[192:207]
    s_add_u32 s56, s56, s57
    s_add_u32 s56, s56, 65536
    v_add_u32 v52, s56, v52
    v_mfma_f32_32x32x16_bf16 v[208:223], a[128:131], a[4:7], v[208:223]
    s_add_u32 s47, s65, 20480
    buffer_load_dwordx4 a[128:131], v2, s[24:27], s47 offen offset:0 sc1
    s_lshl_b32 s56, s54, 6
    v_mfma_f32_32x32x16_bf16 v[192:207], a[132:135], a[8:11], v[192:207]
    s_lshl_b32 s57, s67, 5
    s_add_u32 s56, s56, s57
    s_lshl_b32 s57, s66, 4
    v_mfma_f32_32x32x16_bf16 v[208:223], a[132:135], a[12:15], v[208:223]
    buffer_load_dwordx4 a[132:135], v2, s[24:27], s47 offen offset:1024 sc1
    s_add_u32 s56, s56, s57
    v_add_u32 v53, s56, v48
    v_mfma_f32_32x32x16_bf16 v[192:207], a[144:147], a[16:19], v[192:207]
    v_lshl_add_u32 v8, v53, 12, v49
    v_cmp_ne_u32 s[4:5], 1, v53
    s_lshl_b32 s69, s68, 6
    v_mfma_f32_32x32x16_bf16 v[208:223], a[144:147], a[20:23], v[208:223]
    buffer_load_dwordx4 a[144:147], v2, s[24:27], s47 offen offset:2048 sc1
    s_add_u32 s56, s69, 0x0
    s_add_u32 s57, s69, 0x400000
    v_mfma_f32_32x32x16_bf16 v[192:207], a[148:151], a[24:27], v[192:207]
    buffer_load_dwordx4 v[16:19], v8, s[24:27], s56 offen offset:0 sc1
    buffer_load_dwordx4 v[24:27], v8, s[24:27], s57 offen offset:0 sc1
    buffer_load_dwordx4 v[20:23], v8, s[24:27], s56 offen offset:128 sc1
    v_mfma_f32_32x32x16_bf16 v[208:223], a[148:151], a[28:31], v[208:223]
    buffer_load_dwordx4 a[148:151], v2, s[24:27], s47 offen offset:3072 sc1
    buffer_load_dwordx4 v[28:31], v8, s[24:27], s57 offen offset:128 sc1
    s_add_u32 s58, s69, 0x600000
    s_waitcnt vmcnt(21)
    v_mfma_f32_32x32x16_bf16 v[192:207], a[160:163], v[128:131], v[192:207]
    v_lshlrev_b32 v9, 1, v49
    s_lshl_b32 s59, s68, 7
    s_add_u32 s60, s59, 0x2004000
    v_mfma_f32_32x32x16_bf16 v[208:223], a[160:163], v[132:135], v[208:223]
    s_add_u32 s47, s65, 24576
    buffer_load_dwordx4 a[160:163], v2, s[24:27], s47 offen offset:0 sc1
    s_add_u32 s59, s59, 0x2002000
    s_waitcnt vmcnt(21)
    v_mfma_f32_32x32x16_bf16 v[192:207], a[164:167], v[136:139], v[192:207]
    v_lshrrev_b32 v55, 1, v1
    v_and_b32 v55, 6, v55
    v_and_b32 v53, 1, v1
    v_mfma_f32_32x32x16_bf16 v[208:223], a[164:167], v[140:143], v[208:223]
    buffer_load_dwordx4 a[164:167], v2, s[24:27], s47 offen offset:1024 sc1
    v_or_b32 v55, v55, v53
    v_lshl_add_u32 v10, v55, 2, v9
    s_waitcnt vmcnt(21)
    v_mfma_f32_32x32x16_bf16 v[192:207], a[168:171], v[144:147], v[192:207]
    v_cmp_eq_u32 s[6:7], 1, v53
    s_lshl_b32 s56, s3, 7
    s_add_u32 s56, s56, 131072
    v_mfma_f32_32x32x16_bf16 v[208:223], a[168:171], v[148:151], v[208:223]
    buffer_load_dwordx4 a[168:171], v2, s[24:27], s47 offen offset:2048 sc1
    v_add_u32 v12, s56, v10
    v_lshlrev_b32 v55, 2, v1
    s_waitcnt vmcnt(21)
    v_mfma_f32_32x32x16_bf16 v[192:207], a[172:175], v[152:155], v[192:207]
    v_add_u32 v13, 131072, v55
    s_add_u32 s61, s60, 256
    s_cmp_lg_u32 s3, 0
    s_cselect_b32 s61, 0x4000000, s61
    v_mfma_f32_32x32x16_bf16 v[208:223], a[172:175], v[156:159], v[208:223]
    buffer_load_dwordx4 a[172:175], v2, s[24:27], s47 offen offset:3072 sc1
    s_waitcnt vmcnt(21)
    v_mfma_f32_32x32x16_bf16 v[192:207], a[176:179], v[160:163], v[192:207]
    v_mfma_f32_32x32x16_bf16 v[208:223], a[176:179], v[164:167], v[208:223]
    s_waitcnt vmcnt(20)
    buffer_load_dword v57, v14, s[24:27], s37 offen sc1
    v_mfma_f32_32x32x16_bf16 v[192:207], a[180:183], v[168:171], v[192:207]
    v_mfma_f32_32x32x16_bf16 v[208:223], a[180:183], v[172:175], v[208:223]
    s_waitcnt vmcnt(18)
    v_mfma_f32_32x32x16_bf16 v[192:207], a[184:187], v[176:179], v[192:207]
    v_mfma_f32_32x32x16_bf16 v[208:223], a[184:187], v[180:183], v[208:223]
    s_waitcnt vmcnt(17)
    v_mfma_f32_32x32x16_bf16 v[192:207], a[188:191], v[184:187], v[192:207]
    v_mfma_f32_32x32x16_bf16 v[208:223], a[188:191], v[188:191], v[208:223]
    s_waitcnt vmcnt(16)
    v_mfma_f32_32x32x16_bf16 v[192:207], a[96:99], a[32:35], v[192:207]
    v_mfma_f32_32x32x16_bf16 v[208:223], a[96:99], a[36:39], v[208:223]
    s_waitcnt vmcnt(15)
    s_waitcnt vmcnt(0)
    v_cmp_gt_u32 vcc, 14, v57
    s_cbranch_vccz Lcb30
    s_mov_b32 m0, 0
Lcp31:
    s_sleep 3
    buffer_load_dword v57, v14, s[24:27], s37 offen sc1
    s_add_u32 m0, m0, 1
    s_cmp_gt_u32 m0, 400000
    s_cbranch_scc1 Lcb30
    s_waitcnt vmcnt(0)
    v_cmp_gt_u32 vcc, 14, v57
    s_cbranch_vccnz Lcp31
Lcb30:
    v_mfma_f32_32x32x16_bf16 v[192:207], a[100:103], a[40:43], v[192:207]
    s_add_u32 s47, s65, 3670016
    buffer_load_dwordx4 a[176:179], v2, s[24:27], s47 offen offset:0 sc1
    v_mfma_f32_32x32x16_bf16 v[208:223], a[100:103], a[44:47], v[208:223]
    buffer_load_dwordx4 a[180:183], v2, s[24:27], s47 offen offset:1024 sc1
    v_mfma_f32_32x32x16_bf16 v[192:207], a[112:115], a[48:51], v[192:207]
    buffer_load_dwordx4 a[184:187], v2, s[24:27], s47 offen offset:2048 sc1
    v_mfma_f32_32x32x16_bf16 v[208:223], a[112:115], a[52:55], v[208:223]
    buffer_load_dwordx4 a[188:191], v2, s[24:27], s47 offen offset:3072 sc1
    v_mfma_f32_32x32x16_bf16 v[192:207], a[116:119], a[56:59], v[192:207]
    s_add_u32 s47, s65, 3674112
    buffer_load_dwordx4 a[96:99], v2, s[24:27], s47 offen offset:0 sc1
    v_mfma_f32_32x32x16_bf16 v[208:223], a[116:119], a[60:63], v[208:223]
    buffer_load_dwordx4 a[100:103], v2, s[24:27], s47 offen offset:1024 sc1
    v_mfma_f32_32x32x16_bf16 v[192:207], a[128:131], a[64:67], v[192:207]
    buffer_load_dwordx4 a[112:115], v2, s[24:27], s47 offen offset:2048 sc1
    v_mfma_f32_32x32x16_bf16 v[208:223], a[128:131], a[68:71], v[208:223]
    buffer_load_dwordx4 a[116:119], v2, s[24:27], s47 offen offset:3072 sc1
    v_mfma_f32_32x32x16_bf16 v[192:207], a[132:135], a[72:75], v[192:207]
    s_add_u32 s47, s65, 3678208
    buffer_load_dwordx4 a[128:131], v2, s[24:27], s47 offen offset:0 sc1
    v_mfma_f32_32x32x16_bf16 v[208:223], a[132:135], a[76:79], v[208:223]
    buffer_load_dwordx4 a[132:135], v2, s[24:27], s47 offen offset:1024 sc1
    v_mfma_f32_32x32x16_bf16 v[192:207], a[144:147], a[80:83], v[192:207]
    v_mfma_f32_32x32x16_bf16 v[208:223], a[144:147], a[84:87], v[208:223]
    buffer_load_dwordx4 a[144:147], v2, s[24:27], s47 offen offset:2048 sc1
    v_mfma_f32_32x32x16_bf16 v[192:207], a[148:151], a[88:91], v[192:207]
    v_mfma_f32_32x32x16_bf16 v[208:223], a[148:151], a[92:95], v[208:223]
    buffer_load_dwordx4 a[148:151], v2, s[24:27], s47 offen offset:3072 sc1
    v_mfma_f32_32x32x16_bf16 v[192:207], a[160:163], a[104:107], v[192:207]
    v_mfma_f32_32x32x16_bf16 v[208:223], a[160:163], a[108:111], v[208:223]
    s_add_u32 s47, s65, 3682304
    buffer_load_dwordx4 a[160:163], v2, s[24:27], s47 offen offset:0 sc1
    buffer_load_dword v57, v14, s[24:27], s43 offen sc1
    v_mfma_f32_32x32x16_bf16 v[192:207], a[164:167], a[120:123], v[192:207]
    v_mfma_f32_32x32x16_bf16 v[208:223], a[164:167], a[124:127], v[208:223]
    buffer_load_dwordx4 a[164:167], v2, s[24:27], s47 offen offset:1024 sc1
    v_mfma_f32_32x32x16_bf16 v[192:207], a[168:171], a[136:139], v[192:207]
    v_mfma_f32_32x32x16_bf16 v[208:223], a[168:171], a[140:143], v[208:223]
    buffer_load_dwordx4 a[168:171], v2, s[24:27], s47 offen offset:2048 sc1
    v_mfma_f32_32x32x16_bf16 v[192:207], a[172:175], a[152:155], v[192:207]
    v_mfma_f32_32x32x16_bf16 v[208:223], a[172:175], a[156:159], v[208:223]
    buffer_load_dwordx4 a[172:175], v2, s[24:27], s47 offen offset:3072 sc1
    s_mov_b32 s56, 0x3b000000
    v_mov_b32 v11, 0x3727c5ac
    s_waitcnt vmcnt(16)
    v_mfma_f32_32x32x16_bf16 v[224:239], a[176:179], v[96:99], 0
    v_mfma_f32_32x32x16_bf16 v[240:255], a[176:179], v[100:103], 0
    s_add_u32 s47, s65, 3686400
    buffer_load_dwordx4 a[176:179], v2, s[24:27], s47 offen offset:0 sc1
    s_waitcnt vmcnt(16)
    v_mfma_f32_32x32x16_bf16 v[224:239], a[180:183], v[104:107], v[224:239]
    s_nop 0
    ds_write_b128 v50, v[192:195] offset:0
    v_mfma_f32_32x32x16_bf16 v[240:255], a[180:183], v[108:111], v[240:255]
    buffer_load_dwordx4 a[180:183], v2, s[24:27], s47 offen offset:1024 sc1
    ds_write_b128 v50, v[196:199] offset:1024
    s_waitcnt vmcnt(16)
    v_mfma_f32_32x32x16_bf16 v[224:239], a[184:187], v[112:115], v[224:239]
    ds_write_b128 v50, v[200:203] offset:2048
    v_lshlrev_b32 v80, 16, v16
    v_and_b32 v81, 0xffff0000, v16
    v_lshlrev_b32 v96, 16, v24
    v_mfma_f32_32x32x16_bf16 v[240:255], a[184:187], v[116:119], v[240:255]
    buffer_load_dwordx4 a[184:187], v2, s[24:27], s47 offen offset:2048 sc1
    ds_write_b128 v50, v[204:207] offset:3072
    v_and_b32 v97, 0xffff0000, v24
    s_waitcnt vmcnt(16)
    v_mfma_f32_32x32x16_bf16 v[224:239], a[188:191], v[120:123], v[224:239]
    ds_write_b128 v50, v[208:211] offset:4096
    v_lshlrev_b32 v82, 16, v17
    v_and_b32 v83, 0xffff0000, v17
    v_lshlrev_b32 v98, 16, v25
    v_mfma_f32_32x32x16_bf16 v[240:255], a[188:191], v[124:127], v[240:255]
    buffer_load_dwordx4 a[188:191], v2, s[24:27], s47 offen offset:3072 sc1
    ds_write_b128 v50, v[212:215] offset:5120
    v_and_b32 v99, 0xffff0000, v25
    s_waitcnt vmcnt(16)
    v_mfma_f32_32x32x16_bf16 v[224:239], a[96:99], a[0:3], v[224:239]
    ds_write_b128 v50, v[216:219] offset:6144
    v_lshlrev_b32 v84, 16, v18
    v_and_b32 v85, 0xffff0000, v18
    v_lshlrev_b32 v100, 16, v26
    v_mfma_f32_32x32x16_bf16 v[240:255], a[96:99], a[4:7], v[240:255]
    s_add_u32 s47, s65, 3690496
    buffer_load_dwordx4 a[96:99], v2, s[24:27], s47 offen offset:0 sc1
    ds_write_b128 v50, v[220:223] offset:7168
    v_and_b32 v101, 0xffff0000, v26
    s_waitcnt vmcnt(16)
    v_mfma_f32_32x32x16_bf16 v[224:239], a[100:103], a[8:11], v[224:239]
    v_lshlrev_b32 v86, 16, v19
    v_and_b32 v87, 0xffff0000, v19
    v_lshlrev_b32 v102, 16, v27
    v_and_b32 v103, 0xffff0000, v27
    v_mfma_f32_32x32x16_bf16 v[240:255], a[100:103], a[12:15], v[240:255]
    buffer_load_dwordx4 a[100:103], v2, s[24:27], s47 offen offset:1024 sc1
    v_lshlrev_b32 v88, 16, v20
    v_and_b32 v89, 0xffff0000, v20
    s_waitcnt vmcnt(16)
    v_mfma_f32_32x32x16_bf16 v[224:239], a[112:115], a[16:19], v[224:239]
    v_lshlrev_b32 v104, 16, v28
    v_and_b32 v105, 0xffff0000, v28
    v_lshlrev_b32 v90, 16, v21
    v_and_b32 v91, 0xffff0000, v21
    v_mfma_f32_32x32x16_bf16 v[240:255], a[112:115], a[20:23], v[240:255]
    buffer_load_dwordx4 a[112:115], v2, s[24:27], s47 offen offset:2048 sc1
    v_lshlrev_b32 v106, 16, v29
    v_and_b32 v107, 0xffff0000, v29
    s_waitcnt vmcnt(16)
    v_mfma_f32_32x32x16_bf16 v[224:239], a[116:119], a[24:27], v[224:239]
    s_waitcnt vmcnt(10)
    v_cmp_gt_u32 vcc, 14, v57
    s_cbranch_vccz Lcb32
    s_mov_b32 m0, 0
Lcp33:
    s_sleep 3
    buffer_load_dword v57, v14, s[24:27], s43 offen sc1
    s_add_u32 m0, m0, 1
    s_cmp_gt_u32 m0, 400000
    s_cbranch_scc1 Lcb32
    s_waitcnt vmcnt(0)
    v_cmp_gt_u32 vcc, 14, v57
    s_cbranch_vccnz Lcp33
Lcb32:
    buffer_load_dwordx4 v[32:35], v9, s[24:27], s59 offen offset:0 sc1
    buffer_load_dwordx4 v[36:39], v9, s[24:27], s59 offen offset:16 sc1
    buffer_load_dwordx4 v[40:43], v9, s[24:27], s59 offen offset:256 sc1
    buffer_load_dwordx4 v[44:47], v9, s[24:27], s59 offen offset:272 sc1
    v_lshlrev_b32 v92, 16, v22
    v_and_b32 v93, 0xffff0000, v22
    v_lshlrev_b32 v108, 16, v30
    v_and_b32 v109, 0xffff0000, v30
    v_mfma_f32_32x32x16_bf16 v[240:255], a[116:119], a[28:31], v[240:255]
    buffer_load_dwordx4 a[116:119], v2, s[24:27], s47 offen offset:3072 sc1
    v_lshlrev_b32 v94, 16, v23
    v_and_b32 v95, 0xffff0000, v23
    v_mfma_f32_32x32x16_bf16 v[224:239], a[128:131], v[128:131], v[224:239]
    v_lshlrev_b32 v110, 16, v31
    v_and_b32 v111, 0xffff0000, v31
    v_mfma_f32_32x32x16_bf16 v[240:255], a[128:131], v[132:135], v[240:255]
    s_add_u32 s47, s65, 3694592
    buffer_load_dwordx4 a[128:131], v2, s[24:27], s47 offen offset:0 sc1
    v_mfma_f32_32x32x16_bf16 v[224:239], a[132:135], v[136:139], v[224:239]
    v_mfma_f32_32x32x16_bf16 v[240:255], a[132:135], v[140:143], v[240:255]
    buffer_load_dwordx4 a[132:135], v2, s[24:27], s47 offen offset:1024 sc1
    v_mfma_f32_32x32x16_bf16 v[224:239], a[144:147], v[144:147], v[224:239]
    s_waitcnt lgkmcnt(0)
    s_barrier
    ds_read_b128 v[192:195], v52 offset:0
    ds_read_b128 v[196:199], v52 offset:1024
    ds_read_b128 v[200:203], v52 offset:8192
    ds_read_b128 v[204:207], v52 offset:9216
    v_mfma_f32_32x32x16_bf16 v[240:255], a[144:147], v[148:151], v[240:255]
    buffer_load_dwordx4 a[144:147], v2, s[24:27], s47 offen offset:2048 sc1
    ds_read_b128 v[208:211], v52 offset:16384
    ds_read_b128 v[212:215], v52 offset:17408
    v_mfma_f32_32x32x16_bf16 v[224:239], a[148:151], v[152:155], v[224:239]
    ds_read_b128 v[216:219], v52 offset:24576
    ds_read_b128 v[220:223], v52 offset:25600
    s_waitcnt lgkmcnt(4)
    v_add_f32 v192, v192, v200
    v_mfma_f32_32x32x16_bf16 v[240:255], a[148:151], v[156:159], v[240:255]
    buffer_load_dwordx4 a[148:151], v2, s[24:27], s47 offen offset:3072 sc1
    v_add_f32 v193, v193, v201
    v_add_f32 v194, v194, v202
    v_mfma_f32_32x32x16_bf16 v[224:239], a[160:163], v[160:163], v[224:239]
    v_add_f32 v195, v195, v203
    v_add_f32 v196, v196, v204
    v_add_f32 v197, v197, v205
    v_add_f32 v198, v198, v206
    v_mfma_f32_32x32x16_bf16 v[240:255], a[160:163], v[164:167], v[240:255]
    v_add_f32 v199, v199, v207
    s_waitcnt lgkmcnt(0)
    v_add_f32 v208, v208, v216
    v_add_f32 v209, v209, v217
    s_waitcnt vmcnt(18)
    v_mfma_f32_32x32x16_bf16 v[224:239], a[164:167], v[168:171], v[224:239]
    v_add_f32 v210, v210, v218
    v_add_f32 v211, v211, v219
    v_add_f32 v212, v212, v220
    v_add_f32 v213, v213, v221
    v_mfma_f32_32x32x16_bf16 v[240:255], a[164:167], v[172:175], v[240:255]
    v_add_f32 v214, v214, v222
    v_add_f32 v215, v215, v223
    v_add_f32 v192, v192, v208
    v_add_f32 v193, v193, v209
    s_waitcnt vmcnt(17)
    v_mfma_f32_32x32x16_bf16 v[224:239], a[168:171], v[176:179], v[224:239]
    v_add_f32 v194, v194, v210
    v_add_f32 v195, v195, v211
    v_add_f32 v196, v196, v212
    v_add_f32 v197, v197, v213
    v_mfma_f32_32x32x16_bf16 v[240:255], a[168:171], v[180:183], v[240:255]
    v_add_f32 v198, v198, v214
    v_add_f32 v199, v199, v215
    s_waitcnt vmcnt(16)
    v_mfma_f32_32x32x16_bf16 v[224:239], a[172:175], v[184:187], v[224:239]
    s_waitcnt vmcnt(5)
    v_fma_f32 v32, v32, s56, v11
    v_fma_f32 v33, v33, s56, v11
    v_fma_f32 v34, v34, s56, v11
    v_mfma_f32_32x32x16_bf16 v[240:255], a[172:175], v[188:191], v[240:255]
    v_fma_f32 v35, v35, s56, v11
    v_fma_f32 v36, v36, s56, v11
    v_fma_f32 v37, v37, s56, v11
    v_fma_f32 v38, v38, s56, v11
    v_mfma_f32_32x32x16_bf16 v[224:239], a[176:179], a[32:35], v[224:239]
    v_fma_f32 v39, v39, s56, v11
    v_rcp_f32 v32, v32
    v_rcp_f32 v33, v33
    v_rcp_f32 v34, v34
    v_mfma_f32_32x32x16_bf16 v[240:255], a[176:179], a[36:39], v[240:255]
    v_rcp_f32 v35, v35
    v_rcp_f32 v36, v36
    v_rcp_f32 v37, v37
    v_rcp_f32 v38, v38
    v_mfma_f32_32x32x16_bf16 v[224:239], a[180:183], a[40:43], v[224:239]
    v_rcp_f32 v39, v39
    v_fma_f32 v40, v40, s56, v11
    v_fma_f32 v41, v41, s56, v11
    v_fma_f32 v42, v42, s56, v11
    v_mfma_f32_32x32x16_bf16 v[240:255], a[180:183], a[44:47], v[240:255]
    v_fma_f32 v43, v43, s56, v11
    v_fma_f32 v44, v44, s56, v11
    v_fma_f32 v45, v45, s56, v11
    v_fma_f32 v46, v46, s56, v11
    v_mfma_f32_32x32x16_bf16 v[224:239], a[184:187], a[48:51], v[224:239]
    v_fma_f32 v47, v47, s56, v11
    v_rcp_f32 v40, v40
    v_rcp_f32 v41, v41
    v_rcp_f32 v42, v42
    v_mfma_f32_32x32x16_bf16 v[240:255], a[184:187], a[52:55], v[240:255]
    v_rcp_f32 v43, v43
    v_rcp_f32 v44, v44
    v_rcp_f32 v45, v45
    v_rcp_f32 v46, v46
    v_mfma_f32_32x32x16_bf16 v[224:239], a[188:191], a[56:59], v[224:239]
    v_rcp_f32 v47, v47
    v_fma_f32 v192, v192, v32, v96
    v_fma_f32 v193, v193, v33, v97
    v_fma_f32 v194, v194, v34, v98
    v_mfma_f32_32x32x16_bf16 v[240:255], a[188:191], a[60:63], v[240:255]
    v_fma_f32 v195, v195, v35, v99
    v_fma_f32 v196, v196, v36, v100
    v_fma_f32 v197, v197, v37, v101
    v_fma_f32 v198, v198, v38, v102
    v_mfma_f32_32x32x16_bf16 v[224:239], a[96:99], a[64:67], v[224:239]
    v_fma_f32 v199, v199, v39, v103
    v_cvt_pk_bf16_f32 v200, v192, v193
    v_cvt_pk_bf16_f32 v201, v194, v195
    v_cvt_pk_bf16_f32 v202, v196, v197
    v_mfma_f32_32x32x16_bf16 v[240:255], a[96:99], a[68:71], v[240:255]
    v_cvt_pk_bf16_f32 v203, v198, v199
    buffer_store_dwordx4 v[200:203], v8, s[24:27], s58 offen offset:0 sc1
    v_add_f32 v208, v192, v80
    v_add_f32 v209, v193, v81
    v_mfma_f32_32x32x16_bf16 v[224:239], a[100:103], a[72:75], v[224:239]
    v_add_f32 v210, v194, v82
    v_add_f32 v211, v195, v83
    v_add_f32 v212, v196, v84
    v_add_f32 v213, v197, v85
    v_mfma_f32_32x32x16_bf16 v[240:255], a[100:103], a[76:79], v[240:255]
    v_add_f32 v214, v198, v86
    v_add_f32 v215, v199, v87
    v_mul_f32 v208, v208, v208
    v_mul_f32 v209, v209, v209
    v_mfma_f32_32x32x16_bf16 v[224:239], a[112:115], a[80:83], v[224:239]
    v_mul_f32 v210, v210, v210
    v_mul_f32 v211, v211, v211
    v_mul_f32 v212, v212, v212
    v_mul_f32 v213, v213, v213
    v_mfma_f32_32x32x16_bf16 v[240:255], a[112:115], a[84:87], v[240:255]
    v_mul_f32 v214, v214, v214
    v_mul_f32 v215, v215, v215
    v_cndmask_b32 v208, 0, v208, s[4:5]
    v_cndmask_b32 v209, 0, v209, s[4:5]
    s_waitcnt vmcnt(5)
    v_mfma_f32_32x32x16_bf16 v[224:239], a[116:119], a[88:91], v[224:239]
    v_cndmask_b32 v210, 0, v210, s[4:5]
    v_cndmask_b32 v211, 0, v211, s[4:5]
    v_cndmask_b32 v212, 0, v212, s[4:5]
    v_cndmask_b32 v213, 0, v213, s[4:5]
    v_mfma_f32_32x32x16_bf16 v[240:255], a[116:119], a[92:95], v[240:255]
    v_cndmask_b32 v214, 0, v214, s[4:5]
    v_cndmask_b32 v215, 0, v215, s[4:5]
    v_add_f32_dpp v216, v208, v208 row_ror:8 row_mask:0xf bank_mask:0x3
    s_nop 1
    v_add_f32_dpp v216, v212, v212 row_ror:8 row_mask:0xf bank_mask:0xc
    s_waitcnt vmcnt(4)
    v_mfma_f32_32x32x16_bf16 v[224:239], a[128:131], a[104:107], v[224:239]
    v_add_f32_dpp v217, v209, v209 row_ror:8 row_mask:0xf bank_mask:0x3
    s_nop 1
    v_add_f32_dpp v217, v213, v213 row_ror:8 row_mask:0xf bank_mask:0xc
    v_add_f32_dpp v218, v210, v210 row_ror:8 row_mask:0xf bank_mask:0x3
    s_nop 1
    v_add_f32_dpp v218, v214, v214 row_ror:8 row_mask:0xf bank_mask:0xc
    s_waitcnt vmcnt(3)
    v_mfma_f32_32x32x16_bf16 v[224:239], a[132:135], a[120:123], v[224:239]
    v_add_f32_dpp v219, v211, v211 row_ror:8 row_mask:0xf bank_mask:0x3
    s_nop 1
    v_add_f32_dpp v219, v215, v215 row_ror:8 row_mask:0xf bank_mask:0xc
    v_add_f32_dpp v208, v216, v216 row_half_mirror row_mask:0xf bank_mask:0x5
    s_nop 1
    v_add_f32_dpp v208, v218, v218 row_half_mirror row_mask:0xf bank_mask:0xa
    s_waitcnt vmcnt(2)
    v_mfma_f32_32x32x16_bf16 v[224:239], a[144:147], a[136:139], v[224:239]
    v_add_f32_dpp v209, v217, v217 row_half_mirror row_mask:0xf bank_mask:0x5
    s_nop 1
    v_add_f32_dpp v209, v219, v219 row_half_mirror row_mask:0xf bank_mask:0xa
    v_add_f32_dpp v208, v208, v208 quad_perm:[1,0,3,2] row_mask:0xf bank_mask:0xf
    s_nop 0
    v_add_f32_dpp v209, v209, v209 quad_perm:[1,0,3,2] row_mask:0xf bank_mask:0xf
    s_waitcnt vmcnt(1)
    v_mfma_f32_32x32x16_bf16 v[224:239], a[148:151], a[152:155], v[224:239]
    v_add_f32_dpp v208, v208, v208 quad_perm:[2,3,0,1] row_mask:0xf bank_mask:0xf
    v_add_f32_dpp v209, v209, v209 quad_perm:[2,3,0,1] row_mask:0xf bank_mask:0xf
    v_cndmask_b32 v208, v208, v209, s[6:7]
    s_mov_b32 exec_lo, 0x33333333
    s_mov_b32 exec_hi, 0x33333333
    buffer_atomic_add_f32 v208, v10, s[24:27], s60 offen offset:0 sc1
    s_mov_b64 exec, -1
    v_mfma_f32_32x32x16_bf16 v[240:255], a[128:131], a[108:111], v[240:255]
    v_mfma_f32_32x32x16_bf16 v[240:255], a[132:135], a[124:127], v[240:255]
    s_nop 2
    ds_write_b128 v50, v[224:227] offset:32768
    v_mfma_f32_32x32x16_bf16 v[240:255], a[144:147], a[140:143], v[240:255]
    ds_write_b128 v50, v[228:231] offset:33792
    v_mfma_f32_32x32x16_bf16 v[240:255], a[148:151], a[156:159], v[240:255]
    ds_write_b128 v50, v[232:235] offset:34816
    ds_write_b128 v50, v[236:239] offset:35840
    s_nop 9
    ds_write_b128 v50, v[240:243] offset:36864
    ds_write_b128 v50, v[244:247] offset:37888
    ds_write_b128 v50, v[248:251] offset:38912
    ds_write_b128 v50, v[252:255] offset:39936
    s_waitcnt lgkmcnt(0)
    s_barrier
    ds_read_b128 v[128:131], v52 offset:32768
    ds_read_b128 v[132:135], v52 offset:33792
    ds_read_b128 v[136:139], v52 offset:40960
    ds_read_b128 v[140:143], v52 offset:41984
    ds_read_b128 v[144:147], v52 offset:49152
    ds_read_b128 v[148:151], v52 offset:50176
    ds_read_b128 v[152:155], v52 offset:57344
    ds_read_b128 v[156:159], v52 offset:58368
    s_waitcnt lgkmcnt(4)
    v_pk_add_f32 v[128:129], v[128:129], v[136:137]
    v_pk_add_f32 v[130:131], v[130:131], v[138:139]
    v_pk_add_f32 v[132:133], v[132:133], v[140:141]
    v_pk_add_f32 v[134:135], v[134:135], v[142:143]
    s_waitcnt lgkmcnt(0)
    v_pk_add_f32 v[144:145], v[144:145], v[152:153]
    v_pk_add_f32 v[146:147], v[146:147], v[154:155]
    v_pk_add_f32 v[148:149], v[148:149], v[156:157]
    v_pk_add_f32 v[150:151], v[150:151], v[158:159]
    v_pk_add_f32 v[128:129], v[128:129], v[144:145]
    v_pk_add_f32 v[130:131], v[130:131], v[146:147]
    v_pk_add_f32 v[132:133], v[132:133], v[148:149]
    v_pk_add_f32 v[134:135], v[134:135], v[150:151]
    v_pk_fma_f32 v[128:129], v[128:129], v[40:41], v[104:105]
    v_pk_fma_f32 v[130:131], v[130:131], v[42:43], v[106:107]
    v_pk_fma_f32 v[132:133], v[132:133], v[44:45], v[108:109]
    v_pk_fma_f32 v[134:135], v[134:135], v[46:47], v[110:111]
    v_cvt_pk_bf16_f32 v136, v128, v129
    v_cvt_pk_bf16_f32 v137, v130, v131
    v_cvt_pk_bf16_f32 v138, v132, v133
    v_cvt_pk_bf16_f32 v139, v134, v135
    buffer_store_dwordx4 v[136:139], v8, s[24:27], s58 offen offset:128 sc1
    v_pk_add_f32 v[144:145], v[128:129], v[88:89]
    v_pk_add_f32 v[146:147], v[130:131], v[90:91]
    v_pk_add_f32 v[148:149], v[132:133], v[92:93]
    v_pk_add_f32 v[150:151], v[134:135], v[94:95]
    v_mul_f32 v144, v144, v144
    v_mul_f32 v145, v145, v145
    v_mul_f32 v146, v146, v146
    v_mul_f32 v147, v147, v147
    v_mul_f32 v148, v148, v148
    v_mul_f32 v149, v149, v149
    v_mul_f32 v150, v150, v150
    v_mul_f32 v151, v151, v151
    v_cndmask_b32 v144, 0, v144, s[4:5]
    v_cndmask_b32 v145, 0, v145, s[4:5]
    v_cndmask_b32 v146, 0, v146, s[4:5]
    v_cndmask_b32 v147, 0, v147, s[4:5]
    v_cndmask_b32 v148, 0, v148, s[4:5]
    v_cndmask_b32 v149, 0, v149, s[4:5]
    v_cndmask_b32 v150, 0, v150, s[4:5]
    v_cndmask_b32 v151, 0, v151, s[4:5]
    v_add_f32_dpp v152, v144, v144 row_ror:8 row_mask:0xf bank_mask:0x3
    s_nop 1
    v_add_f32_dpp v152, v148, v148 row_ror:8 row_mask:0xf bank_mask:0xc
    v_add_f32_dpp v153, v145, v145 row_ror:8 row_mask:0xf bank_mask:0x3
    s_nop 1
    v_add_f32_dpp v153, v149, v149 row_ror:8 row_mask:0xf bank_mask:0xc
    v_add_f32_dpp v154, v146, v146 row_ror:8 row_mask:0xf bank_mask:0x3
    s_nop 1
    v_add_f32_dpp v154, v150, v150 row_ror:8 row_mask:0xf bank_mask:0xc
    v_add_f32_dpp v155, v147, v147 row_ror:8 row_mask:0xf bank_mask:0x3
    s_nop 1
    v_add_f32_dpp v155, v151, v151 row_ror:8 row_mask:0xf bank_mask:0xc
    v_add_f32_dpp v144, v152, v152 row_half_mirror row_mask:0xf bank_mask:0x5
    s_nop 1
    v_add_f32_dpp v144, v154, v154 row_half_mirror row_mask:0xf bank_mask:0xa
    v_add_f32_dpp v145, v153, v153 row_half_mirror row_mask:0xf bank_mask:0x5
    s_nop 1
    v_add_f32_dpp v145, v155, v155 row_half_mirror row_mask:0xf bank_mask:0xa
    v_add_f32_dpp v144, v144, v144 quad_perm:[1,0,3,2] row_mask:0xf bank_mask:0xf
    s_nop 0
    v_add_f32_dpp v145, v145, v145 quad_perm:[1,0,3,2] row_mask:0xf bank_mask:0xf
    v_add_f32_dpp v144, v144, v144 quad_perm:[2,3,0,1] row_mask:0xf bank_mask:0xf
    s_nop 0
    v_add_f32_dpp v145, v145, v145 quad_perm:[2,3,0,1] row_mask:0xf bank_mask:0xf
    v_cndmask_b32 v144, v144, v145, s[6:7]
    s_mov_b32 exec_lo, 0x33333333
    s_mov_b32 exec_hi, 0x33333333
    ds_write_b32 v12, v144
    s_mov_b64 exec, -1
    s_waitcnt lgkmcnt(0)
    s_barrier
    ds_read2st64_b32 v[146:147], v13 offset0:0 offset1:1
    s_waitcnt lgkmcnt(0)
    v_add_f32 v144, v146, v147
    v_mov_b32 v145, v144
    s_nop 1
    v_permlane32_swap_b32 v144, v145
    v_add_f32 v144, v144, v145
    s_mov_b32 exec_hi, 0
    buffer_atomic_add_f32 v144, v55, s[24:27], s61 offen sc1
    s_mov_b32 exec_hi, -1
    s_lshl_b32 s57, s3, 12
    s_add_u32 s57, s57, 147456
    v_add_u32 v44, s57, v2
    ds_read_b128 v[64:67], v44 offset:0
    ds_read_b128 v[68:71], v44 offset:1024
    ds_read_b128 v[72:75], v44 offset:2048
    ds_read_b128 v[76:79], v44 offset:3072
    v_and_b32 v8, 15, v1
    v_lshrrev_b32 v9, 4, v1
    s_lshl_b32 s56, s3, 4
    v_add_u32 v40, s56, v8
    v_cvt_f32_u32 v40, v40
    v_lshlrev_b32 v41, 2, v9
    v_cvt_f32_u32 v41, v41
    v_mul_f32 v42, 0x3c800000, v40
    v_mul_f32 v43, v42, v41
    v_fmamk_f32 v240, v42, 0x00000000, v43
    v_fmamk_f32 v241, v42, 0x3f800000, v43
    v_fmamk_f32 v242, v42, 0x40000000, v43
    v_fmamk_f32 v243, v42, 0x40400000, v43
    v_fmamk_f32 v244, v42, 0x41800000, v43
    v_fmamk_f32 v245, v42, 0x41880000, v43
    v_fmamk_f32 v246, v42, 0x41900000, v43
    v_fmamk_f32 v247, v42, 0x41980000, v43
    v_cos_f32 v224, v240
    v_cos_f32 v225, v241
    v_cos_f32 v226, v242
    v_cos_f32 v227, v243
    v_cos_f32 v228, v244
    v_cos_f32 v229, v245
    v_cos_f32 v230, v246
    v_cos_f32 v231, v247
    v_sin_f32 v232, v240
    v_sin_f32 v233, v241
    v_sin_f32 v234, v242
    v_sin_f32 v235, v243
    v_sin_f32 v236, v244
    v_sin_f32 v237, v245
    v_sin_f32 v238, v246
    v_sin_f32 v239, v247
    v_cvt_pk_bf16_f32 v128, v224, v225
    v_cvt_pk_bf16_f32 v129, v226, v227
    v_cvt_pk_bf16_f32 v130, v228, v229
    v_cvt_pk_bf16_f32 v131, v230, v231
    v_cvt_pk_bf16_f32 v144, v232, v233
    v_cvt_pk_bf16_f32 v145, v234, v235
    v_cvt_pk_bf16_f32 v146, v236, v237
    v_cvt_pk_bf16_f32 v147, v238, v239
    v_xor_b32 v136, 0x80008000, v144
    v_xor_b32 v137, 0x80008000, v145
    v_xor_b32 v138, 0x80008000, v146
    v_xor_b32 v139, 0x80008000, v147
    v_fmamk_f32 v240, v42, 0x42000000, v43
    v_fmamk_f32 v241, v42, 0x42040000, v43
    v_fmamk_f32 v242, v42, 0x42080000, v43
    v_fmamk_f32 v243, v42, 0x420c0000, v43
    v_fmamk_f32 v244, v42, 0x42400000, v43
    v_fmamk_f32 v245, v42, 0x42440000, v43
    v_fmamk_f32 v246, v42, 0x42480000, v43
    v_fmamk_f32 v247, v42, 0x424c0000, v43
    v_cos_f32 v224, v240
    v_cos_f32 v225, v241
    v_cos_f32 v226, v242
    v_cos_f32 v227, v243
    v_cos_f32 v228, v244
    v_cos_f32 v229, v245
    v_cos_f32 v230, v246
    v_cos_f32 v231, v247
    v_sin_f32 v232, v240
    v_sin_f32 v233, v241
    v_sin_f32 v234, v242
    v_sin_f32 v235, v243
    v_sin_f32 v236, v244
    v_sin_f32 v237, v245
    v_sin_f32 v238, v246
    v_sin_f32 v239, v247
    v_cvt_pk_bf16_f32 v132, v224, v225
    v_cvt_pk_bf16_f32 v133, v226, v227
    v_cvt_pk_bf16_f32 v134, v228, v229
    v_cvt_pk_bf16_f32 v135, v230, v231
    v_cvt_pk_bf16_f32 v148, v232, v233
    v_cvt_pk_bf16_f32 v149, v234, v235
    v_cvt_pk_bf16_f32 v150, v236, v237
    v_cvt_pk_bf16_f32 v151, v238, v239
    v_xor_b32 v140, 0x80008000, v148
    v_xor_b32 v141, 0x80008000, v149
    v_xor_b32 v142, 0x80008000, v150
    v_xor_b32 v143, 0x80008000, v151
    v_add_u32 v42, 0, v8
    v_cvt_f32_u32 v42, v42
    v_mul_f32 v42, 0x3d000000, v42
    v_mul_f32 v43, v42, v41
    v_fmamk_f32 v240, v42, 0x00000000, v43
    v_fmamk_f32 v241, v42, 0x3f800000, v43
    v_fmamk_f32 v242, v42, 0x40000000, v43
    v_fmamk_f32 v243, v42, 0x40400000, v43
    v_fmamk_f32 v244, v42, 0x41800000, v43
    v_fmamk_f32 v245, v42, 0x41880000, v43
    s_lshl_b32 s57, s55, 3
    s_add_u32 s57, s57, s54
    s_waitcnt vmcnt(0)
    s_barrier
    s_lshl_b32 s56, s57, 7
    s_add_u32 s56, s56, 0x2180000
    s_cmp_lg_u32 s3, 0
    s_cselect_b32 s56, 0x4000000, s56
    v_lshlrev_b32 v6, 2, v1
    v_mov_b32 v7, 1
    s_mov_b64 exec, 0xffff
    buffer_store_dword v7, v6, s[24:27], s56 offen sc1
    s_mov_b64 exec, -1
    s_getpc_b64 s[32:33]
Lpc3:
    s_mov_b32 s34, Lend-Lpc3
    s_mov_b32 s35, 0x20000
    s_lshr_b32 s36, s2, 3
    s_and_b32 s36, s36, 1
    s_lshl_b32 s36, s36, 14
    s_cmp_lt_u32 s2, 64
    s_cselect_b32 s36, s36, 0x100000
    v_lshlrev_b32 v45, 6, v0
    buffer_load_dword v46, v45, s[32:35], s36 offen
    s_lshl_b32 s56, s3, 14
    v_add_u32 v49, s56, v2
    ds_read_b128 a[128:131], v49 offset:0
    ds_read_b128 a[132:135], v49 offset:1024
    ds_read_b128 a[136:139], v49 offset:2048
    ds_read_b128 a[140:143], v49 offset:3072
    ds_read_b128 a[144:147], v49 offset:4096
    ds_read_b128 a[148:151], v49 offset:5120
    ds_read_b128 a[152:155], v49 offset:6144
    ds_read_b128 a[156:159], v49 offset:7168
    ds_read_b128 a[160:163], v49 offset:8192
    ds_read_b128 a[164:167], v49 offset:9216
    ds_read_b128 a[168:171], v49 offset:10240
    ds_read_b128 a[172:175], v49 offset:11264
    ds_read_b128 a[176:179], v49 offset:12288
    ds_read_b128 a[180:183], v49 offset:13312
    ds_read_b128 a[184:187], v49 offset:14336
    ds_read_b128 a[188:191], v49 offset:15360
    s_lshl_b32 s62, s52, 2
    s_add_u32 s62, s62, s3
    s_lshl_b32 s62, s62, 16
    s_add_u32 s62, s62, 0xc00000
    v_lshlrev_b32 v6, 7, v0
    s_mov_b32 s16, 0x2180000
    v_fmamk_f32 v246, v42, 0x41900000, v43
    v_fmamk_f32 v247, v42, 0x41980000, v43
    v_cos_f32 v224, v240
    v_cos_f32 v225, v241
    v_cos_f32 v226, v242
    s_add_u32 s47, s62, 0
    buffer_load_dwordx4 a[0:3], v2, s[24:27], s47 offen offset:0 sc1
    v_cos_f32 v227, v243
    v_cos_f32 v228, v244
    v_cos_f32 v229, v245
    v_cos_f32 v230, v246
    v_cos_f32 v231, v247
    buffer_load_dwordx4 a[4:7], v2, s[24:27], s47 offen offset:1024 sc1
    v_sin_f32 v232, v240
    v_sin_f32 v233, v241
    v_sin_f32 v234, v242
    v_sin_f32 v235, v243
    v_sin_f32 v236, v244
    buffer_load_dwordx4 a[8:11], v2, s[24:27], s47 offen offset:2048 sc1
    v_sin_f32 v237, v245
    v_sin_f32 v238, v246
    v_sin_f32 v239, v247
    v_cvt_pk_bf16_f32 v152, v224, v225
    v_cvt_pk_bf16_f32 v153, v226, v227
    buffer_load_dwordx4 a[12:15], v2, s[24:27], s47 offen offset:3072 sc1
    v_cvt_pk_bf16_f32 v154, v228, v229
    v_cvt_pk_bf16_f32 v155, v230, v231
    v_cvt_pk_bf16_f32 v168, v232, v233
    v_cvt_pk_bf16_f32 v169, v234, v235
    v_cvt_pk_bf16_f32 v170, v236, v237
    s_add_u32 s47, s62, 4096
    buffer_load_dwordx4 a[16:19], v2, s[24:27], s47 offen offset:0 sc1
    v_cvt_pk_bf16_f32 v171, v238, v239
    v_xor_b32 v160, 0x80008000, v168
    v_xor_b32 v161, 0x80008000, v169
    v_xor_b32 v162, 0x80008000, v170
    v_xor_b32 v163, 0x80008000, v171
    buffer_load_dwordx4 a[20:23], v2, s[24:27], s47 offen offset:1024 sc1
    v_add_u32 v42, 16, v8
    v_cvt_f32_u32 v42, v42
    v_mul_f32 v42, 0x3d000000, v42
    v_mul_f32 v43, v42, v41
    v_fmamk_f32 v240, v42, 0x00000000, v43
    buffer_load_dwordx4 a[24:27], v2, s[24:27], s47 offen offset:2048 sc1
    v_fmamk_f32 v241, v42, 0x3f800000, v43
    v_fmamk_f32 v242, v42, 0x40000000, v43
    v_fmamk_f32 v243, v42, 0x40400000, v43
    v_fmamk_f32 v244, v42, 0x41800000, v43
    v_fmamk_f32 v245, v42, 0x41880000, v43
    buffer_load_dwordx4 a[28:31], v2, s[24:27], s47 offen offset:3072 sc1
    v_fmamk_f32 v246, v42, 0x41900000, v43
    v_fmamk_f32 v247, v42, 0x41980000, v43
    v_cos_f32 v224, v240
    v_cos_f32 v225, v241
    v_cos_f32 v226, v242
    v_cos_f32 v227, v243
    v_cos_f32 v228, v244
    v_cos_f32 v229, v245
    v_cos_f32 v230, v246
    v_cos_f32 v231, v247
    v_sin_f32 v232, v240
    v_sin_f32 v233, v241
    v_sin_f32 v234, v242
    v_sin_f32 v235, v243
    v_sin_f32 v236, v244
    v_sin_f32 v237, v245
    v_sin_f32 v238, v246
    v_sin_f32 v239, v247
    buffer_load_dword v7, v6, s[24:27], s16 offen sc1
    v_cvt_pk_bf16_f32 v156, v224, v225
    v_cvt_pk_bf16_f32 v157, v226, v227
    v_cvt_pk_bf16_f32 v158, v228, v229
    v_cvt_pk_bf16_f32 v159, v230, v231
    v_cvt_pk_bf16_f32 v172, v232, v233
    v_cvt_pk_bf16_f32 v173, v234, v235
    v_cvt_pk_bf16_f32 v174, v236, v237
    v_cvt_pk_bf16_f32 v175, v238, v239
    v_xor_b32 v164, 0x80008000, v172
    v_xor_b32 v165, 0x80008000, v173
    v_xor_b32 v166, 0x80008000, v174
    v_xor_b32 v167, 0x80008000, v175
    v_mul_f32 v42, 0xba000000, v40
    v_mul_f32 v43, v42, v41
    v_fmamk_f32 v240, v42, 0x00000000, v43
    v_fmamk_f32 v241, v42, 0x3f800000, v43
    v_fmamk_f32 v242, v42, 0x40000000, v43
    v_fmamk_f32 v243, v42, 0x40400000, v43
    v_fmamk_f32 v244, v42, 0x41800000, v43
    v_fmamk_f32 v245, v42, 0x41880000, v43
    v_fmamk_f32 v246, v42, 0x41900000, v43
    v_fmamk_f32 v247, v42, 0x41980000, v43
    v_cos_f32 v176, v240
    v_sin_f32 v184, v240
    v_cos_f32 v177, v241
    v_sin_f32 v185, v241
    v_cos_f32 v178, v242
    v_sin_f32 v186, v242
    v_cos_f32 v179, v243
    v_sin_f32 v187, v243
    v_cos_f32 v180, v244
    v_sin_f32 v188, v244
    v_cos_f32 v181, v245
    v_sin_f32 v189, v245
    v_cos_f32 v182, v246
    v_sin_f32 v190, v246
    v_cos_f32 v183, v247
    v_sin_f32 v191, v247
    s_lshr_b32 s56, s3, 1
    s_lshl_b32 s56, s56, 10
    s_and_b32 s57, s3, 1
    s_lshl_b32 s57, s57, 3
    s_add_u32 s56, s56, s57
    s_add_u32 s56, s56, 131072
    v_add_u32 v10, s56, v2
    v_lshlrev_b32 v11, 5, v8
    v_lshl_add_u32 v11, v9, 3, v11
    s_lshl_b32 s56, s3, 11
    s_add_u32 s56, s56, 139264
    v_add_u32 v11, s56, v11
    v_lshlrev_b32 v12, 3, v1
    v_add_u32 v12, 139264, v12
    v_add_u32 v13, 131072, v2
    v_lshlrev_b32 v15, 5, v1
    s_lshl_b32 s58, s2, 13
    s_lshl_b32 s59, s3, 10
    s_add_u32 s58, s58, s59
    s_lshl_b32 s59, s3, 11
    s_waitcnt lgkmcnt(0)
    v_lshlrev_b32 v96, 16, v64
    v_and_b32 v97, 0xffff0000, v64
    v_lshlrev_b32 v98, 16, v65
    v_and_b32 v99, 0xffff0000, v65
    v_lshlrev_b32 v100, 16, v66
    v_and_b32 v101, 0xffff0000, v66
    v_lshlrev_b32 v102, 16, v67
    v_and_b32 v103, 0xffff0000, v67
    v_lshlrev_b32 v104, 16, v68
    v_and_b32 v105, 0xffff0000, v68
    v_lshlrev_b32 v106, 16, v69
    v_and_b32 v107, 0xffff0000, v69
    v_lshlrev_b32 v108, 16, v70
    v_and_b32 v109, 0xffff0000, v70
    v_lshlrev_b32 v110, 16, v71
    v_and_b32 v111, 0xffff0000, v71
    v_lshlrev_b32 v16, 16, v72
    v_and_b32 v24, 0xffff0000, v72
    v_lshlrev_b32 v17, 16, v73
    v_and_b32 v25, 0xffff0000, v73
    v_lshlrev_b32 v18, 16, v74
    v_and_b32 v26, 0xffff0000, v74
    v_lshlrev_b32 v19, 16, v75
    v_and_b32 v27, 0xffff0000, v75
    v_lshlrev_b32 v20, 16, v76
    v_and_b32 v28, 0xffff0000, v76
    v_lshlrev_b32 v21, 16, v77
    v_and_b32 v29, 0xffff0000, v77
    v_lshlrev_b32 v22, 16, v78
    v_and_b32 v30, 0xffff0000, v78
    v_lshlrev_b32 v23, 16, v79
    v_and_b32 v31, 0xffff0000, v79
    s_waitcnt vmcnt(0)
    v_cmp_eq_u32 vcc, 0, v7
    s_cbranch_vccz Lfo34
    v_lshlrev_b32 v6, 7, v0
    s_mov_b32 s56, 0x2180000
    s_mov_b32 m0, 0
Lfp35:
    buffer_load_dword v7, v6, s[24:27], s56 offen sc1
    s_waitcnt vmcnt(0)
    v_cmp_eq_u32 vcc, 0, v7
    s_cbranch_vccz Lfx36
    s_nop 0
    s_mov_b64 exec, vcc
    s_sleep 1
    s_add_u32 m0, m0, 1
    s_cmp_lt_u32 m0, 400000
    s_cbranch_scc1 Lfp35
Lfx36:
    s_mov_b64 exec, -1
Lfo34:
    s_add_u32 s56, s59, 0x2004000
    s_add_u32 s60, s58, 0x600000
    s_add_u32 s61, s60, 4096
    buffer_load_dwordx4 v[80:83], v2, s[24:27], s60 offen sc1
    buffer_load_dwordx4 v[84:87], v2, s[24:27], s61 offen sc1
    buffer_load_dwordx4 v[88:91], v15, s[24:27], s56 offen sc1
    buffer_load_dwordx4 v[92:95], v15, s[24:27], s56 offen offset:16 sc1
    s_mov_b32 s56, 0x46000000
    v_mov_b32 v240, 0x4227c5ac
    s_cmp_eq_u32 s2, 0
    s_cselect_b32 s66, 0, 1.0
    s_add_u32 s68, s58, 0x2200000
    s_add_u32 s69, s68, 4096
    s_add_u32 s60, s58, 0x800000
    s_add_u32 s61, s60, 4096
    s_waitcnt vmcnt(0)
    v_fma_f32 v88, v88, s56, v240
    v_fma_f32 v89, v89, s56, v240
    v_fma_f32 v90, v90, s56, v240
    v_fma_f32 v91, v91, s56, v240
    v_fma_f32 v92, v92, s56, v240
    v_fma_f32 v93, v93, s56, v240
    v_fma_f32 v94, v94, s56, v240
    v_fma_f32 v95, v95, s56, v240
    v_rsq_f32 v88, v88
    v_rsq_f32 v89, v89
    v_rsq_f32 v90, v90
    v_rsq_f32 v91, v91
    v_rsq_f32 v92, v92
    v_rsq_f32 v93, v93
    v_rsq_f32 v94, v94
    v_rsq_f32 v95, v95
    v_lshlrev_b32 v112, 16, v80
    v_and_b32 v113, 0xffff0000, v80
    v_lshlrev_b32 v114, 16, v81
    v_and_b32 v115, 0xffff0000, v81
    v_lshlrev_b32 v116, 16, v82
    v_and_b32 v117, 0xffff0000, v82
    v_lshlrev_b32 v118, 16, v83
    v_and_b32 v119, 0xffff0000, v83
    v_lshlrev_b32 v120, 16, v84
    v_and_b32 v121, 0xffff0000, v84
    v_lshlrev_b32 v122, 16, v85
    v_and_b32 v123, 0xffff0000, v85
    v_lshlrev_b32 v124, 16, v86
    v_and_b32 v125, 0xffff0000, v86
    v_lshlrev_b32 v126, 16, v87
    v_and_b32 v127, 0xffff0000, v87
    v_pk_add_f32 v[96:97], v[96:97], v[112:113]
    v_pk_fma_f32 v[104:105], v[120:121], s[66:67], v[104:105] op_sel_hi:[1,0,1]
    v_pk_add_f32 v[98:99], v[98:99], v[114:115]
    v_pk_fma_f32 v[106:107], v[122:123], s[66:67], v[106:107] op_sel_hi:[1,0,1]
    v_pk_add_f32 v[100:101], v[100:101], v[116:117]
    v_pk_fma_f32 v[108:109], v[124:125], s[66:67], v[108:109] op_sel_hi:[1,0,1]
    v_pk_add_f32 v[102:103], v[102:103], v[118:119]
    v_pk_fma_f32 v[110:111], v[126:127], s[66:67], v[110:111] op_sel_hi:[1,0,1]
    v_pk_mul_f32 v[224:225], v[96:97], v[88:89]
    v_pk_mul_f32 v[226:227], v[98:99], v[90:91]
    v_cvt_pk_bf16_f32 v32, v224, v225
    v_cvt_pk_bf16_f32 v33, v226, v227
    ds_write_b64 v10, v[32:33] offset:0
    v_pk_mul_f32 v[228:229], v[100:101], v[92:93]
    v_pk_mul_f32 v[230:231], v[102:103], v[94:95]
    v_cvt_pk_bf16_f32 v34, v228, v229
    v_cvt_pk_bf16_f32 v35, v230, v231
    ds_write_b64 v10, v[34:35] offset:2048
    v_pk_mul_f32 v[232:233], v[104:105], v[88:89]
    v_pk_mul_f32 v[234:235], v[106:107], v[90:91]
    v_cvt_pk_bf16_f32 v36, v232, v233
    v_cvt_pk_bf16_f32 v37, v234, v235
    ds_write_b64 v10, v[36:37] offset:4096
    v_pk_mul_f32 v[236:237], v[108:109], v[92:93]
    v_pk_mul_f32 v[238:239], v[110:111], v[94:95]
    v_cvt_pk_bf16_f32 v38, v236, v237
    v_cvt_pk_bf16_f32 v39, v238, v239
    ds_write_b64 v10, v[38:39] offset:6144
    s_waitcnt lgkmcnt(0)
    s_barrier
    ds_read_b128 v[192:195], v13 offset:0
    ds_read_b128 v[208:211], v13 offset:4096
    ds_read_b128 v[196:199], v13 offset:1024
    ds_read_b128 v[212:215], v13 offset:5120
    ds_read_b128 v[200:203], v13 offset:2048
    ds_read_b128 v[216:219], v13 offset:6144
    ds_read_b128 v[204:207], v13 offset:3072
    ds_read_b128 v[220:223], v13 offset:7168
    s_waitcnt lgkmcnt(6)
    v_mfma_f32_16x16x32_bf16 v[224:227], v[192:195], v[128:131], 0
    v_mfma_f32_16x16x32_bf16 v[232:235], v[192:195], v[136:139], 0
    v_mfma_f32_16x16x32_bf16 v[224:227], v[208:211], v[144:147], v[224:227]
    v_mfma_f32_16x16x32_bf16 v[232:235], v[208:211], v[128:131], v[232:235]
    s_waitcnt lgkmcnt(4)
    s_add_u32 s47, s62, 8192
    buffer_load_dwordx4 a[32:35], v2, s[24:27], s47 offen offset:0 sc1
    v_mfma_f32_16x16x32_bf16 v[224:227], v[196:199], v[132:135], v[224:227]
    v_mfma_f32_16x16x32_bf16 v[232:235], v[196:199], v[140:143], v[232:235]
    v_mfma_f32_16x16x32_bf16 v[224:227], v[212:215], v[148:151], v[224:227]
    v_mfma_f32_16x16x32_bf16 v[232:235], v[212:215], v[132:135], v[232:235]
    s_waitcnt lgkmcnt(2)
    v_mfma_f32_16x16x32_bf16 v[228:231], v[200:203], v[128:131], 0
    buffer_load_dwordx4 a[36:39], v2, s[24:27], s47 offen offset:1024 sc1
    v_mfma_f32_16x16x32_bf16 v[236:239], v[200:203], v[136:139], 0
    v_mfma_f32_16x16x32_bf16 v[228:231], v[216:219], v[144:147], v[228:231]
    v_mfma_f32_16x16x32_bf16 v[236:239], v[216:219], v[128:131], v[236:239]
    s_waitcnt lgkmcnt(0)
    v_mfma_f32_16x16x32_bf16 v[228:231], v[204:207], v[132:135], v[228:231]
    v_mfma_f32_16x16x32_bf16 v[236:239], v[204:207], v[140:143], v[236:239]
    buffer_load_dwordx4 a[40:43], v2, s[24:27], s47 offen offset:2048 sc1
    v_mfma_f32_16x16x32_bf16 v[228:231], v[220:223], v[148:151], v[228:231]
    v_mfma_f32_16x16x32_bf16 v[236:239], v[220:223], v[132:135], v[236:239]
    v_pk_mul_f32 v[240:241], v[232:233], v[184:185]
    v_pk_mul_f32 v[242:243], v[224:225], v[184:185]
    v_pk_fma_f32 v[224:225], v[224:225], v[176:177], v[240:241] neg_lo:[0,0,1] neg_hi:[0,0,1]
    v_pk_fma_f32 v[232:233], v[232:233], v[176:177], v[242:243]
    buffer_load_dwordx4 a[44:47], v2, s[24:27], s47 offen offset:3072 sc1
    v_pk_mul_f32 v[240:241], v[234:235], v[186:187]
    v_pk_mul_f32 v[242:243], v[226:227], v[186:187]
    v_pk_fma_f32 v[226:227], v[226:227], v[178:179], v[240:241] neg_lo:[0,0,1] neg_hi:[0,0,1]
    v_pk_fma_f32 v[234:235], v[234:235], v[178:179], v[242:243]
    v_cvt_pk_bf16_f32 v32, v224, v225
    v_cvt_pk_bf16_f32 v33, v226, v227
    s_add_u32 s47, s62, 12288
    buffer_load_dwordx4 a[48:51], v2, s[24:27], s47 offen offset:0 sc1
    v_cvt_pk_bf16_f32 v36, v232, v233
    v_cvt_pk_bf16_f32 v37, v234, v235
    v_pk_mul_f32 v[240:241], v[236:237], v[188:189]
    v_pk_mul_f32 v[242:243], v[228:229], v[188:189]
    v_pk_fma_f32 v[228:229], v[228:229], v[180:181], v[240:241] neg_lo:[0,0,1] neg_hi:[0,0,1]
    v_pk_fma_f32 v[236:237], v[236:237], v[180:181], v[242:243]
    buffer_load_dwordx4 a[52:55], v2, s[24:27], s47 offen offset:1024 sc1
    v_pk_mul_f32 v[240:241], v[238:239], v[190:191]
    v_pk_mul_f32 v[242:243], v[230:231], v[190:191]
    v_pk_fma_f32 v[230:231], v[230:231], v[182:183], v[240:241] neg_lo:[0,0,1] neg_hi:[0,0,1]
    v_pk_fma_f32 v[238:239], v[238:239], v[182:183], v[242:243]
    v_cvt_pk_bf16_f32 v34, v228, v229
    v_cvt_pk_bf16_f32 v35, v230, v231
    buffer_load_dwordx4 a[56:59], v2, s[24:27], s47 offen offset:2048 sc1
    v_cvt_pk_bf16_f32 v38, v236, v237
    v_cvt_pk_bf16_f32 v39, v238, v239
    v_mfma_f32_16x16x32_bf16 v[224:227], v[152:155], v[32:35], 0
    v_mfma_f32_16x16x32_bf16 v[232:235], v[160:163], v[32:35], 0
    v_mfma_f32_16x16x32_bf16 v[224:227], v[168:171], v[36:39], v[224:227]
    v_mfma_f32_16x16x32_bf16 v[232:235], v[152:155], v[36:39], v[232:235]
    buffer_load_dwordx4 a[60:63], v2, s[24:27], s47 offen offset:3072 sc1
    v_mfma_f32_16x16x32_bf16 v[228:231], v[156:159], v[32:35], 0
    v_mfma_f32_16x16x32_bf16 v[236:239], v[164:167], v[32:35], 0
    v_mfma_f32_16x16x32_bf16 v[228:231], v[172:175], v[36:39], v[228:231]
    v_mfma_f32_16x16x32_bf16 v[236:239], v[156:159], v[36:39], v[236:239]
    s_nop 2
    v_pk_mul_f32 v[240:241], v[232:233], v[24:25]
    v_pk_mul_f32 v[242:243], v[224:225], v[24:25]
    s_add_u32 s47, s62, 16384
    buffer_load_dwordx4 a[64:67], v2, s[24:27], s47 offen offset:0 sc1
    v_pk_fma_f32 v[224:225], v[224:225], v[16:17], v[240:241] neg_lo:[0,0,1] neg_hi:[0,0,1]
    v_pk_fma_f32 v[232:233], v[232:233], v[16:17], v[242:243]
    v_pk_mul_f32 v[240:241], v[234:235], v[26:27]
    v_pk_mul_f32 v[242:243], v[226:227], v[26:27]
    v_pk_fma_f32 v[226:227], v[226:227], v[18:19], v[240:241] neg_lo:[0,0,1] neg_hi:[0,0,1]
    v_pk_fma_f32 v[234:235], v[234:235], v[18:19], v[242:243]
    buffer_load_dwordx4 a[68:71], v2, s[24:27], s47 offen offset:1024 sc1
    v_cvt_pk_bf16_f32 v32, v224, v225
    v_cvt_pk_bf16_f32 v33, v226, v227
    v_cvt_pk_bf16_f32 v36, v232, v233
    v_cvt_pk_bf16_f32 v37, v234, v235
    v_pk_mul_f32 v[240:241], v[236:237], v[28:29]
    v_pk_mul_f32 v[242:243], v[228:229], v[28:29]
    buffer_load_dwordx4 a[72:75], v2, s[24:27], s47 offen offset:2048 sc1
    v_pk_fma_f32 v[228:229], v[228:229], v[20:21], v[240:241] neg_lo:[0,0,1] neg_hi:[0,0,1]
    v_pk_fma_f32 v[236:237], v[236:237], v[20:21], v[242:243]
    v_pk_mul_f32 v[240:241], v[238:239], v[30:31]
    v_pk_mul_f32 v[242:243], v[230:231], v[30:31]
    v_pk_fma_f32 v[230:231], v[230:231], v[22:23], v[240:241] neg_lo:[0,0,1] neg_hi:[0,0,1]
    v_pk_fma_f32 v[238:239], v[238:239], v[22:23], v[242:243]
    buffer_load_dwordx4 a[76:79], v2, s[24:27], s47 offen offset:3072 sc1
    v_cvt_pk_bf16_f32 v34, v228, v229
    v_cvt_pk_bf16_f32 v35, v230, v231
    v_cvt_pk_bf16_f32 v38, v236, v237
    v_cvt_pk_bf16_f32 v39, v238, v239
    v_mfma_f32_16x16x32_bf16 v[224:227], v[152:155], v[32:35], 0
    v_mfma_f32_16x16x32_bf16 v[232:235], v[168:171], v[32:35], 0
    s_add_u32 s47, s62, 20480
    buffer_load_dwordx4 a[80:83], v2, s[24:27], s47 offen offset:0 sc1
    v_mfma_f32_16x16x32_bf16 v[224:227], v[160:163], v[36:39], v[224:227]
    v_mfma_f32_16x16x32_bf16 v[232:235], v[152:155], v[36:39], v[232:235]
    v_mfma_f32_16x16x32_bf16 v[228:231], v[156:159], v[32:35], 0
    v_mfma_f32_16x16x32_bf16 v[236:239], v[172:175], v[32:35], 0
    v_mfma_f32_16x16x32_bf16 v[228:231], v[164:167], v[36:39], v[228:231]
    v_mfma_f32_16x16x32_bf16 v[236:239], v[156:159], v[36:39], v[236:239]
    buffer_load_dwordx4 a[84:87], v2, s[24:27], s47 offen offset:1024 sc1
    s_nop 2
    v_pk_mul_f32 v[240:241], v[232:233], v[184:185]
    v_pk_mul_f32 v[242:243], v[224:225], v[184:185]
    v_pk_fma_f32 v[224:225], v[224:225], v[176:177], v[240:241]
    v_pk_fma_f32 v[232:233], v[232:233], v[176:177], v[242:243] neg_lo:[0,0,1] neg_hi:[0,0,1]
    v_pk_mul_f32 v[240:241], v[234:235], v[186:187]
    v_pk_mul_f32 v[242:243], v[226:227], v[186:187]
    buffer_load_dwordx4 a[88:91], v2, s[24:27], s47 offen offset:2048 sc1
    v_pk_fma_f32 v[226:227], v[226:227], v[178:179], v[240:241]
    v_pk_fma_f32 v[234:235], v[234:235], v[178:179], v[242:243] neg_lo:[0,0,1] neg_hi:[0,0,1]
    v_cvt_pk_bf16_f32 v32, v224, v225
    v_cvt_pk_bf16_f32 v33, v226, v227
    v_cvt_pk_bf16_f32 v36, v232, v233
    v_cvt_pk_bf16_f32 v37, v234, v235
    buffer_load_dwordx4 a[92:95], v2, s[24:27], s47 offen offset:3072 sc1
    ds_write_b64 v11, v[32:33] offset:0
    ds_write_b64 v11, v[36:37] offset:512
    v_pk_mul_f32 v[240:241], v[236:237], v[188:189]
    v_pk_mul_f32 v[242:243], v[228:229], v[188:189]
    v_pk_fma_f32 v[228:229], v[228:229], v[180:181], v[240:241]
    v_pk_fma_f32 v[236:237], v[236:237], v[180:181], v[242:243] neg_lo:[0,0,1] neg_hi:[0,0,1]
    s_add_u32 s47, s62, 24576
    buffer_load_dwordx4 a[96:99], v2, s[24:27], s47 offen offset:0 sc1
    v_pk_mul_f32 v[240:241], v[238:239], v[190:191]
    v_pk_mul_f32 v[242:243], v[230:231], v[190:191]
    v_pk_fma_f32 v[230:231], v[230:231], v[182:183], v[240:241]
    v_pk_fma_f32 v[238:239], v[238:239], v[182:183], v[242:243] neg_lo:[0,0,1] neg_hi:[0,0,1]
    v_cvt_pk_bf16_f32 v34, v228, v229
    v_cvt_pk_bf16_f32 v35, v230, v231
    buffer_load_dwordx4 a[100:103], v2, s[24:27], s47 offen offset:1024 sc1
    v_cvt_pk_bf16_f32 v38, v236, v237
    v_cvt_pk_bf16_f32 v39, v238, v239
    ds_write_b64 v11, v[34:35] offset:1024
    ds_write_b64 v11, v[38:39] offset:1536
    buffer_load_dwordx4 a[104:107], v2, s[24:27], s47 offen offset:2048 sc1
    buffer_load_dwordx4 a[108:111], v2, s[24:27], s47 offen offset:3072 sc1
    s_add_u32 s47, s62, 28672
    buffer_load_dwordx4 a[112:115], v2, s[24:27], s47 offen offset:0 sc1
    buffer_load_dwordx4 a[116:119], v2, s[24:27], s47 offen offset:1024 sc1
    buffer_load_dwordx4 a[120:123], v2, s[24:27], s47 offen offset:2048 sc1
    buffer_load_dwordx4 a[124:127], v2, s[24:27], s47 offen offset:3072 sc1
    s_waitcnt lgkmcnt(0)
    s_barrier
    ds_read_b64_tr_b16 v[192:193], v12 offset:0
    ds_read_b64_tr_b16 v[194:195], v12 offset:2048
    ds_read_b64_tr_b16 v[208:209], v12 offset:512
    ds_read_b64_tr_b16 v[210:211], v12 offset:2560
    ds_read_b64_tr_b16 v[196:197], v12 offset:4096
    ds_read_b64_tr_b16 v[198:199], v12 offset:6144
    ds_read_b64_tr_b16 v[212:213], v12 offset:4608
    ds_read_b64_tr_b16 v[214:215], v12 offset:6656
    ds_read_b64_tr_b16 v[200:201], v12 offset:1024
    ds_read_b64_tr_b16 v[202:203], v12 offset:3072
    ds_read_b64_tr_b16 v[216:217], v12 offset:1536
    ds_read_b64_tr_b16 v[218:219], v12 offset:3584
    ds_read_b64_tr_b16 v[204:205], v12 offset:5120
    ds_read_b64_tr_b16 v[206:207], v12 offset:7168
    ds_read_b64_tr_b16 v[220:221], v12 offset:5632
    ds_read_b64_tr_b16 v[222:223], v12 offset:7680
    s_waitcnt lgkmcnt(12)
    v_mfma_f32_16x16x32_bf16 v[224:227], v[128:131], v[192:195], 0
    v_mfma_f32_16x16x32_bf16 v[232:235], v[144:147], v[192:195], 0
    v_mfma_f32_16x16x32_bf16 v[224:227], v[136:139], v[208:211], v[224:227]
    v_mfma_f32_16x16x32_bf16 v[232:235], v[128:131], v[208:211], v[232:235]
    s_waitcnt lgkmcnt(8)
    v_mfma_f32_16x16x32_bf16 v[224:227], v[132:135], v[196:199], v[224:227]
    v_mfma_f32_16x16x32_bf16 v[232:235], v[148:151], v[196:199], v[232:235]
    v_mfma_f32_16x16x32_bf16 v[224:227], v[140:143], v[212:215], v[224:227]
    v_mfma_f32_16x16x32_bf16 v[232:235], v[132:135], v[212:215], v[232:235]
    s_waitcnt lgkmcnt(4)
    v_mfma_f32_16x16x32_bf16 v[228:231], v[128:131], v[200:203], 0
    v_mfma_f32_16x16x32_bf16 v[236:239], v[144:147], v[200:203], 0
    v_mfma_f32_16x16x32_bf16 v[228:231], v[136:139], v[216:219], v[228:231]
    v_mfma_f32_16x16x32_bf16 v[236:239], v[128:131], v[216:219], v[236:239]
    s_waitcnt lgkmcnt(0)
    v_mfma_f32_16x16x32_bf16 v[228:231], v[132:135], v[204:207], v[228:231]
    v_mfma_f32_16x16x32_bf16 v[236:239], v[148:151], v[204:207], v[236:239]
    v_mfma_f32_16x16x32_bf16 v[228:231], v[140:143], v[220:223], v[228:231]
    v_mfma_f32_16x16x32_bf16 v[236:239], v[132:135], v[220:223], v[236:239]
    v_pk_add_f32 v[96:97], v[96:97], v[224:225]
    v_pk_fma_f32 v[104:105], v[232:233], s[66:67], v[104:105] op_sel_hi:[1,0,1]
    v_pk_add_f32 v[98:99], v[98:99], v[226:227]
    v_pk_fma_f32 v[106:107], v[234:235], s[66:67], v[106:107] op_sel_hi:[1,0,1]
    v_cvt_pk_bf16_f32 v64, v96, v97
    v_cvt_pk_bf16_f32 v65, v98, v99
    v_cvt_pk_bf16_f32 v68, v104, v105
    v_cvt_pk_bf16_f32 v69, v106, v107
    v_pk_add_f32 v[100:101], v[100:101], v[228:229]
    v_pk_fma_f32 v[108:109], v[236:237], s[66:67], v[108:109] op_sel_hi:[1,0,1]
    v_pk_add_f32 v[102:103], v[102:103], v[230:231]
    v_pk_fma_f32 v[110:111], v[238:239], s[66:67], v[110:111] op_sel_hi:[1,0,1]
    v_cvt_pk_bf16_f32 v66, v100, v101
    v_cvt_pk_bf16_f32 v67, v102, v103
    v_cvt_pk_bf16_f32 v70, v108, v109
    v_cvt_pk_bf16_f32 v71, v110, v111
    buffer_store_dwordx4 v[64:67], v2, s[24:27], s68 offen sc1
    buffer_store_dwordx4 v[68:71], v2, s[24:27], s69 offen sc1
    v_pk_add_f32 v[224:225], v[112:113], v[224:225]
    v_pk_fma_f32 v[232:233], v[232:233], s[66:67], v[120:121] op_sel_hi:[1,0,1]
    v_pk_add_f32 v[226:227], v[114:115], v[226:227]
    v_pk_fma_f32 v[234:235], v[234:235], s[66:67], v[122:123] op_sel_hi:[1,0,1]
    v_pk_add_f32 v[228:229], v[116:117], v[228:229]
    v_pk_fma_f32 v[236:237], v[236:237], s[66:67], v[124:125] op_sel_hi:[1,0,1]
    v_pk_add_f32 v[230:231], v[118:119], v[230:231]
    v_pk_fma_f32 v[238:239], v[238:239], s[66:67], v[126:127] op_sel_hi:[1,0,1]
    v_cvt_pk_bf16_f32 v80, v224, v225
    v_cvt_pk_bf16_f32 v81, v226, v227
    v_cvt_pk_bf16_f32 v82, v228, v229
    v_cvt_pk_bf16_f32 v83, v230, v231
    v_cvt_pk_bf16_f32 v84, v232, v233
    v_cvt_pk_bf16_f32 v85, v234, v235
    v_cvt_pk_bf16_f32 v86, v236, v237
    v_cvt_pk_bf16_f32 v87, v238, v239
    buffer_store_dwordx4 v[80:83], v2, s[24:27], s60 offen sc1
    buffer_store_dwordx4 v[84:87], v2, s[24:27], s61 offen sc1
    v_lshrrev_b32 v40, 3, v1
    v_and_b32 v41, 7, v1
    v_lshrrev_b32 v42, 2, v1
    v_and_b32 v42, 4, v42
    v_xor_b32 v41, v41, v42
    v_lshlrev_b32 v41, 4, v41
    v_lshl_add_u32 v13, v40, 12, v41
    v_xor_b32 v51, 32, v13
    v_lshrrev_b32 v40, 2, v1
    v_and_b32 v40, 3, v40
    v_and_b32 v42, 1, v1
    v_lshlrev_b32 v41, 4, v42
    v_and_b32 v42, 2, v1
    v_lshl_or_b32 v41, v42, 2, v41
    v_lshl_or_b32 v41, v40, 7, v41
    v_lshrrev_b32 v42, 1, v40
    v_lshl_or_b32 v41, v42, 6, v41
    v_and_b32 v42, 16, v1
    v_lshl_or_b32 v41, v42, 1, v41
    v_and_b32 v42, 48, v1
    v_lshl_or_b32 v8, v42, 6, v41
    v_xor_b32 v9, 32, v8
    v_xor_b32 v10, 64, v8
    v_xor_b32 v11, 96, v8
    s_lshr_b32 s66, s3, 1
    s_and_b32 s67, s3, 1
    v_lshl_or_b32 v12, v4, 10, v41
    v_lshlrev_b32 v42, 5, v4
    v_xor_b32 v12, v12, v42
    s_lshl_b32 s56, s67, 6
    v_xor_b32 v12, s56, v12
    s_lshl_b32 s56, s66, 16
    s_lshl_b32 s57, s52, 11
    s_add_u32 s56, s56, s57
    v_add_u32 v12, s56, v12
    v_and_b32 v50, 15, v1
    v_lshlrev_b32 v50, 4, v50
    v_and_b32 v42, 48, v1
    v_lshl_or_b32 v50, v42, 5, v50
    v_mov_b32 v14, 0
    v_mov_b32 v15, 1
    s_mul_i32 s56, s3, 57344
    s_mul_i32 s64, s54, 229376
    s_add_u32 s64, s64, s56
    s_add_u32 s64, s64, 0x1200000
    s_mul_i32 s65, s55, 229376
    s_add_u32 s65, s65, s56
    s_lshr_b32 s65, s65, 1
    s_add_u32 s65, s65, 0x1400000
    s_lshl_b32 s58, s3, 16
    s_lshl_b32 s59, s53, 8
    s_add_u32 s58, s58, s59
    s_mov_b32 s56, 0x2200000
    s_mov_b32 s57, 0x800000
    s_cmp_ge_u32 s52, 14
    s_cselect_b32 s56, s57, s56
    s_add_u32 s58, s58, s56
    s_lshl_b32 s59, s3, 11
    s_mov_b32 s15, 0x2128000
    s_lshl_b32 s60, s52, 2
    s_add_u32 s60, s60, s3
    s_lshl_b32 s60, s60, 12
    s_mul_i32 s32, s53, 458752
    s_add_u32 s32, s32, s60
    s_lshr_b32 s32, s32, 1
    s_add_u32 s32, s32, 0x1400000
    s_add_u32 s33, s32, 114688
    s_add_u32 s34, s32, 3670016
    s_add_u32 s35, s33, 3670016
    s_lshl_b32 s56, s53, 17
    s_lshr_b32 s57, s60, 1
    s_add_u32 s56, s56, s57
    s_add_u32 s56, s56, 0x1be4000
    s_cmp_ge_u32 s52, 14
    s_cselect_b32 s32, s56, s32
    s_add_u32 s56, s56, 0x8000
    s_cmp_ge_u32 s52, 14
    s_cselect_b32 s33, s56, s33
    s_add_u32 s56, s56, 0x8000
    s_cmp_ge_u32 s52, 14
    s_cselect_b32 s34, s56, s34
    s_add_u32 s56, s56, 0x8000
    s_cmp_ge_u32 s52, 14
    s_cselect_b32 s35, s56, s35
    s_lshl_b32 s40, s53, 8
    s_add_u32 s40, s40, 0x2130000
    s_add_u32 s41, s40, 0x4000
    s_cmp_lg_u32 s3, 0
    s_cselect_b32 s41, 0x4000000, s41
    s_cselect_b32 s40, 0x4000000, s40
    s_lshr_b32 s42, s55, 1
    s_lshl_b32 s42, s42, 8
    s_add_u32 s42, s42, 0x2130000
    s_add_u32 s43, s42, 0x4000
    s_lshr_b32 s36, s60, 12
    s_mul_i32 s36, s36, 37
    s_lshr_b32 s36, s36, 9
    s_lshl_b32 s57, s53, 2
    s_add_u32 s36, s36, s57
    s_lshl_b32 s36, s36, 8
    s_add_u32 s36, s36, 0x2144000
    s_lshr_b32 s37, s55, 1
    s_lshl_b32 s37, s37, 2
    s_add_u32 s37, s37, s3
    s_lshl_b32 s37, s37, 8
    s_add_u32 s37, s37, 0x2144000
    s_lshl_b32 s44, s53, 9
    s_lshl_b32 s57, s3, 7
    s_add_u32 s44, s44, s57
    s_add_u32 s44, s44, 0x2006000
    s_waitcnt vmcnt(0)
    s_barrier
    s_cmp_lg_u32 s3, 0
    s_cbranch_scc1 Lar37
    v_mov_b32 v6, 0
    v_mov_b32 v7, 1
    s_mov_b64 exec, 1
    s_and_b32 s56, s2, 15
    s_lshl_b32 s56, s56, 8
    s_add_u32 s56, s56, 0x2128000
    buffer_atomic_add v7, v6, s[24:27], s56 offen sc1
    s_mov_b64 exec, -1
Lar37:
    s_cmp_ge_u32 s52, 14
    s_cbranch_scc1 Lalt38
    v_add_u32 v49, s59, v2
    v_and_b32 v59, 15, v1
    v_lshlrev_b32 v59, 8, v59
    s_add_u32 s60, s58, 0
    buffer_load_dwordx4 v[224:227], v13, s[24:27], s60 offen sc1
    s_add_u32 s60, s58, 32768
    buffer_load_dwordx4 v[228:231], v51, s[24:27], s60 offen sc1
    s_add_u32 s60, s58, 262144
    buffer_load_dwordx4 v[232:235], v13, s[24:27], s60 offen sc1
    s_add_u32 s60, s58, 294912
    buffer_load_dwordx4 v[236:239], v51, s[24:27], s60 offen sc1
    s_add_u32 s60, s58, 524288
    buffer_load_dwordx4 v[240:243], v13, s[24:27], s60 offen sc1
    s_add_u32 s60, s58, 557056
    buffer_load_dwordx4 v[244:247], v51, s[24:27], s60 offen sc1
    s_add_u32 s60, s58, 786432
    buffer_load_dwordx4 v[248:251], v13, s[24:27], s60 offen sc1
    s_add_u32 s60, s58, 819200
    buffer_load_dwordx4 v[252:255], v51, s[24:27], s60 offen sc1
    s_waitcnt vmcnt(6)
    v_max3_u32 v58, v224, v225, v226
    v_max3_u32 v58, v58, v227, v228
    v_max3_u32 v58, v58, v229, v230
    v_max_u32 v58, v58, v231
    v_cmp_eq_u32 vcc, -1, v58
    s_cbranch_vccnz Lsr40
Lsb41:
    ds_write_b128 v49, v[224:227] offset:0
    ds_write_b128 v49, v[228:231] offset:1024
    s_waitcnt lgkmcnt(0)
    s_barrier
    ds_read_b64_tr_b16 v[64:65], v8 offset:0
    ds_read_b64_tr_b16 v[66:67], v8 offset:512
    ds_read_b64_tr_b16 v[68:69], v9 offset:0
    ds_read_b64_tr_b16 v[70:71], v9 offset:512
    ds_read_b64_tr_b16 v[72:73], v10 offset:0
    ds_read_b64_tr_b16 v[74:75], v10 offset:512
    ds_read_b64_tr_b16 v[76:77], v11 offset:0
    ds_read_b64_tr_b16 v[78:79], v11 offset:512
    s_waitcnt vmcnt(4)
    v_max3_u32 v58, v232, v233, v234
    v_max3_u32 v58, v58, v235, v236
    v_max3_u32 v58, v58, v237, v238
    v_max_u32 v58, v58, v239
    v_cmp_eq_u32 vcc, -1, v58
    s_cbranch_vccnz Lsr44
Lsb45:
    ds_write_b128 v49, v[232:235] offset:8192
    ds_write_b128 v49, v[236:239] offset:9216
    s_waitcnt lgkmcnt(8)
    v_mfma_f32_16x16x32_bf16 v[128:131], a[0:3], v[64:67], 0
    ds_read_b64_tr_b16 v[80:81], v8 offset:4096
    v_mfma_f32_16x16x32_bf16 v[132:135], a[4:7], v[64:67], 0
    ds_read_b64_tr_b16 v[82:83], v8 offset:4608
    v_mfma_f32_16x16x32_bf16 v[160:163], a[8:11], v[64:67], 0
    v_mfma_f32_16x16x32_bf16 v[164:167], a[12:15], v[64:67], 0
    s_waitcnt lgkmcnt(8)
    v_mfma_f32_16x16x32_bf16 v[136:139], a[0:3], v[68:71], 0
    ds_read_b64_tr_b16 v[84:85], v9 offset:4096
    v_mfma_f32_16x16x32_bf16 v[140:143], a[4:7], v[68:71], 0
    ds_read_b64_tr_b16 v[86:87], v9 offset:4608
    v_mfma_f32_16x16x32_bf16 v[168:171], a[8:11], v[68:71], 0
    v_mfma_f32_16x16x32_bf16 v[172:175], a[12:15], v[68:71], 0
    s_waitcnt lgkmcnt(8)
    v_mfma_f32_16x16x32_bf16 v[144:147], a[0:3], v[72:75], 0
    ds_read_b64_tr_b16 v[88:89], v10 offset:4096
    v_mfma_f32_16x16x32_bf16 v[148:151], a[4:7], v[72:75], 0
    ds_read_b64_tr_b16 v[90:91], v10 offset:4608
    v_mfma_f32_16x16x32_bf16 v[176:179], a[8:11], v[72:75], 0
    v_mfma_f32_16x16x32_bf16 v[180:183], a[12:15], v[72:75], 0
    s_waitcnt lgkmcnt(8)
    v_mfma_f32_16x16x32_bf16 v[152:155], a[0:3], v[76:79], 0
    ds_read_b64_tr_b16 v[92:93], v11 offset:4096
    v_mfma_f32_16x16x32_bf16 v[156:159], a[4:7], v[76:79], 0
    ds_read_b64_tr_b16 v[94:95], v11 offset:4608
    v_mfma_f32_16x16x32_bf16 v[184:187], a[8:11], v[76:79], 0
    v_mfma_f32_16x16x32_bf16 v[188:191], a[12:15], v[76:79], 0
    s_waitcnt lgkmcnt(8)
    s_barrier
    s_waitcnt lgkmcnt(6)
    v_mfma_f32_16x16x32_bf16 v[128:131], a[16:19], v[80:83], v[128:131]
    ds_read_b64_tr_b16 v[64:65], v8 offset:8192
    v_mfma_f32_16x16x32_bf16 v[132:135], a[20:23], v[80:83], v[132:135]
    ds_read_b64_tr_b16 v[66:67], v8 offset:8704
    v_mfma_f32_16x16x32_bf16 v[160:163], a[24:27], v[80:83], v[160:163]
    v_mfma_f32_16x16x32_bf16 v[164:167], a[28:31], v[80:83], v[164:167]
    s_waitcnt lgkmcnt(6)
    v_mfma_f32_16x16x32_bf16 v[136:139], a[16:19], v[84:87], v[136:139]
    ds_read_b64_tr_b16 v[68:69], v9 offset:8192
    v_mfma_f32_16x16x32_bf16 v[140:143], a[20:23], v[84:87], v[140:143]
    ds_read_b64_tr_b16 v[70:71], v9 offset:8704
    v_mfma_f32_16x16x32_bf16 v[168:171], a[24:27], v[84:87], v[168:171]
    v_mfma_f32_16x16x32_bf16 v[172:175], a[28:31], v[84:87], v[172:175]
    buffer_load_dword v57, v59, s[24:27], s15 offen sc1
    s_waitcnt lgkmcnt(6)
    v_mfma_f32_16x16x32_bf16 v[144:147], a[16:19], v[88:91], v[144:147]
    ds_read_b64_tr_b16 v[72:73], v10 offset:8192
    v_mfma_f32_16x16x32_bf16 v[148:151], a[20:23], v[88:91], v[148:151]
    ds_read_b64_tr_b16 v[74:75], v10 offset:8704
    v_mfma_f32_16x16x32_bf16 v[176:179], a[24:27], v[88:91], v[176:179]
    v_mfma_f32_16x16x32_bf16 v[180:183], a[28:31], v[88:91], v[180:183]
    s_waitcnt lgkmcnt(6)
    v_mfma_f32_16x16x32_bf16 v[152:155], a[16:19], v[92:95], v[152:155]
    ds_read_b64_tr_b16 v[76:77], v11 offset:8192
    v_mfma_f32_16x16x32_bf16 v[156:159], a[20:23], v[92:95], v[156:159]
    ds_read_b64_tr_b16 v[78:79], v11 offset:8704
    v_mfma_f32_16x16x32_bf16 v[184:187], a[24:27], v[92:95], v[184:187]
    v_mfma_f32_16x16x32_bf16 v[188:191], a[28:31], v[92:95], v[188:191]
    s_waitcnt vmcnt(1)
    v_max3_u32 v58, v240, v241, v242
    v_max3_u32 v58, v58, v243, v244
    v_max3_u32 v58, v58, v245, v246
    v_max3_u32 v58, v58, v247, v248
    v_max3_u32 v58, v58, v249, v250
    v_max3_u32 v58, v58, v251, v252
    v_max3_u32 v58, v58, v253, v254
    v_max_u32 v58, v58, v255
    v_cmp_eq_u32 vcc, -1, v58
    s_cbranch_vccnz Lsr48
Lsb49:
    ds_write_b128 v49, v[240:243] offset:16384
    ds_write_b128 v49, v[244:247] offset:17408
    ds_write_b128 v49, v[248:251] offset:24576
    ds_write_b128 v49, v[252:255] offset:25600
    s_waitcnt lgkmcnt(10)
    v_mfma_f32_16x16x32_bf16 v[128:131], a[32:35], v[64:67], v[128:131]
    ds_read_b64_tr_b16 v[80:81], v8 offset:12288
    v_mfma_f32_16x16x32_bf16 v[132:135], a[36:39], v[64:67], v[132:135]
    ds_read_b64_tr_b16 v[82:83], v8 offset:12800
    v_mfma_f32_16x16x32_bf16 v[160:163], a[40:43], v[64:67], v[160:163]
    v_mfma_f32_16x16x32_bf16 v[164:167], a[44:47], v[64:67], v[164:167]
    s_waitcnt lgkmcnt(10)
    v_mfma_f32_16x16x32_bf16 v[136:139], a[32:35], v[68:71], v[136:139]
    ds_read_b64_tr_b16 v[84:85], v9 offset:12288
    v_mfma_f32_16x16x32_bf16 v[140:143], a[36:39], v[68:71], v[140:143]
    ds_read_b64_tr_b16 v[86:87], v9 offset:12800
    v_mfma_f32_16x16x32_bf16 v[168:171], a[40:43], v[68:71], v[168:171]
    v_mfma_f32_16x16x32_bf16 v[172:175], a[44:47], v[68:71], v[172:175]
    s_waitcnt lgkmcnt(10)
    v_mfma_f32_16x16x32_bf16 v[144:147], a[32:35], v[72:75], v[144:147]
    ds_read_b64_tr_b16 v[88:89], v10 offset:12288
    v_mfma_f32_16x16x32_bf16 v[148:151], a[36:39], v[72:75], v[148:151]
    ds_read_b64_tr_b16 v[90:91], v10 offset:12800
    v_mfma_f32_16x16x32_bf16 v[176:179], a[40:43], v[72:75], v[176:179]
    v_mfma_f32_16x16x32_bf16 v[180:183], a[44:47], v[72:75], v[180:183]
    s_waitcnt lgkmcnt(10)
    v_mfma_f32_16x16x32_bf16 v[152:155], a[32:35], v[76:79], v[152:155]
    ds_read_b64_tr_b16 v[92:93], v11 offset:12288
    v_mfma_f32_16x16x32_bf16 v[156:159], a[36:39], v[76:79], v[156:159]
    ds_read_b64_tr_b16 v[94:95], v11 offset:12800
    v_mfma_f32_16x16x32_bf16 v[184:187], a[40:43], v[76:79], v[184:187]
    v_mfma_f32_16x16x32_bf16 v[188:191], a[44:47], v[76:79], v[188:191]
    s_waitcnt lgkmcnt(8)
    s_barrier
    s_waitcnt lgkmcnt(6)
    v_mfma_f32_16x16x32_bf16 v[128:131], a[48:51], v[80:83], v[128:131]
    ds_read_b64_tr_b16 v[64:65], v8 offset:16384
    v_mfma_f32_16x16x32_bf16 v[132:135], a[52:55], v[80:83], v[132:135]
    ds_read_b64_tr_b16 v[66:67], v8 offset:16896
    v_mfma_f32_16x16x32_bf16 v[160:163], a[56:59], v[80:83], v[160:163]
    v_mfma_f32_16x16x32_bf16 v[164:167], a[60:63], v[80:83], v[164:167]
    s_waitcnt lgkmcnt(6)
    v_mfma_f32_16x16x32_bf16 v[136:139], a[48:51], v[84:87], v[136:139]
    ds_read_b64_tr_b16 v[68:69], v9 offset:16384
    v_mfma_f32_16x16x32_bf16 v[140:143], a[52:55], v[84:87], v[140:143]
    ds_read_b64_tr_b16 v[70:71], v9 offset:16896
    v_mfma_f32_16x16x32_bf16 v[168:171], a[56:59], v[84:87], v[168:171]
    v_mfma_f32_16x16x32_bf16 v[172:175], a[60:63], v[84:87], v[172:175]
    s_waitcnt lgkmcnt(6)
    v_mfma_f32_16x16x32_bf16 v[144:147], a[48:51], v[88:91], v[144:147]
    ds_read_b64_tr_b16 v[72:73], v10 offset:16384
    v_mfma_f32_16x16x32_bf16 v[148:151], a[52:55], v[88:91], v[148:151]
    ds_read_b64_tr_b16 v[74:75], v10 offset:16896
    v_mfma_f32_16x16x32_bf16 v[176:179], a[56:59], v[88:91], v[176:179]
    v_mfma_f32_16x16x32_bf16 v[180:183], a[60:63], v[88:91], v[180:183]
    s_waitcnt lgkmcnt(6)
    v_mfma_f32_16x16x32_bf16 v[152:155], a[48:51], v[92:95], v[152:155]
    ds_read_b64_tr_b16 v[76:77], v11 offset:16384
    v_mfma_f32_16x16x32_bf16 v[156:159], a[52:55], v[92:95], v[156:159]
    ds_read_b64_tr_b16 v[78:79], v11 offset:16896
    v_mfma_f32_16x16x32_bf16 v[184:187], a[56:59], v[92:95], v[184:187]
    v_mfma_f32_16x16x32_bf16 v[188:191], a[60:63], v[92:95], v[188:191]
    s_waitcnt vmcnt(0)
    v_cmp_gt_u32 vcc, 16, v57
    s_cbranch_vccnz Lgk52
Lgb53:
    s_waitcnt lgkmcnt(6)
    v_mfma_f32_16x16x32_bf16 v[128:131], a[64:67], v[64:67], v[128:131]
    ds_read_b64_tr_b16 v[80:81], v8 offset:20480
    s_add_u32 m0, s59, 32768
    v_mfma_f32_16x16x32_bf16 v[132:135], a[68:71], v[64:67], v[132:135]
    ds_read_b64_tr_b16 v[82:83], v8 offset:20992
    s_add_u32 s60, s58, 1048576
    v_mfma_f32_16x16x32_bf16 v[160:163], a[72:75], v[64:67], v[160:163]
    buffer_load_dwordx4 v13, s[24:27], s60 offen sc1 lds
    v_mfma_f32_16x16x32_bf16 v[164:167], a[76:79], v[64:67], v[164:167]
    s_waitcnt lgkmcnt(6)
    v_mfma_f32_16x16x32_bf16 v[136:139], a[64:67], v[68:71], v[136:139]
    ds_read_b64_tr_b16 v[84:85], v9 offset:20480
    s_add_u32 m0, s59, 33792
    v_mfma_f32_16x16x32_bf16 v[140:143], a[68:71], v[68:71], v[140:143]
    ds_read_b64_tr_b16 v[86:87], v9 offset:20992
    s_add_u32 s60, s58, 1081344
    v_mfma_f32_16x16x32_bf16 v[168:171], a[72:75], v[68:71], v[168:171]
    buffer_load_dwordx4 v51, s[24:27], s60 offen sc1 lds
    v_mfma_f32_16x16x32_bf16 v[172:175], a[76:79], v[68:71], v[172:175]
    s_waitcnt lgkmcnt(6)
    v_mfma_f32_16x16x32_bf16 v[144:147], a[64:67], v[72:75], v[144:147]
    ds_read_b64_tr_b16 v[88:89], v10 offset:20480
    s_add_u32 m0, s59, 40960
    v_mfma_f32_16x16x32_bf16 v[148:151], a[68:71], v[72:75], v[148:151]
    ds_read_b64_tr_b16 v[90:91], v10 offset:20992
    s_add_u32 s60, s58, 1310720
    v_mfma_f32_16x16x32_bf16 v[176:179], a[72:75], v[72:75], v[176:179]
    buffer_load_dwordx4 v13, s[24:27], s60 offen sc1 lds
    v_mfma_f32_16x16x32_bf16 v[180:183], a[76:79], v[72:75], v[180:183]
    s_waitcnt lgkmcnt(6)
    v_mfma_f32_16x16x32_bf16 v[152:155], a[64:67], v[76:79], v[152:155]
    ds_read_b64_tr_b16 v[92:93], v11 offset:20480
    s_add_u32 m0, s59, 41984
    v_mfma_f32_16x16x32_bf16 v[156:159], a[68:71], v[76:79], v[156:159]
    ds_read_b64_tr_b16 v[94:95], v11 offset:20992
    s_add_u32 s60, s58, 1343488
    v_mfma_f32_16x16x32_bf16 v[184:187], a[72:75], v[76:79], v[184:187]
    buffer_load_dwordx4 v51, s[24:27], s60 offen sc1 lds
    v_mfma_f32_16x16x32_bf16 v[188:191], a[76:79], v[76:79], v[188:191]
    s_waitcnt lgkmcnt(6)
    v_mfma_f32_16x16x32_bf16 v[128:131], a[80:83], v[80:83], v[128:131]
    ds_read_b64_tr_b16 v[64:65], v8 offset:24576
    s_add_u32 m0, s59, 49152
    v_mfma_f32_16x16x32_bf16 v[132:135], a[84:87], v[80:83], v[132:135]
    ds_read_b64_tr_b16 v[66:67], v8 offset:25088
    s_add_u32 s60, s58, 1572864
    v_mfma_f32_16x16x32_bf16 v[160:163], a[88:91], v[80:83], v[160:163]
    buffer_load_dwordx4 v13, s[24:27], s60 offen sc1 lds
    v_mfma_f32_16x16x32_bf16 v[164:167], a[92:95], v[80:83], v[164:167]
    s_waitcnt lgkmcnt(6)
    v_mfma_f32_16x16x32_bf16 v[136:139], a[80:83], v[84:87], v[136:139]
    ds_read_b64_tr_b16 v[68:69], v9 offset:24576
    s_add_u32 m0, s59, 50176
    v_mfma_f32_16x16x32_bf16 v[140:143], a[84:87], v[84:87], v[140:143]
    ds_read_b64_tr_b16 v[70:71], v9 offset:25088
    s_add_u32 s60, s58, 1605632
    v_mfma_f32_16x16x32_bf16 v[168:171], a[88:91], v[84:87], v[168:171]
    buffer_load_dwordx4 v51, s[24:27], s60 offen sc1 lds
    v_mfma_f32_16x16x32_bf16 v[172:175], a[92:95], v[84:87], v[172:175]
    s_waitcnt lgkmcnt(6)
    v_mfma_f32_16x16x32_bf16 v[144:147], a[80:83], v[88:91], v[144:147]
    ds_read_b64_tr_b16 v[72:73], v10 offset:24576
    s_add_u32 m0, s59, 57344
    v_mfma_f32_16x16x32_bf16 v[148:151], a[84:87], v[88:91], v[148:151]
    ds_read_b64_tr_b16 v[74:75], v10 offset:25088
    s_add_u32 s60, s58, 1835008
    v_mfma_f32_16x16x32_bf16 v[176:179], a[88:91], v[88:91], v[176:179]
    buffer_load_dwordx4 v13, s[24:27], s60 offen sc1 lds
    v_mfma_f32_16x16x32_bf16 v[180:183], a[92:95], v[88:91], v[180:183]
    s_waitcnt lgkmcnt(6)
    v_mfma_f32_16x16x32_bf16 v[152:155], a[80:83], v[92:95], v[152:155]
    ds_read_b64_tr_b16 v[76:77], v11 offset:24576
    s_add_u32 m0, s59, 58368
    v_mfma_f32_16x16x32_bf16 v[156:159], a[84:87], v[92:95], v[156:159]
    ds_read_b64_tr_b16 v[78:79], v11 offset:25088
    s_add_u32 s60, s58, 1867776
    v_mfma_f32_16x16x32_bf16 v[184:187], a[88:91], v[92:95], v[184:187]
    buffer_load_dwordx4 v51, s[24:27], s60 offen sc1 lds
    v_mfma_f32_16x16x32_bf16 v[188:191], a[92:95], v[92:95], v[188:191]
    s_waitcnt lgkmcnt(6)
    v_mfma_f32_16x16x32_bf16 v[128:131], a[96:99], v[64:67], v[128:131]
    ds_read_b64_tr_b16 v[80:81], v8 offset:28672
    s_add_u32 m0, s59, 65536
    v_mfma_f32_16x16x32_bf16 v[132:135], a[100:103], v[64:67], v[132:135]
    ds_read_b64_tr_b16 v[82:83], v8 offset:29184
    s_add_u32 s60, s58, 128
    v_mfma_f32_16x16x32_bf16 v[160:163], a[104:107], v[64:67], v[160:163]
    buffer_load_dwordx4 v13, s[24:27], s60 offen sc1 lds
    v_mfma_f32_16x16x32_bf16 v[164:167], a[108:111], v[64:67], v[164:167]
    s_waitcnt lgkmcnt(6)
    v_mfma_f32_16x16x32_bf16 v[136:139], a[96:99], v[68:71], v[136:139]
    ds_read_b64_tr_b16 v[84:85], v9 offset:28672
    s_add_u32 m0, s59, 66560
    v_mfma_f32_16x16x32_bf16 v[140:143], a[100:103], v[68:71], v[140:143]
    ds_read_b64_tr_b16 v[86:87], v9 offset:29184
    s_add_u32 s60, s58, 32896
    v_mfma_f32_16x16x32_bf16 v[168:171], a[104:107], v[68:71], v[168:171]
    buffer_load_dwordx4 v51, s[24:27], s60 offen sc1 lds
    v_mfma_f32_16x16x32_bf16 v[172:175], a[108:111], v[68:71], v[172:175]
    s_waitcnt lgkmcnt(6)
    v_mfma_f32_16x16x32_bf16 v[144:147], a[96:99], v[72:75], v[144:147]
    ds_read_b64_tr_b16 v[88:89], v10 offset:28672
    s_add_u32 m0, s59, 73728
    v_mfma_f32_16x16x32_bf16 v[148:151], a[100:103], v[72:75], v[148:151]
    ds_read_b64_tr_b16 v[90:91], v10 offset:29184
    s_add_u32 s60, s58, 262272
    v_mfma_f32_16x16x32_bf16 v[176:179], a[104:107], v[72:75], v[176:179]
    buffer_load_dwordx4 v13, s[24:27], s60 offen sc1 lds
    v_mfma_f32_16x16x32_bf16 v[180:183], a[108:111], v[72:75], v[180:183]
    s_waitcnt lgkmcnt(6)
    v_mfma_f32_16x16x32_bf16 v[152:155], a[96:99], v[76:79], v[152:155]
    ds_read_b64_tr_b16 v[92:93], v11 offset:28672
    s_add_u32 m0, s59, 74752
    v_mfma_f32_16x16x32_bf16 v[156:159], a[100:103], v[76:79], v[156:159]
    ds_read_b64_tr_b16 v[94:95], v11 offset:29184
    s_add_u32 s60, s58, 295040
    v_mfma_f32_16x16x32_bf16 v[184:187], a[104:107], v[76:79], v[184:187]
    buffer_load_dwordx4 v51, s[24:27], s60 offen sc1 lds
    v_mfma_f32_16x16x32_bf16 v[188:191], a[108:111], v[76:79], v[188:191]
    s_waitcnt vmcnt(8)
    s_barrier
    s_waitcnt lgkmcnt(6)
    v_mfma_f32_16x16x32_bf16 v[128:131], a[112:115], v[80:83], v[128:131]
    ds_read_b64_tr_b16 v[64:65], v8 offset:32768
    s_add_u32 m0, s59, 81920
    v_mfma_f32_16x16x32_bf16 v[132:135], a[116:119], v[80:83], v[132:135]
    ds_read_b64_tr_b16 v[66:67], v8 offset:33280
    s_add_u32 s60, s58, 524416
    v_mfma_f32_16x16x32_bf16 v[160:163], a[120:123], v[80:83], v[160:163]
    buffer_load_dwordx4 v13, s[24:27], s60 offen sc1 lds
    v_mfma_f32_16x16x32_bf16 v[164:167], a[124:127], v[80:83], v[164:167]
    s_waitcnt lgkmcnt(6)
    v_mfma_f32_16x16x32_bf16 v[136:139], a[112:115], v[84:87], v[136:139]
    ds_read_b64_tr_b16 v[68:69], v9 offset:32768
    s_add_u32 m0, s59, 82944
    v_mfma_f32_16x16x32_bf16 v[140:143], a[116:119], v[84:87], v[140:143]
    ds_read_b64_tr_b16 v[70:71], v9 offset:33280
    s_add_u32 s60, s58, 557184
    v_mfma_f32_16x16x32_bf16 v[168:171], a[120:123], v[84:87], v[168:171]
    buffer_load_dwordx4 v51, s[24:27], s60 offen sc1 lds
    v_mfma_f32_16x16x32_bf16 v[172:175], a[124:127], v[84:87], v[172:175]
    s_waitcnt lgkmcnt(6)
    v_mfma_f32_16x16x32_bf16 v[144:147], a[112:115], v[88:91], v[144:147]
    ds_read_b64_tr_b16 v[72:73], v10 offset:32768
    s_add_u32 m0, s59, 90112
    v_mfma_f32_16x16x32_bf16 v[148:151], a[116:119], v[88:91], v[148:151]
    ds_read_b64_tr_b16 v[74:75], v10 offset:33280
    s_add_u32 s60, s58, 786560
    v_mfma_f32_16x16x32_bf16 v[176:179], a[120:123], v[88:91], v[176:179]
    buffer_load_dwordx4 v13, s[24:27], s60 offen sc1 lds
    v_mfma_f32_16x16x32_bf16 v[180:183], a[124:127], v[88:91], v[180:183]
    s_waitcnt lgkmcnt(6)
    v_mfma_f32_16x16x32_bf16 v[152:155], a[112:115], v[92:95], v[152:155]
    ds_read_b64_tr_b16 v[76:77], v11 offset:32768
    s_add_u32 m0, s59, 91136
    v_mfma_f32_16x16x32_bf16 v[156:159], a[116:119], v[92:95], v[156:159]
    ds_read_b64_tr_b16 v[78:79], v11 offset:33280
    s_add_u32 s60, s58, 819328
    v_mfma_f32_16x16x32_bf16 v[184:187], a[120:123], v[92:95], v[184:187]
    buffer_load_dwordx4 v51, s[24:27], s60 offen sc1 lds
    v_mfma_f32_16x16x32_bf16 v[188:191], a[124:127], v[92:95], v[188:191]
    s_waitcnt lgkmcnt(6)
    v_mfma_f32_16x16x32_bf16 v[128:131], a[128:131], v[64:67], v[128:131]
    ds_read_b64_tr_b16 v[80:81], v8 offset:36864
    s_add_u32 m0, s59, 98304
    v_mfma_f32_16x16x32_bf16 v[132:135], a[132:135], v[64:67], v[132:135]
    ds_read_b64_tr_b16 v[82:83], v8 offset:37376
    s_add_u32 s60, s58, 1048704
    v_mfma_f32_16x16x32_bf16 v[160:163], a[136:139], v[64:67], v[160:163]
    buffer_load_dwordx4 v13, s[24:27], s60 offen sc1 lds
    v_mfma_f32_16x16x32_bf16 v[164:167], a[140:143], v[64:67], v[164:167]
    s_waitcnt lgkmcnt(6)
    v_mfma_f32_16x16x32_bf16 v[136:139], a[128:131], v[68:71], v[136:139]
    ds_read_b64_tr_b16 v[84:85], v9 offset:36864
    s_add_u32 m0, s59, 99328
    v_mfma_f32_16x16x32_bf16 v[140:143], a[132:135], v[68:71], v[140:143]
    ds_read_b64_tr_b16 v[86:87], v9 offset:37376
    s_add_u32 s60, s58, 1081472
    v_mfma_f32_16x16x32_bf16 v[168:171], a[136:139], v[68:71], v[168:171]
    buffer_load_dwordx4 v51, s[24:27], s60 offen sc1 lds
    v_mfma_f32_16x16x32_bf16 v[172:175], a[140:143], v[68:71], v[172:175]
    s_waitcnt lgkmcnt(6)
    v_mfma_f32_16x16x32_bf16 v[144:147], a[128:131], v[72:75], v[144:147]
    ds_read_b64_tr_b16 v[88:89], v10 offset:36864
    s_add_u32 m0, s59, 106496
    v_mfma_f32_16x16x32_bf16 v[148:151], a[132:135], v[72:75], v[148:151]
    ds_read_b64_tr_b16 v[90:91], v10 offset:37376
    s_add_u32 s60, s58, 1310848
    v_mfma_f32_16x16x32_bf16 v[176:179], a[136:139], v[72:75], v[176:179]
    buffer_load_dwordx4 v13, s[24:27], s60 offen sc1 lds
    v_mfma_f32_16x16x32_bf16 v[180:183], a[140:143], v[72:75], v[180:183]
    s_waitcnt lgkmcnt(6)
    v_mfma_f32_16x16x32_bf16 v[152:155], a[128:131], v[76:79], v[152:155]
    ds_read_b64_tr_b16 v[92:93], v11 offset:36864
    s_add_u32 m0, s59, 107520
    v_mfma_f32_16x16x32_bf16 v[156:159], a[132:135], v[76:79], v[156:159]
    ds_read_b64_tr_b16 v[94:95], v11 offset:37376
    s_add_u32 s60, s58, 1343616
    v_mfma_f32_16x16x32_bf16 v[184:187], a[136:139], v[76:79], v[184:187]
    buffer_load_dwordx4 v51, s[24:27], s60 offen sc1 lds
    v_mfma_f32_16x16x32_bf16 v[188:191], a[140:143], v[76:79], v[188:191]
    s_waitcnt lgkmcnt(6)
    v_mfma_f32_16x16x32_bf16 v[128:131], a[144:147], v[80:83], v[128:131]
    ds_read_b64_tr_b16 v[64:65], v8 offset:40960
    s_add_u32 m0, s59, 114688
    v_mfma_f32_16x16x32_bf16 v[132:135], a[148:151], v[80:83], v[132:135]
    ds_read_b64_tr_b16 v[66:67], v8 offset:41472
    s_add_u32 s60, s58, 1572992
    v_mfma_f32_16x16x32_bf16 v[160:163], a[152:155], v[80:83], v[160:163]
    buffer_load_dwordx4 v13, s[24:27], s60 offen sc1 lds
    v_mfma_f32_16x16x32_bf16 v[164:167], a[156:159], v[80:83], v[164:167]
    s_waitcnt lgkmcnt(6)
    v_mfma_f32_16x16x32_bf16 v[136:139], a[144:147], v[84:87], v[136:139]
    ds_read_b64_tr_b16 v[68:69], v9 offset:40960
    s_add_u32 m0, s59, 115712
    v_mfma_f32_16x16x32_bf16 v[140:143], a[148:151], v[84:87], v[140:143]
    ds_read_b64_tr_b16 v[70:71], v9 offset:41472
    s_add_u32 s60, s58, 1605760
    v_mfma_f32_16x16x32_bf16 v[168:171], a[152:155], v[84:87], v[168:171]
    buffer_load_dwordx4 v51, s[24:27], s60 offen sc1 lds
    v_mfma_f32_16x16x32_bf16 v[172:175], a[156:159], v[84:87], v[172:175]
    s_waitcnt lgkmcnt(6)
    v_mfma_f32_16x16x32_bf16 v[144:147], a[144:147], v[88:91], v[144:147]
    ds_read_b64_tr_b16 v[72:73], v10 offset:40960
    s_add_u32 m0, s59, 122880
    v_mfma_f32_16x16x32_bf16 v[148:151], a[148:151], v[88:91], v[148:151]
    ds_read_b64_tr_b16 v[74:75], v10 offset:41472
    s_add_u32 s60, s58, 1835136
    v_mfma_f32_16x16x32_bf16 v[176:179], a[152:155], v[88:91], v[176:179]
    buffer_load_dwordx4 v13, s[24:27], s60 offen sc1 lds
    v_mfma_f32_16x16x32_bf16 v[180:183], a[156:159], v[88:91], v[180:183]
    s_waitcnt lgkmcnt(6)
    v_mfma_f32_16x16x32_bf16 v[152:155], a[144:147], v[92:95], v[152:155]
    ds_read_b64_tr_b16 v[76:77], v11 offset:40960
    s_add_u32 m0, s59, 123904
    v_mfma_f32_16x16x32_bf16 v[156:159], a[148:151], v[92:95], v[156:159]
    ds_read_b64_tr_b16 v[78:79], v11 offset:41472
    s_add_u32 s60, s58, 1867904
    v_mfma_f32_16x16x32_bf16 v[184:187], a[152:155], v[92:95], v[184:187]
    buffer_load_dwordx4 v51, s[24:27], s60 offen sc1 lds
    v_mfma_f32_16x16x32_bf16 v[188:191], a[156:159], v[92:95], v[188:191]
    s_waitcnt lgkmcnt(6)
    v_mfma_f32_16x16x32_bf16 v[128:131], a[160:163], v[64:67], v[128:131]
    ds_read_b64_tr_b16 v[80:81], v8 offset:45056
    s_add_u32 s63, s64, 0
    v_mfma_f32_16x16x32_bf16 v[132:135], a[164:167], v[64:67], v[132:135]
    ds_read_b64_tr_b16 v[82:83], v8 offset:45568
    buffer_load_dwordx4 v[96:99], v2, s[24:27], s63 offen offset:0 sc1
    v_mfma_f32_16x16x32_bf16 v[160:163], a[168:171], v[64:67], v[160:163]
    v_mfma_f32_16x16x32_bf16 v[164:167], a[172:175], v[64:67], v[164:167]
    s_waitcnt lgkmcnt(6)
    v_mfma_f32_16x16x32_bf16 v[136:139], a[160:163], v[68:71], v[136:139]
    ds_read_b64_tr_b16 v[84:85], v9 offset:45056
    buffer_load_dwordx4 v[100:103], v2, s[24:27], s63 offen offset:1024 sc1
    v_mfma_f32_16x16x32_bf16 v[140:143], a[164:167], v[68:71], v[140:143]
    ds_read_b64_tr_b16 v[86:87], v9 offset:45568
    v_mfma_f32_16x16x32_bf16 v[168:171], a[168:171], v[68:71], v[168:171]
    v_mfma_f32_16x16x32_bf16 v[172:175], a[172:175], v[68:71], v[172:175]
    s_waitcnt lgkmcnt(6)
    v_mfma_f32_16x16x32_bf16 v[144:147], a[160:163], v[72:75], v[144:147]
    ds_read_b64_tr_b16 v[88:89], v10 offset:45056
    buffer_load_dwordx4 v[104:107], v2, s[24:27], s63 offen offset:2048 sc1
    v_mfma_f32_16x16x32_bf16 v[148:151], a[164:167], v[72:75], v[148:151]
    ds_read_b64_tr_b16 v[90:91], v10 offset:45568
    v_mfma_f32_16x16x32_bf16 v[176:179], a[168:171], v[72:75], v[176:179]
    v_mfma_f32_16x16x32_bf16 v[180:183], a[172:175], v[72:75], v[180:183]
    s_waitcnt lgkmcnt(6)
    v_mfma_f32_16x16x32_bf16 v[152:155], a[160:163], v[76:79], v[152:155]
    ds_read_b64_tr_b16 v[92:93], v11 offset:45056
    buffer_load_dwordx4 v[108:111], v2, s[24:27], s63 offen offset:3072 sc1
    v_mfma_f32_16x16x32_bf16 v[156:159], a[164:167], v[76:79], v[156:159]
    ds_read_b64_tr_b16 v[94:95], v11 offset:45568
    v_mfma_f32_16x16x32_bf16 v[184:187], a[168:171], v[76:79], v[184:187]
    v_mfma_f32_16x16x32_bf16 v[188:191], a[172:175], v[76:79], v[188:191]
    s_waitcnt vmcnt(20)
    s_barrier
    s_waitcnt lgkmcnt(6)
    v_mfma_f32_16x16x32_bf16 v[128:131], a[176:179], v[80:83], v[128:131]
    ds_read_b64_tr_b16 v[64:65], v8 offset:49152
    s_add_u32 s63, s64, 4096
    v_mfma_f32_16x16x32_bf16 v[132:135], a[180:183], v[80:83], v[132:135]
    ds_read_b64_tr_b16 v[66:67], v8 offset:49664
    buffer_load_dwordx4 v[112:115], v2, s[24:27], s63 offen offset:0 sc1
    v_mfma_f32_16x16x32_bf16 v[160:163], a[184:187], v[80:83], v[160:163]
    v_mfma_f32_16x16x32_bf16 v[164:167], a[188:191], v[80:83], v[164:167]
    s_waitcnt lgkmcnt(6)
    v_mfma_f32_16x16x32_bf16 v[136:139], a[176:179], v[84:87], v[136:139]
    ds_read_b64_tr_b16 v[68:69], v8 offset:53248
    buffer_load_dwordx4 v[116:119], v2, s[24:27], s63 offen offset:1024 sc1
    v_mfma_f32_16x16x32_bf16 v[140:143], a[180:183], v[84:87], v[140:143]
    ds_read_b64_tr_b16 v[70:71], v8 offset:53760
    v_mfma_f32_16x16x32_bf16 v[168:171], a[184:187], v[84:87], v[168:171]
    v_mfma_f32_16x16x32_bf16 v[172:175], a[188:191], v[84:87], v[172:175]
    s_waitcnt lgkmcnt(6)
    v_mfma_f32_16x16x32_bf16 v[144:147], a[176:179], v[88:91], v[144:147]
    ds_read_b64_tr_b16 v[72:73], v8 offset:57344
    buffer_load_dwordx4 v[120:123], v2, s[24:27], s63 offen offset:2048 sc1
    v_mfma_f32_16x16x32_bf16 v[148:151], a[180:183], v[88:91], v[148:151]
    ds_read_b64_tr_b16 v[74:75], v8 offset:57856
    v_mfma_f32_16x16x32_bf16 v[176:179], a[184:187], v[88:91], v[176:179]
    v_mfma_f32_16x16x32_bf16 v[180:183], a[188:191], v[88:91], v[180:183]
    s_waitcnt lgkmcnt(6)
    v_mfma_f32_16x16x32_bf16 v[152:155], a[176:179], v[92:95], v[152:155]
    ds_read_b64_tr_b16 v[76:77], v8 offset:61440
    buffer_load_dwordx4 v[124:127], v2, s[24:27], s63 offen offset:3072 sc1
    v_mfma_f32_16x16x32_bf16 v[156:159], a[180:183], v[92:95], v[156:159]
    ds_read_b64_tr_b16 v[78:79], v8 offset:61952
    v_mfma_f32_16x16x32_bf16 v[184:187], a[184:187], v[92:95], v[184:187]
    v_mfma_f32_16x16x32_bf16 v[188:191], a[188:191], v[92:95], v[188:191]
    s_waitcnt lgkmcnt(6)
    v_mfma_f32_16x16x32_bf16 v[128:131], a[192:195], v[64:67], v[128:131]
    ds_read_b64_tr_b16 v[80:81], v9 offset:49152
    v_mfma_f32_16x16x32_bf16 v[132:135], a[196:199], v[64:67], v[132:135]
    ds_read_b64_tr_b16 v[82:83], v9 offset:49664
    v_mfma_f32_16x16x32_bf16 v[160:163], a[200:203], v[64:67], v[160:163]
    v_mfma_f32_16x16x32_bf16 v[164:167], a[204:207], v[64:67], v[164:167]
    s_waitcnt lgkmcnt(6)
    v_mfma_f32_16x16x32_bf16 v[128:131], a[208:211], v[68:71], v[128:131]
    ds_read_b64_tr_b16 v[84:85], v9 offset:53248
    v_mfma_f32_16x16x32_bf16 v[132:135], a[212:215], v[68:71], v[132:135]
    ds_read_b64_tr_b16 v[86:87], v9 offset:53760
    v_mfma_f32_16x16x32_bf16 v[160:163], a[216:219], v[68:71], v[160:163]
    v_mfma_f32_16x16x32_bf16 v[164:167], a[220:223], v[68:71], v[164:167]
    s_waitcnt lgkmcnt(6)
    v_mfma_f32_16x16x32_bf16 v[128:131], a[224:227], v[72:75], v[128:131]
    ds_read_b64_tr_b16 v[88:89], v9 offset:57344
    v_mfma_f32_16x16x32_bf16 v[132:135], a[228:231], v[72:75], v[132:135]
    ds_read_b64_tr_b16 v[90:91], v9 offset:57856
    v_mfma_f32_16x16x32_bf16 v[160:163], a[232:235], v[72:75], v[160:163]
    v_mfma_f32_16x16x32_bf16 v[164:167], a[236:239], v[72:75], v[164:167]
    s_waitcnt lgkmcnt(6)
    v_mfma_f32_16x16x32_bf16 v[128:131], a[240:243], v[76:79], v[128:131]
    ds_read_b64_tr_b16 v[92:93], v9 offset:61440
    v_mfma_f32_16x16x32_bf16 v[132:135], a[244:247], v[76:79], v[132:135]
    ds_read_b64_tr_b16 v[94:95], v9 offset:61952
    v_mfma_f32_16x16x32_bf16 v[160:163], a[248:251], v[76:79], v[160:163]
    v_mfma_f32_16x16x32_bf16 v[164:167], a[252:255], v[76:79], v[164:167]
    s_waitcnt lgkmcnt(6)
    v_mfma_f32_16x16x32_bf16 v[136:139], a[192:195], v[80:83], v[136:139]
    ds_read_b64_tr_b16 v[64:65], v10 offset:49152
    v_mfma_f32_16x16x32_bf16 v[140:143], a[196:199], v[80:83], v[140:143]
    ds_read_b64_tr_b16 v[66:67], v10 offset:49664
    v_mfma_f32_16x16x32_bf16 v[168:171], a[200:203], v[80:83], v[168:171]
    v_mfma_f32_16x16x32_bf16 v[172:175], a[204:207], v[80:83], v[172:175]
    s_waitcnt lgkmcnt(6)
    v_mfma_f32_16x16x32_bf16 v[136:139], a[208:211], v[84:87], v[136:139]
    ds_read_b64_tr_b16 v[68:69], v10 offset:53248
    v_max_f32 v128, 0, v128
    v_mfma_f32_16x16x32_bf16 v[140:143], a[212:215], v[84:87], v[140:143]
    ds_read_b64_tr_b16 v[70:71], v10 offset:53760
    v_max_f32 v129, 0, v129
    v_mfma_f32_16x16x32_bf16 v[168:171], a[216:219], v[84:87], v[168:171]
    v_mul_f32 v128, v160, v128
    v_mul_f32 v129, v161, v129
    v_cvt_pk_bf16_f32 v32, v128, v129
    v_mfma_f32_16x16x32_bf16 v[172:175], a[220:223], v[84:87], v[172:175]
    v_max_f32 v130, 0, v130
    s_waitcnt lgkmcnt(6)
    v_mfma_f32_16x16x32_bf16 v[136:139], a[224:227], v[88:91], v[136:139]
    ds_read_b64_tr_b16 v[72:73], v10 offset:57344
    v_max_f32 v131, 0, v131
    v_mfma_f32_16x16x32_bf16 v[140:143], a[228:231], v[88:91], v[140:143]
    ds_read_b64_tr_b16 v[74:75], v10 offset:57856
    v_mul_f32 v130, v162, v130
    v_mfma_f32_16x16x32_bf16 v[168:171], a[232:235], v[88:91], v[168:171]
    v_mul_f32 v131, v163, v131
    v_cvt_pk_bf16_f32 v33, v130, v131
    v_max_f32 v132, 0, v132
    v_mfma_f32_16x16x32_bf16 v[172:175], a[236:239], v[88:91], v[172:175]
    v_max_f32 v133, 0, v133
    s_waitcnt lgkmcnt(6)
    v_mfma_f32_16x16x32_bf16 v[136:139], a[240:243], v[92:95], v[136:139]
    ds_read_b64_tr_b16 v[76:77], v10 offset:61440
    v_mul_f32 v132, v164, v132
    v_mfma_f32_16x16x32_bf16 v[140:143], a[244:247], v[92:95], v[140:143]
    ds_read_b64_tr_b16 v[78:79], v10 offset:61952
    v_mul_f32 v133, v165, v133
    v_mfma_f32_16x16x32_bf16 v[168:171], a[248:251], v[92:95], v[168:171]
    v_cvt_pk_bf16_f32 v34, v132, v133
    v_max_f32 v134, 0, v134
    v_max_f32 v135, 0, v135
    v_mfma_f32_16x16x32_bf16 v[172:175], a[252:255], v[92:95], v[172:175]
    v_mul_f32 v134, v166, v134
    s_waitcnt lgkmcnt(6)
    v_mfma_f32_16x16x32_bf16 v[144:147], a[192:195], v[64:67], v[144:147]
    ds_read_b64_tr_b16 v[80:81], v11 offset:49152
    v_mul_f32 v135, v167, v135
    v_mfma_f32_16x16x32_bf16 v[148:151], a[196:199], v[64:67], v[148:151]
    ds_read_b64_tr_b16 v[82:83], v11 offset:49664
    v_cvt_pk_bf16_f32 v35, v134, v135
    v_mfma_f32_16x16x32_bf16 v[176:179], a[200:203], v[64:67], v[176:179]
    buffer_store_dwordx4 v[32:35], v50, s[24:27], s32 offen offset:0 sc1
    v_mfma_f32_16x16x32_bf16 v[180:183], a[204:207], v[64:67], v[180:183]
    s_waitcnt lgkmcnt(6)
    v_mfma_f32_16x16x32_bf16 v[144:147], a[208:211], v[68:71], v[144:147]
    ds_read_b64_tr_b16 v[84:85], v11 offset:53248
    v_max_f32 v136, 0, v136
    v_mfma_f32_16x16x32_bf16 v[148:151], a[212:215], v[68:71], v[148:151]
    ds_read_b64_tr_b16 v[86:87], v11 offset:53760
    v_max_f32 v137, 0, v137
    v_mfma_f32_16x16x32_bf16 v[176:179], a[216:219], v[68:71], v[176:179]
    v_mul_f32 v136, v168, v136
    v_mul_f32 v137, v169, v137
    v_cvt_pk_bf16_f32 v36, v136, v137
    v_mfma_f32_16x16x32_bf16 v[180:183], a[220:223], v[68:71], v[180:183]
    v_max_f32 v138, 0, v138
    s_waitcnt lgkmcnt(6)
    v_mfma_f32_16x16x32_bf16 v[144:147], a[224:227], v[72:75], v[144:147]
    ds_read_b64_tr_b16 v[88:89], v11 offset:57344
    v_max_f32 v139, 0, v139
    v_mfma_f32_16x16x32_bf16 v[148:151], a[228:231], v[72:75], v[148:151]
    ds_read_b64_tr_b16 v[90:91], v11 offset:57856
    v_mul_f32 v138, v170, v138
    v_mfma_f32_16x16x32_bf16 v[176:179], a[232:235], v[72:75], v[176:179]
    v_mul_f32 v139, v171, v139
    v_cvt_pk_bf16_f32 v37, v138, v139
    v_max_f32 v140, 0, v140
    v_mfma_f32_16x16x32_bf16 v[180:183], a[236:239], v[72:75], v[180:183]
    v_max_f32 v141, 0, v141
    s_waitcnt lgkmcnt(6)
    v_mfma_f32_16x16x32_bf16 v[144:147], a[240:243], v[76:79], v[144:147]
    ds_read_b64_tr_b16 v[92:93], v11 offset:61440
    v_mul_f32 v140, v172, v140
    v_mfma_f32_16x16x32_bf16 v[148:151], a[244:247], v[76:79], v[148:151]
    ds_read_b64_tr_b16 v[94:95], v11 offset:61952
    v_mul_f32 v141, v173, v141
    v_mfma_f32_16x16x32_bf16 v[176:179], a[248:251], v[76:79], v[176:179]
    v_cvt_pk_bf16_f32 v38, v140, v141
    v_max_f32 v142, 0, v142
    v_max_f32 v143, 0, v143
    v_mfma_f32_16x16x32_bf16 v[180:183], a[252:255], v[76:79], v[180:183]
    v_mul_f32 v142, v174, v142
    s_waitcnt vmcnt(21)
    s_barrier
    s_waitcnt lgkmcnt(6)
    v_mfma_f32_16x16x32_bf16 v[152:155], a[192:195], v[80:83], v[152:155]
    v_add_u32 v8, 0x10000, v8
    ds_read_b64_tr_b16 v[64:65], v8 offset:0
    v_mul_f32 v143, v175, v143
    v_mfma_f32_16x16x32_bf16 v[156:159], a[196:199], v[80:83], v[156:159]
    ds_read_b64_tr_b16 v[66:67], v8 offset:512
    v_cvt_pk_bf16_f32 v39, v142, v143
    v_mfma_f32_16x16x32_bf16 v[184:187], a[200:203], v[80:83], v[184:187]
    buffer_store_dwordx4 v[36:39], v50, s[24:27], s32 offen offset:256 sc1
    v_mfma_f32_16x16x32_bf16 v[188:191], a[204:207], v[80:83], v[188:191]
    s_waitcnt lgkmcnt(6)
    v_mfma_f32_16x16x32_bf16 v[152:155], a[208:211], v[84:87], v[152:155]
    v_add_u32 v9, 0x10000, v9
    ds_read_b64_tr_b16 v[68:69], v9 offset:0
    v_max_f32 v144, 0, v144
    v_mfma_f32_16x16x32_bf16 v[156:159], a[212:215], v[84:87], v[156:159]
    ds_read_b64_tr_b16 v[70:71], v9 offset:512
    v_max_f32 v145, 0, v145
    v_mfma_f32_16x16x32_bf16 v[184:187], a[216:219], v[84:87], v[184:187]
    v_mul_f32 v144, v176, v144
    v_mul_f32 v145, v177, v145
    v_cvt_pk_bf16_f32 v40, v144, v145
    v_mfma_f32_16x16x32_bf16 v[188:191], a[220:223], v[84:87], v[188:191]
    v_max_f32 v146, 0, v146
    s_waitcnt lgkmcnt(6)
    v_mfma_f32_16x16x32_bf16 v[152:155], a[224:227], v[88:91], v[152:155]
    v_add_u32 v10, 0x10000, v10
    ds_read_b64_tr_b16 v[72:73], v10 offset:0
    v_max_f32 v147, 0, v147
    v_mfma_f32_16x16x32_bf16 v[156:159], a[228:231], v[88:91], v[156:159]
    ds_read_b64_tr_b16 v[74:75], v10 offset:512
    v_mul_f32 v146, v178, v146
    v_mfma_f32_16x16x32_bf16 v[184:187], a[232:235], v[88:91], v[184:187]
    v_mul_f32 v147, v179, v147
    v_cvt_pk_bf16_f32 v41, v146, v147
    v_max_f32 v148, 0, v148
    v_mfma_f32_16x16x32_bf16 v[188:191], a[236:239], v[88:91], v[188:191]
    v_max_f32 v149, 0, v149
    s_waitcnt lgkmcnt(6)
    v_mfma_f32_16x16x32_bf16 v[152:155], a[240:243], v[92:95], v[152:155]
    v_add_u32 v11, 0x10000, v11
    ds_read_b64_tr_b16 v[76:77], v11 offset:0
    v_mul_f32 v148, v180, v148
    v_mfma_f32_16x16x32_bf16 v[156:159], a[244:247], v[92:95], v[156:159]
    ds_read_b64_tr_b16 v[78:79], v11 offset:512
    v_mul_f32 v149, v181, v149
    v_mfma_f32_16x16x32_bf16 v[184:187], a[248:251], v[92:95], v[184:187]
    v_cvt_pk_bf16_f32 v42, v148, v149
    v_max_f32 v150, 0, v150
    v_max_f32 v151, 0, v151
    v_mfma_f32_16x16x32_bf16 v[188:191], a[252:255], v[92:95], v[188:191]
    v_mul_f32 v150, v182, v150
    s_waitcnt lgkmcnt(6)
    v_mfma_f32_16x16x32_bf16 v[192:195], a[0:3], v[64:67], 0
    ds_read_b64_tr_b16 v[80:81], v8 offset:4096
    v_mul_f32 v151, v183, v151
    v_mfma_f32_16x16x32_bf16 v[196:199], a[4:7], v[64:67], 0
    ds_read_b64_tr_b16 v[82:83], v8 offset:4608
    v_cvt_pk_bf16_f32 v43, v150, v151
    v_mfma_f32_16x16x32_bf16 v[224:227], a[8:11], v[64:67], 0
    buffer_store_dwordx4 v[40:43], v50, s[24:27], s33 offen offset:0 sc1
    v_mfma_f32_16x16x32_bf16 v[228:231], a[12:15], v[64:67], 0
    s_waitcnt lgkmcnt(6)
    v_mfma_f32_16x16x32_bf16 v[200:203], a[0:3], v[68:71], 0
    ds_read_b64_tr_b16 v[84:85], v9 offset:4096
    v_max_f32 v152, 0, v152
    v_mfma_f32_16x16x32_bf16 v[204:207], a[4:7], v[68:71], 0
    ds_read_b64_tr_b16 v[86:87], v9 offset:4608
    v_max_f32 v153, 0, v153
    v_mfma_f32_16x16x32_bf16 v[232:235], a[8:11], v[68:71], 0
    v_mul_f32 v152, v184, v152
    v_mul_f32 v153, v185, v153
    v_cvt_pk_bf16_f32 v44, v152, v153
    v_mfma_f32_16x16x32_bf16 v[236:239], a[12:15], v[68:71], 0
    v_max_f32 v154, 0, v154
    s_waitcnt lgkmcnt(6)
    v_mfma_f32_16x16x32_bf16 v[208:211], a[0:3], v[72:75], 0
    ds_read_b64_tr_b16 v[88:89], v10 offset:4096
    v_max_f32 v155, 0, v155
    v_mfma_f32_16x16x32_bf16 v[212:215], a[4:7], v[72:75], 0
    ds_read_b64_tr_b16 v[90:91], v10 offset:4608
    v_mul_f32 v154, v186, v154
    v_mfma_f32_16x16x32_bf16 v[240:243], a[8:11], v[72:75], 0
    v_mul_f32 v155, v187, v155
    v_cvt_pk_bf16_f32 v45, v154, v155
    v_max_f32 v156, 0, v156
    v_mfma_f32_16x16x32_bf16 v[244:247], a[12:15], v[72:75], 0
    v_max_f32 v157, 0, v157
    s_waitcnt lgkmcnt(6)
    v_mfma_f32_16x16x32_bf16 v[216:219], a[0:3], v[76:79], 0
    ds_read_b64_tr_b16 v[92:93], v11 offset:4096
    v_mul_f32 v156, v188, v156
    v_mfma_f32_16x16x32_bf16 v[220:223], a[4:7], v[76:79], 0
    ds_read_b64_tr_b16 v[94:95], v11 offset:4608
    v_mul_f32 v157, v189, v157
    v_mfma_f32_16x16x32_bf16 v[248:251], a[8:11], v[76:79], 0
    v_cvt_pk_bf16_f32 v46, v156, v157
    v_max_f32 v158, 0, v158
    v_max_f32 v159, 0, v159
    v_mfma_f32_16x16x32_bf16 v[252:255], a[12:15], v[76:79], 0
    v_mul_f32 v158, v190, v158
    s_waitcnt lgkmcnt(6)
    v_mfma_f32_16x16x32_bf16 v[192:195], a[16:19], v[80:83], v[192:195]
    ds_read_b64_tr_b16 v[64:65], v8 offset:8192
    v_mul_f32 v159, v191, v159
    v_mfma_f32_16x16x32_bf16 v[196:199], a[20:23], v[80:83], v[196:199]
    ds_read_b64_tr_b16 v[66:67], v8 offset:8704
    v_cvt_pk_bf16_f32 v47, v158, v159
    v_mfma_f32_16x16x32_bf16 v[224:227], a[24:27], v[80:83], v[224:227]
    buffer_store_dwordx4 v[44:47], v50, s[24:27], s33 offen offset:256 sc1
    v_mfma_f32_16x16x32_bf16 v[228:231], a[28:31], v[80:83], v[228:231]
    s_waitcnt lgkmcnt(6)
    v_mfma_f32_16x16x32_bf16 v[200:203], a[16:19], v[84:87], v[200:203]
    ds_read_b64_tr_b16 v[68:69], v9 offset:8192
    v_mfma_f32_16x16x32_bf16 v[204:207], a[20:23], v[84:87], v[204:207]
    ds_read_b64_tr_b16 v[70:71], v9 offset:8704
    v_mfma_f32_16x16x32_bf16 v[232:235], a[24:27], v[84:87], v[232:235]
    v_mfma_f32_16x16x32_bf16 v[236:239], a[28:31], v[84:87], v[236:239]
    s_waitcnt lgkmcnt(6)
    v_mfma_f32_16x16x32_bf16 v[208:211], a[16:19], v[88:91], v[208:211]
    ds_read_b64_tr_b16 v[72:73], v10 offset:8192
    v_mfma_f32_16x16x32_bf16 v[212:215], a[20:23], v[88:91], v[212:215]
    ds_read_b64_tr_b16 v[74:75], v10 offset:8704
    v_mfma_f32_16x16x32_bf16 v[240:243], a[24:27], v[88:91], v[240:243]
    v_mfma_f32_16x16x32_bf16 v[244:247], a[28:31], v[88:91], v[244:247]
    s_waitcnt lgkmcnt(6)
    v_mfma_f32_16x16x32_bf16 v[216:219], a[16:19], v[92:95], v[216:219]
    ds_read_b64_tr_b16 v[76:77], v11 offset:8192
    v_mfma_f32_16x16x32_bf16 v[220:223], a[20:23], v[92:95], v[220:223]
    ds_read_b64_tr_b16 v[78:79], v11 offset:8704
    v_mfma_f32_16x16x32_bf16 v[248:251], a[24:27], v[92:95], v[248:251]
    v_mfma_f32_16x16x32_bf16 v[252:255], a[28:31], v[92:95], v[252:255]
    s_waitcnt lgkmcnt(6)
    v_mfma_f32_16x16x32_bf16 v[192:195], a[32:35], v[64:67], v[192:195]
    ds_read_b64_tr_b16 v[80:81], v8 offset:12288
    s_add_u32 s63, s64, 8192
    v_mfma_f32_16x16x32_bf16 v[196:199], a[36:39], v[64:67], v[196:199]
    ds_read_b64_tr_b16 v[82:83], v8 offset:12800
    buffer_load_dwordx4 a[0:3], v2, s[24:27], s63 offen offset:0 sc1
    v_mfma_f32_16x16x32_bf16 v[224:227], a[40:43], v[64:67], v[224:227]
    v_mfma_f32_16x16x32_bf16 v[228:231], a[44:47], v[64:67], v[228:231]
    s_waitcnt lgkmcnt(6)
    v_mfma_f32_16x16x32_bf16 v[200:203], a[32:35], v[68:71], v[200:203]
    ds_read_b64_tr_b16 v[84:85], v9 offset:12288
    buffer_load_dwordx4 a[4:7], v2, s[24:27], s63 offen offset:1024 sc1
    v_mfma_f32_16x16x32_bf16 v[204:207], a[36:39], v[68:71], v[204:207]
    ds_read_b64_tr_b16 v[86:87], v9 offset:12800
    v_mfma_f32_16x16x32_bf16 v[232:235], a[40:43], v[68:71], v[232:235]
    v_mfma_f32_16x16x32_bf16 v[236:239], a[44:47], v[68:71], v[236:239]
    s_waitcnt lgkmcnt(6)
    v_mfma_f32_16x16x32_bf16 v[208:211], a[32:35], v[72:75], v[208:211]
    ds_read_b64_tr_b16 v[88:89], v10 offset:12288
    buffer_load_dwordx4 a[8:11], v2, s[24:27], s63 offen offset:2048 sc1
    v_mfma_f32_16x16x32_bf16 v[212:215], a[36:39], v[72:75], v[212:215]
    ds_read_b64_tr_b16 v[90:91], v10 offset:12800
    v_mfma_f32_16x16x32_bf16 v[240:243], a[40:43], v[72:75], v[240:243]
    v_mfma_f32_16x16x32_bf16 v[244:247], a[44:47], v[72:75], v[244:247]
    s_waitcnt lgkmcnt(6)
    v_mfma_f32_16x16x32_bf16 v[216:219], a[32:35], v[76:79], v[216:219]
    ds_read_b64_tr_b16 v[92:93], v11 offset:12288
    buffer_load_dwordx4 a[12:15], v2, s[24:27], s63 offen offset:3072 sc1
    v_mfma_f32_16x16x32_bf16 v[220:223], a[36:39], v[76:79], v[220:223]
    ds_read_b64_tr_b16 v[94:95], v11 offset:12800
    v_mfma_f32_16x16x32_bf16 v[248:251], a[40:43], v[76:79], v[248:251]
    v_mfma_f32_16x16x32_bf16 v[252:255], a[44:47], v[76:79], v[252:255]
    s_waitcnt vmcnt(16)
    s_barrier
    s_waitcnt lgkmcnt(6)
    v_mfma_f32_16x16x32_bf16 v[192:195], a[48:51], v[80:83], v[192:195]
    ds_read_b64_tr_b16 v[64:65], v8 offset:16384
    s_add_u32 s63, s64, 12288
    v_mfma_f32_16x16x32_bf16 v[196:199], a[52:55], v[80:83], v[196:199]
    ds_read_b64_tr_b16 v[66:67], v8 offset:16896
    buffer_load_dwordx4 a[16:19], v2, s[24:27], s63 offen offset:0 sc1
    v_mfma_f32_16x16x32_bf16 v[224:227], a[56:59], v[80:83], v[224:227]
    v_mfma_f32_16x16x32_bf16 v[228:231], a[60:63], v[80:83], v[228:231]
    s_waitcnt lgkmcnt(6)
    v_mfma_f32_16x16x32_bf16 v[200:203], a[48:51], v[84:87], v[200:203]
    ds_read_b64_tr_b16 v[68:69], v9 offset:16384
    buffer_load_dwordx4 a[20:23], v2, s[24:27], s63 offen offset:1024 sc1
    v_mfma_f32_16x16x32_bf16 v[204:207], a[52:55], v[84:87], v[204:207]
    ds_read_b64_tr_b16 v[70:71], v9 offset:16896
    v_mfma_f32_16x16x32_bf16 v[232:235], a[56:59], v[84:87], v[232:235]
    v_mfma_f32_16x16x32_bf16 v[236:239], a[60:63], v[84:87], v[236:239]
    s_waitcnt lgkmcnt(6)
    v_mfma_f32_16x16x32_bf16 v[208:211], a[48:51], v[88:91], v[208:211]
    ds_read_b64_tr_b16 v[72:73], v10 offset:16384
    buffer_load_dwordx4 a[24:27], v2, s[24:27], s63 offen offset:2048 sc1
    v_mfma_f32_16x16x32_bf16 v[212:215], a[52:55], v[88:91], v[212:215]
    ds_read_b64_tr_b16 v[74:75], v10 offset:16896
    v_mfma_f32_16x16x32_bf16 v[240:243], a[56:59], v[88:91], v[240:243]
    v_mfma_f32_16x16x32_bf16 v[244:247], a[60:63], v[88:91], v[244:247]
    s_waitcnt lgkmcnt(6)
    v_mfma_f32_16x16x32_bf16 v[216:219], a[48:51], v[92:95], v[216:219]
    ds_read_b64_tr_b16 v[76:77], v11 offset:16384
    buffer_load_dwordx4 a[28:31], v2, s[24:27], s63 offen offset:3072 sc1
    v_mfma_f32_16x16x32_bf16 v[220:223], a[52:55], v[92:95], v[220:223]
    ds_read_b64_tr_b16 v[78:79], v11 offset:16896
    v_mfma_f32_16x16x32_bf16 v[248:251], a[56:59], v[92:95], v[248:251]
    v_mfma_f32_16x16x32_bf16 v[252:255], a[60:63], v[92:95], v[252:255]
    s_waitcnt lgkmcnt(6)
    v_mfma_f32_16x16x32_bf16 v[192:195], a[64:67], v[64:67], v[192:195]
    ds_read_b64_tr_b16 v[80:81], v8 offset:20480
    s_add_u32 s63, s64, 16384
    v_mfma_f32_16x16x32_bf16 v[196:199], a[68:71], v[64:67], v[196:199]
    ds_read_b64_tr_b16 v[82:83], v8 offset:20992
    buffer_load_dwordx4 v[128:131], v2, s[24:27], s63 offen offset:0 sc1
    v_mfma_f32_16x16x32_bf16 v[224:227], a[72:75], v[64:67], v[224:227]
    s_cmp_lt_u32 s52, 4
    s_cselect_b32 s57, -1, 0
    ds_read_b64_tr_b16 v[16:17], v12 offset:0
    ds_read_b64_tr_b16 v[18:19], v12 offset:512
    v_mfma_f32_16x16x32_bf16 v[228:231], a[76:79], v[64:67], v[228:231]
    ds_read_b64_tr_b16 v[20:21], v12 offset:28672
    s_waitcnt lgkmcnt(9)
    v_mfma_f32_16x16x32_bf16 v[200:203], a[64:67], v[68:71], v[200:203]
    ds_read_b64_tr_b16 v[84:85], v9 offset:20480
    buffer_load_dwordx4 v[132:135], v2, s[24:27], s63 offen offset:1024 sc1
    v_mfma_f32_16x16x32_bf16 v[204:207], a[68:71], v[68:71], v[204:207]
    ds_read_b64_tr_b16 v[86:87], v9 offset:20992
    ds_read_b64_tr_b16 v[22:23], v12 offset:29184
    v_mfma_f32_16x16x32_bf16 v[232:235], a[72:75], v[68:71], v[232:235]
    ds_read_b64_tr_b16 v[24:25], v12 offset:57344
    ds_read_b64_tr_b16 v[26:27], v12 offset:57856
    v_lshlrev_b32 v48, 2, v5
    v_mfma_f32_16x16x32_bf16 v[236:239], a[76:79], v[68:71], v[236:239]
    s_nop 0
    s_waitcnt lgkmcnt(12)
    v_mfma_f32_16x16x32_bf16 v[208:211], a[64:67], v[72:75], v[208:211]
    ds_read_b64_tr_b16 v[88:89], v10 offset:20480
    buffer_load_dwordx4 v[136:139], v2, s[24:27], s63 offen offset:2048 sc1
    v_mfma_f32_16x16x32_bf16 v[212:215], a[68:71], v[72:75], v[212:215]
    ds_read_b64_tr_b16 v[90:91], v10 offset:20992
    s_nop 0
    v_mfma_f32_16x16x32_bf16 v[240:243], a[72:75], v[72:75], v[240:243]
    s_waitcnt lgkmcnt(2)
    v_lshlrev_b32 v28, 16, v16
    v_and_b32 v29, 0xffff0000, v16
    v_mfma_f32_16x16x32_bf16 v[244:247], a[76:79], v[72:75], v[244:247]
    v_mul_f32 v30, v28, v28
    v_mfma_f32_16x16x32_bf16 v[216:219], a[64:67], v[76:79], v[216:219]
    ds_read_b64_tr_b16 v[92:93], v11 offset:20480
    buffer_load_dwordx4 v[140:143], v2, s[24:27], s63 offen offset:3072 sc1
    v_mfma_f32_16x16x32_bf16 v[220:223], a[68:71], v[76:79], v[220:223]
    ds_read_b64_tr_b16 v[94:95], v11 offset:20992
    v_mul_f32 v31, v29, v29
    v_mfma_f32_16x16x32_bf16 v[248:251], a[72:75], v[76:79], v[248:251]
    v_lshlrev_b32 v28, 16, v17
    v_and_b32 v29, 0xffff0000, v17
    v_fmac_f32 v30, v28, v28
    v_mfma_f32_16x16x32_bf16 v[252:255], a[76:79], v[76:79], v[252:255]
    v_fmac_f32 v31, v29, v29
    v_mfma_f32_16x16x32_bf16 v[192:195], a[80:83], v[80:83], v[192:195]
    ds_read_b64_tr_b16 v[64:65], v8 offset:24576
    s_add_u32 s63, s64, 20480
    v_mfma_f32_16x16x32_bf16 v[196:199], a[84:87], v[80:83], v[196:199]
    ds_read_b64_tr_b16 v[66:67], v8 offset:25088
    buffer_load_dwordx4 v[144:147], v2, s[24:27], s63 offen offset:0 sc1
    v_mfma_f32_16x16x32_bf16 v[224:227], a[88:91], v[80:83], v[224:227]
    v_lshlrev_b32 v28, 16, v18
    v_and_b32 v29, 0xffff0000, v18
    v_fmac_f32 v30, v28, v28
    v_mfma_f32_16x16x32_bf16 v[228:231], a[92:95], v[80:83], v[228:231]
    v_fmac_f32 v31, v29, v29
    v_mfma_f32_16x16x32_bf16 v[200:203], a[80:83], v[84:87], v[200:203]
    ds_read_b64_tr_b16 v[68:69], v9 offset:24576
    buffer_load_dwordx4 v[148:151], v2, s[24:27], s63 offen offset:1024 sc1
    v_mfma_f32_16x16x32_bf16 v[204:207], a[84:87], v[84:87], v[204:207]
    ds_read_b64_tr_b16 v[70:71], v9 offset:25088
    v_lshlrev_b32 v28, 16, v19
    v_mfma_f32_16x16x32_bf16 v[232:235], a[88:91], v[84:87], v[232:235]
    v_and_b32 v29, 0xffff0000, v19
    v_fmac_f32 v30, v28, v28
    v_fmac_f32 v31, v29, v29
    v_mfma_f32_16x16x32_bf16 v[236:239], a[92:95], v[84:87], v[236:239]
    v_lshlrev_b32 v28, 16, v20
    s_waitcnt vmcnt(14)
    s_barrier
    s_mov_b64 exec, 1
    buffer_atomic_add v15, v14, s[24:27], s40 offen sc1
    s_mov_b64 exec, -1
    s_waitcnt lgkmcnt(6)
    v_mfma_f32_16x16x32_bf16 v[208:211], a[80:83], v[88:91], v[208:211]
    ds_read_b64_tr_b16 v[72:73], v10 offset:24576
    buffer_load_dwordx4 v[152:155], v2, s[24:27], s63 offen offset:2048 sc1
    v_mfma_f32_16x16x32_bf16 v[212:215], a[84:87], v[88:91], v[212:215]
    ds_read_b64_tr_b16 v[74:75], v10 offset:25088
    v_and_b32 v29, 0xffff0000, v20
    v_mfma_f32_16x16x32_bf16 v[240:243], a[88:91], v[88:91], v[240:243]
    v_fmac_f32 v30, v28, v28
    v_fmac_f32 v31, v29, v29
    v_lshlrev_b32 v28, 16, v21
    v_mfma_f32_16x16x32_bf16 v[244:247], a[92:95], v[88:91], v[244:247]
    v_and_b32 v29, 0xffff0000, v21
    s_waitcnt lgkmcnt(6)
    v_mfma_f32_16x16x32_bf16 v[216:219], a[80:83], v[92:95], v[216:219]
    ds_read_b64_tr_b16 v[76:77], v11 offset:24576
    buffer_load_dwordx4 v[156:159], v2, s[24:27], s63 offen offset:3072 sc1
    v_mfma_f32_16x16x32_bf16 v[220:223], a[84:87], v[92:95], v[220:223]
    ds_read_b64_tr_b16 v[78:79], v11 offset:25088
    v_fmac_f32 v30, v28, v28
    v_mfma_f32_16x16x32_bf16 v[248:251], a[88:91], v[92:95], v[248:251]
    v_fmac_f32 v31, v29, v29
    v_lshlrev_b32 v28, 16, v22
    v_and_b32 v29, 0xffff0000, v22
    v_mfma_f32_16x16x32_bf16 v[252:255], a[92:95], v[92:95], v[252:255]
    v_fmac_f32 v30, v28, v28
    s_waitcnt lgkmcnt(6)
    v_mfma_f32_16x16x32_bf16 v[192:195], a[96:99], v[64:67], v[192:195]
    ds_read_b64_tr_b16 v[80:81], v8 offset:28672
    s_add_u32 s63, s64, 24576
    v_mfma_f32_16x16x32_bf16 v[196:199], a[100:103], v[64:67], v[196:199]
    ds_read_b64_tr_b16 v[82:83], v8 offset:29184
    buffer_load_dwordx4 v[160:163], v2, s[24:27], s63 offen offset:0 sc1
    v_mfma_f32_16x16x32_bf16 v[224:227], a[104:107], v[64:67], v[224:227]
    v_fmac_f32 v31, v29, v29
    v_lshlrev_b32 v28, 16, v23
    v_and_b32 v29, 0xffff0000, v23
    v_mfma_f32_16x16x32_bf16 v[228:231], a[108:111], v[64:67], v[228:231]
    v_fmac_f32 v30, v28, v28
    s_waitcnt lgkmcnt(6)
    v_mfma_f32_16x16x32_bf16 v[200:203], a[96:99], v[68:71], v[200:203]
    ds_read_b64_tr_b16 v[84:85], v9 offset:28672
    buffer_load_dwordx4 v[164:167], v2, s[24:27], s63 offen offset:1024 sc1
    v_mfma_f32_16x16x32_bf16 v[204:207], a[100:103], v[68:71], v[204:207]
    ds_read_b64_tr_b16 v[86:87], v9 offset:29184
    v_fmac_f32 v31, v29, v29
    v_mfma_f32_16x16x32_bf16 v[232:235], a[104:107], v[68:71], v[232:235]
    v_and_b32 v24, s57, v24
    v_lshlrev_b32 v28, 16, v24
    v_and_b32 v29, 0xffff0000, v24
    v_mfma_f32_16x16x32_bf16 v[236:239], a[108:111], v[68:71], v[236:239]
    v_fmac_f32 v30, v28, v28
    s_waitcnt lgkmcnt(6)
    v_mfma_f32_16x16x32_bf16 v[208:211], a[96:99], v[72:75], v[208:211]
    ds_read_b64_tr_b16 v[88:89], v10 offset:28672
    buffer_load_dwordx4 v[168:171], v2, s[24:27], s63 offen offset:2048 sc1
    v_mfma_f32_16x16x32_bf16 v[212:215], a[100:103], v[72:75], v[212:215]
    ds_read_b64_tr_b16 v[90:91], v10 offset:29184
    v_fmac_f32 v31, v29, v29
    v_mfma_f32_16x16x32_bf16 v[240:243], a[104:107], v[72:75], v[240:243]
    v_and_b32 v25, s57, v25
    v_lshlrev_b32 v28, 16, v25
    v_and_b32 v29, 0xffff0000, v25
    v_mfma_f32_16x16x32_bf16 v[244:247], a[108:111], v[72:75], v[244:247]
    v_fmac_f32 v30, v28, v28
    s_waitcnt lgkmcnt(6)
    v_mfma_f32_16x16x32_bf16 v[216:219], a[96:99], v[76:79], v[216:219]
    ds_read_b64_tr_b16 v[92:93], v11 offset:28672
    buffer_load_dwordx4 v[172:175], v2, s[24:27], s63 offen offset:3072 sc1
    v_mfma_f32_16x16x32_bf16 v[220:223], a[100:103], v[76:79], v[220:223]
    ds_read_b64_tr_b16 v[94:95], v11 offset:29184
    v_fmac_f32 v31, v29, v29
    v_mfma_f32_16x16x32_bf16 v[248:251], a[104:107], v[76:79], v[248:251]
    v_and_b32 v26, s57, v26
    v_lshlrev_b32 v28, 16, v26
    v_and_b32 v29, 0xffff0000, v26
    v_mfma_f32_16x16x32_bf16 v[252:255], a[108:111], v[76:79], v[252:255]
    v_fmac_f32 v30, v28, v28
    s_waitcnt lgkmcnt(6)
    v_mfma_f32_16x16x32_bf16 v[192:195], a[112:115], v[80:83], v[192:195]
    ds_read_b64_tr_b16 v[64:65], v8 offset:32768
    s_add_u32 s63, s64, 28672
    v_mfma_f32_16x16x32_bf16 v[196:199], a[116:119], v[80:83], v[196:199]
    ds_read_b64_tr_b16 v[66:67], v8 offset:33280
    buffer_load_dwordx4 v[176:179], v2, s[24:27], s63 offen offset:0 sc1
    v_mfma_f32_16x16x32_bf16 v[224:227], a[120:123], v[80:83], v[224:227]
    v_fmac_f32 v31, v29, v29
    v_and_b32 v27, s57, v27
    v_lshlrev_b32 v28, 16, v27
    v_mfma_f32_16x16x32_bf16 v[228:231], a[124:127], v[80:83], v[228:231]
    v_and_b32 v29, 0xffff0000, v27
    s_waitcnt lgkmcnt(6)
    v_mfma_f32_16x16x32_bf16 v[200:203], a[112:115], v[84:87], v[200:203]
    ds_read_b64_tr_b16 v[68:69], v9 offset:32768
    buffer_load_dwordx4 v[180:183], v2, s[24:27], s63 offen offset:1024 sc1
    v_mfma_f32_16x16x32_bf16 v[204:207], a[116:119], v[84:87], v[204:207]
    ds_read_b64_tr_b16 v[70:71], v9 offset:33280
    v_fmac_f32 v30, v28, v28
    v_mfma_f32_16x16x32_bf16 v[232:235], a[120:123], v[84:87], v[232:235]
    v_fmac_f32 v31, v29, v29
    v_add_f32 v30, v30, v31
    v_mov_b32 v31, v30
    v_mfma_f32_16x16x32_bf16 v[236:239], a[124:127], v[84:87], v[236:239]
    s_nop 0
    s_waitcnt lgkmcnt(6)
    v_mfma_f32_16x16x32_bf16 v[208:211], a[112:115], v[88:91], v[208:211]
    ds_read_b64_tr_b16 v[72:73], v10 offset:32768
    buffer_load_dwordx4 v[184:187], v2, s[24:27], s63 offen offset:2048 sc1
    v_mfma_f32_16x16x32_bf16 v[212:215], a[116:119], v[88:91], v[212:215]
    ds_read_b64_tr_b16 v[74:75], v10 offset:33280
    v_permlane32_swap_b32 v30, v31
    v_mfma_f32_16x16x32_bf16 v[240:243], a[120:123], v[88:91], v[240:243]
    v_add_f32 v30, v30, v31
    s_mov_b32 exec_hi, 0
    buffer_atomic_add_f32 v30, v48, s[24:27], s44 offen sc1
    s_mov_b32 exec_hi, -1
    v_mfma_f32_16x16x32_bf16 v[244:247], a[124:127], v[88:91], v[244:247]
    s_waitcnt lgkmcnt(6)
    v_mfma_f32_16x16x32_bf16 v[216:219], a[112:115], v[92:95], v[216:219]
    ds_read_b64_tr_b16 v[76:77], v11 offset:32768
    buffer_load_dwordx4 v[188:191], v2, s[24:27], s63 offen offset:3072 sc1
    v_mfma_f32_16x16x32_bf16 v[220:223], a[116:119], v[92:95], v[220:223]
    ds_read_b64_tr_b16 v[78:79], v11 offset:33280
    v_mfma_f32_16x16x32_bf16 v[248:251], a[120:123], v[92:95], v[248:251]
    v_mfma_f32_16x16x32_bf16 v[252:255], a[124:127], v[92:95], v[252:255]
    s_waitcnt lgkmcnt(6)
    v_mfma_f32_16x16x32_bf16 v[192:195], a[128:131], v[64:67], v[192:195]
    ds_read_b64_tr_b16 v[80:81], v8 offset:36864
    s_add_u32 s63, s64, 32768
    v_mfma_f32_16x16x32_bf16 v[196:199], a[132:135], v[64:67], v[196:199]
    ds_read_b64_tr_b16 v[82:83], v8 offset:37376
    buffer_load_dwordx4 a[32:35], v2, s[24:27], s63 offen offset:0 sc1
    v_mfma_f32_16x16x32_bf16 v[224:227], a[136:139], v[64:67], v[224:227]
    v_mfma_f32_16x16x32_bf16 v[228:231], a[140:143], v[64:67], v[228:231]
    s_waitcnt lgkmcnt(6)
    v_mfma_f32_16x16x32_bf16 v[200:203], a[128:131], v[68:71], v[200:203]
    ds_read_b64_tr_b16 v[84:85], v9 offset:36864
    buffer_load_dwordx4 a[36:39], v2, s[24:27], s63 offen offset:1024 sc1
    v_mfma_f32_16x16x32_bf16 v[204:207], a[132:135], v[68:71], v[204:207]
    ds_read_b64_tr_b16 v[86:87], v9 offset:37376
    v_mfma_f32_16x16x32_bf16 v[232:235], a[136:139], v[68:71], v[232:235]
    v_mfma_f32_16x16x32_bf16 v[236:239], a[140:143], v[68:71], v[236:239]
    s_waitcnt lgkmcnt(6)
    v_mfma_f32_16x16x32_bf16 v[208:211], a[128:131], v[72:75], v[208:211]
    ds_read_b64_tr_b16 v[88:89], v10 offset:36864
    buffer_load_dwordx4 a[40:43], v2, s[24:27], s63 offen offset:2048 sc1
    v_mfma_f32_16x16x32_bf16 v[212:215], a[132:135], v[72:75], v[212:215]
    ds_read_b64_tr_b16 v[90:91], v10 offset:37376
    v_mfma_f32_16x16x32_bf16 v[240:243], a[136:139], v[72:75], v[240:243]
    v_mfma_f32_16x16x32_bf16 v[244:247], a[140:143], v[72:75], v[244:247]
    s_waitcnt lgkmcnt(6)
    v_mfma_f32_16x16x32_bf16 v[216:219], a[128:131], v[76:79], v[216:219]
    ds_read_b64_tr_b16 v[92:93], v11 offset:36864
    buffer_load_dwordx4 a[44:47], v2, s[24:27], s63 offen offset:3072 sc1
    v_mfma_f32_16x16x32_bf16 v[220:223], a[132:135], v[76:79], v[220:223]
    ds_read_b64_tr_b16 v[94:95], v11 offset:37376
    v_mfma_f32_16x16x32_bf16 v[248:251], a[136:139], v[76:79], v[248:251]
    v_mfma_f32_16x16x32_bf16 v[252:255], a[140:143], v[76:79], v[252:255]
    s_waitcnt lgkmcnt(6)
    v_mfma_f32_16x16x32_bf16 v[192:195], a[144:147], v[80:83], v[192:195]
    ds_read_b64_tr_b16 v[64:65], v8 offset:40960
    s_add_u32 s63, s64, 36864
    v_mfma_f32_16x16x32_bf16 v[196:199], a[148:151], v[80:83], v[196:199]
    ds_read_b64_tr_b16 v[66:67], v8 offset:41472
    buffer_load_dwordx4 a[48:51], v2, s[24:27], s63 offen offset:0 sc1
    v_mfma_f32_16x16x32_bf16 v[224:227], a[152:155], v[80:83], v[224:227]
    v_mfma_f32_16x16x32_bf16 v[228:231], a[156:159], v[80:83], v[228:231]
    s_waitcnt lgkmcnt(6)
    v_mfma_f32_16x16x32_bf16 v[200:203], a[144:147], v[84:87], v[200:203]
    ds_read_b64_tr_b16 v[68:69], v9 offset:40960
    buffer_load_dwordx4 a[52:55], v2, s[24:27], s63 offen offset:1024 sc1
    v_mfma_f32_16x16x32_bf16 v[204:207], a[148:151], v[84:87], v[204:207]
    ds_read_b64_tr_b16 v[70:71], v9 offset:41472
    v_mfma_f32_16x16x32_bf16 v[232:235], a[152:155], v[84:87], v[232:235]
    v_mfma_f32_16x16x32_bf16 v[236:239], a[156:159], v[84:87], v[236:239]
    s_waitcnt lgkmcnt(6)
    v_mfma_f32_16x16x32_bf16 v[208:211], a[144:147], v[88:91], v[208:211]
    ds_read_b64_tr_b16 v[72:73], v10 offset:40960
    buffer_load_dwordx4 a[56:59], v2, s[24:27], s63 offen offset:2048 sc1
    v_mfma_f32_16x16x32_bf16 v[212:215], a[148:151], v[88:91], v[212:215]
    ds_read_b64_tr_b16 v[74:75], v10 offset:41472
    v_mfma_f32_16x16x32_bf16 v[240:243], a[152:155], v[88:91], v[240:243]
    v_mfma_f32_16x16x32_bf16 v[244:247], a[156:159], v[88:91], v[244:247]
    s_waitcnt lgkmcnt(6)
    v_mfma_f32_16x16x32_bf16 v[216:219], a[144:147], v[92:95], v[216:219]
    ds_read_b64_tr_b16 v[76:77], v11 offset:40960
    buffer_load_dwordx4 a[60:63], v2, s[24:27], s63 offen offset:3072 sc1
    v_mfma_f32_16x16x32_bf16 v[220:223], a[148:151], v[92:95], v[220:223]
    ds_read_b64_tr_b16 v[78:79], v11 offset:41472
    v_mfma_f32_16x16x32_bf16 v[248:251], a[152:155], v[92:95], v[248:251]
    v_mfma_f32_16x16x32_bf16 v[252:255], a[156:159], v[92:95], v[252:255]
    buffer_load_dword v57, v14, s[24:27], s42 offen sc1
    s_waitcnt lgkmcnt(6)
    v_mfma_f32_16x16x32_bf16 v[192:195], a[160:163], v[64:67], v[192:195]
    ds_read_b64_tr_b16 v[80:81], v8 offset:45056
    s_add_u32 s63, s64, 40960
    v_mfma_f32_16x16x32_bf16 v[196:199], a[164:167], v[64:67], v[196:199]
    ds_read_b64_tr_b16 v[82:83], v8 offset:45568
    buffer_load_dwordx4 a[64:67], v2, s[24:27], s63 offen offset:0 sc1
    v_mfma_f32_16x16x32_bf16 v[224:227], a[168:171], v[64:67], v[224:227]
    v_mfma_f32_16x16x32_bf16 v[228:231], a[172:175], v[64:67], v[228:231]
    s_waitcnt lgkmcnt(6)
    v_mfma_f32_16x16x32_bf16 v[200:203], a[160:163], v[68:71], v[200:203]
    ds_read_b64_tr_b16 v[84:85], v9 offset:45056
    buffer_load_dwordx4 a[68:71], v2, s[24:27], s63 offen offset:1024 sc1
    v_mfma_f32_16x16x32_bf16 v[204:207], a[164:167], v[68:71], v[204:207]
    ds_read_b64_tr_b16 v[86:87], v9 offset:45568
    v_mfma_f32_16x16x32_bf16 v[232:235], a[168:171], v[68:71], v[232:235]
    v_mfma_f32_16x16x32_bf16 v[236:239], a[172:175], v[68:71], v[236:239]
    s_waitcnt lgkmcnt(6)
    v_mfma_f32_16x16x32_bf16 v[208:211], a[160:163], v[72:75], v[208:211]
    ds_read_b64_tr_b16 v[88:89], v10 offset:45056
    buffer_load_dwordx4 a[72:75], v2, s[24:27], s63 offen offset:2048 sc1
    v_mfma_f32_16x16x32_bf16 v[212:215], a[164:167], v[72:75], v[212:215]
    ds_read_b64_tr_b16 v[90:91], v10 offset:45568
    v_mfma_f32_16x16x32_bf16 v[240:243], a[168:171], v[72:75], v[240:243]
    v_mfma_f32_16x16x32_bf16 v[244:247], a[172:175], v[72:75], v[244:247]
    s_waitcnt lgkmcnt(6)
    v_mfma_f32_16x16x32_bf16 v[216:219], a[160:163], v[76:79], v[216:219]
    ds_read_b64_tr_b16 v[92:93], v11 offset:45056
    buffer_load_dwordx4 a[76:79], v2, s[24:27], s63 offen offset:3072 sc1
    v_mfma_f32_16x16x32_bf16 v[220:223], a[164:167], v[76:79], v[220:223]
    ds_read_b64_tr_b16 v[94:95], v11 offset:45568
    v_mfma_f32_16x16x32_bf16 v[248:251], a[168:171], v[76:79], v[248:251]
    v_mfma_f32_16x16x32_bf16 v[252:255], a[172:175], v[76:79], v[252:255]
    s_waitcnt lgkmcnt(6)
    v_mfma_f32_16x16x32_bf16 v[192:195], a[176:179], v[80:83], v[192:195]
    ds_read_b64_tr_b16 v[64:65], v8 offset:49152
    s_add_u32 s63, s64, 45056
    v_mfma_f32_16x16x32_bf16 v[196:199], a[180:183], v[80:83], v[196:199]
    ds_read_b64_tr_b16 v[66:67], v8 offset:49664
    buffer_load_dwordx4 a[80:83], v2, s[24:27], s63 offen offset:0 sc1
    v_mfma_f32_16x16x32_bf16 v[224:227], a[184:187], v[80:83], v[224:227]
    v_mfma_f32_16x16x32_bf16 v[228:231], a[188:191], v[80:83], v[228:231]
    s_waitcnt lgkmcnt(6)
    v_mfma_f32_16x16x32_bf16 v[200:203], a[176:179], v[84:87], v[200:203]
    ds_read_b64_tr_b16 v[68:69], v8 offset:53248
    buffer_load_dwordx4 a[84:87], v2, s[24:27], s63 offen offset:1024 sc1
    v_mfma_f32_16x16x32_bf16 v[204:207], a[180:183], v[84:87], v[204:207]
    ds_read_b64_tr_b16 v[70:71], v8 offset:53760
    v_mfma_f32_16x16x32_bf16 v[232:235], a[184:187], v[84:87], v[232:235]
    v_mfma_f32_16x16x32_bf16 v[236:239], a[188:191], v[84:87], v[236:239]
    s_waitcnt lgkmcnt(6)
    v_mfma_f32_16x16x32_bf16 v[208:211], a[176:179], v[88:91], v[208:211]
    ds_read_b64_tr_b16 v[72:73], v8 offset:57344
    buffer_load_dwordx4 a[88:91], v2, s[24:27], s63 offen offset:2048 sc1
    v_mfma_f32_16x16x32_bf16 v[212:215], a[180:183], v[88:91], v[212:215]
    ds_read_b64_tr_b16 v[74:75], v8 offset:57856
    v_mfma_f32_16x16x32_bf16 v[240:243], a[184:187], v[88:91], v[240:243]
    v_mfma_f32_16x16x32_bf16 v[244:247], a[188:191], v[88:91], v[244:247]
    s_waitcnt lgkmcnt(6)
    v_mfma_f32_16x16x32_bf16 v[216:219], a[176:179], v[92:95], v[216:219]
    ds_read_b64_tr_b16 v[76:77], v8 offset:61440
    buffer_load_dwordx4 a[92:95], v2, s[24:27], s63 offen offset:3072 sc1
    v_mfma_f32_16x16x32_bf16 v[220:223], a[180:183], v[92:95], v[220:223]
    ds_read_b64_tr_b16 v[78:79], v8 offset:61952
    v_mfma_f32_16x16x32_bf16 v[248:251], a[184:187], v[92:95], v[248:251]
    v_mfma_f32_16x16x32_bf16 v[252:255], a[188:191], v[92:95], v[252:255]
    s_waitcnt lgkmcnt(6)
    v_mfma_f32_16x16x32_bf16 v[192:195], a[192:195], v[64:67], v[192:195]
    ds_read_b64_tr_b16 v[80:81], v9 offset:49152
    v_mfma_f32_16x16x32_bf16 v[196:199], a[196:199], v[64:67], v[196:199]
    ds_read_b64_tr_b16 v[82:83], v9 offset:49664
    v_mfma_f32_16x16x32_bf16 v[224:227], a[200:203], v[64:67], v[224:227]
    v_mfma_f32_16x16x32_bf16 v[228:231], a[204:207], v[64:67], v[228:231]
    s_waitcnt lgkmcnt(6)
    v_mfma_f32_16x16x32_bf16 v[192:195], a[208:211], v[68:71], v[192:195]
    ds_read_b64_tr_b16 v[84:85], v9 offset:53248
    v_mfma_f32_16x16x32_bf16 v[196:199], a[212:215], v[68:71], v[196:199]
    ds_read_b64_tr_b16 v[86:87], v9 offset:53760
    v_mfma_f32_16x16x32_bf16 v[224:227], a[216:219], v[68:71], v[224:227]
    v_mfma_f32_16x16x32_bf16 v[228:231], a[220:223], v[68:71], v[228:231]
    s_waitcnt vmcnt(8)
    v_cmp_gt_u32 vcc, 14, v57
    s_cbranch_vccnz Lck54
Lcb55:
    s_waitcnt lgkmcnt(6)
    v_mfma_f32_16x16x32_bf16 v[192:195], a[224:227], v[72:75], v[192:195]
    ds_read_b64_tr_b16 v[88:89], v9 offset:57344
    s_add_u32 s47, s65, 0
    v_mfma_f32_16x16x32_bf16 v[196:199], a[228:231], v[72:75], v[196:199]
    ds_read_b64_tr_b16 v[90:91], v9 offset:57856
    buffer_load_dwordx4 a[96:99], v2, s[24:27], s47 offen offset:0 sc1
    v_mfma_f32_16x16x32_bf16 v[224:227], a[232:235], v[72:75], v[224:227]
    v_mfma_f32_16x16x32_bf16 v[228:231], a[236:239], v[72:75], v[228:231]
    s_waitcnt lgkmcnt(6)
    v_mfma_f32_16x16x32_bf16 v[192:195], a[240:243], v[76:79], v[192:195]
    ds_read_b64_tr_b16 v[92:93], v9 offset:61440
    buffer_load_dwordx4 a[100:103], v2, s[24:27], s47 offen offset:1024 sc1
    v_mfma_f32_16x16x32_bf16 v[196:199], a[244:247], v[76:79], v[196:199]
    ds_read_b64_tr_b16 v[94:95], v9 offset:61952
    v_mfma_f32_16x16x32_bf16 v[224:227], a[248:251], v[76:79], v[224:227]
    v_mfma_f32_16x16x32_bf16 v[228:231], a[252:255], v[76:79], v[228:231]
    s_waitcnt lgkmcnt(6)
    v_mfma_f32_16x16x32_bf16 v[200:203], a[192:195], v[80:83], v[200:203]
    ds_read_b64_tr_b16 v[64:65], v10 offset:49152
    s_add_u32 s63, s64, 49152
    v_mfma_f32_16x16x32_bf16 v[204:207], a[196:199], v[80:83], v[204:207]
    ds_read_b64_tr_b16 v[66:67], v10 offset:49664
    buffer_load_dwordx4 a[104:107], v2, s[24:27], s63 offen offset:0 sc1
    v_mfma_f32_16x16x32_bf16 v[232:235], a[200:203], v[80:83], v[232:235]
    v_mfma_f32_16x16x32_bf16 v[236:239], a[204:207], v[80:83], v[236:239]
    s_waitcnt lgkmcnt(6)
    v_mfma_f32_16x16x32_bf16 v[200:203], a[208:211], v[84:87], v[200:203]
    ds_read_b64_tr_b16 v[68:69], v10 offset:53248
    buffer_load_dwordx4 a[108:111], v2, s[24:27], s63 offen offset:1024 sc1
    v_mfma_f32_16x16x32_bf16 v[204:207], a[212:215], v[84:87], v[204:207]
    ds_read_b64_tr_b16 v[70:71], v10 offset:53760
    v_max_f32 v192, 0, v192
    v_mfma_f32_16x16x32_bf16 v[232:235], a[216:219], v[84:87], v[232:235]
    v_max_f32 v193, 0, v193
    v_mul_f32 v192, v224, v192
    v_mul_f32 v193, v225, v193
    v_mfma_f32_16x16x32_bf16 v[236:239], a[220:223], v[84:87], v[236:239]
    v_cvt_pk_bf16_f32 v32, v192, v193
    s_waitcnt lgkmcnt(6)
    v_mfma_f32_16x16x32_bf16 v[200:203], a[224:227], v[88:91], v[200:203]
    ds_read_b64_tr_b16 v[72:73], v10 offset:57344
    buffer_load_dwordx4 a[112:115], v2, s[24:27], s47 offen offset:2048 sc1
    v_mfma_f32_16x16x32_bf16 v[204:207], a[228:231], v[88:91], v[204:207]
    ds_read_b64_tr_b16 v[74:75], v10 offset:57856
    v_max_f32 v194, 0, v194
    v_mfma_f32_16x16x32_bf16 v[232:235], a[232:235], v[88:91], v[232:235]
    v_max_f32 v195, 0, v195
    v_mul_f32 v194, v226, v194
    v_mul_f32 v195, v227, v195
    v_mfma_f32_16x16x32_bf16 v[236:239], a[236:239], v[88:91], v[236:239]
    v_cvt_pk_bf16_f32 v33, v194, v195
    s_waitcnt lgkmcnt(6)
    v_mfma_f32_16x16x32_bf16 v[200:203], a[240:243], v[92:95], v[200:203]
    ds_read_b64_tr_b16 v[76:77], v10 offset:61440
    buffer_load_dwordx4 a[116:119], v2, s[24:27], s47 offen offset:3072 sc1
    v_mfma_f32_16x16x32_bf16 v[204:207], a[244:247], v[92:95], v[204:207]
    ds_read_b64_tr_b16 v[78:79], v10 offset:61952
    v_max_f32 v196, 0, v196
    v_mfma_f32_16x16x32_bf16 v[232:235], a[248:251], v[92:95], v[232:235]
    v_max_f32 v197, 0, v197
    v_mul_f32 v196, v228, v196
    v_mul_f32 v197, v229, v197
    v_mfma_f32_16x16x32_bf16 v[236:239], a[252:255], v[92:95], v[236:239]
    v_cvt_pk_bf16_f32 v34, v196, v197
    s_waitcnt lgkmcnt(6)
    v_mfma_f32_16x16x32_bf16 v[208:211], a[192:195], v[64:67], v[208:211]
    ds_read_b64_tr_b16 v[80:81], v11 offset:49152
    s_add_u32 s63, s64, 49152
    v_mfma_f32_16x16x32_bf16 v[212:215], a[196:199], v[64:67], v[212:215]
    ds_read_b64_tr_b16 v[82:83], v11 offset:49664
    buffer_load_dwordx4 a[120:123], v2, s[24:27], s63 offen offset:2048 sc1
    v_mfma_f32_16x16x32_bf16 v[240:243], a[200:203], v[64:67], v[240:243]
    v_max_f32 v198, 0, v198
    v_max_f32 v199, 0, v199
    v_mul_f32 v198, v230, v198
    v_mfma_f32_16x16x32_bf16 v[244:247], a[204:207], v[64:67], v[244:247]
    v_mul_f32 v199, v231, v199
    s_waitcnt lgkmcnt(6)
    v_mfma_f32_16x16x32_bf16 v[208:211], a[208:211], v[68:71], v[208:211]
    ds_read_b64_tr_b16 v[84:85], v11 offset:53248
    buffer_load_dwordx4 a[124:127], v2, s[24:27], s63 offen offset:3072 sc1
    v_mfma_f32_16x16x32_bf16 v[212:215], a[212:215], v[68:71], v[212:215]
    ds_read_b64_tr_b16 v[86:87], v11 offset:53760
    v_cvt_pk_bf16_f32 v35, v198, v199
    v_mfma_f32_16x16x32_bf16 v[240:243], a[216:219], v[68:71], v[240:243]
    buffer_store_dwordx4 v[32:35], v50, s[24:27], s34 offen offset:0 sc1
    v_max_f32 v200, 0, v200
    v_max_f32 v201, 0, v201
    v_mfma_f32_16x16x32_bf16 v[244:247], a[220:223], v[68:71], v[244:247]
    v_mul_f32 v200, v232, v200
    s_waitcnt lgkmcnt(6)
    v_mfma_f32_16x16x32_bf16 v[208:211], a[224:227], v[72:75], v[208:211]
    ds_read_b64_tr_b16 v[88:89], v11 offset:57344
    s_add_u32 s47, s65, 4096
    v_mfma_f32_16x16x32_bf16 v[212:215], a[228:231], v[72:75], v[212:215]
    ds_read_b64_tr_b16 v[90:91], v11 offset:57856
    buffer_load_dwordx4 a[128:131], v2, s[24:27], s47 offen offset:0 sc1
    v_mfma_f32_16x16x32_bf16 v[240:243], a[232:235], v[72:75], v[240:243]
    v_mul_f32 v201, v233, v201
    v_cvt_pk_bf16_f32 v36, v200, v201
    v_max_f32 v202, 0, v202
    v_mfma_f32_16x16x32_bf16 v[244:247], a[236:239], v[72:75], v[244:247]
    v_max_f32 v203, 0, v203
    s_waitcnt lgkmcnt(6)
    v_mfma_f32_16x16x32_bf16 v[208:211], a[240:243], v[76:79], v[208:211]
    ds_read_b64_tr_b16 v[92:93], v11 offset:61440
    buffer_load_dwordx4 a[132:135], v2, s[24:27], s47 offen offset:1024 sc1
    v_mfma_f32_16x16x32_bf16 v[212:215], a[244:247], v[76:79], v[212:215]
    ds_read_b64_tr_b16 v[94:95], v11 offset:61952
    v_mul_f32 v202, v234, v202
    v_mfma_f32_16x16x32_bf16 v[240:243], a[248:251], v[76:79], v[240:243]
    v_mul_f32 v203, v235, v203
    v_cvt_pk_bf16_f32 v37, v202, v203
    v_max_f32 v204, 0, v204
    v_mfma_f32_16x16x32_bf16 v[244:247], a[252:255], v[76:79], v[244:247]
    v_max_f32 v205, 0, v205
    s_waitcnt lgkmcnt(6)
    v_mfma_f32_16x16x32_bf16 v[216:219], a[192:195], v[80:83], v[216:219]
    s_add_u32 s63, s64, 53248
    buffer_load_dwordx4 a[136:139], v2, s[24:27], s63 offen offset:0 sc1
    v_mfma_f32_16x16x32_bf16 v[220:223], a[196:199], v[80:83], v[220:223]
    v_mul_f32 v204, v236, v204
    v_mul_f32 v205, v237, v205
    v_mfma_f32_16x16x32_bf16 v[248:251], a[200:203], v[80:83], v[248:251]
    v_cvt_pk_bf16_f32 v38, v204, v205
    v_max_f32 v206, 0, v206
    v_max_f32 v207, 0, v207
    v_mfma_f32_16x16x32_bf16 v[252:255], a[204:207], v[80:83], v[252:255]
    v_mul_f32 v206, v238, v206
    s_waitcnt lgkmcnt(4)
    v_mfma_f32_16x16x32_bf16 v[216:219], a[208:211], v[84:87], v[216:219]
    buffer_load_dwordx4 a[140:143], v2, s[24:27], s63 offen offset:1024 sc1
    v_mul_f32 v207, v239, v207
    v_mfma_f32_16x16x32_bf16 v[220:223], a[212:215], v[84:87], v[220:223]
    v_cvt_pk_bf16_f32 v39, v206, v207
    buffer_store_dwordx4 v[36:39], v50, s[24:27], s34 offen offset:256 sc1
    v_mfma_f32_16x16x32_bf16 v[248:251], a[216:219], v[84:87], v[248:251]
    v_max_f32 v208, 0, v208
    v_max_f32 v209, 0, v209
    v_mul_f32 v208, v240, v208
    v_mfma_f32_16x16x32_bf16 v[252:255], a[220:223], v[84:87], v[252:255]
    v_mul_f32 v209, v241, v209
    s_waitcnt lgkmcnt(2)
    v_mfma_f32_16x16x32_bf16 v[216:219], a[224:227], v[88:91], v[216:219]
    buffer_load_dwordx4 a[144:147], v2, s[24:27], s47 offen offset:2048 sc1
    v_cvt_pk_bf16_f32 v40, v208, v209
    v_mfma_f32_16x16x32_bf16 v[220:223], a[228:231], v[88:91], v[220:223]
    v_max_f32 v210, 0, v210
    v_max_f32 v211, 0, v211
    v_mfma_f32_16x16x32_bf16 v[248:251], a[232:235], v[88:91], v[248:251]
    v_mul_f32 v210, v242, v210
    v_mul_f32 v211, v243, v211
    v_cvt_pk_bf16_f32 v41, v210, v211
    v_mfma_f32_16x16x32_bf16 v[252:255], a[236:239], v[88:91], v[252:255]
    v_max_f32 v212, 0, v212
    s_waitcnt lgkmcnt(0)
    v_mfma_f32_16x16x32_bf16 v[216:219], a[240:243], v[92:95], v[216:219]
    buffer_load_dwordx4 a[148:151], v2, s[24:27], s47 offen offset:3072 sc1
    v_max_f32 v213, 0, v213
    v_mfma_f32_16x16x32_bf16 v[220:223], a[244:247], v[92:95], v[220:223]
    v_mul_f32 v212, v244, v212
    v_mul_f32 v213, v245, v213
    v_mfma_f32_16x16x32_bf16 v[248:251], a[248:251], v[92:95], v[248:251]
    v_cvt_pk_bf16_f32 v42, v212, v213
    v_max_f32 v214, 0, v214
    v_max_f32 v215, 0, v215
    v_mfma_f32_16x16x32_bf16 v[252:255], a[252:255], v[92:95], v[252:255]
    v_mul_f32 v214, v246, v214
    v_mul_f32 v215, v247, v215
    v_cvt_pk_bf16_f32 v43, v214, v215
    buffer_store_dwordx4 v[40:43], v50, s[24:27], s35 offen offset:0 sc1
    v_max_f32 v216, 0, v216
    v_max_f32 v217, 0, v217
    v_mul_f32 v216, v248, v216
    v_mul_f32 v217, v249, v217
    v_cvt_pk_bf16_f32 v44, v216, v217
    v_max_f32 v218, 0, v218
    v_max_f32 v219, 0, v219
    v_mul_f32 v218, v250, v218
    v_mul_f32 v219, v251, v219
    v_cvt_pk_bf16_f32 v45, v218, v219
    v_max_f32 v220, 0, v220
    v_max_f32 v221, 0, v221
    v_mul_f32 v220, v252, v220
    v_mul_f32 v221, v253, v221
    v_cvt_pk_bf16_f32 v46, v220, v221
    v_max_f32 v222, 0, v222
    v_max_f32 v223, 0, v223
    v_mul_f32 v222, v254, v222
    v_mul_f32 v223, v255, v223
    v_cvt_pk_bf16_f32 v47, v222, v223
    buffer_store_dwordx4 v[44:47], v50, s[24:27], s35 offen offset:256 sc1
    s_add_u32 s63, s64, 53248
    buffer_load_dwordx4 a[152:155], v2, s[24:27], s63 offen offset:2048 sc1
    buffer_load_dwordx4 a[156:159], v2, s[24:27], s63 offen offset:3072 sc1
    s_add_u32 s47, s65, 8192
    buffer_load_dwordx4 a[160:163], v2, s[24:27], s47 offen offset:0 sc1
    buffer_load_dwordx4 a[164:167], v2, s[24:27], s47 offen offset:1024 sc1
    buffer_load_dwordx4 a[168:171], v2, s[24:27], s47 offen offset:2048 sc1
    buffer_load_dwordx4 a[172:175], v2, s[24:27], s47 offen offset:3072 sc1
    s_add_u32 s47, s65, 12288
    buffer_load_dwordx4 a[176:179], v2, s[24:27], s47 offen offset:0 sc1
    buffer_load_dwordx4 a[180:183], v2, s[24:27], s47 offen offset:1024 sc1
    s_waitcnt vmcnt(8)
    s_mov_b64 exec, 1
    buffer_atomic_add v15, v14, s[24:27], s36 offen sc1
    s_mov_b64 exec, -1
    s_barrier
    s_mov_b64 exec, 1
    buffer_atomic_add v15, v14, s[24:27], s41 offen sc1
    s_mov_b64 exec, -1
Lg1j39:
    s_waitcnt vmcnt(10)
    v_mfma_f32_32x32x16_bf16 v[192:207], v[96:99], a[96:99], 0
    buffer_load_dwordx4 a[184:187], v2, s[24:27], s47 offen offset:2048 sc1
    v_and_b32 v48, 15, v5
    v_and_b32 v49, 16, v1
    v_mfma_f32_32x32x16_bf16 v[208:223], v[100:103], a[96:99], 0
    buffer_load_dwordx4 a[188:191], v2, s[24:27], s47 offen offset:3072 sc1
    v_lshlrev_b32 v49, 1, v49
    v_lshl_or_b32 v49, v4, 4, v49
    v_mfma_f32_32x32x16_bf16 v[192:207], v[104:107], a[100:103], v[192:207]
    s_add_u32 s47, s65, 16384
    buffer_load_dwordx4 a[96:99], v2, s[24:27], s47 offen offset:0 sc1
    s_lshr_b32 s68, s55, 1
    v_mfma_f32_32x32x16_bf16 v[208:223], v[108:111], a[100:103], v[208:223]
    buffer_load_dwordx4 a[100:103], v2, s[24:27], s47 offen offset:1024 sc1
    s_lshl_b32 s68, s68, 2
    s_and_b32 s56, s55, 1
    v_mfma_f32_32x32x16_bf16 v[192:207], v[112:115], a[112:115], v[192:207]
    s_add_u32 s68, s68, s56
    s_lshl_b32 s56, s3, 13
    s_add_u32 s56, s56, 65536
    v_mfma_f32_32x32x16_bf16 v[208:223], v[116:119], a[112:115], v[208:223]
    buffer_load_dwordx4 a[112:115], v2, s[24:27], s47 offen offset:2048 sc1
    v_add_u32 v50, s56, v2
    v_and_b32 v52, 0x2f0, v2
    v_mfma_f32_32x32x16_bf16 v[192:207], v[120:123], a[116:119], v[192:207]
    v_and_b32 v53, 16, v1
    v_lshl_or_b32 v54, v53, 6, v52
    v_lshl_or_b32 v52, v53, 7, v52
    v_mfma_f32_32x32x16_bf16 v[208:223], v[124:127], a[116:119], v[208:223]
    buffer_load_dwordx4 a[116:119], v2, s[24:27], s47 offen offset:3072 sc1
    s_lshl_b32 s56, s67, 12
    s_lshl_b32 s57, s66, 8
    v_mfma_f32_32x32x16_bf16 v[192:207], a[0:3], a[128:131], v[192:207]
    s_add_u32 s56, s56, s57
    s_add_u32 s56, s56, 65536
    v_add_u32 v52, s56, v52
    v_mfma_f32_32x32x16_bf16 v[208:223], a[4:7], a[128:131], v[208:223]
    s_add_u32 s47, s65, 20480
    buffer_load_dwordx4 a[128:131], v2, s[24:27], s47 offen offset:0 sc1
    v_and_b32 v53, 3, v48
    v_mfma_f32_32x32x16_bf16 v[192:207], a[8:11], a[132:135], v[192:207]
    v_lshlrev_b32 v53, 5, v53
    v_and_b32 v55, 4, v48
    v_lshl_or_b32 v53, v55, 2, v53
    v_mfma_f32_32x32x16_bf16 v[208:223], a[12:15], a[132:135], v[208:223]
    buffer_load_dwordx4 a[132:135], v2, s[24:27], s47 offen offset:1024 sc1
    v_lshrrev_b32 v55, 3, v48
    v_or_b32 v53, v53, v55
    v_mfma_f32_32x32x16_bf16 v[192:207], a[16:19], a[144:147], v[192:207]
    v_lshl_add_u32 v8, v53, 10, v49
    s_lshr_b32 s69, s55, 1
    s_lshl_b32 s69, s69, 7
    v_mfma_f32_32x32x16_bf16 v[208:223], a[20:23], a[144:147], v[208:223]
    buffer_load_dwordx4 a[144:147], v2, s[24:27], s47 offen offset:2048 sc1
    s_and_b32 s57, s55, 1
    s_lshl_b32 s57, s57, 2
    v_mfma_f32_32x32x16_bf16 v[192:207], a[24:27], a[148:151], v[192:207]
    s_add_u32 s69, s69, s57
    s_lshl_b32 s57, s66, 1
    s_add_u32 s69, s69, s57
    v_mfma_f32_32x32x16_bf16 v[208:223], a[28:31], a[148:151], v[208:223]
    buffer_load_dwordx4 a[148:151], v2, s[24:27], s47 offen offset:3072 sc1
    s_lshl_b32 s69, s69, 10
    s_lshl_b32 s57, s54, 7
    s_waitcnt vmcnt(17)
    v_mfma_f32_32x32x16_bf16 v[192:207], v[128:131], a[160:163], v[192:207]
    s_add_u32 s69, s69, s57
    s_lshl_b32 s57, s67, 6
    s_add_u32 s69, s69, s57
    v_mfma_f32_32x32x16_bf16 v[208:223], v[132:135], a[160:163], v[208:223]
    s_add_u32 s47, s65, 24576
    buffer_load_dwordx4 a[160:163], v2, s[24:27], s47 offen offset:0 sc1
    s_add_u32 s58, s69, 8192
    s_waitcnt vmcnt(17)
    v_mfma_f32_32x32x16_bf16 v[192:207], v[136:139], a[164:167], v[192:207]
    s_mov_b32 s32, s18
    s_mov_b32 s33, s19
    s_mov_b32 s34, 0x200000
    v_mfma_f32_32x32x16_bf16 v[208:223], v[140:143], a[164:167], v[208:223]
    buffer_load_dwordx4 a[164:167], v2, s[24:27], s47 offen offset:1024 sc1
    s_mov_b32 s35, 0x20000
    buffer_load_dwordx4 v[16:19], v8, s[28:31], s69 offen
    s_waitcnt vmcnt(18)
    v_mfma_f32_32x32x16_bf16 v[192:207], v[144:147], a[168:171], v[192:207]
    buffer_load_dwordx4 v[20:23], v8, s[28:31], s58 offen
    v_lshlrev_b32 v9, 2, v48
    s_lshl_b32 s59, s68, 7
    v_mfma_f32_32x32x16_bf16 v[208:223], v[148:151], a[168:171], v[208:223]
    buffer_load_dwordx4 a[168:171], v2, s[24:27], s47 offen offset:2048 sc1
    s_lshl_b32 s57, s66, 6
    s_add_u32 s59, s59, s57
    s_waitcnt vmcnt(19)
    v_mfma_f32_32x32x16_bf16 v[192:207], v[152:155], a[172:175], v[192:207]
    s_add_u32 s59, s59, 0x2006000
    s_lshl_b32 s60, s68, 4
    s_lshl_b32 s57, s54, 1
    v_mfma_f32_32x32x16_bf16 v[208:223], v[156:159], a[172:175], v[208:223]
    buffer_load_dwordx4 a[172:175], v2, s[24:27], s47 offen offset:3072 sc1
    s_add_u32 s60, s60, s57
    s_add_u32 s60, s60, s67
    s_waitcnt vmcnt(19)
    v_mfma_f32_32x32x16_bf16 v[192:207], v[160:163], a[176:179], v[192:207]
    s_lshl_b32 s60, s60, 11
    s_lshl_b32 s57, s66, 8
    s_add_u32 s60, s60, s57
    v_mfma_f32_32x32x16_bf16 v[208:223], v[164:167], a[176:179], v[208:223]
    s_add_u32 s60, s60, 0x1c00000
    s_add_u32 s61, s60, 0x10000
    s_waitcnt vmcnt(18)
    buffer_load_dword v57, v14, s[24:27], s37 offen sc1
    v_mfma_f32_32x32x16_bf16 v[192:207], v[168:171], a[180:183], v[192:207]
    v_mfma_f32_32x32x16_bf16 v[208:223], v[172:175], a[180:183], v[208:223]
    s_waitcnt vmcnt(16)
    v_mfma_f32_32x32x16_bf16 v[192:207], v[176:179], a[184:187], v[192:207]
    v_mfma_f32_32x32x16_bf16 v[208:223], v[180:183], a[184:187], v[208:223]
    s_waitcnt vmcnt(15)
    v_mfma_f32_32x32x16_bf16 v[192:207], v[184:187], a[188:191], v[192:207]
    v_mfma_f32_32x32x16_bf16 v[208:223], v[188:191], a[188:191], v[208:223]
    s_waitcnt vmcnt(14)
    v_mfma_f32_32x32x16_bf16 v[192:207], a[32:35], a[96:99], v[192:207]
    v_mfma_f32_32x32x16_bf16 v[208:223], a[36:39], a[96:99], v[208:223]
    s_waitcnt vmcnt(13)
    s_waitcnt vmcnt(0)
    v_cmp_gt_u32 vcc, 14, v57
    s_cbranch_vccz Lcb56
    s_mov_b32 m0, 0
Lcp57:
    s_sleep 3
    buffer_load_dword v57, v14, s[24:27], s37 offen sc1
    s_add_u32 m0, m0, 1
    s_cmp_gt_u32 m0, 400000
    s_cbranch_scc1 Lcb56
    s_waitcnt vmcnt(0)
    v_cmp_gt_u32 vcc, 14, v57
    s_cbranch_vccnz Lcp57
Lcb56:
    v_mfma_f32_32x32x16_bf16 v[192:207], a[40:43], a[100:103], v[192:207]
    s_add_u32 s47, s65, 3670016
    buffer_load_dwordx4 a[176:179], v2, s[24:27], s47 offen offset:0 sc1
    v_mfma_f32_32x32x16_bf16 v[208:223], a[44:47], a[100:103], v[208:223]
    buffer_load_dwordx4 a[180:183], v2, s[24:27], s47 offen offset:1024 sc1
    v_mfma_f32_32x32x16_bf16 v[192:207], a[48:51], a[112:115], v[192:207]
    buffer_load_dwordx4 a[184:187], v2, s[24:27], s47 offen offset:2048 sc1
    v_mfma_f32_32x32x16_bf16 v[208:223], a[52:55], a[112:115], v[208:223]
    buffer_load_dwordx4 a[188:191], v2, s[24:27], s47 offen offset:3072 sc1
    v_mfma_f32_32x32x16_bf16 v[192:207], a[56:59], a[116:119], v[192:207]
    s_add_u32 s47, s65, 3674112
    buffer_load_dwordx4 a[96:99], v2, s[24:27], s47 offen offset:0 sc1
    v_mfma_f32_32x32x16_bf16 v[208:223], a[60:63], a[116:119], v[208:223]
    buffer_load_dwordx4 a[100:103], v2, s[24:27], s47 offen offset:1024 sc1
    v_mfma_f32_32x32x16_bf16 v[192:207], a[64:67], a[128:131], v[192:207]
    buffer_load_dwordx4 a[112:115], v2, s[24:27], s47 offen offset:2048 sc1
    v_mfma_f32_32x32x16_bf16 v[208:223], a[68:71], a[128:131], v[208:223]
    buffer_load_dwordx4 a[116:119], v2, s[24:27], s47 offen offset:3072 sc1
    v_mfma_f32_32x32x16_bf16 v[192:207], a[72:75], a[132:135], v[192:207]
    s_add_u32 s47, s65, 3678208
    buffer_load_dwordx4 a[128:131], v2, s[24:27], s47 offen offset:0 sc1
    v_mfma_f32_32x32x16_bf16 v[208:223], a[76:79], a[132:135], v[208:223]
    buffer_load_dwordx4 a[132:135], v2, s[24:27], s47 offen offset:1024 sc1
    v_mfma_f32_32x32x16_bf16 v[192:207], a[80:83], a[144:147], v[192:207]
    v_mfma_f32_32x32x16_bf16 v[208:223], a[84:87], a[144:147], v[208:223]
    buffer_load_dwordx4 a[144:147], v2, s[24:27], s47 offen offset:2048 sc1
    v_mfma_f32_32x32x16_bf16 v[192:207], a[88:91], a[148:151], v[192:207]
    v_mfma_f32_32x32x16_bf16 v[208:223], a[92:95], a[148:151], v[208:223]
    buffer_load_dwordx4 a[148:151], v2, s[24:27], s47 offen offset:3072 sc1
    v_mfma_f32_32x32x16_bf16 v[192:207], a[104:107], a[160:163], v[192:207]
    v_mfma_f32_32x32x16_bf16 v[208:223], a[108:111], a[160:163], v[208:223]
    s_add_u32 s47, s65, 3682304
    buffer_load_dwordx4 a[160:163], v2, s[24:27], s47 offen offset:0 sc1
    buffer_load_dword v57, v14, s[24:27], s43 offen sc1
    v_mfma_f32_32x32x16_bf16 v[192:207], a[120:123], a[164:167], v[192:207]
    v_mfma_f32_32x32x16_bf16 v[208:223], a[124:127], a[164:167], v[208:223]
    buffer_load_dwordx4 a[164:167], v2, s[24:27], s47 offen offset:1024 sc1
    v_mfma_f32_32x32x16_bf16 v[192:207], a[136:139], a[168:171], v[192:207]
    v_mfma_f32_32x32x16_bf16 v[208:223], a[140:143], a[168:171], v[208:223]
    buffer_load_dwordx4 a[168:171], v2, s[24:27], s47 offen offset:2048 sc1
    v_mfma_f32_32x32x16_bf16 v[192:207], a[152:155], a[172:175], v[192:207]
    v_mfma_f32_32x32x16_bf16 v[208:223], a[156:159], a[172:175], v[208:223]
    buffer_load_dwordx4 a[172:175], v2, s[24:27], s47 offen offset:3072 sc1
    s_mov_b32 s56, 0x3b000000
    v_mov_b32 v11, 0x3727c5ac
    s_waitcnt vmcnt(16)
    v_mfma_f32_32x32x16_bf16 v[224:239], v[96:99], a[176:179], 0
    v_mfma_f32_32x32x16_bf16 v[240:255], v[100:103], a[176:179], 0
    s_add_u32 s47, s65, 3686400
    buffer_load_dwordx4 a[176:179], v2, s[24:27], s47 offen offset:0 sc1
    s_waitcnt vmcnt(16)
    v_mfma_f32_32x32x16_bf16 v[224:239], v[104:107], a[180:183], v[224:239]
    s_nop 0
    ds_write_b128 v50, v[192:195] offset:0
    v_mfma_f32_32x32x16_bf16 v[240:255], v[108:111], a[180:183], v[240:255]
    buffer_load_dwordx4 a[180:183], v2, s[24:27], s47 offen offset:1024 sc1
    ds_write_b128 v50, v[196:199] offset:1024
    s_waitcnt vmcnt(16)
    v_mfma_f32_32x32x16_bf16 v[224:239], v[112:115], a[184:187], v[224:239]
    ds_write_b128 v50, v[200:203] offset:2048
    v_lshlrev_b32 v80, 16, v16
    v_and_b32 v81, 0xffff0000, v16
    v_lshlrev_b32 v82, 16, v17
    v_mfma_f32_32x32x16_bf16 v[240:255], v[116:119], a[184:187], v[240:255]
    buffer_load_dwordx4 a[184:187], v2, s[24:27], s47 offen offset:2048 sc1
    ds_write_b128 v50, v[204:207] offset:3072
    v_and_b32 v83, 0xffff0000, v17
    s_waitcnt vmcnt(16)
    v_mfma_f32_32x32x16_bf16 v[224:239], v[120:123], a[188:191], v[224:239]
    ds_write_b128 v50, v[208:211] offset:4096
    v_lshlrev_b32 v84, 16, v18
    v_and_b32 v85, 0xffff0000, v18
    v_lshlrev_b32 v86, 16, v19
    v_mfma_f32_32x32x16_bf16 v[240:255], v[124:127], a[188:191], v[240:255]
    buffer_load_dwordx4 a[188:191], v2, s[24:27], s47 offen offset:3072 sc1
    ds_write_b128 v50, v[212:215] offset:5120
    v_and_b32 v87, 0xffff0000, v19
    s_waitcnt vmcnt(16)
    v_mfma_f32_32x32x16_bf16 v[224:239], a[0:3], a[96:99], v[224:239]
    ds_write_b128 v50, v[216:219] offset:6144
    v_lshlrev_b32 v88, 16, v20
    v_and_b32 v89, 0xffff0000, v20
    v_lshlrev_b32 v90, 16, v21
    v_mfma_f32_32x32x16_bf16 v[240:255], a[4:7], a[96:99], v[240:255]
    s_add_u32 s47, s65, 3690496
    buffer_load_dwordx4 a[96:99], v2, s[24:27], s47 offen offset:0 sc1
    ds_write_b128 v50, v[220:223] offset:7168
    v_and_b32 v91, 0xffff0000, v21
    s_waitcnt vmcnt(16)
    v_mfma_f32_32x32x16_bf16 v[224:239], a[8:11], a[100:103], v[224:239]
    v_lshlrev_b32 v92, 16, v22
    v_and_b32 v93, 0xffff0000, v22
    v_lshlrev_b32 v94, 16, v23
    v_and_b32 v95, 0xffff0000, v23
    v_mfma_f32_32x32x16_bf16 v[240:255], a[12:15], a[100:103], v[240:255]
    buffer_load_dwordx4 a[100:103], v2, s[24:27], s47 offen offset:1024 sc1
    s_waitcnt vmcnt(16)
    v_mfma_f32_32x32x16_bf16 v[224:239], a[16:19], a[112:115], v[224:239]
    v_mfma_f32_32x32x16_bf16 v[240:255], a[20:23], a[112:115], v[240:255]
    buffer_load_dwordx4 a[112:115], v2, s[24:27], s47 offen offset:2048 sc1
    s_waitcnt vmcnt(16)
    v_mfma_f32_32x32x16_bf16 v[224:239], a[24:27], a[116:119], v[224:239]
    s_waitcnt vmcnt(10)
    v_cmp_gt_u32 vcc, 16, v57
    s_cbranch_vccz Lcb58
    s_mov_b32 m0, 0
Lcp59:
    s_sleep 3
    buffer_load_dword v57, v14, s[24:27], s43 offen sc1
    s_add_u32 m0, m0, 1
    s_cmp_gt_u32 m0, 400000
    s_cbranch_scc1 Lcb58
    s_waitcnt vmcnt(0)
    v_cmp_gt_u32 vcc, 16, v57
    s_cbranch_vccnz Lcp59
Lcb58:
    buffer_load_dword v32, v9, s[24:27], s59 offen offset:0 sc1
    buffer_load_dwordx4 v[24:27], v54, s[24:27], s60 offen sc1
    buffer_load_dword v40, v9, s[24:27], s59 offen offset:256 sc1
    buffer_load_dwordx4 v[28:31], v54, s[24:27], s61 offen sc1
    v_mfma_f32_32x32x16_bf16 v[240:255], a[28:31], a[116:119], v[240:255]
    buffer_load_dwordx4 a[116:119], v2, s[24:27], s47 offen offset:3072 sc1
    v_mfma_f32_32x32x16_bf16 v[224:239], v[128:131], a[128:131], v[224:239]
    v_mfma_f32_32x32x16_bf16 v[240:255], v[132:135], a[128:131], v[240:255]
    s_add_u32 s47, s65, 3694592
    buffer_load_dwordx4 a[128:131], v2, s[24:27], s47 offen offset:0 sc1
    v_mfma_f32_32x32x16_bf16 v[224:239], v[136:139], a[132:135], v[224:239]
    v_mfma_f32_32x32x16_bf16 v[240:255], v[140:143], a[132:135], v[240:255]
    buffer_load_dwordx4 a[132:135], v2, s[24:27], s47 offen offset:1024 sc1
    v_mfma_f32_32x32x16_bf16 v[224:239], v[144:147], a[144:147], v[224:239]
    s_waitcnt lgkmcnt(0)
    s_barrier
    ds_read_b128 v[192:195], v52 offset:0
    ds_read_b128 v[196:199], v52 offset:1024
    ds_read_b128 v[200:203], v52 offset:8192
    ds_read_b128 v[204:207], v52 offset:9216
    v_mfma_f32_32x32x16_bf16 v[240:255], v[148:151], a[144:147], v[240:255]
    buffer_load_dwordx4 a[144:147], v2, s[24:27], s47 offen offset:2048 sc1
    ds_read_b128 v[208:211], v52 offset:16384
    ds_read_b128 v[212:215], v52 offset:17408
    v_mfma_f32_32x32x16_bf16 v[224:239], v[152:155], a[148:151], v[224:239]
    ds_read_b128 v[216:219], v52 offset:24576
    ds_read_b128 v[220:223], v52 offset:25600
    s_waitcnt lgkmcnt(4)
    v_add_f32 v192, v192, v200
    v_mfma_f32_32x32x16_bf16 v[240:255], v[156:159], a[148:151], v[240:255]
    buffer_load_dwordx4 a[148:151], v2, s[24:27], s47 offen offset:3072 sc1
    v_add_f32 v193, v193, v201
    v_add_f32 v194, v194, v202
    v_mfma_f32_32x32x16_bf16 v[224:239], v[160:163], a[160:163], v[224:239]
    v_add_f32 v195, v195, v203
    v_add_f32 v196, v196, v204
    v_add_f32 v197, v197, v205
    v_add_f32 v198, v198, v206
    v_mfma_f32_32x32x16_bf16 v[240:255], v[164:167], a[160:163], v[240:255]
    v_add_f32 v199, v199, v207
    s_waitcnt lgkmcnt(0)
    v_add_f32 v208, v208, v216
    v_add_f32 v209, v209, v217
    s_waitcnt vmcnt(18)
    v_mfma_f32_32x32x16_bf16 v[224:239], v[168:171], a[164:167], v[224:239]
    v_add_f32 v210, v210, v218
    v_add_f32 v211, v211, v219
    v_add_f32 v212, v212, v220
    v_add_f32 v213, v213, v221
    v_mfma_f32_32x32x16_bf16 v[240:255], v[172:175], a[164:167], v[240:255]
    v_add_f32 v214, v214, v222
    v_add_f32 v215, v215, v223
    v_add_f32 v192, v192, v208
    v_add_f32 v193, v193, v209
    s_waitcnt vmcnt(17)
    v_mfma_f32_32x32x16_bf16 v[224:239], v[176:179], a[168:171], v[224:239]
    v_add_f32 v194, v194, v210
    v_add_f32 v195, v195, v211
    v_add_f32 v196, v196, v212
    v_add_f32 v197, v197, v213
    v_mfma_f32_32x32x16_bf16 v[240:255], v[180:183], a[168:171], v[240:255]
    v_add_f32 v198, v198, v214
    v_add_f32 v199, v199, v215
    s_waitcnt vmcnt(16)
    v_mfma_f32_32x32x16_bf16 v[224:239], v[184:187], a[172:175], v[224:239]
    s_waitcnt vmcnt(5)
    v_fma_f32 v32, v32, s56, v11
    v_rcp_f32 v32, v32
    v_lshlrev_b32 v96, 16, v24
    v_mfma_f32_32x32x16_bf16 v[240:255], v[188:191], a[172:175], v[240:255]
    v_and_b32 v97, 0xffff0000, v24
    v_lshlrev_b32 v98, 16, v25
    v_and_b32 v99, 0xffff0000, v25
    v_lshlrev_b32 v100, 16, v26
    v_mfma_f32_32x32x16_bf16 v[224:239], a[32:35], a[176:179], v[224:239]
    v_and_b32 v101, 0xffff0000, v26
    v_lshlrev_b32 v102, 16, v27
    v_and_b32 v103, 0xffff0000, v27
    v_add_f32 v96, v96, v80
    v_mfma_f32_32x32x16_bf16 v[240:255], a[36:39], a[176:179], v[240:255]
    v_add_f32 v97, v97, v81
    v_add_f32 v98, v98, v82
    v_add_f32 v99, v99, v83
    v_add_f32 v100, v100, v84
    v_mfma_f32_32x32x16_bf16 v[224:239], a[40:43], a[180:183], v[224:239]
    v_add_f32 v101, v101, v85
    v_add_f32 v102, v102, v86
    v_add_f32 v103, v103, v87
    v_fma_f32 v40, v40, s56, v11
    v_mfma_f32_32x32x16_bf16 v[240:255], a[44:47], a[180:183], v[240:255]
    v_rcp_f32 v40, v40
    v_lshlrev_b32 v104, 16, v28
    v_and_b32 v105, 0xffff0000, v28
    v_lshlrev_b32 v106, 16, v29
    v_mfma_f32_32x32x16_bf16 v[224:239], a[48:51], a[184:187], v[224:239]
    v_and_b32 v107, 0xffff0000, v29
    v_lshlrev_b32 v108, 16, v30
    v_and_b32 v109, 0xffff0000, v30
    v_lshlrev_b32 v110, 16, v31
    v_mfma_f32_32x32x16_bf16 v[240:255], a[52:55], a[184:187], v[240:255]
    v_and_b32 v111, 0xffff0000, v31
    v_add_f32 v104, v104, v88
    v_add_f32 v105, v105, v89
    v_add_f32 v106, v106, v90
    v_mfma_f32_32x32x16_bf16 v[224:239], a[56:59], a[188:191], v[224:239]
    v_add_f32 v107, v107, v91
    v_add_f32 v108, v108, v92
    v_add_f32 v109, v109, v93
    v_add_f32 v110, v110, v94
    v_mfma_f32_32x32x16_bf16 v[240:255], a[60:63], a[188:191], v[240:255]
    v_add_f32 v111, v111, v95
    v_fma_f32 v192, v192, v32, v96
    v_fma_f32 v193, v193, v32, v97
    v_fma_f32 v194, v194, v32, v98
    v_mfma_f32_32x32x16_bf16 v[224:239], a[64:67], a[96:99], v[224:239]
    v_fma_f32 v195, v195, v32, v99
    v_fma_f32 v196, v196, v32, v100
    v_fma_f32 v197, v197, v32, v101
    v_fma_f32 v198, v198, v32, v102
    v_mfma_f32_32x32x16_bf16 v[240:255], a[68:71], a[96:99], v[240:255]
    v_fma_f32 v199, v199, v32, v103
    v_cvt_pk_bf16_f32 v200, v192, v193
    v_cvt_pk_bf16_f32 v201, v194, v195
    v_cvt_pk_bf16_f32 v202, v196, v197
    v_mfma_f32_32x32x16_bf16 v[224:239], a[72:75], a[100:103], v[224:239]
    v_cvt_pk_bf16_f32 v203, v198, v199
    buffer_store_dwordx4 v[200:203], v8, s[32:35], s69 offen
    v_mfma_f32_32x32x16_bf16 v[240:255], a[76:79], a[100:103], v[240:255]
    v_mfma_f32_32x32x16_bf16 v[224:239], a[80:83], a[112:115], v[224:239]
    v_mfma_f32_32x32x16_bf16 v[240:255], a[84:87], a[112:115], v[240:255]
    s_waitcnt vmcnt(5)
    v_mfma_f32_32x32x16_bf16 v[224:239], a[88:91], a[116:119], v[224:239]
    v_mfma_f32_32x32x16_bf16 v[240:255], a[92:95], a[116:119], v[240:255]
    s_waitcnt vmcnt(4)
    v_mfma_f32_32x32x16_bf16 v[224:239], a[104:107], a[128:131], v[224:239]
    s_waitcnt vmcnt(3)
    v_mfma_f32_32x32x16_bf16 v[224:239], a[120:123], a[132:135], v[224:239]
    s_waitcnt vmcnt(2)
    v_mfma_f32_32x32x16_bf16 v[224:239], a[136:139], a[144:147], v[224:239]
    s_waitcnt vmcnt(1)
    v_mfma_f32_32x32x16_bf16 v[224:239], a[152:155], a[148:151], v[224:239]
    v_mfma_f32_32x32x16_bf16 v[240:255], a[108:111], a[128:131], v[240:255]
    v_mfma_f32_32x32x16_bf16 v[240:255], a[124:127], a[132:135], v[240:255]
    s_nop 9
    ds_write_b128 v50, v[224:227] offset:32768
    v_mfma_f32_32x32x16_bf16 v[240:255], a[140:143], a[144:147], v[240:255]
    ds_write_b128 v50, v[228:231] offset:33792
    v_mfma_f32_32x32x16_bf16 v[240:255], a[156:159], a[148:151], v[240:255]
    ds_write_b128 v50, v[232:235] offset:34816
    ds_write_b128 v50, v[236:239] offset:35840
    s_nop 9
    ds_write_b128 v50, v[240:243] offset:36864
    ds_write_b128 v50, v[244:247] offset:37888
    ds_write_b128 v50, v[248:251] offset:38912
    ds_write_b128 v50, v[252:255] offset:39936
    s_waitcnt lgkmcnt(0)
    s_barrier
    ds_read_b128 v[128:131], v52 offset:32768
    ds_read_b128 v[132:135], v52 offset:33792
    ds_read_b128 v[136:139], v52 offset:40960
    ds_read_b128 v[140:143], v52 offset:41984
    ds_read_b128 v[144:147], v52 offset:49152
    ds_read_b128 v[148:151], v52 offset:50176
    ds_read_b128 v[152:155], v52 offset:57344
    ds_read_b128 v[156:159], v52 offset:58368
    s_waitcnt lgkmcnt(4)
    v_pk_add_f32 v[128:129], v[128:129], v[136:137]
    v_pk_add_f32 v[130:131], v[130:131], v[138:139]
    v_pk_add_f32 v[132:133], v[132:133], v[140:141]
    v_pk_add_f32 v[134:135], v[134:135], v[142:143]
    s_waitcnt lgkmcnt(0)
    v_pk_add_f32 v[144:145], v[144:145], v[152:153]
    v_pk_add_f32 v[146:147], v[146:147], v[154:155]
    v_pk_add_f32 v[148:149], v[148:149], v[156:157]
    v_pk_add_f32 v[150:151], v[150:151], v[158:159]
    v_pk_add_f32 v[128:129], v[128:129], v[144:145]
    v_pk_add_f32 v[130:131], v[130:131], v[146:147]
    v_pk_add_f32 v[132:133], v[132:133], v[148:149]
    v_pk_add_f32 v[134:135], v[134:135], v[150:151]
    v_pk_fma_f32 v[128:129], v[128:129], v[40:41], v[104:105] op_sel_hi:[1,0,1]
    v_pk_fma_f32 v[130:131], v[130:131], v[40:41], v[106:107] op_sel_hi:[1,0,1]
    v_pk_fma_f32 v[132:133], v[132:133], v[40:41], v[108:109] op_sel_hi:[1,0,1]
    v_pk_fma_f32 v[134:135], v[134:135], v[40:41], v[110:111] op_sel_hi:[1,0,1]
    v_cvt_pk_bf16_f32 v136, v128, v129
    v_cvt_pk_bf16_f32 v137, v130, v131
    v_cvt_pk_bf16_f32 v138, v132, v133
    v_cvt_pk_bf16_f32 v139, v134, v135
    buffer_store_dwordx4 v[136:139], v8, s[32:35], s58 offen
Lexit:
    s_endpgm
Lzc4:
    s_mov_b64 exec, 0x1
    s_mov_b32 m0, 0
Lpl60:
    buffer_load_dword v7, v6, s[48:51], 0 offen sc1
    s_waitcnt vmcnt(0)
    v_cmp_gt_u32 vcc, 1, v7
    s_cbranch_vccz Lpx61
    s_sleep 1
    s_add_u32 m0, m0, 1
    s_cmp_lt_u32 m0, 400000
    s_cbranch_scc1 Lpl60
Lpx61:
    s_mov_b64 exec, -1
    s_branch Lzd5
Lalt2:
    s_lshl_b32 s15, s3, 13
    buffer_load_dwordx4 v[128:131], v2, s[20:23], s15 offen offset:0
    buffer_load_dwordx4 v[132:135], v2, s[20:23], s15 offen offset:1024
    buffer_load_dwordx4 v[136:139], v2, s[20:23], s15 offen offset:2048
    buffer_load_dwordx4 v[140:143], v2, s[20:23], s15 offen offset:3072
    s_add_u32 s15, s15, 4096
    buffer_load_dwordx4 v[176:179], v2, s[20:23], s15 offen offset:0
    buffer_load_dwordx4 v[180:183], v2, s[20:23], s15 offen offset:1024
    buffer_load_dwordx4 v[184:187], v2, s[20:23], s15 offen offset:2048
    buffer_load_dwordx4 v[188:191], v2, s[20:23], s15 offen offset:3072
    s_mov_b32 s15, 32768
    buffer_load_dwordx4 v[152:155], v2, s[20:23], s15 offen offset:0
    buffer_load_dwordx4 v[156:159], v2, s[20:23], s15 offen offset:1024
    buffer_load_dwordx4 v[160:163], v2, s[20:23], s15 offen offset:2048
    buffer_load_dwordx4 v[164:167], v2, s[20:23], s15 offen offset:3072
    v_and_b32 v8, 15, v1
    v_lshrrev_b32 v9, 4, v1
    s_lshr_b32 s56, s3, 1
    s_lshl_b32 s56, s56, 10
    s_and_b32 s57, s3, 1
    s_lshl_b32 s57, s57, 3
    s_add_u32 s56, s56, s57
    s_add_u32 s56, s56, 131072
    v_add_u32 v10, s56, v2
    v_lshlrev_b32 v11, 5, v8
    v_lshl_add_u32 v11, v9, 3, v11
    s_lshl_b32 s56, s3, 11
    s_add_u32 s56, s56, 139264
    v_add_u32 v11, s56, v11
    v_lshlrev_b32 v12, 3, v1
    v_add_u32 v12, 139264, v12
    v_add_u32 v13, 131072, v2
    v_lshlrev_b32 v15, 5, v1
    s_lshl_b32 s58, s2, 13
    s_lshl_b32 s59, s3, 10
    s_add_u32 s58, s58, s59
    s_lshl_b32 s59, s3, 11
    v_lshlrev_b32 v6, 7, v0
    s_mov_b32 s56, 0x2190000
    s_mov_b32 m0, 0
Lfp62:
    buffer_load_dword v7, v6, s[24:27], s56 offen sc1
    s_waitcnt vmcnt(0)
    v_cmp_eq_u32 vcc, 0, v7
    s_cbranch_vccz Lfx63
    s_nop 0
    s_mov_b64 exec, vcc
    s_sleep 1
    s_add_u32 m0, m0, 1
    s_cmp_lt_u32 m0, 400000
    s_cbranch_scc1 Lfp62
Lfx63:
    s_mov_b64 exec, -1
    s_barrier
    s_lshl_b32 s56, s59, 1
    s_add_u32 s56, s56, 0x2010000
    v_lshlrev_b32 v15, 6, v1
    buffer_load_dwordx4 v[88:91], v15, s[24:27], s56 offen sc1
    buffer_load_dwordx4 v[92:95], v15, s[24:27], s56 offen offset:16 sc1
    s_mul_i32 s61, s2, 8448
    s_lshl_b32 s60, s3, 11
    s_add_u32 s61, s61, s60
    s_add_u32 s61, s61, 0x2400000
    s_lshr_b32 s60, s60, 1
    s_lshl_b32 s57, s2, 13
    s_add_u32 s60, s60, s57
    buffer_load_dwordx4 v[64:67], v2, s[24:27], s60 offen sc1
    s_add_u32 s60, s60, 4096
    s_cmp_eq_u32 s2, 0
    s_cselect_b32 s60, 0x4000000, s60
    buffer_load_dwordx4 v[68:71], v2, s[24:27], s60 offen sc1
    buffer_load_dwordx4 v[72:75], v2, s[24:27], s61 offen sc1
    buffer_load_dwordx4 v[76:79], v2, s[24:27], s61 offen offset:1024 sc1
    s_waitcnt vmcnt(0)
    s_branch Lp1d3
Lzc6:
    s_mov_b64 exec, 0x1
    s_mov_b32 m0, 0
Lpl64:
    buffer_load_dword v7, v6, s[48:51], 0 offen sc1
    s_waitcnt vmcnt(0)
    v_cmp_gt_u32 vcc, 1, v7
    s_cbranch_vccz Lpx65
    s_sleep 1
    s_add_u32 m0, m0, 1
    s_cmp_lt_u32 m0, 400000
    s_cbranch_scc1 Lpl64
Lpx65:
    s_mov_b64 exec, -1
    s_branch Lzd7
Lpt20:
    s_lshl_b32 s56, s2, 2
    s_add_u32 s56, s56, s3
    s_sub_u32 s56, s56, 896
    s_lshr_b32 s57, s56, 4
    s_lshl_b32 s57, s57, 5
    v_add_u32 v42, s57, v5
    v_cvt_f32_u32 v42, v42
    s_and_b32 s57, s56, 14
    s_lshl_b32 s57, s57, 4
    s_and_b32 s60, s56, 1
    s_add_u32 s57, s57, s60
    v_lshl_add_u32 v41, v4, 3, s57
    v_cmp_eq_u32 vcc, 0, v41
    v_cvt_f32_u32 v41, v41
    s_lshl_b32 s56, s56, 12
    s_add_u32 s56, s56, 0xf80000
    v_mul_f32 v43, 0x3b000000, v42
    v_mul_f32 v16, v43, v41
    v_fmamk_f32 v96, v43, 0x00000000, v16
    v_add_f32 v97, 0x3e800000, v96
    v_fmamk_f32 v98, v43, 0x40000000, v16
    v_add_f32 v99, 0x3e800000, v98
    v_fmamk_f32 v100, v43, 0x40800000, v16
    v_add_f32 v101, 0x3e800000, v100
    v_fmamk_f32 v102, v43, 0x40c00000, v16
    v_add_f32 v103, 0x3e800000, v102
    v_mov_b32 v17, 0x3e000000
    v_fma_f32 v18, v42, 0.5, v17
    v_cndmask_b32 v96, v96, v18, vcc
    v_cndmask_b32 v97, v97, v17, vcc
    v_cos_f32 v96, v96
    v_cos_f32 v97, v97
    v_cos_f32 v98, v98
    v_cos_f32 v99, v99
    v_cos_f32 v100, v100
    v_cos_f32 v101, v101
    v_cos_f32 v102, v102
    v_cos_f32 v103, v103
    v_mul_f32 v96, 0x3d800000, v96
    v_mul_f32 v97, 0x3d800000, v97
    v_mul_f32 v98, 0x3d800000, v98
    v_mul_f32 v99, 0x3d800000, v99
    v_mul_f32 v100, 0x3d800000, v100
    v_mul_f32 v101, 0x3d800000, v101
    v_mul_f32 v102, 0x3d800000, v102
    v_mul_f32 v103, 0x3d800000, v103
    v_cvt_pk_bf16_f32 v104, v96, v97
    v_cvt_pk_bf16_f32 v105, v98, v99
    v_cvt_pk_bf16_f32 v106, v100, v101
    v_cvt_pk_bf16_f32 v107, v102, v103
    buffer_store_dwordx4 v[104:107], v3, s[24:27], s56 offen offset:0 sc1
    buffer_store_dwordx4 v[104:107], v3, s[24:27], s56 offen offset:2048 sc1
    v_fmamk_f32 v96, v43, 0x41800000, v16
    v_add_f32 v97, 0x3e800000, v96
    v_fmamk_f32 v98, v43, 0x41900000, v16
    v_add_f32 v99, 0x3e800000, v98
    v_fmamk_f32 v100, v43, 0x41a00000, v16
    v_add_f32 v101, 0x3e800000, v100
    v_fmamk_f32 v102, v43, 0x41b00000, v16
    v_add_f32 v103, 0x3e800000, v102
    v_cos_f32 v96, v96
    v_cos_f32 v97, v97
    v_cos_f32 v98, v98
    v_cos_f32 v99, v99
    v_cos_f32 v100, v100
    v_cos_f32 v101, v101
    v_cos_f32 v102, v102
    v_cos_f32 v103, v103
    v_mul_f32 v96, 0x3d800000, v96
    v_mul_f32 v97, 0x3d800000, v97
    v_mul_f32 v98, 0x3d800000, v98
    v_mul_f32 v99, 0x3d800000, v99
    v_mul_f32 v100, 0x3d800000, v100
    v_mul_f32 v101, 0x3d800000, v101
    v_mul_f32 v102, 0x3d800000, v102
    v_mul_f32 v103, 0x3d800000, v103
    v_cvt_pk_bf16_f32 v108, v96, v97
    v_cvt_pk_bf16_f32 v109, v98, v99
    v_cvt_pk_bf16_f32 v110, v100, v101
    v_cvt_pk_bf16_f32 v111, v102, v103
    buffer_store_dwordx4 v[108:111], v3, s[24:27], s56 offen offset:512 sc1
    buffer_store_dwordx4 v[108:111], v3, s[24:27], s56 offen offset:2560 sc1
    s_branch Lsk19
Lck26:
    s_mov_b64 exec, 0x1
    s_mov_b32 m0, 0
Lpl66:
    buffer_load_dword v7, v14, s[24:27], s39 offen sc1
    s_waitcnt vmcnt(0)
    v_cmp_gt_u32 vcc, 14, v7
    s_cbranch_vccz Lpx67
    s_sleep 1
    s_add_u32 m0, m0, 1
    s_cmp_lt_u32 m0, 400000
    s_cbranch_scc1 Lpl66
Lpx67:
    s_mov_b64 exec, -1
    s_branch Lcb27
Lck28:
    s_mov_b64 exec, 0x1
    s_mov_b32 m0, 0
Lpl68:
    buffer_load_dword v7, v14, s[24:27], s42 offen sc1
    s_waitcnt vmcnt(0)
    v_cmp_gt_u32 vcc, 14, v7
    s_cbranch_vccz Lpx69
    s_sleep 1
    s_add_u32 m0, m0, 1
    s_cmp_lt_u32 m0, 400000
    s_cbranch_scc1 Lpl68
Lpx69:
    s_mov_b64 exec, -1
    s_branch Lcb29
Lalt24:
    s_waitcnt vmcnt(0)
    s_barrier
    s_mov_b32 s56, 0x213f000
    s_cmp_lg_u32 s3, 0
    s_cselect_b32 s57, 0x4000000, s56
    s_mov_b64 exec, 1
    buffer_atomic_add v15, v14, s[24:27], s57 offen sc1
    s_mov_b64 exec, -1
    s_mov_b64 exec, 0x1
    s_mov_b32 m0, 0
Lpl70:
    buffer_load_dword v7, v14, s[24:27], s56 offen sc1
    s_waitcnt vmcnt(0)
    v_cmp_gt_u32 vcc, 32, v7
    s_cbranch_vccz Lpx71
    s_sleep 16
    s_add_u32 m0, m0, 1
    s_cmp_lt_u32 m0, 400000
    s_cbranch_scc1 Lpl70
Lpx71:
    s_mov_b64 exec, -1
    s_lshl_b32 s62, s52, 2
    s_add_u32 s62, s62, s3
    s_lshl_b32 s62, s62, 16
    s_add_u32 s62, s62, 0xc00000
    s_add_u32 s47, s62, 49152
    buffer_load_dwordx4 a[192:195], v2, s[24:27], s47 offen offset:0 sc1
    buffer_load_dwordx4 a[196:199], v2, s[24:27], s47 offen offset:1024 sc1
    buffer_load_dwordx4 a[200:203], v2, s[24:27], s47 offen offset:2048 sc1
    buffer_load_dwordx4 a[204:207], v2, s[24:27], s47 offen offset:3072 sc1
    s_add_u32 s47, s62, 53248
    buffer_load_dwordx4 a[208:211], v2, s[24:27], s47 offen offset:0 sc1
    buffer_load_dwordx4 a[212:215], v2, s[24:27], s47 offen offset:1024 sc1
    buffer_load_dwordx4 a[216:219], v2, s[24:27], s47 offen offset:2048 sc1
    buffer_load_dwordx4 a[220:223], v2, s[24:27], s47 offen offset:3072 sc1
    s_add_u32 s47, s62, 57344
    buffer_load_dwordx4 a[224:227], v2, s[24:27], s47 offen offset:0 sc1
    buffer_load_dwordx4 a[228:231], v2, s[24:27], s47 offen offset:1024 sc1
    buffer_load_dwordx4 a[232:235], v2, s[24:27], s47 offen offset:2048 sc1
    buffer_load_dwordx4 a[236:239], v2, s[24:27], s47 offen offset:3072 sc1
    s_add_u32 s47, s62, 61440
    buffer_load_dwordx4 a[240:243], v2, s[24:27], s47 offen offset:0 sc1
    buffer_load_dwordx4 a[244:247], v2, s[24:27], s47 offen offset:1024 sc1
    buffer_load_dwordx4 a[248:251], v2, s[24:27], s47 offen offset:2048 sc1
    buffer_load_dwordx4 a[252:255], v2, s[24:27], s47 offen offset:3072 sc1
    s_lshl_b32 s56, s3, 14
    s_add_u32 m0, s56, 0
    s_add_u32 s47, s62, 32768
    buffer_load_dwordx4 v2, s[24:27], s47 offen sc1 lds
    s_add_u32 m0, s56, 1024
    s_add_u32 s47, s62, 33792
    buffer_load_dwordx4 v2, s[24:27], s47 offen sc1 lds
    s_add_u32 m0, s56, 2048
    s_add_u32 s47, s62, 34816
    buffer_load_dwordx4 v2, s[24:27], s47 offen sc1 lds
    s_add_u32 m0, s56, 3072
    s_add_u32 s47, s62, 35840
    buffer_load_dwordx4 v2, s[24:27], s47 offen sc1 lds
    s_add_u32 m0, s56, 4096
    s_add_u32 s47, s62, 36864
    buffer_load_dwordx4 v2, s[24:27], s47 offen sc1 lds
    s_add_u32 m0, s56, 5120
    s_add_u32 s47, s62, 37888
    buffer_load_dwordx4 v2, s[24:27], s47 offen sc1 lds
    s_add_u32 m0, s56, 6144
    s_add_u32 s47, s62, 38912
    buffer_load_dwordx4 v2, s[24:27], s47 offen sc1 lds
    s_add_u32 m0, s56, 7168
    s_add_u32 s47, s62, 39936
    buffer_load_dwordx4 v2, s[24:27], s47 offen sc1 lds
    s_add_u32 m0, s56, 8192
    s_add_u32 s47, s62, 40960
    buffer_load_dwordx4 v2, s[24:27], s47 offen sc1 lds
    s_add_u32 m0, s56, 9216
    s_add_u32 s47, s62, 41984
    buffer_load_dwordx4 v2, s[24:27], s47 offen sc1 lds
    s_add_u32 m0, s56, 10240
    s_add_u32 s47, s62, 43008
    buffer_load_dwordx4 v2, s[24:27], s47 offen sc1 lds
    s_add_u32 m0, s56, 11264
    s_add_u32 s47, s62, 44032
    buffer_load_dwordx4 v2, s[24:27], s47 offen sc1 lds
    s_add_u32 m0, s56, 12288
    s_add_u32 s47, s62, 45056
    buffer_load_dwordx4 v2, s[24:27], s47 offen sc1 lds
    s_add_u32 m0, s56, 13312
    s_add_u32 s47, s62, 46080
    buffer_load_dwordx4 v2, s[24:27], s47 offen sc1 lds
    s_add_u32 m0, s56, 14336
    s_add_u32 s47, s62, 47104
    buffer_load_dwordx4 v2, s[24:27], s47 offen sc1 lds
    s_add_u32 m0, s56, 15360
    s_add_u32 s47, s62, 48128
    buffer_load_dwordx4 v2, s[24:27], s47 offen sc1 lds
    s_mov_b64 exec, 0x1
    s_mov_b32 m0, 0
Lpl72:
    buffer_load_dword v7, v14, s[24:27], s39 offen sc1
    s_waitcnt vmcnt(0)
    v_cmp_gt_u32 vcc, 14, v7
    s_cbranch_vccz Lpx73
    s_sleep 16
    s_add_u32 m0, m0, 1
    s_cmp_lt_u32 m0, 400000
    s_cbranch_scc1 Lpl72
Lpx73:
    s_mov_b64 exec, -1
    s_add_u32 s63, s64, 0
    buffer_load_dwordx4 v[96:99], v2, s[24:27], s63 offen offset:0 sc1
    buffer_load_dwordx4 v[100:103], v2, s[24:27], s63 offen offset:1024 sc1
    buffer_load_dwordx4 v[104:107], v2, s[24:27], s63 offen offset:2048 sc1
    buffer_load_dwordx4 v[108:111], v2, s[24:27], s63 offen offset:3072 sc1
    s_add_u32 s63, s64, 4096
    buffer_load_dwordx4 v[112:115], v2, s[24:27], s63 offen offset:0 sc1
    buffer_load_dwordx4 v[116:119], v2, s[24:27], s63 offen offset:1024 sc1
    buffer_load_dwordx4 v[120:123], v2, s[24:27], s63 offen offset:2048 sc1
    buffer_load_dwordx4 v[124:127], v2, s[24:27], s63 offen offset:3072 sc1
    s_add_u32 s63, s64, 8192
    buffer_load_dwordx4 a[0:3], v2, s[24:27], s63 offen offset:0 sc1
    buffer_load_dwordx4 a[4:7], v2, s[24:27], s63 offen offset:1024 sc1
    buffer_load_dwordx4 a[8:11], v2, s[24:27], s63 offen offset:2048 sc1
    buffer_load_dwordx4 a[12:15], v2, s[24:27], s63 offen offset:3072 sc1
    s_add_u32 s63, s64, 12288
    buffer_load_dwordx4 a[16:19], v2, s[24:27], s63 offen offset:0 sc1
    buffer_load_dwordx4 a[20:23], v2, s[24:27], s63 offen offset:1024 sc1
    buffer_load_dwordx4 a[24:27], v2, s[24:27], s63 offen offset:2048 sc1
    buffer_load_dwordx4 a[28:31], v2, s[24:27], s63 offen offset:3072 sc1
    s_add_u32 s63, s64, 16384
    buffer_load_dwordx4 v[128:131], v2, s[24:27], s63 offen offset:0 sc1
    buffer_load_dwordx4 v[132:135], v2, s[24:27], s63 offen offset:1024 sc1
    buffer_load_dwordx4 v[136:139], v2, s[24:27], s63 offen offset:2048 sc1
    buffer_load_dwordx4 v[140:143], v2, s[24:27], s63 offen offset:3072 sc1
    s_add_u32 s63, s64, 20480
    buffer_load_dwordx4 v[144:147], v2, s[24:27], s63 offen offset:0 sc1
    buffer_load_dwordx4 v[148:151], v2, s[24:27], s63 offen offset:1024 sc1
    buffer_load_dwordx4 v[152:155], v2, s[24:27], s63 offen offset:2048 sc1
    buffer_load_dwordx4 v[156:159], v2, s[24:27], s63 offen offset:3072 sc1
    s_add_u32 s63, s64, 24576
    buffer_load_dwordx4 v[160:163], v2, s[24:27], s63 offen offset:0 sc1
    buffer_load_dwordx4 v[164:167], v2, s[24:27], s63 offen offset:1024 sc1
    buffer_load_dwordx4 v[168:171], v2, s[24:27], s63 offen offset:2048 sc1
    buffer_load_dwordx4 v[172:175], v2, s[24:27], s63 offen offset:3072 sc1
    s_add_u32 s63, s64, 28672
    buffer_load_dwordx4 v[176:179], v2, s[24:27], s63 offen offset:0 sc1
    buffer_load_dwordx4 v[180:183], v2, s[24:27], s63 offen offset:1024 sc1
    buffer_load_dwordx4 v[184:187], v2, s[24:27], s63 offen offset:2048 sc1
    buffer_load_dwordx4 v[188:191], v2, s[24:27], s63 offen offset:3072 sc1
    s_add_u32 s63, s64, 32768
    buffer_load_dwordx4 a[32:35], v2, s[24:27], s63 offen offset:0 sc1
    buffer_load_dwordx4 a[36:39], v2, s[24:27], s63 offen offset:1024 sc1
    buffer_load_dwordx4 a[40:43], v2, s[24:27], s63 offen offset:2048 sc1
    buffer_load_dwordx4 a[44:47], v2, s[24:27], s63 offen offset:3072 sc1
    s_add_u32 s63, s64, 36864
    buffer_load_dwordx4 a[48:51], v2, s[24:27], s63 offen offset:0 sc1
    buffer_load_dwordx4 a[52:55], v2, s[24:27], s63 offen offset:1024 sc1
    buffer_load_dwordx4 a[56:59], v2, s[24:27], s63 offen offset:2048 sc1
    buffer_load_dwordx4 a[60:63], v2, s[24:27], s63 offen offset:3072 sc1
    s_add_u32 s63, s64, 40960
    buffer_load_dwordx4 a[64:67], v2, s[24:27], s63 offen offset:0 sc1
    buffer_load_dwordx4 a[68:71], v2, s[24:27], s63 offen offset:1024 sc1
    buffer_load_dwordx4 a[72:75], v2, s[24:27], s63 offen offset:2048 sc1
    buffer_load_dwordx4 a[76:79], v2, s[24:27], s63 offen offset:3072 sc1
    s_add_u32 s63, s64, 45056
    buffer_load_dwordx4 a[80:83], v2, s[24:27], s63 offen offset:0 sc1
    buffer_load_dwordx4 a[84:87], v2, s[24:27], s63 offen offset:1024 sc1
    buffer_load_dwordx4 a[88:91], v2, s[24:27], s63 offen offset:2048 sc1
    buffer_load_dwordx4 a[92:95], v2, s[24:27], s63 offen offset:3072 sc1
    s_add_u32 s63, s64, 49152
    buffer_load_dwordx4 a[104:107], v2, s[24:27], s63 offen offset:0 sc1
    buffer_load_dwordx4 a[108:111], v2, s[24:27], s63 offen offset:1024 sc1
    s_add_u32 s63, s64, 49152
    buffer_load_dwordx4 a[120:123], v2, s[24:27], s63 offen offset:2048 sc1
    buffer_load_dwordx4 a[124:127], v2, s[24:27], s63 offen offset:3072 sc1
    s_add_u32 s63, s64, 53248
    buffer_load_dwordx4 a[136:139], v2, s[24:27], s63 offen offset:0 sc1
    buffer_load_dwordx4 a[140:143], v2, s[24:27], s63 offen offset:1024 sc1
    s_add_u32 s63, s64, 53248
    buffer_load_dwordx4 a[152:155], v2, s[24:27], s63 offen offset:2048 sc1
    buffer_load_dwordx4 a[156:159], v2, s[24:27], s63 offen offset:3072 sc1
    s_mov_b64 exec, 0x1
    s_mov_b32 m0, 0
Lpl74:
    buffer_load_dword v7, v14, s[24:27], s42 offen sc1
    s_waitcnt vmcnt(0)
    v_cmp_gt_u32 vcc, 14, v7
    s_cbranch_vccz Lpx75
    s_sleep 16
    s_add_u32 m0, m0, 1
    s_cmp_lt_u32 m0, 400000
    s_cbranch_scc1 Lpl74
Lpx75:
    s_mov_b64 exec, -1
    s_add_u32 s47, s65, 0
    buffer_load_dwordx4 a[96:99], v2, s[24:27], s47 offen offset:0 sc1
    buffer_load_dwordx4 a[100:103], v2, s[24:27], s47 offen offset:1024 sc1
    buffer_load_dwordx4 a[112:115], v2, s[24:27], s47 offen offset:2048 sc1
    buffer_load_dwordx4 a[116:119], v2, s[24:27], s47 offen offset:3072 sc1
    s_add_u32 s47, s65, 4096
    buffer_load_dwordx4 a[128:131], v2, s[24:27], s47 offen offset:0 sc1
    buffer_load_dwordx4 a[132:135], v2, s[24:27], s47 offen offset:1024 sc1
    buffer_load_dwordx4 a[144:147], v2, s[24:27], s47 offen offset:2048 sc1
    buffer_load_dwordx4 a[148:151], v2, s[24:27], s47 offen offset:3072 sc1
    s_add_u32 s47, s65, 8192
    buffer_load_dwordx4 a[160:163], v2, s[24:27], s47 offen offset:0 sc1
    buffer_load_dwordx4 a[164:167], v2, s[24:27], s47 offen offset:1024 sc1
    buffer_load_dwordx4 a[168:171], v2, s[24:27], s47 offen offset:2048 sc1
    buffer_load_dwordx4 a[172:175], v2, s[24:27], s47 offen offset:3072 sc1
    s_add_u32 s47, s65, 12288
    buffer_load_dwordx4 a[176:179], v2, s[24:27], s47 offen offset:0 sc1
    buffer_load_dwordx4 a[180:183], v2, s[24:27], s47 offen offset:1024 sc1
    s_waitcnt vmcnt(0)
    s_branch Lg1j25
Lsr40:
    s_mov_b32 m0, 0
Lsp42:
    s_sleep 2
    s_add_u32 s60, s58, 0
    buffer_load_dwordx4 v[224:227], v13, s[24:27], s60 offen sc1
    s_add_u32 s60, s58, 32768
    buffer_load_dwordx4 v[228:231], v51, s[24:27], s60 offen sc1
    s_add_u32 s60, s58, 262144
    buffer_load_dwordx4 v[232:235], v13, s[24:27], s60 offen sc1
    s_add_u32 s60, s58, 294912
    buffer_load_dwordx4 v[236:239], v51, s[24:27], s60 offen sc1
    s_add_u32 s60, s58, 524288
    buffer_load_dwordx4 v[240:243], v13, s[24:27], s60 offen sc1
    s_add_u32 s60, s58, 557056
    buffer_load_dwordx4 v[244:247], v51, s[24:27], s60 offen sc1
    s_add_u32 s60, s58, 786432
    buffer_load_dwordx4 v[248:251], v13, s[24:27], s60 offen sc1
    s_add_u32 s60, s58, 819200
    buffer_load_dwordx4 v[252:255], v51, s[24:27], s60 offen sc1
    s_waitcnt vmcnt(0)
    v_max3_u32 v58, v224, v225, v226
    v_max3_u32 v58, v58, v227, v228
    v_max3_u32 v58, v58, v229, v230
    v_max_u32 v58, v58, v231
    v_cmp_eq_u32 vcc, -1, v58
    s_cbranch_vccz Lsx43
    s_add_u32 m0, m0, 1
    s_cmp_lt_u32 m0, 200
    s_cbranch_scc1 Lsp42
    s_mov_b64 exec, -1
    s_mov_b64 exec, 0xffff
    s_mov_b32 m0, 0
Lpl76:
    buffer_load_dword v7, v59, s[24:27], s15 offen sc1
    s_waitcnt vmcnt(0)
    v_cmp_gt_u32 vcc, 16, v7
    s_cbranch_vccz Lpx77
    s_sleep 4
    s_add_u32 m0, m0, 1
    s_cmp_lt_u32 m0, 400000
    s_cbranch_scc1 Lpl76
Lpx77:
    s_mov_b64 exec, -1
    s_add_u32 s60, s58, 0
    buffer_load_dwordx4 v[224:227], v13, s[24:27], s60 offen sc1
    s_add_u32 s60, s58, 32768
    buffer_load_dwordx4 v[228:231], v51, s[24:27], s60 offen sc1
    s_waitcnt vmcnt(0)
Lsx43:
    s_mov_b64 exec, -1
    s_branch Lsb41
Lsr44:
    s_mov_b32 m0, 0
Lsp46:
    s_mov_b64 exec, vcc
    s_sleep 2
    s_add_u32 s60, s58, 262144
    buffer_load_dwordx4 v[232:235], v13, s[24:27], s60 offen sc1
    s_add_u32 s60, s58, 294912
    buffer_load_dwordx4 v[236:239], v51, s[24:27], s60 offen sc1
    s_waitcnt vmcnt(0)
    v_max3_u32 v58, v232, v233, v234
    v_max3_u32 v58, v58, v235, v236
    v_max3_u32 v58, v58, v237, v238
    v_max_u32 v58, v58, v239
    v_cmp_eq_u32 vcc, -1, v58
    s_cbranch_vccz Lsx47
    s_add_u32 m0, m0, 1
    s_cmp_lt_u32 m0, 200
    s_cbranch_scc1 Lsp46
    s_mov_b64 exec, -1
    s_mov_b64 exec, 0xffff
    s_mov_b32 m0, 0
Lpl78:
    buffer_load_dword v7, v59, s[24:27], s15 offen sc1
    s_waitcnt vmcnt(0)
    v_cmp_gt_u32 vcc, 16, v7
    s_cbranch_vccz Lpx79
    s_sleep 4
    s_add_u32 m0, m0, 1
    s_cmp_lt_u32 m0, 400000
    s_cbranch_scc1 Lpl78
Lpx79:
    s_mov_b64 exec, -1
    s_add_u32 s60, s58, 262144
    buffer_load_dwordx4 v[232:235], v13, s[24:27], s60 offen sc1
    s_add_u32 s60, s58, 294912
    buffer_load_dwordx4 v[236:239], v51, s[24:27], s60 offen sc1
    s_waitcnt vmcnt(0)
Lsx47:
    s_mov_b64 exec, -1
    s_branch Lsb45
Lsr48:
    s_mov_b32 m0, 0
Lsp50:
    s_mov_b64 exec, vcc
    s_sleep 2
    s_add_u32 s60, s58, 524288
    buffer_load_dwordx4 v[240:243], v13, s[24:27], s60 offen sc1
    s_add_u32 s60, s58, 557056
    buffer_load_dwordx4 v[244:247], v51, s[24:27], s60 offen sc1
    s_add_u32 s60, s58, 786432
    buffer_load_dwordx4 v[248:251], v13, s[24:27], s60 offen sc1
    s_add_u32 s60, s58, 819200
    buffer_load_dwordx4 v[252:255], v51, s[24:27], s60 offen sc1
    s_waitcnt vmcnt(0)
    v_max3_u32 v58, v240, v241, v242
    v_max3_u32 v58, v58, v243, v244
    v_max3_u32 v58, v58, v245, v246
    v_max3_u32 v58, v58, v247, v248
    v_max3_u32 v58, v58, v249, v250
    v_max3_u32 v58, v58, v251, v252
    v_max3_u32 v58, v58, v253, v254
    v_max_u32 v58, v58, v255
    v_cmp_eq_u32 vcc, -1, v58
    s_cbranch_vccz Lsx51
    s_add_u32 m0, m0, 1
    s_cmp_lt_u32 m0, 200
    s_cbranch_scc1 Lsp50
    s_mov_b64 exec, -1
    s_mov_b64 exec, 0xffff
    s_mov_b32 m0, 0
Lpl80:
    buffer_load_dword v7, v59, s[24:27], s15 offen sc1
    s_waitcnt vmcnt(0)
    v_cmp_gt_u32 vcc, 16, v7
    s_cbranch_vccz Lpx81
    s_sleep 4
    s_add_u32 m0, m0, 1
    s_cmp_lt_u32 m0, 400000
    s_cbranch_scc1 Lpl80
Lpx81:
    s_mov_b64 exec, -1
    s_add_u32 s60, s58, 524288
    buffer_load_dwordx4 v[240:243], v13, s[24:27], s60 offen sc1
    s_add_u32 s60, s58, 557056
    buffer_load_dwordx4 v[244:247], v51, s[24:27], s60 offen sc1
    s_add_u32 s60, s58, 786432
    buffer_load_dwordx4 v[248:251], v13, s[24:27], s60 offen sc1
    s_add_u32 s60, s58, 819200
    buffer_load_dwordx4 v[252:255], v51, s[24:27], s60 offen sc1
    s_waitcnt vmcnt(0)
Lsx51:
    s_mov_b64 exec, -1
    s_branch Lsb49
Lgk52:
    s_mov_b64 exec, 0xffff
    s_mov_b32 m0, 0
Lpl82:
    buffer_load_dword v7, v59, s[24:27], s15 offen sc1
    s_waitcnt vmcnt(0)
    v_cmp_gt_u32 vcc, 16, v7
    s_cbranch_vccz Lpx83
    s_sleep 4
    s_add_u32 m0, m0, 1
    s_cmp_lt_u32 m0, 400000
    s_cbranch_scc1 Lpl82
Lpx83:
    s_mov_b64 exec, -1
    s_branch Lgb53
Lck54:
    s_mov_b64 exec, 0x1
    s_mov_b32 m0, 0
Lpl84:
    buffer_load_dword v7, v14, s[24:27], s42 offen sc1
    s_waitcnt vmcnt(0)
    v_cmp_gt_u32 vcc, 14, v7
    s_cbranch_vccz Lpx85
    s_sleep 1
    s_add_u32 m0, m0, 1
    s_cmp_lt_u32 m0, 400000
    s_cbranch_scc1 Lpl84
Lpx85:
    s_mov_b64 exec, -1
    s_branch Lcb55
Lalt38:
    v_lshrrev_b32 v40, 3, v1
    v_and_b32 v41, 7, v1
    v_lshlrev_b32 v42, 2, v4
    v_xor_b32 v41, v41, v42
    s_lshl_b32 s56, s67, 1
    v_xor_b32 v41, s56, v41
    v_lshlrev_b32 v41, 4, v41
    v_lshl_add_u32 v13, v40, 12, v41
    v_mov_b32 v51, v13
    v_and_b32 v8, 0xf8, v8
    v_and_b32 v42, 8, v1
    v_lshl_or_b32 v8, v42, 6, v8
    v_and_b32 v42, 48, v1
    v_lshl_or_b32 v8, v42, 7, v8
    v_xor_b32 v9, 32, v8
    v_xor_b32 v10, 64, v8
    v_xor_b32 v11, 96, v8
    v_add_u32 v52, 16384, v50
    v_add_u32 v49, s59, v2
    v_and_b32 v59, 15, v1
    v_lshlrev_b32 v59, 8, v59
    s_add_u32 s60, s58, 0
    buffer_load_dwordx4 v[224:227], v13, s[24:27], s60 offen sc1
    s_add_u32 s60, s58, 32768
    buffer_load_dwordx4 v[228:231], v51, s[24:27], s60 offen sc1
    s_add_u32 s60, s58, 262144
    buffer_load_dwordx4 v[232:235], v13, s[24:27], s60 offen sc1
    s_add_u32 s60, s58, 294912
    buffer_load_dwordx4 v[236:239], v51, s[24:27], s60 offen sc1
    s_add_u32 s60, s58, 524288
    buffer_load_dwordx4 v[240:243], v13, s[24:27], s60 offen sc1
    s_add_u32 s60, s58, 557056
    buffer_load_dwordx4 v[244:247], v51, s[24:27], s60 offen sc1
    s_add_u32 s60, s58, 786432
    buffer_load_dwordx4 v[248:251], v13, s[24:27], s60 offen sc1
    s_add_u32 s60, s58, 819200
    buffer_load_dwordx4 v[252:255], v51, s[24:27], s60 offen sc1
    s_waitcnt vmcnt(6)
    v_max3_u32 v58, v224, v225, v226
    v_max3_u32 v58, v58, v227, v228
    v_max3_u32 v58, v58, v229, v230
    v_max_u32 v58, v58, v231
    v_cmp_eq_u32 vcc, -1, v58
    s_cbranch_vccnz Lsr86
Lsb87:
    ds_write_b128 v49, v[224:227] offset:0
    ds_write_b128 v49, v[228:231] offset:1024
    s_waitcnt lgkmcnt(0)
    s_barrier
    ds_read_b64_tr_b16 v[64:65], v8 offset:0
    ds_read_b64_tr_b16 v[66:67], v8 offset:1024
    ds_read_b64_tr_b16 v[68:69], v9 offset:0
    ds_read_b64_tr_b16 v[70:71], v9 offset:1024
    ds_read_b64_tr_b16 v[72:73], v10 offset:0
    ds_read_b64_tr_b16 v[74:75], v10 offset:1024
    ds_read_b64_tr_b16 v[76:77], v11 offset:0
    ds_read_b64_tr_b16 v[78:79], v11 offset:1024
    s_waitcnt vmcnt(4)
    v_max3_u32 v58, v232, v233, v234
    v_max3_u32 v58, v58, v235, v236
    v_max3_u32 v58, v58, v237, v238
    v_max_u32 v58, v58, v239
    v_cmp_eq_u32 vcc, -1, v58
    s_cbranch_vccnz Lsr90
Lsb91:
    ds_write_b128 v49, v[232:235] offset:8192
    ds_write_b128 v49, v[236:239] offset:9216
    s_waitcnt lgkmcnt(8)
    v_mfma_f32_16x16x32_bf16 v[128:131], a[0:3], v[64:67], 0
    ds_read_b64_tr_b16 v[80:81], v8 offset:256
    ds_read_b64_tr_b16 v[82:83], v8 offset:1280
    v_mfma_f32_16x16x32_bf16 v[132:135], a[4:7], v[64:67], 0
    s_waitcnt lgkmcnt(8)
    v_mfma_f32_16x16x32_bf16 v[136:139], a[0:3], v[68:71], 0
    ds_read_b64_tr_b16 v[84:85], v9 offset:256
    ds_read_b64_tr_b16 v[86:87], v9 offset:1280
    v_mfma_f32_16x16x32_bf16 v[140:143], a[4:7], v[68:71], 0
    s_waitcnt lgkmcnt(8)
    v_mfma_f32_16x16x32_bf16 v[144:147], a[0:3], v[72:75], 0
    ds_read_b64_tr_b16 v[88:89], v10 offset:256
    ds_read_b64_tr_b16 v[90:91], v10 offset:1280
    v_mfma_f32_16x16x32_bf16 v[148:151], a[4:7], v[72:75], 0
    s_waitcnt lgkmcnt(8)
    v_mfma_f32_16x16x32_bf16 v[152:155], a[0:3], v[76:79], 0
    ds_read_b64_tr_b16 v[92:93], v11 offset:256
    ds_read_b64_tr_b16 v[94:95], v11 offset:1280
    v_mfma_f32_16x16x32_bf16 v[156:159], a[4:7], v[76:79], 0
    s_waitcnt lgkmcnt(8)
    s_barrier
    s_waitcnt lgkmcnt(6)
    v_mfma_f32_16x16x32_bf16 v[160:163], a[16:19], v[80:83], 0
    ds_read_b64_tr_b16 v[64:65], v8 offset:8192
    ds_read_b64_tr_b16 v[66:67], v8 offset:9216
    v_mfma_f32_16x16x32_bf16 v[164:167], a[20:23], v[80:83], 0
    s_waitcnt lgkmcnt(6)
    v_mfma_f32_16x16x32_bf16 v[168:171], a[16:19], v[84:87], 0
    ds_read_b64_tr_b16 v[68:69], v9 offset:8192
    ds_read_b64_tr_b16 v[70:71], v9 offset:9216
    v_mfma_f32_16x16x32_bf16 v[172:175], a[20:23], v[84:87], 0
    buffer_load_dword v57, v59, s[24:27], s15 offen sc1
    s_waitcnt lgkmcnt(6)
    v_mfma_f32_16x16x32_bf16 v[176:179], a[16:19], v[88:91], 0
    ds_read_b64_tr_b16 v[72:73], v10 offset:8192
    ds_read_b64_tr_b16 v[74:75], v10 offset:9216
    v_mfma_f32_16x16x32_bf16 v[180:183], a[20:23], v[88:91], 0
    s_waitcnt lgkmcnt(6)
    v_mfma_f32_16x16x32_bf16 v[184:187], a[16:19], v[92:95], 0
    ds_read_b64_tr_b16 v[76:77], v11 offset:8192
    ds_read_b64_tr_b16 v[78:79], v11 offset:9216
    v_mfma_f32_16x16x32_bf16 v[188:191], a[20:23], v[92:95], 0
    s_waitcnt vmcnt(1)
    v_max3_u32 v58, v240, v241, v242
    v_max3_u32 v58, v58, v243, v244
    v_max3_u32 v58, v58, v245, v246
    v_max3_u32 v58, v58, v247, v248
    v_max3_u32 v58, v58, v249, v250
    v_max3_u32 v58, v58, v251, v252
    v_max3_u32 v58, v58, v253, v254
    v_max_u32 v58, v58, v255
    v_cmp_eq_u32 vcc, -1, v58
    s_cbranch_vccnz Lsr94
Lsb95:
    ds_write_b128 v49, v[240:243] offset:16384
    ds_write_b128 v49, v[244:247] offset:17408
    ds_write_b128 v49, v[248:251] offset:24576
    ds_write_b128 v49, v[252:255] offset:25600
    s_waitcnt lgkmcnt(10)
    v_mfma_f32_16x16x32_bf16 v[128:131], a[32:35], v[64:67], v[128:131]
    ds_read_b64_tr_b16 v[80:81], v8 offset:8448
    ds_read_b64_tr_b16 v[82:83], v8 offset:9472
    v_mfma_f32_16x16x32_bf16 v[132:135], a[36:39], v[64:67], v[132:135]
    s_waitcnt lgkmcnt(10)
    v_mfma_f32_16x16x32_bf16 v[136:139], a[32:35], v[68:71], v[136:139]
    ds_read_b64_tr_b16 v[84:85], v9 offset:8448
    ds_read_b64_tr_b16 v[86:87], v9 offset:9472
    v_mfma_f32_16x16x32_bf16 v[140:143], a[36:39], v[68:71], v[140:143]
    s_waitcnt lgkmcnt(10)
    v_mfma_f32_16x16x32_bf16 v[144:147], a[32:35], v[72:75], v[144:147]
    ds_read_b64_tr_b16 v[88:89], v10 offset:8448
    ds_read_b64_tr_b16 v[90:91], v10 offset:9472
    v_mfma_f32_16x16x32_bf16 v[148:151], a[36:39], v[72:75], v[148:151]
    s_waitcnt lgkmcnt(10)
    v_mfma_f32_16x16x32_bf16 v[152:155], a[32:35], v[76:79], v[152:155]
    ds_read_b64_tr_b16 v[92:93], v11 offset:8448
    ds_read_b64_tr_b16 v[94:95], v11 offset:9472
    v_mfma_f32_16x16x32_bf16 v[156:159], a[36:39], v[76:79], v[156:159]
    s_waitcnt lgkmcnt(8)
    s_barrier
    s_waitcnt lgkmcnt(6)
    v_mfma_f32_16x16x32_bf16 v[160:163], a[48:51], v[80:83], v[160:163]
    ds_read_b64_tr_b16 v[64:65], v8 offset:16384
    ds_read_b64_tr_b16 v[66:67], v8 offset:17408
    v_mfma_f32_16x16x32_bf16 v[164:167], a[52:55], v[80:83], v[164:167]
    s_waitcnt lgkmcnt(6)
    v_mfma_f32_16x16x32_bf16 v[168:171], a[48:51], v[84:87], v[168:171]
    ds_read_b64_tr_b16 v[68:69], v9 offset:16384
    ds_read_b64_tr_b16 v[70:71], v9 offset:17408
    v_mfma_f32_16x16x32_bf16 v[172:175], a[52:55], v[84:87], v[172:175]
    s_waitcnt lgkmcnt(6)
    v_mfma_f32_16x16x32_bf16 v[176:179], a[48:51], v[88:91], v[176:179]
    ds_read_b64_tr_b16 v[72:73], v10 offset:16384
    ds_read_b64_tr_b16 v[74:75], v10 offset:17408
    v_mfma_f32_16x16x32_bf16 v[180:183], a[52:55], v[88:91], v[180:183]
    s_waitcnt lgkmcnt(6)
    v_mfma_f32_16x16x32_bf16 v[184:187], a[48:51], v[92:95], v[184:187]
    ds_read_b64_tr_b16 v[76:77], v11 offset:16384
    ds_read_b64_tr_b16 v[78:79], v11 offset:17408
    v_mfma_f32_16x16x32_bf16 v[188:191], a[52:55], v[92:95], v[188:191]
    s_waitcnt vmcnt(0)
    v_cmp_gt_u32 vcc, 16, v57
    s_cbranch_vccnz Lgk98
Lgb99:
    s_waitcnt lgkmcnt(6)
    v_mfma_f32_16x16x32_bf16 v[128:131], a[64:67], v[64:67], v[128:131]
    ds_read_b64_tr_b16 v[80:81], v8 offset:16640
    s_add_u32 m0, s59, 32768
    ds_read_b64_tr_b16 v[82:83], v8 offset:17664
    s_add_u32 s60, s58, 1048576
    v_mfma_f32_16x16x32_bf16 v[132:135], a[68:71], v[64:67], v[132:135]
    buffer_load_dwordx4 v13, s[24:27], s60 offen sc1 lds
    s_waitcnt lgkmcnt(6)
    v_mfma_f32_16x16x32_bf16 v[136:139], a[64:67], v[68:71], v[136:139]
    ds_read_b64_tr_b16 v[84:85], v9 offset:16640
    s_add_u32 m0, s59, 33792
    ds_read_b64_tr_b16 v[86:87], v9 offset:17664
    s_add_u32 s60, s58, 1081344
    v_mfma_f32_16x16x32_bf16 v[140:143], a[68:71], v[68:71], v[140:143]
    buffer_load_dwordx4 v51, s[24:27], s60 offen sc1 lds
    s_waitcnt lgkmcnt(6)
    v_mfma_f32_16x16x32_bf16 v[144:147], a[64:67], v[72:75], v[144:147]
    ds_read_b64_tr_b16 v[88:89], v10 offset:16640
    s_add_u32 m0, s59, 40960
    ds_read_b64_tr_b16 v[90:91], v10 offset:17664
    s_add_u32 s60, s58, 1310720
    v_mfma_f32_16x16x32_bf16 v[148:151], a[68:71], v[72:75], v[148:151]
    buffer_load_dwordx4 v13, s[24:27], s60 offen sc1 lds
    s_waitcnt lgkmcnt(6)
    v_mfma_f32_16x16x32_bf16 v[152:155], a[64:67], v[76:79], v[152:155]
    ds_read_b64_tr_b16 v[92:93], v11 offset:16640
    s_add_u32 m0, s59, 41984
    ds_read_b64_tr_b16 v[94:95], v11 offset:17664
    s_add_u32 s60, s58, 1343488
    v_mfma_f32_16x16x32_bf16 v[156:159], a[68:71], v[76:79], v[156:159]
    buffer_load_dwordx4 v51, s[24:27], s60 offen sc1 lds
    s_waitcnt lgkmcnt(6)
    v_mfma_f32_16x16x32_bf16 v[160:163], a[80:83], v[80:83], v[160:163]
    ds_read_b64_tr_b16 v[64:65], v8 offset:24576
    s_add_u32 m0, s59, 49152
    ds_read_b64_tr_b16 v[66:67], v8 offset:25600
    s_add_u32 s60, s58, 1572864
    v_mfma_f32_16x16x32_bf16 v[164:167], a[84:87], v[80:83], v[164:167]
    buffer_load_dwordx4 v13, s[24:27], s60 offen sc1 lds
    s_waitcnt lgkmcnt(6)
    v_mfma_f32_16x16x32_bf16 v[168:171], a[80:83], v[84:87], v[168:171]
    ds_read_b64_tr_b16 v[68:69], v9 offset:24576
    s_add_u32 m0, s59, 50176
    ds_read_b64_tr_b16 v[70:71], v9 offset:25600
    s_add_u32 s60, s58, 1605632
    v_mfma_f32_16x16x32_bf16 v[172:175], a[84:87], v[84:87], v[172:175]
    buffer_load_dwordx4 v51, s[24:27], s60 offen sc1 lds
    s_waitcnt lgkmcnt(6)
    v_mfma_f32_16x16x32_bf16 v[176:179], a[80:83], v[88:91], v[176:179]
    ds_read_b64_tr_b16 v[72:73], v10 offset:24576
    s_add_u32 m0, s59, 57344
    ds_read_b64_tr_b16 v[74:75], v10 offset:25600
    s_add_u32 s60, s58, 1835008
    v_mfma_f32_16x16x32_bf16 v[180:183], a[84:87], v[88:91], v[180:183]
    buffer_load_dwordx4 v13, s[24:27], s60 offen sc1 lds
    s_waitcnt lgkmcnt(6)
    v_mfma_f32_16x16x32_bf16 v[184:187], a[80:83], v[92:95], v[184:187]
    ds_read_b64_tr_b16 v[76:77], v11 offset:24576
    s_add_u32 m0, s59, 58368
    ds_read_b64_tr_b16 v[78:79], v11 offset:25600
    s_add_u32 s60, s58, 1867776
    v_mfma_f32_16x16x32_bf16 v[188:191], a[84:87], v[92:95], v[188:191]
    buffer_load_dwordx4 v51, s[24:27], s60 offen sc1 lds
    s_waitcnt lgkmcnt(6)
    v_mfma_f32_16x16x32_bf16 v[128:131], a[96:99], v[64:67], v[128:131]
    ds_read_b64_tr_b16 v[80:81], v8 offset:24832
    s_add_u32 m0, s59, 65536
    ds_read_b64_tr_b16 v[82:83], v8 offset:25856
    s_add_u32 s60, s58, 128
    v_mfma_f32_16x16x32_bf16 v[132:135], a[100:103], v[64:67], v[132:135]
    buffer_load_dwordx4 v13, s[24:27], s60 offen sc1 lds
    s_waitcnt lgkmcnt(6)
    v_mfma_f32_16x16x32_bf16 v[136:139], a[96:99], v[68:71], v[136:139]
    ds_read_b64_tr_b16 v[84:85], v9 offset:24832
    s_add_u32 m0, s59, 66560
    ds_read_b64_tr_b16 v[86:87], v9 offset:25856
    s_add_u32 s60, s58, 32896
    v_mfma_f32_16x16x32_bf16 v[140:143], a[100:103], v[68:71], v[140:143]
    buffer_load_dwordx4 v51, s[24:27], s60 offen sc1 lds
    s_waitcnt lgkmcnt(6)
    v_mfma_f32_16x16x32_bf16 v[144:147], a[96:99], v[72:75], v[144:147]
    ds_read_b64_tr_b16 v[88:89], v10 offset:24832
    s_add_u32 m0, s59, 73728
    ds_read_b64_tr_b16 v[90:91], v10 offset:25856
    s_add_u32 s60, s58, 262272
    v_mfma_f32_16x16x32_bf16 v[148:151], a[100:103], v[72:75], v[148:151]
    buffer_load_dwordx4 v13, s[24:27], s60 offen sc1 lds
    s_waitcnt lgkmcnt(6)
    v_mfma_f32_16x16x32_bf16 v[152:155], a[96:99], v[76:79], v[152:155]
    ds_read_b64_tr_b16 v[92:93], v11 offset:24832
    s_add_u32 m0, s59, 74752
    ds_read_b64_tr_b16 v[94:95], v11 offset:25856
    s_add_u32 s60, s58, 295040
    v_mfma_f32_16x16x32_bf16 v[156:159], a[100:103], v[76:79], v[156:159]
    buffer_load_dwordx4 v51, s[24:27], s60 offen sc1 lds
    s_waitcnt vmcnt(8)
    s_barrier
    s_waitcnt lgkmcnt(6)
    v_mfma_f32_16x16x32_bf16 v[160:163], a[112:115], v[80:83], v[160:163]
    ds_read_b64_tr_b16 v[64:65], v8 offset:32768
    s_add_u32 m0, s59, 81920
    ds_read_b64_tr_b16 v[66:67], v8 offset:33792
    s_add_u32 s60, s58, 524416
    v_mfma_f32_16x16x32_bf16 v[164:167], a[116:119], v[80:83], v[164:167]
    buffer_load_dwordx4 v13, s[24:27], s60 offen sc1 lds
    s_waitcnt lgkmcnt(6)
    v_mfma_f32_16x16x32_bf16 v[168:171], a[112:115], v[84:87], v[168:171]
    ds_read_b64_tr_b16 v[68:69], v8 offset:33024
    s_add_u32 m0, s59, 82944
    ds_read_b64_tr_b16 v[70:71], v8 offset:34048
    s_add_u32 s60, s58, 557184
    v_mfma_f32_16x16x32_bf16 v[172:175], a[116:119], v[84:87], v[172:175]
    buffer_load_dwordx4 v51, s[24:27], s60 offen sc1 lds
    s_waitcnt lgkmcnt(6)
    v_mfma_f32_16x16x32_bf16 v[176:179], a[112:115], v[88:91], v[176:179]
    ds_read_b64_tr_b16 v[72:73], v8 offset:40960
    s_add_u32 m0, s59, 90112
    ds_read_b64_tr_b16 v[74:75], v8 offset:41984
    s_add_u32 s60, s58, 786560
    v_mfma_f32_16x16x32_bf16 v[180:183], a[116:119], v[88:91], v[180:183]
    buffer_load_dwordx4 v13, s[24:27], s60 offen sc1 lds
    s_waitcnt lgkmcnt(6)
    v_mfma_f32_16x16x32_bf16 v[184:187], a[112:115], v[92:95], v[184:187]
    ds_read_b64_tr_b16 v[76:77], v8 offset:41216
    s_add_u32 m0, s59, 91136
    ds_read_b64_tr_b16 v[78:79], v8 offset:42240
    s_add_u32 s60, s58, 819328
    v_mfma_f32_16x16x32_bf16 v[188:191], a[116:119], v[92:95], v[188:191]
    buffer_load_dwordx4 v51, s[24:27], s60 offen sc1 lds
    s_waitcnt vmcnt(8)
    s_barrier
    s_waitcnt lgkmcnt(6)
    v_mfma_f32_16x16x32_bf16 v[128:131], a[128:131], v[64:67], v[128:131]
    ds_read_b64_tr_b16 v[80:81], v8 offset:49152
    s_add_u32 m0, s59, 98304
    ds_read_b64_tr_b16 v[82:83], v8 offset:50176
    s_add_u32 s60, s58, 1048704
    v_mfma_f32_16x16x32_bf16 v[132:135], a[132:135], v[64:67], v[132:135]
    buffer_load_dwordx4 v13, s[24:27], s60 offen sc1 lds
    s_waitcnt lgkmcnt(6)
    v_mfma_f32_16x16x32_bf16 v[160:163], a[144:147], v[68:71], v[160:163]
    ds_read_b64_tr_b16 v[84:85], v8 offset:49408
    s_add_u32 m0, s59, 99328
    ds_read_b64_tr_b16 v[86:87], v8 offset:50432
    s_add_u32 s60, s58, 1081472
    v_mfma_f32_16x16x32_bf16 v[164:167], a[148:151], v[68:71], v[164:167]
    buffer_load_dwordx4 v51, s[24:27], s60 offen sc1 lds
    s_waitcnt lgkmcnt(6)
    v_mfma_f32_16x16x32_bf16 v[128:131], a[160:163], v[72:75], v[128:131]
    ds_read_b64_tr_b16 v[88:89], v8 offset:57344
    s_add_u32 m0, s59, 106496
    ds_read_b64_tr_b16 v[90:91], v8 offset:58368
    s_add_u32 s60, s58, 1310848
    v_mfma_f32_16x16x32_bf16 v[132:135], a[164:167], v[72:75], v[132:135]
    buffer_load_dwordx4 v13, s[24:27], s60 offen sc1 lds
    s_waitcnt lgkmcnt(6)
    v_mfma_f32_16x16x32_bf16 v[160:163], a[176:179], v[76:79], v[160:163]
    ds_read_b64_tr_b16 v[92:93], v8 offset:57600
    s_add_u32 m0, s59, 107520
    ds_read_b64_tr_b16 v[94:95], v8 offset:58624
    s_add_u32 s60, s58, 1343616
    v_mfma_f32_16x16x32_bf16 v[164:167], a[180:183], v[76:79], v[164:167]
    buffer_load_dwordx4 v51, s[24:27], s60 offen sc1 lds
    s_waitcnt lgkmcnt(6)
    v_mfma_f32_16x16x32_bf16 v[128:131], a[192:195], v[80:83], v[128:131]
    ds_read_b64_tr_b16 v[64:65], v9 offset:32768
    s_add_u32 m0, s59, 114688
    ds_read_b64_tr_b16 v[66:67], v9 offset:33792
    s_add_u32 s60, s58, 1572992
    v_mfma_f32_16x16x32_bf16 v[132:135], a[196:199], v[80:83], v[132:135]
    buffer_load_dwordx4 v13, s[24:27], s60 offen sc1 lds
    s_waitcnt lgkmcnt(6)
    v_mfma_f32_16x16x32_bf16 v[160:163], a[208:211], v[84:87], v[160:163]
    ds_read_b64_tr_b16 v[68:69], v9 offset:33024
    s_add_u32 m0, s59, 115712
    ds_read_b64_tr_b16 v[70:71], v9 offset:34048
    s_add_u32 s60, s58, 1605760
    v_mfma_f32_16x16x32_bf16 v[164:167], a[212:215], v[84:87], v[164:167]
    buffer_load_dwordx4 v51, s[24:27], s60 offen sc1 lds
    s_waitcnt lgkmcnt(6)
    v_mfma_f32_16x16x32_bf16 v[128:131], a[224:227], v[88:91], v[128:131]
    ds_read_b64_tr_b16 v[72:73], v9 offset:40960
    s_add_u32 m0, s59, 122880
    ds_read_b64_tr_b16 v[74:75], v9 offset:41984
    s_add_u32 s60, s58, 1835136
    v_mfma_f32_16x16x32_bf16 v[132:135], a[228:231], v[88:91], v[132:135]
    buffer_load_dwordx4 v13, s[24:27], s60 offen sc1 lds
    s_waitcnt lgkmcnt(6)
    v_mfma_f32_16x16x32_bf16 v[160:163], a[240:243], v[92:95], v[160:163]
    ds_read_b64_tr_b16 v[76:77], v9 offset:41216
    s_add_u32 m0, s59, 123904
    ds_read_b64_tr_b16 v[78:79], v9 offset:42240
    s_add_u32 s60, s58, 1867904
    v_mfma_f32_16x16x32_bf16 v[164:167], a[244:247], v[92:95], v[164:167]
    buffer_load_dwordx4 v51, s[24:27], s60 offen sc1 lds
    s_waitcnt lgkmcnt(6)
    v_mfma_f32_16x16x32_bf16 v[136:139], a[128:131], v[64:67], v[136:139]
    ds_read_b64_tr_b16 v[80:81], v9 offset:49152
    s_add_u32 s63, s64, 0
    ds_read_b64_tr_b16 v[82:83], v9 offset:50176
    buffer_load_dwordx4 v[96:99], v2, s[24:27], s63 offen offset:0 sc1
    v_mfma_f32_16x16x32_bf16 v[140:143], a[132:135], v[64:67], v[140:143]
    s_waitcnt lgkmcnt(6)
    v_mfma_f32_16x16x32_bf16 v[168:171], a[144:147], v[68:71], v[168:171]
    ds_read_b64_tr_b16 v[84:85], v9 offset:49408
    buffer_load_dwordx4 v[100:103], v2, s[24:27], s63 offen offset:1024 sc1
    ds_read_b64_tr_b16 v[86:87], v9 offset:50432
    v_add_f32 v53, v128, v160
    v_mfma_f32_16x16x32_bf16 v[172:175], a[148:151], v[68:71], v[172:175]
    v_add_f32 v54, v129, v161
    v_cvt_pk_bf16_f32 v16, v53, v54
    v_add_f32 v53, v130, v162
    v_add_f32 v54, v131, v163
    s_waitcnt lgkmcnt(6)
    v_mfma_f32_16x16x32_bf16 v[136:139], a[160:163], v[72:75], v[136:139]
    ds_read_b64_tr_b16 v[88:89], v9 offset:57344
    buffer_load_dwordx4 v[104:107], v2, s[24:27], s63 offen offset:2048 sc1
    ds_read_b64_tr_b16 v[90:91], v9 offset:58368
    v_cvt_pk_bf16_f32 v17, v53, v54
    v_mfma_f32_16x16x32_bf16 v[140:143], a[164:167], v[72:75], v[140:143]
    v_add_f32 v53, v132, v164
    v_add_f32 v54, v133, v165
    v_cvt_pk_bf16_f32 v18, v53, v54
    v_add_f32 v53, v134, v166
    s_waitcnt lgkmcnt(6)
    v_mfma_f32_16x16x32_bf16 v[168:171], a[176:179], v[76:79], v[168:171]
    ds_read_b64_tr_b16 v[92:93], v9 offset:57600
    buffer_load_dwordx4 v[108:111], v2, s[24:27], s63 offen offset:3072 sc1
    ds_read_b64_tr_b16 v[94:95], v9 offset:58624
    v_add_f32 v54, v135, v167
    v_mfma_f32_16x16x32_bf16 v[172:175], a[180:183], v[76:79], v[172:175]
    v_cvt_pk_bf16_f32 v19, v53, v54
    buffer_store_dwordx4 v[16:19], v50, s[24:27], s32 offen offset:0 sc1
    v_sub_f32 v53, v128, v160
    v_sub_f32 v54, v129, v161
    s_waitcnt lgkmcnt(6)
    v_mfma_f32_16x16x32_bf16 v[136:139], a[192:195], v[80:83], v[136:139]
    ds_read_b64_tr_b16 v[64:65], v10 offset:32768
    s_add_u32 s63, s64, 4096
    ds_read_b64_tr_b16 v[66:67], v10 offset:33792
    buffer_load_dwordx4 v[112:115], v2, s[24:27], s63 offen offset:0 sc1
    v_mfma_f32_16x16x32_bf16 v[140:143], a[196:199], v[80:83], v[140:143]
    v_cvt_pk_bf16_f32 v20, v53, v54
    v_sub_f32 v53, v130, v162
    v_sub_f32 v54, v131, v163
    v_cvt_pk_bf16_f32 v21, v53, v54
    s_waitcnt lgkmcnt(6)
    v_mfma_f32_16x16x32_bf16 v[168:171], a[208:211], v[84:87], v[168:171]
    ds_read_b64_tr_b16 v[68:69], v10 offset:33024
    buffer_load_dwordx4 v[116:119], v2, s[24:27], s63 offen offset:1024 sc1
    ds_read_b64_tr_b16 v[70:71], v10 offset:34048
    v_sub_f32 v53, v132, v164
    v_mfma_f32_16x16x32_bf16 v[172:175], a[212:215], v[84:87], v[172:175]
    v_sub_f32 v54, v133, v165
    v_cvt_pk_bf16_f32 v22, v53, v54
    v_sub_f32 v53, v134, v166
    v_sub_f32 v54, v135, v167
    s_waitcnt lgkmcnt(6)
    v_mfma_f32_16x16x32_bf16 v[136:139], a[224:227], v[88:91], v[136:139]
    ds_read_b64_tr_b16 v[72:73], v10 offset:40960
    buffer_load_dwordx4 v[120:123], v2, s[24:27], s63 offen offset:2048 sc1
    ds_read_b64_tr_b16 v[74:75], v10 offset:41984
    v_cvt_pk_bf16_f32 v23, v53, v54
    v_mfma_f32_16x16x32_bf16 v[140:143], a[228:231], v[88:91], v[140:143]
    buffer_store_dwordx4 v[20:23], v52, s[24:27], s32 offen offset:0 sc1
    s_waitcnt lgkmcnt(6)
    v_mfma_f32_16x16x32_bf16 v[168:171], a[240:243], v[92:95], v[168:171]
    ds_read_b64_tr_b16 v[76:77], v10 offset:41216
    buffer_load_dwordx4 v[124:127], v2, s[24:27], s63 offen offset:3072 sc1
    ds_read_b64_tr_b16 v[78:79], v10 offset:42240
    v_mfma_f32_16x16x32_bf16 v[172:175], a[244:247], v[92:95], v[172:175]
    s_waitcnt lgkmcnt(6)
    v_mfma_f32_16x16x32_bf16 v[144:147], a[128:131], v[64:67], v[144:147]
    ds_read_b64_tr_b16 v[80:81], v10 offset:49152
    ds_read_b64_tr_b16 v[82:83], v10 offset:50176
    v_mfma_f32_16x16x32_bf16 v[148:151], a[132:135], v[64:67], v[148:151]
    s_waitcnt lgkmcnt(6)
    v_mfma_f32_16x16x32_bf16 v[176:179], a[144:147], v[68:71], v[176:179]
    ds_read_b64_tr_b16 v[84:85], v10 offset:49408
    v_add_f32 v53, v136, v168
    ds_read_b64_tr_b16 v[86:87], v10 offset:50432
    v_add_f32 v54, v137, v169
    v_mfma_f32_16x16x32_bf16 v[180:183], a[148:151], v[68:71], v[180:183]
    v_cvt_pk_bf16_f32 v24, v53, v54
    v_add_f32 v53, v138, v170
    v_add_f32 v54, v139, v171
    v_cvt_pk_bf16_f32 v25, v53, v54
    s_waitcnt lgkmcnt(6)
    v_mfma_f32_16x16x32_bf16 v[144:147], a[160:163], v[72:75], v[144:147]
    ds_read_b64_tr_b16 v[88:89], v10 offset:57344
    v_add_f32 v53, v140, v172
    ds_read_b64_tr_b16 v[90:91], v10 offset:58368
    v_add_f32 v54, v141, v173
    v_mfma_f32_16x16x32_bf16 v[148:151], a[164:167], v[72:75], v[148:151]
    v_cvt_pk_bf16_f32 v26, v53, v54
    v_add_f32 v53, v142, v174
    v_add_f32 v54, v143, v175
    v_cvt_pk_bf16_f32 v27, v53, v54
    s_waitcnt lgkmcnt(6)
    v_mfma_f32_16x16x32_bf16 v[176:179], a[176:179], v[76:79], v[176:179]
    ds_read_b64_tr_b16 v[92:93], v10 offset:57600
    buffer_store_dwordx4 v[24:27], v50, s[24:27], s32 offen offset:256 sc1
    ds_read_b64_tr_b16 v[94:95], v10 offset:58624
    v_sub_f32 v53, v136, v168
    v_mfma_f32_16x16x32_bf16 v[180:183], a[180:183], v[76:79], v[180:183]
    v_sub_f32 v54, v137, v169
    v_cvt_pk_bf16_f32 v28, v53, v54
    v_sub_f32 v53, v138, v170
    v_sub_f32 v54, v139, v171
    s_waitcnt lgkmcnt(6)
    v_mfma_f32_16x16x32_bf16 v[144:147], a[192:195], v[80:83], v[144:147]
    ds_read_b64_tr_b16 v[64:65], v11 offset:32768
    v_cvt_pk_bf16_f32 v29, v53, v54
    ds_read_b64_tr_b16 v[66:67], v11 offset:33792
    v_sub_f32 v53, v140, v172
    v_mfma_f32_16x16x32_bf16 v[148:151], a[196:199], v[80:83], v[148:151]
    v_sub_f32 v54, v141, v173
    v_cvt_pk_bf16_f32 v30, v53, v54
    v_sub_f32 v53, v142, v174
    v_sub_f32 v54, v143, v175
    s_waitcnt lgkmcnt(6)
    v_mfma_f32_16x16x32_bf16 v[176:179], a[208:211], v[84:87], v[176:179]
    ds_read_b64_tr_b16 v[68:69], v11 offset:33024
    v_cvt_pk_bf16_f32 v31, v53, v54
    ds_read_b64_tr_b16 v[70:71], v11 offset:34048
    buffer_store_dwordx4 v[28:31], v52, s[24:27], s32 offen offset:256 sc1
    v_mfma_f32_16x16x32_bf16 v[180:183], a[212:215], v[84:87], v[180:183]
    s_waitcnt lgkmcnt(6)
    v_mfma_f32_16x16x32_bf16 v[144:147], a[224:227], v[88:91], v[144:147]
    ds_read_b64_tr_b16 v[72:73], v11 offset:40960
    ds_read_b64_tr_b16 v[74:75], v11 offset:41984
    v_mfma_f32_16x16x32_bf16 v[148:151], a[228:231], v[88:91], v[148:151]
    s_waitcnt lgkmcnt(6)
    v_mfma_f32_16x16x32_bf16 v[176:179], a[240:243], v[92:95], v[176:179]
    ds_read_b64_tr_b16 v[76:77], v11 offset:41216
    ds_read_b64_tr_b16 v[78:79], v11 offset:42240
    v_mfma_f32_16x16x32_bf16 v[180:183], a[244:247], v[92:95], v[180:183]
    s_waitcnt lgkmcnt(6)
    v_mfma_f32_16x16x32_bf16 v[152:155], a[128:131], v[64:67], v[152:155]
    ds_read_b64_tr_b16 v[80:81], v11 offset:49152
    ds_read_b64_tr_b16 v[82:83], v11 offset:50176
    v_mfma_f32_16x16x32_bf16 v[156:159], a[132:135], v[64:67], v[156:159]
    s_waitcnt lgkmcnt(6)
    v_mfma_f32_16x16x32_bf16 v[184:187], a[144:147], v[68:71], v[184:187]
    ds_read_b64_tr_b16 v[84:85], v11 offset:49408
    v_add_f32 v53, v144, v176
    ds_read_b64_tr_b16 v[86:87], v11 offset:50432
    v_add_f32 v54, v145, v177
    v_mfma_f32_16x16x32_bf16 v[188:191], a[148:151], v[68:71], v[188:191]
    v_cvt_pk_bf16_f32 v32, v53, v54
    v_add_f32 v53, v146, v178
    v_add_f32 v54, v147, v179
    v_cvt_pk_bf16_f32 v33, v53, v54
    s_waitcnt lgkmcnt(6)
    v_mfma_f32_16x16x32_bf16 v[152:155], a[160:163], v[72:75], v[152:155]
    ds_read_b64_tr_b16 v[88:89], v11 offset:57344
    v_add_f32 v53, v148, v180
    ds_read_b64_tr_b16 v[90:91], v11 offset:58368
    v_add_f32 v54, v149, v181
    v_mfma_f32_16x16x32_bf16 v[156:159], a[164:167], v[72:75], v[156:159]
    v_cvt_pk_bf16_f32 v34, v53, v54
    v_add_f32 v53, v150, v182
    v_add_f32 v54, v151, v183
    v_cvt_pk_bf16_f32 v35, v53, v54
    s_waitcnt lgkmcnt(6)
    v_mfma_f32_16x16x32_bf16 v[184:187], a[176:179], v[76:79], v[184:187]
    ds_read_b64_tr_b16 v[92:93], v11 offset:57600
    buffer_store_dwordx4 v[32:35], v50, s[24:27], s33 offen offset:0 sc1
    ds_read_b64_tr_b16 v[94:95], v11 offset:58624
    v_sub_f32 v53, v144, v176
    v_mfma_f32_16x16x32_bf16 v[188:191], a[180:183], v[76:79], v[188:191]
    v_sub_f32 v54, v145, v177
    v_cvt_pk_bf16_f32 v36, v53, v54
    v_sub_f32 v53, v146, v178
    v_sub_f32 v54, v147, v179
    s_waitcnt vmcnt(25)
    s_barrier
    s_waitcnt lgkmcnt(6)
    v_mfma_f32_16x16x32_bf16 v[152:155], a[192:195], v[80:83], v[152:155]
    v_add_u32 v8, 0x10000, v8
    ds_read_b64_tr_b16 v[64:65], v8 offset:0
    v_cvt_pk_bf16_f32 v37, v53, v54
    ds_read_b64_tr_b16 v[66:67], v8 offset:1024
    v_sub_f32 v53, v148, v180
    v_mfma_f32_16x16x32_bf16 v[156:159], a[196:199], v[80:83], v[156:159]
    v_sub_f32 v54, v149, v181
    v_cvt_pk_bf16_f32 v38, v53, v54
    v_sub_f32 v53, v150, v182
    v_sub_f32 v54, v151, v183
    s_waitcnt lgkmcnt(6)
    v_mfma_f32_16x16x32_bf16 v[184:187], a[208:211], v[84:87], v[184:187]
    v_add_u32 v9, 0x10000, v9
    ds_read_b64_tr_b16 v[68:69], v9 offset:0
    v_cvt_pk_bf16_f32 v39, v53, v54
    ds_read_b64_tr_b16 v[70:71], v9 offset:1024
    buffer_store_dwordx4 v[36:39], v52, s[24:27], s33 offen offset:0 sc1
    v_mfma_f32_16x16x32_bf16 v[188:191], a[212:215], v[84:87], v[188:191]
    s_waitcnt lgkmcnt(6)
    v_mfma_f32_16x16x32_bf16 v[152:155], a[224:227], v[88:91], v[152:155]
    v_add_u32 v10, 0x10000, v10
    ds_read_b64_tr_b16 v[72:73], v10 offset:0
    ds_read_b64_tr_b16 v[74:75], v10 offset:1024
    v_mfma_f32_16x16x32_bf16 v[156:159], a[228:231], v[88:91], v[156:159]
    s_waitcnt lgkmcnt(6)
    v_mfma_f32_16x16x32_bf16 v[184:187], a[240:243], v[92:95], v[184:187]
    v_add_u32 v11, 0x10000, v11
    ds_read_b64_tr_b16 v[76:77], v11 offset:0
    ds_read_b64_tr_b16 v[78:79], v11 offset:1024
    v_mfma_f32_16x16x32_bf16 v[188:191], a[244:247], v[92:95], v[188:191]
    s_waitcnt lgkmcnt(6)
    v_mfma_f32_16x16x32_bf16 v[192:195], a[0:3], v[64:67], 0
    ds_read_b64_tr_b16 v[80:81], v8 offset:256
    ds_read_b64_tr_b16 v[82:83], v8 offset:1280
    v_mfma_f32_16x16x32_bf16 v[196:199], a[4:7], v[64:67], 0
    s_waitcnt lgkmcnt(6)
    v_mfma_f32_16x16x32_bf16 v[200:203], a[0:3], v[68:71], 0
    ds_read_b64_tr_b16 v[84:85], v9 offset:256
    v_add_f32 v53, v152, v184
    ds_read_b64_tr_b16 v[86:87], v9 offset:1280
    v_add_f32 v54, v153, v185
    v_mfma_f32_16x16x32_bf16 v[204:207], a[4:7], v[68:71], 0
    v_cvt_pk_bf16_f32 v40, v53, v54
    v_add_f32 v53, v154, v186
    v_add_f32 v54, v155, v187
    v_cvt_pk_bf16_f32 v41, v53, v54
    s_waitcnt lgkmcnt(6)
    v_mfma_f32_16x16x32_bf16 v[208:211], a[0:3], v[72:75], 0
    ds_read_b64_tr_b16 v[88:89], v10 offset:256
    v_add_f32 v53, v156, v188
    ds_read_b64_tr_b16 v[90:91], v10 offset:1280
    v_add_f32 v54, v157, v189
    v_mfma_f32_16x16x32_bf16 v[212:215], a[4:7], v[72:75], 0
    v_cvt_pk_bf16_f32 v42, v53, v54
    v_add_f32 v53, v158, v190
    v_add_f32 v54, v159, v191
    v_cvt_pk_bf16_f32 v43, v53, v54
    s_waitcnt lgkmcnt(6)
    v_mfma_f32_16x16x32_bf16 v[216:219], a[0:3], v[76:79], 0
    ds_read_b64_tr_b16 v[92:93], v11 offset:256
    buffer_store_dwordx4 v[40:43], v50, s[24:27], s33 offen offset:256 sc1
    ds_read_b64_tr_b16 v[94:95], v11 offset:1280
    v_sub_f32 v53, v152, v184
    v_mfma_f32_16x16x32_bf16 v[220:223], a[4:7], v[76:79], 0
    v_sub_f32 v54, v153, v185
    v_cvt_pk_bf16_f32 v44, v53, v54
    v_sub_f32 v53, v154, v186
    v_sub_f32 v54, v155, v187
    s_waitcnt lgkmcnt(6)
    v_mfma_f32_16x16x32_bf16 v[224:227], a[16:19], v[80:83], 0
    ds_read_b64_tr_b16 v[64:65], v8 offset:8192
    v_cvt_pk_bf16_f32 v45, v53, v54
    ds_read_b64_tr_b16 v[66:67], v8 offset:9216
    v_sub_f32 v53, v156, v188
    v_mfma_f32_16x16x32_bf16 v[228:231], a[20:23], v[80:83], 0
    v_sub_f32 v54, v157, v189
    v_cvt_pk_bf16_f32 v46, v53, v54
    v_sub_f32 v53, v158, v190
    v_sub_f32 v54, v159, v191
    s_waitcnt lgkmcnt(6)
    v_mfma_f32_16x16x32_bf16 v[232:235], a[16:19], v[84:87], 0
    ds_read_b64_tr_b16 v[68:69], v9 offset:8192
    v_cvt_pk_bf16_f32 v47, v53, v54
    ds_read_b64_tr_b16 v[70:71], v9 offset:9216
    buffer_store_dwordx4 v[44:47], v52, s[24:27], s33 offen offset:256 sc1
    v_mfma_f32_16x16x32_bf16 v[236:239], a[20:23], v[84:87], 0
    s_waitcnt lgkmcnt(6)
    v_mfma_f32_16x16x32_bf16 v[240:243], a[16:19], v[88:91], 0
    ds_read_b64_tr_b16 v[72:73], v10 offset:8192
    ds_read_b64_tr_b16 v[74:75], v10 offset:9216
    v_mfma_f32_16x16x32_bf16 v[244:247], a[20:23], v[88:91], 0
    s_waitcnt lgkmcnt(6)
    v_mfma_f32_16x16x32_bf16 v[248:251], a[16:19], v[92:95], 0
    ds_read_b64_tr_b16 v[76:77], v11 offset:8192
    ds_read_b64_tr_b16 v[78:79], v11 offset:9216
    v_mfma_f32_16x16x32_bf16 v[252:255], a[20:23], v[92:95], 0
    s_waitcnt lgkmcnt(6)
    v_mfma_f32_16x16x32_bf16 v[192:195], a[32:35], v[64:67], v[192:195]
    ds_read_b64_tr_b16 v[80:81], v8 offset:8448
    s_add_u32 s63, s64, 8192
    ds_read_b64_tr_b16 v[82:83], v8 offset:9472
    buffer_load_dwordx4 a[0:3], v2, s[24:27], s63 offen offset:0 sc1
    v_mfma_f32_16x16x32_bf16 v[196:199], a[36:39], v[64:67], v[196:199]
    s_waitcnt lgkmcnt(6)
    v_mfma_f32_16x16x32_bf16 v[200:203], a[32:35], v[68:71], v[200:203]
    ds_read_b64_tr_b16 v[84:85], v9 offset:8448
    buffer_load_dwordx4 a[4:7], v2, s[24:27], s63 offen offset:1024 sc1
    ds_read_b64_tr_b16 v[86:87], v9 offset:9472
    v_mfma_f32_16x16x32_bf16 v[204:207], a[36:39], v[68:71], v[204:207]
    s_waitcnt lgkmcnt(6)
    v_mfma_f32_16x16x32_bf16 v[208:211], a[32:35], v[72:75], v[208:211]
    ds_read_b64_tr_b16 v[88:89], v10 offset:8448
    buffer_load_dwordx4 a[8:11], v2, s[24:27], s63 offen offset:2048 sc1
    ds_read_b64_tr_b16 v[90:91], v10 offset:9472
    v_mfma_f32_16x16x32_bf16 v[212:215], a[36:39], v[72:75], v[212:215]
    s_waitcnt lgkmcnt(6)
    v_mfma_f32_16x16x32_bf16 v[216:219], a[32:35], v[76:79], v[216:219]
    ds_read_b64_tr_b16 v[92:93], v11 offset:8448
    buffer_load_dwordx4 a[12:15], v2, s[24:27], s63 offen offset:3072 sc1
    ds_read_b64_tr_b16 v[94:95], v11 offset:9472
    v_mfma_f32_16x16x32_bf16 v[220:223], a[36:39], v[76:79], v[220:223]
    s_waitcnt vmcnt(20)
    s_barrier
    s_waitcnt lgkmcnt(6)
    v_mfma_f32_16x16x32_bf16 v[224:227], a[48:51], v[80:83], v[224:227]
    ds_read_b64_tr_b16 v[64:65], v8 offset:16384
    s_add_u32 s63, s64, 12288
    ds_read_b64_tr_b16 v[66:67], v8 offset:17408
    buffer_load_dwordx4 a[16:19], v2, s[24:27], s63 offen offset:0 sc1
    v_mfma_f32_16x16x32_bf16 v[228:231], a[52:55], v[80:83], v[228:231]
    s_waitcnt lgkmcnt(6)
    v_mfma_f32_16x16x32_bf16 v[232:235], a[48:51], v[84:87], v[232:235]
    ds_read_b64_tr_b16 v[68:69], v9 offset:16384
    buffer_load_dwordx4 a[20:23], v2, s[24:27], s63 offen offset:1024 sc1
    ds_read_b64_tr_b16 v[70:71], v9 offset:17408
    v_mfma_f32_16x16x32_bf16 v[236:239], a[52:55], v[84:87], v[236:239]
    s_waitcnt lgkmcnt(6)
    v_mfma_f32_16x16x32_bf16 v[240:243], a[48:51], v[88:91], v[240:243]
    ds_read_b64_tr_b16 v[72:73], v10 offset:16384
    buffer_load_dwordx4 a[24:27], v2, s[24:27], s63 offen offset:2048 sc1
    ds_read_b64_tr_b16 v[74:75], v10 offset:17408
    v_mfma_f32_16x16x32_bf16 v[244:247], a[52:55], v[88:91], v[244:247]
    s_waitcnt lgkmcnt(6)
    v_mfma_f32_16x16x32_bf16 v[248:251], a[48:51], v[92:95], v[248:251]
    ds_read_b64_tr_b16 v[76:77], v11 offset:16384
    buffer_load_dwordx4 a[28:31], v2, s[24:27], s63 offen offset:3072 sc1
    ds_read_b64_tr_b16 v[78:79], v11 offset:17408
    v_mfma_f32_16x16x32_bf16 v[252:255], a[52:55], v[92:95], v[252:255]
    s_waitcnt lgkmcnt(6)
    v_mfma_f32_16x16x32_bf16 v[192:195], a[64:67], v[64:67], v[192:195]
    ds_read_b64_tr_b16 v[80:81], v8 offset:16640
    s_add_u32 s63, s64, 16384
    ds_read_b64_tr_b16 v[82:83], v8 offset:17664
    buffer_load_dwordx4 v[128:131], v2, s[24:27], s63 offen offset:0 sc1
    v_mfma_f32_16x16x32_bf16 v[196:199], a[68:71], v[64:67], v[196:199]
    s_waitcnt lgkmcnt(6)
    v_mfma_f32_16x16x32_bf16 v[200:203], a[64:67], v[68:71], v[200:203]
    ds_read_b64_tr_b16 v[84:85], v9 offset:16640
    buffer_load_dwordx4 v[132:135], v2, s[24:27], s63 offen offset:1024 sc1
    ds_read_b64_tr_b16 v[86:87], v9 offset:17664
    v_mfma_f32_16x16x32_bf16 v[204:207], a[68:71], v[68:71], v[204:207]
    s_waitcnt lgkmcnt(6)
    v_mfma_f32_16x16x32_bf16 v[208:211], a[64:67], v[72:75], v[208:211]
    ds_read_b64_tr_b16 v[88:89], v10 offset:16640
    buffer_load_dwordx4 v[136:139], v2, s[24:27], s63 offen offset:2048 sc1
    ds_read_b64_tr_b16 v[90:91], v10 offset:17664
    v_mfma_f32_16x16x32_bf16 v[212:215], a[68:71], v[72:75], v[212:215]
    s_waitcnt lgkmcnt(6)
    v_mfma_f32_16x16x32_bf16 v[216:219], a[64:67], v[76:79], v[216:219]
    ds_read_b64_tr_b16 v[92:93], v11 offset:16640
    buffer_load_dwordx4 v[140:143], v2, s[24:27], s63 offen offset:3072 sc1
    ds_read_b64_tr_b16 v[94:95], v11 offset:17664
    v_mfma_f32_16x16x32_bf16 v[220:223], a[68:71], v[76:79], v[220:223]
    s_waitcnt lgkmcnt(6)
    v_mfma_f32_16x16x32_bf16 v[224:227], a[80:83], v[80:83], v[224:227]
    ds_read_b64_tr_b16 v[64:65], v8 offset:24576
    s_add_u32 s63, s64, 20480
    ds_read_b64_tr_b16 v[66:67], v8 offset:25600
    buffer_load_dwordx4 v[144:147], v2, s[24:27], s63 offen offset:0 sc1
    v_mfma_f32_16x16x32_bf16 v[228:231], a[84:87], v[80:83], v[228:231]
    s_waitcnt lgkmcnt(6)
    v_mfma_f32_16x16x32_bf16 v[232:235], a[80:83], v[84:87], v[232:235]
    ds_read_b64_tr_b16 v[68:69], v9 offset:24576
    buffer_load_dwordx4 v[148:151], v2, s[24:27], s63 offen offset:1024 sc1
    ds_read_b64_tr_b16 v[70:71], v9 offset:25600
    v_mfma_f32_16x16x32_bf16 v[236:239], a[84:87], v[84:87], v[236:239]
    s_waitcnt lgkmcnt(6)
    v_mfma_f32_16x16x32_bf16 v[240:243], a[80:83], v[88:91], v[240:243]
    ds_read_b64_tr_b16 v[72:73], v10 offset:24576
    buffer_load_dwordx4 v[152:155], v2, s[24:27], s63 offen offset:2048 sc1
    ds_read_b64_tr_b16 v[74:75], v10 offset:25600
    v_mfma_f32_16x16x32_bf16 v[244:247], a[84:87], v[88:91], v[244:247]
    s_waitcnt lgkmcnt(6)
    v_mfma_f32_16x16x32_bf16 v[248:251], a[80:83], v[92:95], v[248:251]
    ds_read_b64_tr_b16 v[76:77], v11 offset:24576
    buffer_load_dwordx4 v[156:159], v2, s[24:27], s63 offen offset:3072 sc1
    ds_read_b64_tr_b16 v[78:79], v11 offset:25600
    v_mfma_f32_16x16x32_bf16 v[252:255], a[84:87], v[92:95], v[252:255]
    s_waitcnt lgkmcnt(6)
    v_mfma_f32_16x16x32_bf16 v[192:195], a[96:99], v[64:67], v[192:195]
    ds_read_b64_tr_b16 v[80:81], v8 offset:24832
    s_add_u32 s63, s64, 24576
    ds_read_b64_tr_b16 v[82:83], v8 offset:25856
    buffer_load_dwordx4 v[160:163], v2, s[24:27], s63 offen offset:0 sc1
    v_mfma_f32_16x16x32_bf16 v[196:199], a[100:103], v[64:67], v[196:199]
    s_waitcnt lgkmcnt(6)
    v_mfma_f32_16x16x32_bf16 v[200:203], a[96:99], v[68:71], v[200:203]
    ds_read_b64_tr_b16 v[84:85], v9 offset:24832
    buffer_load_dwordx4 v[164:167], v2, s[24:27], s63 offen offset:1024 sc1
    ds_read_b64_tr_b16 v[86:87], v9 offset:25856
    v_mfma_f32_16x16x32_bf16 v[204:207], a[100:103], v[68:71], v[204:207]
    s_waitcnt lgkmcnt(6)
    v_mfma_f32_16x16x32_bf16 v[208:211], a[96:99], v[72:75], v[208:211]
    ds_read_b64_tr_b16 v[88:89], v10 offset:24832
    buffer_load_dwordx4 v[168:171], v2, s[24:27], s63 offen offset:2048 sc1
    ds_read_b64_tr_b16 v[90:91], v10 offset:25856
    v_mfma_f32_16x16x32_bf16 v[212:215], a[100:103], v[72:75], v[212:215]
    s_waitcnt lgkmcnt(6)
    v_mfma_f32_16x16x32_bf16 v[216:219], a[96:99], v[76:79], v[216:219]
    ds_read_b64_tr_b16 v[92:93], v11 offset:24832
    buffer_load_dwordx4 v[172:175], v2, s[24:27], s63 offen offset:3072 sc1
    ds_read_b64_tr_b16 v[94:95], v11 offset:25856
    v_mfma_f32_16x16x32_bf16 v[220:223], a[100:103], v[76:79], v[220:223]
    s_waitcnt lgkmcnt(6)
    v_mfma_f32_16x16x32_bf16 v[224:227], a[112:115], v[80:83], v[224:227]
    ds_read_b64_tr_b16 v[64:65], v8 offset:32768
    s_add_u32 s63, s64, 28672
    ds_read_b64_tr_b16 v[66:67], v8 offset:33792
    buffer_load_dwordx4 v[176:179], v2, s[24:27], s63 offen offset:0 sc1
    v_mfma_f32_16x16x32_bf16 v[228:231], a[116:119], v[80:83], v[228:231]
    s_waitcnt lgkmcnt(6)
    v_mfma_f32_16x16x32_bf16 v[232:235], a[112:115], v[84:87], v[232:235]
    ds_read_b64_tr_b16 v[68:69], v8 offset:33024
    buffer_load_dwordx4 v[180:183], v2, s[24:27], s63 offen offset:1024 sc1
    ds_read_b64_tr_b16 v[70:71], v8 offset:34048
    v_mfma_f32_16x16x32_bf16 v[236:239], a[116:119], v[84:87], v[236:239]
    s_waitcnt lgkmcnt(6)
    v_mfma_f32_16x16x32_bf16 v[240:243], a[112:115], v[88:91], v[240:243]
    ds_read_b64_tr_b16 v[72:73], v8 offset:40960
    buffer_load_dwordx4 v[184:187], v2, s[24:27], s63 offen offset:2048 sc1
    ds_read_b64_tr_b16 v[74:75], v8 offset:41984
    v_mfma_f32_16x16x32_bf16 v[244:247], a[116:119], v[88:91], v[244:247]
    s_waitcnt lgkmcnt(6)
    v_mfma_f32_16x16x32_bf16 v[248:251], a[112:115], v[92:95], v[248:251]
    ds_read_b64_tr_b16 v[76:77], v8 offset:41216
    buffer_load_dwordx4 v[188:191], v2, s[24:27], s63 offen offset:3072 sc1
    ds_read_b64_tr_b16 v[78:79], v8 offset:42240
    v_mfma_f32_16x16x32_bf16 v[252:255], a[116:119], v[92:95], v[252:255]
    s_waitcnt lgkmcnt(6)
    v_mfma_f32_16x16x32_bf16 v[192:195], a[128:131], v[64:67], v[192:195]
    ds_read_b64_tr_b16 v[80:81], v8 offset:49152
    s_add_u32 s63, s64, 32768
    ds_read_b64_tr_b16 v[82:83], v8 offset:50176
    buffer_load_dwordx4 a[32:35], v2, s[24:27], s63 offen offset:0 sc1
    v_mfma_f32_16x16x32_bf16 v[196:199], a[132:135], v[64:67], v[196:199]
    s_waitcnt lgkmcnt(6)
    v_mfma_f32_16x16x32_bf16 v[224:227], a[144:147], v[68:71], v[224:227]
    ds_read_b64_tr_b16 v[84:85], v8 offset:49408
    buffer_load_dwordx4 a[36:39], v2, s[24:27], s63 offen offset:1024 sc1
    ds_read_b64_tr_b16 v[86:87], v8 offset:50432
    v_mfma_f32_16x16x32_bf16 v[228:231], a[148:151], v[68:71], v[228:231]
    s_waitcnt lgkmcnt(6)
    v_mfma_f32_16x16x32_bf16 v[192:195], a[160:163], v[72:75], v[192:195]
    ds_read_b64_tr_b16 v[88:89], v8 offset:57344
    buffer_load_dwordx4 a[40:43], v2, s[24:27], s63 offen offset:2048 sc1
    ds_read_b64_tr_b16 v[90:91], v8 offset:58368
    v_mfma_f32_16x16x32_bf16 v[196:199], a[164:167], v[72:75], v[196:199]
    s_waitcnt lgkmcnt(6)
    v_mfma_f32_16x16x32_bf16 v[224:227], a[176:179], v[76:79], v[224:227]
    ds_read_b64_tr_b16 v[92:93], v8 offset:57600
    buffer_load_dwordx4 a[44:47], v2, s[24:27], s63 offen offset:3072 sc1
    ds_read_b64_tr_b16 v[94:95], v8 offset:58624
    v_mfma_f32_16x16x32_bf16 v[228:231], a[180:183], v[76:79], v[228:231]
    s_waitcnt lgkmcnt(6)
    v_mfma_f32_16x16x32_bf16 v[192:195], a[192:195], v[80:83], v[192:195]
    ds_read_b64_tr_b16 v[64:65], v9 offset:32768
    s_add_u32 s63, s64, 36864
    ds_read_b64_tr_b16 v[66:67], v9 offset:33792
    buffer_load_dwordx4 a[48:51], v2, s[24:27], s63 offen offset:0 sc1
    v_mfma_f32_16x16x32_bf16 v[196:199], a[196:199], v[80:83], v[196:199]
    s_waitcnt lgkmcnt(6)
    v_mfma_f32_16x16x32_bf16 v[224:227], a[208:211], v[84:87], v[224:227]
    ds_read_b64_tr_b16 v[68:69], v9 offset:33024
    buffer_load_dwordx4 a[52:55], v2, s[24:27], s63 offen offset:1024 sc1
    ds_read_b64_tr_b16 v[70:71], v9 offset:34048
    v_mfma_f32_16x16x32_bf16 v[228:231], a[212:215], v[84:87], v[228:231]
    s_waitcnt lgkmcnt(6)
    v_mfma_f32_16x16x32_bf16 v[192:195], a[224:227], v[88:91], v[192:195]
    ds_read_b64_tr_b16 v[72:73], v9 offset:40960
    buffer_load_dwordx4 a[56:59], v2, s[24:27], s63 offen offset:2048 sc1
    ds_read_b64_tr_b16 v[74:75], v9 offset:41984
    v_mfma_f32_16x16x32_bf16 v[196:199], a[228:231], v[88:91], v[196:199]
    s_waitcnt lgkmcnt(6)
    v_mfma_f32_16x16x32_bf16 v[224:227], a[240:243], v[92:95], v[224:227]
    ds_read_b64_tr_b16 v[76:77], v9 offset:41216
    buffer_load_dwordx4 a[60:63], v2, s[24:27], s63 offen offset:3072 sc1
    ds_read_b64_tr_b16 v[78:79], v9 offset:42240
    v_mfma_f32_16x16x32_bf16 v[228:231], a[244:247], v[92:95], v[228:231]
    buffer_load_dword v57, v14, s[24:27], s42 offen sc1
    s_waitcnt lgkmcnt(6)
    v_mfma_f32_16x16x32_bf16 v[200:203], a[128:131], v[64:67], v[200:203]
    ds_read_b64_tr_b16 v[80:81], v9 offset:49152
    s_add_u32 s63, s64, 40960
    ds_read_b64_tr_b16 v[82:83], v9 offset:50176
    buffer_load_dwordx4 a[64:67], v2, s[24:27], s63 offen offset:0 sc1
    v_mfma_f32_16x16x32_bf16 v[204:207], a[132:135], v[64:67], v[204:207]
    s_waitcnt lgkmcnt(6)
    v_mfma_f32_16x16x32_bf16 v[232:235], a[144:147], v[68:71], v[232:235]
    ds_read_b64_tr_b16 v[84:85], v9 offset:49408
    buffer_load_dwordx4 a[68:71], v2, s[24:27], s63 offen offset:1024 sc1
    ds_read_b64_tr_b16 v[86:87], v9 offset:50432
    v_add_f32 v53, v192, v224
    v_mfma_f32_16x16x32_bf16 v[236:239], a[148:151], v[68:71], v[236:239]
    v_add_f32 v54, v193, v225
    v_cvt_pk_bf16_f32 v16, v53, v54
    v_add_f32 v53, v194, v226
    v_add_f32 v54, v195, v227
    s_waitcnt lgkmcnt(6)
    v_mfma_f32_16x16x32_bf16 v[200:203], a[160:163], v[72:75], v[200:203]
    ds_read_b64_tr_b16 v[88:89], v9 offset:57344
    buffer_load_dwordx4 a[72:75], v2, s[24:27], s63 offen offset:2048 sc1
    ds_read_b64_tr_b16 v[90:91], v9 offset:58368
    v_cvt_pk_bf16_f32 v17, v53, v54
    v_mfma_f32_16x16x32_bf16 v[204:207], a[164:167], v[72:75], v[204:207]
    v_add_f32 v53, v196, v228
    v_add_f32 v54, v197, v229
    v_cvt_pk_bf16_f32 v18, v53, v54
    v_add_f32 v53, v198, v230
    s_waitcnt lgkmcnt(6)
    v_mfma_f32_16x16x32_bf16 v[232:235], a[176:179], v[76:79], v[232:235]
    ds_read_b64_tr_b16 v[92:93], v9 offset:57600
    buffer_load_dwordx4 a[76:79], v2, s[24:27], s63 offen offset:3072 sc1
    ds_read_b64_tr_b16 v[94:95], v9 offset:58624
    v_add_f32 v54, v199, v231
    v_mfma_f32_16x16x32_bf16 v[236:239], a[180:183], v[76:79], v[236:239]
    v_cvt_pk_bf16_f32 v19, v53, v54
    buffer_store_dwordx4 v[16:19], v50, s[24:27], s34 offen offset:0 sc1
    v_sub_f32 v53, v192, v224
    v_sub_f32 v54, v193, v225
    s_waitcnt lgkmcnt(6)
    v_mfma_f32_16x16x32_bf16 v[200:203], a[192:195], v[80:83], v[200:203]
    ds_read_b64_tr_b16 v[64:65], v10 offset:32768
    s_add_u32 s63, s64, 45056
    ds_read_b64_tr_b16 v[66:67], v10 offset:33792
    buffer_load_dwordx4 a[80:83], v2, s[24:27], s63 offen offset:0 sc1
    v_mfma_f32_16x16x32_bf16 v[204:207], a[196:199], v[80:83], v[204:207]
    v_cvt_pk_bf16_f32 v20, v53, v54
    v_sub_f32 v53, v194, v226
    v_sub_f32 v54, v195, v227
    v_cvt_pk_bf16_f32 v21, v53, v54
    s_waitcnt lgkmcnt(6)
    v_mfma_f32_16x16x32_bf16 v[232:235], a[208:211], v[84:87], v[232:235]
    ds_read_b64_tr_b16 v[68:69], v10 offset:33024
    buffer_load_dwordx4 a[84:87], v2, s[24:27], s63 offen offset:1024 sc1
    ds_read_b64_tr_b16 v[70:71], v10 offset:34048
    v_sub_f32 v53, v196, v228
    v_mfma_f32_16x16x32_bf16 v[236:239], a[212:215], v[84:87], v[236:239]
    v_sub_f32 v54, v197, v229
    v_cvt_pk_bf16_f32 v22, v53, v54
    v_sub_f32 v53, v198, v230
    v_sub_f32 v54, v199, v231
    s_waitcnt lgkmcnt(6)
    v_mfma_f32_16x16x32_bf16 v[200:203], a[224:227], v[88:91], v[200:203]
    ds_read_b64_tr_b16 v[72:73], v10 offset:40960
    buffer_load_dwordx4 a[88:91], v2, s[24:27], s63 offen offset:2048 sc1
    ds_read_b64_tr_b16 v[74:75], v10 offset:41984
    v_cvt_pk_bf16_f32 v23, v53, v54
    v_mfma_f32_16x16x32_bf16 v[204:207], a[228:231], v[88:91], v[204:207]
    buffer_store_dwordx4 v[20:23], v52, s[24:27], s34 offen offset:0 sc1
    s_waitcnt lgkmcnt(6)
    v_mfma_f32_16x16x32_bf16 v[232:235], a[240:243], v[92:95], v[232:235]
    ds_read_b64_tr_b16 v[76:77], v10 offset:41216
    buffer_load_dwordx4 a[92:95], v2, s[24:27], s63 offen offset:3072 sc1
    ds_read_b64_tr_b16 v[78:79], v10 offset:42240
    v_mfma_f32_16x16x32_bf16 v[236:239], a[244:247], v[92:95], v[236:239]
    s_waitcnt lgkmcnt(6)
    v_mfma_f32_16x16x32_bf16 v[208:211], a[128:131], v[64:67], v[208:211]
    ds_read_b64_tr_b16 v[80:81], v10 offset:49152
    ds_read_b64_tr_b16 v[82:83], v10 offset:50176
    v_mfma_f32_16x16x32_bf16 v[212:215], a[132:135], v[64:67], v[212:215]
    s_waitcnt lgkmcnt(6)
    v_mfma_f32_16x16x32_bf16 v[240:243], a[144:147], v[68:71], v[240:243]
    ds_read_b64_tr_b16 v[84:85], v10 offset:49408
    v_add_f32 v53, v200, v232
    ds_read_b64_tr_b16 v[86:87], v10 offset:50432
    v_add_f32 v54, v201, v233
    v_mfma_f32_16x16x32_bf16 v[244:247], a[148:151], v[68:71], v[244:247]
    v_cvt_pk_bf16_f32 v24, v53, v54
    v_add_f32 v53, v202, v234
    v_add_f32 v54, v203, v235
    v_cvt_pk_bf16_f32 v25, v53, v54
    s_waitcnt vmcnt(10)
    v_cmp_gt_u32 vcc, 14, v57
    s_cbranch_vccnz Lck100
Lcb101:
    s_waitcnt lgkmcnt(6)
    v_mfma_f32_16x16x32_bf16 v[208:211], a[160:163], v[72:75], v[208:211]
    ds_read_b64_tr_b16 v[88:89], v10 offset:57344
    s_add_u32 s47, s65, 0
    ds_read_b64_tr_b16 v[90:91], v10 offset:58368
    buffer_load_dwordx4 a[96:99], v2, s[24:27], s47 offen offset:0 sc1
    v_mfma_f32_16x16x32_bf16 v[212:215], a[164:167], v[72:75], v[212:215]
    v_add_f32 v53, v204, v236
    v_add_f32 v54, v205, v237
    v_cvt_pk_bf16_f32 v26, v53, v54
    v_add_f32 v53, v206, v238
    s_waitcnt lgkmcnt(6)
    v_mfma_f32_16x16x32_bf16 v[240:243], a[176:179], v[76:79], v[240:243]
    ds_read_b64_tr_b16 v[92:93], v10 offset:57600
    buffer_load_dwordx4 a[100:103], v2, s[24:27], s47 offen offset:1024 sc1
    ds_read_b64_tr_b16 v[94:95], v10 offset:58624
    v_add_f32 v54, v207, v239
    v_mfma_f32_16x16x32_bf16 v[244:247], a[180:183], v[76:79], v[244:247]
    v_cvt_pk_bf16_f32 v27, v53, v54
    buffer_store_dwordx4 v[24:27], v50, s[24:27], s34 offen offset:256 sc1
    v_sub_f32 v53, v200, v232
    v_sub_f32 v54, v201, v233
    s_waitcnt lgkmcnt(6)
    v_mfma_f32_16x16x32_bf16 v[208:211], a[192:195], v[80:83], v[208:211]
    ds_read_b64_tr_b16 v[64:65], v11 offset:32768
    s_add_u32 s63, s64, 49152
    ds_read_b64_tr_b16 v[66:67], v11 offset:33792
    buffer_load_dwordx4 a[104:107], v2, s[24:27], s63 offen offset:0 sc1
    v_mfma_f32_16x16x32_bf16 v[212:215], a[196:199], v[80:83], v[212:215]
    v_cvt_pk_bf16_f32 v28, v53, v54
    v_sub_f32 v53, v202, v234
    v_sub_f32 v54, v203, v235
    v_cvt_pk_bf16_f32 v29, v53, v54
    s_waitcnt lgkmcnt(6)
    v_mfma_f32_16x16x32_bf16 v[240:243], a[208:211], v[84:87], v[240:243]
    ds_read_b64_tr_b16 v[68:69], v11 offset:33024
    buffer_load_dwordx4 a[108:111], v2, s[24:27], s63 offen offset:1024 sc1
    ds_read_b64_tr_b16 v[70:71], v11 offset:34048
    v_sub_f32 v53, v204, v236
    v_mfma_f32_16x16x32_bf16 v[244:247], a[212:215], v[84:87], v[244:247]
    v_sub_f32 v54, v205, v237
    v_cvt_pk_bf16_f32 v30, v53, v54
    v_sub_f32 v53, v206, v238
    v_sub_f32 v54, v207, v239
    s_waitcnt lgkmcnt(6)
    v_mfma_f32_16x16x32_bf16 v[208:211], a[224:227], v[88:91], v[208:211]
    ds_read_b64_tr_b16 v[72:73], v11 offset:40960
    buffer_load_dwordx4 a[112:115], v2, s[24:27], s47 offen offset:2048 sc1
    ds_read_b64_tr_b16 v[74:75], v11 offset:41984
    v_cvt_pk_bf16_f32 v31, v53, v54
    v_mfma_f32_16x16x32_bf16 v[212:215], a[228:231], v[88:91], v[212:215]
    buffer_store_dwordx4 v[28:31], v52, s[24:27], s34 offen offset:256 sc1
    s_waitcnt lgkmcnt(6)
    v_mfma_f32_16x16x32_bf16 v[240:243], a[240:243], v[92:95], v[240:243]
    ds_read_b64_tr_b16 v[76:77], v11 offset:41216
    buffer_load_dwordx4 a[116:119], v2, s[24:27], s47 offen offset:3072 sc1
    ds_read_b64_tr_b16 v[78:79], v11 offset:42240
    v_mfma_f32_16x16x32_bf16 v[244:247], a[244:247], v[92:95], v[244:247]
    s_waitcnt lgkmcnt(6)
    v_mfma_f32_16x16x32_bf16 v[216:219], a[128:131], v[64:67], v[216:219]
    ds_read_b64_tr_b16 v[80:81], v11 offset:49152
    s_add_u32 s63, s64, 49152
    ds_read_b64_tr_b16 v[82:83], v11 offset:50176
    buffer_load_dwordx4 a[120:123], v2, s[24:27], s63 offen offset:2048 sc1
    v_mfma_f32_16x16x32_bf16 v[220:223], a[132:135], v[64:67], v[220:223]
    s_waitcnt lgkmcnt(6)
    v_mfma_f32_16x16x32_bf16 v[248:251], a[144:147], v[68:71], v[248:251]
    ds_read_b64_tr_b16 v[84:85], v11 offset:49408
    buffer_load_dwordx4 a[124:127], v2, s[24:27], s63 offen offset:3072 sc1
    ds_read_b64_tr_b16 v[86:87], v11 offset:50432
    v_add_f32 v53, v208, v240
    v_mfma_f32_16x16x32_bf16 v[252:255], a[148:151], v[68:71], v[252:255]
    v_add_f32 v54, v209, v241
    v_cvt_pk_bf16_f32 v32, v53, v54
    v_add_f32 v53, v210, v242
    v_add_f32 v54, v211, v243
    s_waitcnt lgkmcnt(6)
    v_mfma_f32_16x16x32_bf16 v[216:219], a[160:163], v[72:75], v[216:219]
    ds_read_b64_tr_b16 v[88:89], v11 offset:57344
    s_add_u32 s47, s65, 4096
    ds_read_b64_tr_b16 v[90:91], v11 offset:58368
    buffer_load_dwordx4 a[128:131], v2, s[24:27], s47 offen offset:0 sc1
    v_mfma_f32_16x16x32_bf16 v[220:223], a[164:167], v[72:75], v[220:223]
    v_cvt_pk_bf16_f32 v33, v53, v54
    v_add_f32 v53, v212, v244
    v_add_f32 v54, v213, v245
    v_cvt_pk_bf16_f32 v34, v53, v54
    s_waitcnt lgkmcnt(6)
    v_mfma_f32_16x16x32_bf16 v[248:251], a[176:179], v[76:79], v[248:251]
    ds_read_b64_tr_b16 v[92:93], v11 offset:57600
    buffer_load_dwordx4 a[132:135], v2, s[24:27], s47 offen offset:1024 sc1
    ds_read_b64_tr_b16 v[94:95], v11 offset:58624
    v_add_f32 v53, v214, v246
    v_mfma_f32_16x16x32_bf16 v[252:255], a[180:183], v[76:79], v[252:255]
    v_add_f32 v54, v215, v247
    v_cvt_pk_bf16_f32 v35, v53, v54
    buffer_store_dwordx4 v[32:35], v50, s[24:27], s35 offen offset:0 sc1
    v_sub_f32 v53, v208, v240
    s_waitcnt lgkmcnt(6)
    v_mfma_f32_16x16x32_bf16 v[216:219], a[192:195], v[80:83], v[216:219]
    s_add_u32 s63, s64, 53248
    buffer_load_dwordx4 a[136:139], v2, s[24:27], s63 offen offset:0 sc1
    v_sub_f32 v54, v209, v241
    v_cvt_pk_bf16_f32 v36, v53, v54
    v_mfma_f32_16x16x32_bf16 v[220:223], a[196:199], v[80:83], v[220:223]
    v_sub_f32 v53, v210, v242
    v_sub_f32 v54, v211, v243
    v_cvt_pk_bf16_f32 v37, v53, v54
    v_sub_f32 v53, v212, v244
    s_waitcnt lgkmcnt(4)
    v_mfma_f32_16x16x32_bf16 v[248:251], a[208:211], v[84:87], v[248:251]
    buffer_load_dwordx4 a[140:143], v2, s[24:27], s63 offen offset:1024 sc1
    v_sub_f32 v54, v213, v245
    v_cvt_pk_bf16_f32 v38, v53, v54
    v_sub_f32 v53, v214, v246
    v_mfma_f32_16x16x32_bf16 v[252:255], a[212:215], v[84:87], v[252:255]
    v_sub_f32 v54, v215, v247
    v_cvt_pk_bf16_f32 v39, v53, v54
    buffer_store_dwordx4 v[36:39], v52, s[24:27], s35 offen offset:0 sc1
    s_waitcnt lgkmcnt(2)
    v_mfma_f32_16x16x32_bf16 v[216:219], a[224:227], v[88:91], v[216:219]
    buffer_load_dwordx4 a[144:147], v2, s[24:27], s47 offen offset:2048 sc1
    v_mfma_f32_16x16x32_bf16 v[220:223], a[228:231], v[88:91], v[220:223]
    s_waitcnt lgkmcnt(0)
    v_mfma_f32_16x16x32_bf16 v[248:251], a[240:243], v[92:95], v[248:251]
    buffer_load_dwordx4 a[148:151], v2, s[24:27], s47 offen offset:3072 sc1
    v_mfma_f32_16x16x32_bf16 v[252:255], a[244:247], v[92:95], v[252:255]
    s_nop 5
    v_add_f32 v53, v216, v248
    v_add_f32 v54, v217, v249
    v_cvt_pk_bf16_f32 v40, v53, v54
    v_add_f32 v53, v218, v250
    v_add_f32 v54, v219, v251
    v_cvt_pk_bf16_f32 v41, v53, v54
    v_add_f32 v53, v220, v252
    v_add_f32 v54, v221, v253
    v_cvt_pk_bf16_f32 v42, v53, v54
    v_add_f32 v53, v222, v254
    v_add_f32 v54, v223, v255
    v_cvt_pk_bf16_f32 v43, v53, v54
    buffer_store_dwordx4 v[40:43], v50, s[24:27], s35 offen offset:256 sc1
    v_sub_f32 v53, v216, v248
    v_sub_f32 v54, v217, v249
    v_cvt_pk_bf16_f32 v44, v53, v54
    v_sub_f32 v53, v218, v250
    v_sub_f32 v54, v219, v251
    v_cvt_pk_bf16_f32 v45, v53, v54
    v_sub_f32 v53, v220, v252
    v_sub_f32 v54, v221, v253
    v_cvt_pk_bf16_f32 v46, v53, v54
    v_sub_f32 v53, v222, v254
    v_sub_f32 v54, v223, v255
    v_cvt_pk_bf16_f32 v47, v53, v54
    buffer_store_dwordx4 v[44:47], v52, s[24:27], s35 offen offset:256 sc1
    s_add_u32 s63, s64, 53248
    buffer_load_dwordx4 a[152:155], v2, s[24:27], s63 offen offset:2048 sc1
    buffer_load_dwordx4 a[156:159], v2, s[24:27], s63 offen offset:3072 sc1
    s_add_u32 s47, s65, 8192
    buffer_load_dwordx4 a[160:163], v2, s[24:27], s47 offen offset:0 sc1
    buffer_load_dwordx4 a[164:167], v2, s[24:27], s47 offen offset:1024 sc1
    buffer_load_dwordx4 a[168:171], v2, s[24:27], s47 offen offset:2048 sc1
    buffer_load_dwordx4 a[172:175], v2, s[24:27], s47 offen offset:3072 sc1
    s_add_u32 s47, s65, 12288
    buffer_load_dwordx4 a[176:179], v2, s[24:27], s47 offen offset:0 sc1
    buffer_load_dwordx4 a[180:183], v2, s[24:27], s47 offen offset:1024 sc1
    s_waitcnt vmcnt(8)
    s_mov_b32 s36, 0x4000000
    s_mov_b64 exec, 1
    buffer_atomic_add v15, v14, s[24:27], s36 offen sc1
    s_mov_b64 exec, -1
    s_barrier
    s_mov_b64 exec, 1
    buffer_atomic_add v15, v14, s[24:27], s41 offen sc1
    s_mov_b64 exec, -1
    s_branch Lg1j39
Lsr86:
    s_mov_b32 m0, 0
Lsp88:
    s_sleep 2
    s_add_u32 s60, s58, 0
    buffer_load_dwordx4 v[224:227], v13, s[24:27], s60 offen sc1
    s_add_u32 s60, s58, 32768
    buffer_load_dwordx4 v[228:231], v51, s[24:27], s60 offen sc1
    s_add_u32 s60, s58, 262144
    buffer_load_dwordx4 v[232:235], v13, s[24:27], s60 offen sc1
    s_add_u32 s60, s58, 294912
    buffer_load_dwordx4 v[236:239], v51, s[24:27], s60 offen sc1
    s_add_u32 s60, s58, 524288
    buffer_load_dwordx4 v[240:243], v13, s[24:27], s60 offen sc1
    s_add_u32 s60, s58, 557056
    buffer_load_dwordx4 v[244:247], v51, s[24:27], s60 offen sc1
    s_add_u32 s60, s58, 786432
    buffer_load_dwordx4 v[248:251], v13, s[24:27], s60 offen sc1
    s_add_u32 s60, s58, 819200
    buffer_load_dwordx4 v[252:255], v51, s[24:27], s60 offen sc1
    s_waitcnt vmcnt(0)
    v_max3_u32 v58, v224, v225, v226
    v_max3_u32 v58, v58, v227, v228
    v_max3_u32 v58, v58, v229, v230
    v_max_u32 v58, v58, v231
    v_cmp_eq_u32 vcc, -1, v58
    s_cbranch_vccz Lsx89
    s_add_u32 m0, m0, 1
    s_cmp_lt_u32 m0, 200
    s_cbranch_scc1 Lsp88
    s_mov_b64 exec, -1
    s_mov_b64 exec, 0xffff
    s_mov_b32 m0, 0
Lpl102:
    buffer_load_dword v7, v59, s[24:27], s15 offen sc1
    s_waitcnt vmcnt(0)
    v_cmp_gt_u32 vcc, 16, v7
    s_cbranch_vccz Lpx103
    s_sleep 4
    s_add_u32 m0, m0, 1
    s_cmp_lt_u32 m0, 400000
    s_cbranch_scc1 Lpl102
Lpx103:
    s_mov_b64 exec, -1
    s_add_u32 s60, s58, 0
    buffer_load_dwordx4 v[224:227], v13, s[24:27], s60 offen sc1
    s_add_u32 s60, s58, 32768
    buffer_load_dwordx4 v[228:231], v51, s[24:27], s60 offen sc1
    s_waitcnt vmcnt(0)
Lsx89:
    s_mov_b64 exec, -1
    s_branch Lsb87
Lsr90:
    s_mov_b32 m0, 0
Lsp92:
    s_mov_b64 exec, vcc
    s_sleep 2
    s_add_u32 s60, s58, 262144
    buffer_load_dwordx4 v[232:235], v13, s[24:27], s60 offen sc1
    s_add_u32 s60, s58, 294912
    buffer_load_dwordx4 v[236:239], v51, s[24:27], s60 offen sc1
    s_waitcnt vmcnt(0)
    v_max3_u32 v58, v232, v233, v234
    v_max3_u32 v58, v58, v235, v236
    v_max3_u32 v58, v58, v237, v238
    v_max_u32 v58, v58, v239
    v_cmp_eq_u32 vcc, -1, v58
    s_cbranch_vccz Lsx93
    s_add_u32 m0, m0, 1
    s_cmp_lt_u32 m0, 200
    s_cbranch_scc1 Lsp92
    s_mov_b64 exec, -1
    s_mov_b64 exec, 0xffff
    s_mov_b32 m0, 0
Lpl104:
    buffer_load_dword v7, v59, s[24:27], s15 offen sc1
    s_waitcnt vmcnt(0)
    v_cmp_gt_u32 vcc, 16, v7
    s_cbranch_vccz Lpx105
    s_sleep 4
    s_add_u32 m0, m0, 1
    s_cmp_lt_u32 m0, 400000
    s_cbranch_scc1 Lpl104
Lpx105:
    s_mov_b64 exec, -1
    s_add_u32 s60, s58, 262144
    buffer_load_dwordx4 v[232:235], v13, s[24:27], s60 offen sc1
    s_add_u32 s60, s58, 294912
    buffer_load_dwordx4 v[236:239], v51, s[24:27], s60 offen sc1
    s_waitcnt vmcnt(0)
Lsx93:
    s_mov_b64 exec, -1
    s_branch Lsb91
Lsr94:
    s_mov_b32 m0, 0
Lsp96:
    s_mov_b64 exec, vcc
    s_sleep 2
    s_add_u32 s60, s58, 524288
    buffer_load_dwordx4 v[240:243], v13, s[24:27], s60 offen sc1
    s_add_u32 s60, s58, 557056
    buffer_load_dwordx4 v[244:247], v51, s[24:27], s60 offen sc1
    s_add_u32 s60, s58, 786432
    buffer_load_dwordx4 v[248:251], v13, s[24:27], s60 offen sc1
    s_add_u32 s60, s58, 819200
    buffer_load_dwordx4 v[252:255], v51, s[24:27], s60 offen sc1
    s_waitcnt vmcnt(0)
    v_max3_u32 v58, v240, v241, v242
    v_max3_u32 v58, v58, v243, v244
    v_max3_u32 v58, v58, v245, v246
    v_max3_u32 v58, v58, v247, v248
    v_max3_u32 v58, v58, v249, v250
    v_max3_u32 v58, v58, v251, v252
    v_max3_u32 v58, v58, v253, v254
    v_max_u32 v58, v58, v255
    v_cmp_eq_u32 vcc, -1, v58
    s_cbranch_vccz Lsx97
    s_add_u32 m0, m0, 1
    s_cmp_lt_u32 m0, 200
    s_cbranch_scc1 Lsp96
    s_mov_b64 exec, -1
    s_mov_b64 exec, 0xffff
    s_mov_b32 m0, 0
Lpl106:
    buffer_load_dword v7, v59, s[24:27], s15 offen sc1
    s_waitcnt vmcnt(0)
    v_cmp_gt_u32 vcc, 16, v7
    s_cbranch_vccz Lpx107
    s_sleep 4
    s_add_u32 m0, m0, 1
    s_cmp_lt_u32 m0, 400000
    s_cbranch_scc1 Lpl106
Lpx107:
    s_mov_b64 exec, -1
    s_add_u32 s60, s58, 524288
    buffer_load_dwordx4 v[240:243], v13, s[24:27], s60 offen sc1
    s_add_u32 s60, s58, 557056
    buffer_load_dwordx4 v[244:247], v51, s[24:27], s60 offen sc1
    s_add_u32 s60, s58, 786432
    buffer_load_dwordx4 v[248:251], v13, s[24:27], s60 offen sc1
    s_add_u32 s60, s58, 819200
    buffer_load_dwordx4 v[252:255], v51, s[24:27], s60 offen sc1
    s_waitcnt vmcnt(0)
Lsx97:
    s_mov_b64 exec, -1
    s_branch Lsb95
Lgk98:
    s_mov_b64 exec, 0xffff
    s_mov_b32 m0, 0
Lpl108:
    buffer_load_dword v7, v59, s[24:27], s15 offen sc1
    s_waitcnt vmcnt(0)
    v_cmp_gt_u32 vcc, 16, v7
    s_cbranch_vccz Lpx109
    s_sleep 4
    s_add_u32 m0, m0, 1
    s_cmp_lt_u32 m0, 400000
    s_cbranch_scc1 Lpl108
Lpx109:
    s_mov_b64 exec, -1
    s_branch Lgb99
Lck100:
    s_mov_b64 exec, 0x1
    s_mov_b32 m0, 0
Lpl110:
    buffer_load_dword v7, v14, s[24:27], s42 offen sc1
    s_waitcnt vmcnt(0)
    v_cmp_gt_u32 vcc, 14, v7
    s_cbranch_vccz Lpx111
    s_sleep 16
    s_add_u32 m0, m0, 1
    s_cmp_lt_u32 m0, 400000
    s_cbranch_scc1 Lpl110
Lpx111:
    s_mov_b64 exec, -1
    s_branch Lcb101
Lend:
    s_endpgm
.p2align 8
.type Ltab,@object
Ltab:
.quad 0x3f803f803f803f80,0x3f803f803f803f80,0x3f753f7b3f7f3f80,0xbe95be48bdc9248d,0x3f553f6d3f7b3f80,0xbf55bf6dbf7bbf80,0x3f223f553f753f80,0x3f463f0e3e95a554
.quad 0x3ec43f353f6d3f80,0x3ec43f353f6d3f80,0x3dc93f0e3f623f80,0xbf7fbf55bef1248d,0xbe483ec43f553f80,0x3e48bec4bf55bf80,0xbef13e483f463f80,0x3f623f7b3f22a554
.quad 0xbf35248d3f353f80,0xbf35248d3f353f80,0xbf62be483f223f80,0xbef1bf7bbf46248d,0xbf7bbec43f0e3f80,0x3f7b3ec4bf0ebf80,0xbf7fbf0e3ef13f80,0xbdc93f553f62a554
.quad 0xbf6dbf353ec43f80,0xbf6dbf353ec43f80,0xbf46bf553e953f80,0x3f22bf0ebf75248d,0xbf0ebf6d3e483f80,0x3f0e3f6dbe48bf80,0xbe95bf7b3dc93f80,0xbf753e483f7fa554
.quad 0x3f803f803f803f80,0x3f803f803f803f80,0x3f463f553f623f6d,0xbf22bf0ebef1bec4,0x3e483ec43f0e3f35,0xbe48bec4bf0ebf35,0xbef1be483dc93ec4,0x3f623f7b3f7f3f6d
.quad 0xbf6dbf35bec4248d,0xbf6dbf35bec4248d,0xbf75bf7bbf46bec4,0x3e95be48bf22bf6d,0xbf0ebf6dbf7bbf35,0x3f0e3f6d3f7b3f35,0x3dc9bf0ebf75bf6d,0xbf7fbf55be953ec4
.quad 0x3f35a554bf35bf80,0x3f35a554bf35bf80,0x3f7f3f0ebe95bf6d,0x3dc93f553f753ec4,0x3f553f6d3e48bf35,0xbf55bf6dbe483f35,0x3e953f7b3f22bec4,0x3f753e48bf46bf6d
.quad 0xbec43f353f6da554,0xbec43f353f6da554,0xbf623e483f7f3ec4,0xbef1bf7bbdc93f6d,0xbf7bbec43f553f35,0x3f7b3ec4bf55bf35,0xbf22bf553ef13f6d,0xbf463f0e3f62bec4
.quad 0x3f803f803f803f80,0x3f803f803f803f80,0x3ef13f0e3f223f35,0xbf62bf55bf46bf35,0xbf0ebec4be48248d,0x3f0e3ec43e48a554,0xbf7fbf7bbf62bf35,0xbdc93e483ef13f35
.quad 0xbec4bf35bf6dbf80,0xbec4bf35bf6dbf80,0x3f223e48be95bf35,0x3f463f7b3f753f35,0x3f7b3f6d3f0ea554,0xbf7bbf6dbf0e248d,0x3e953f553f7f3f35,0x3f753f0ebdc9bf35
.quad 0xbf35248d3f353f80,0xbf35248d3f353f80,0xbf75bf55bdc93f35,0x3e95bf0ebf7fbf35,0xbe48bf6dbf55248d,0x3e483f6d3f55a554,0x3f46be48bf75bf35,0xbf22bf7bbe953f35
.quad 0x3f6d3f35bec4bf80,0x3f6d3f35bec4bf80,0x3dc93f7b3ef1bf35,0xbf7fbe483f623f35,0xbf553ec43f7ba554,0x3f55bec4bf7b248d,0xbf62bf0e3f463f35,0xbef13f553f22bf35
.quad 0x3f803f803f803f80,0x3f803f803f803f80,0x3dc93e483e953ec4,0xbf7fbf7bbf75bf6d,0xbf7bbf6dbf55bf35,0x3f7b3f6d3f553f35,0xbe95bf0ebf46bf6d,0xbf75bf55bf22bec4
.quad 0x3f6d3f353ec4a554,0x3f6d3f353ec4a554,0x3ef13f553f7f3f6d,0xbf62bf0ebdc93ec4,0xbf55bec43e483f35,0x3f553ec4be48bf35,0xbf22bf7bbf62bec4,0xbf46be483ef13f6d
.quad 0x3f35a554bf35bf80,0x3f35a554bf35bf80,0x3f463f7b3ef1bec4,0xbf223e483f623f6d,0xbf0e3ec43f7b3f35,0x3f0ebec4bf7bbf35,0xbf62bf553dc93f6d,0xbef13f0e3f7f3ec4
.quad 0x3ec4bf35bf6d248d,0x3ec4bf35bf6d248d,0x3f753f0ebf22bf6d,0xbe953f553f46bec4,0xbe483f6d3f0ebf35,0x3e48bf6dbf0e3f35,0xbf7fbe483f753ec4,0xbdc93f7b3e95bf6d
.quad 0x3f803f803f803f80,0x3f803f803f803f80,0xbf75bf7bbf7fbf80,0x3e953e483dc9a554,0x3f553f6d3f7b3f80,0xbf55bf6dbf7bbf80,0xbf22bf55bf75bf80,0xbf46bf0ebe95248d
.quad 0x3ec43f353f6d3f80,0x3ec43f353f6d3f80,0xbdc9bf0ebf62bf80,0x3f7f3f553ef1a554,0xbe483ec43f553f80,0x3e48bec4bf55bf80,0x3ef1be48bf46bf80,0xbf62bf7bbf22248d
.quad 0xbf35248d3f353f80,0xbf35248d3f353f80,0x3f623e48bf22bf80,0x3ef13f7b3f46a554,0xbf7bbec43f0e3f80,0x3f7b3ec4bf0ebf80,0x3f7f3f0ebef1bf80,0x3dc9bf55bf62248d
.quad 0xbf6dbf353ec43f80,0xbf6dbf353ec43f80,0x3f463f55be95bf80,0xbf223f0e3f75a554,0xbf0ebf6d3e483f80,0x3f0e3f6dbe48bf80,0x3e953f7bbdc9bf80,0x3f75be48bf7f248d
.quad 0x3f803f803f803f80,0x3f803f803f803f80,0xbf46bf55bf62bf6d,0x3f223f0e3ef13ec4,0x3e483ec43f0e3f35,0xbe48bec4bf0ebf35,0x3ef13e48bdc9bec4,0xbf62bf7bbf7fbf6d
.quad 0xbf6dbf35bec4248d,0xbf6dbf35bec4248d,0x3f753f7b3f463ec4,0xbe953e483f223f6d,0xbf0ebf6dbf7bbf35,0x3f0e3f6d3f7b3f35,0xbdc93f0e3f753f6d,0x3f7f3f553e95bec4
.quad 0x3f35a554bf35bf80,0x3f35a554bf35bf80,0xbf7fbf0e3e953f6d,0xbdc9bf55bf75bec4,0x3f553f6d3e48bf35,0xbf55bf6dbe483f35,0xbe95bf7bbf223ec4,0xbf75be483f463f6d
.quad 0xbec43f353f6da554,0xbec43f353f6da554,0x3f62be48bf7fbec4,0x3ef13f7b3dc9bf6d,0xbf7bbec43f553f35,0x3f7b3ec4bf55bf35,0x3f223f55bef1bf6d,0x3f46bf0ebf623ec4
.quad 0x3f803f803f803f80,0x3f803f803f803f80,0xbef1bf0ebf22bf35,0x3f623f553f463f35,0xbf0ebec4be48248d,0x3f0e3ec43e48a554,0x3f7f3f7b3f623f35,0x3dc9be48bef1bf35
.quad 0xbec4bf35bf6dbf80,0xbec4bf35bf6dbf80,0xbf22be483e953f35,0xbf46bf7bbf75bf35,0x3f7b3f6d3f0ea554,0xbf7bbf6dbf0e248d,0xbe95bf55bf7fbf35,0xbf75bf0e3dc93f35
.quad 0xbf35248d3f353f80,0xbf35248d3f353f80,0x3f753f553dc9bf35,0xbe953f0e3f7f3f35,0xbe48bf6dbf55248d,0x3e483f6d3f55a554,0xbf463e483f753f35,0x3f223f7b3e95bf35
.quad 0x3f6d3f35bec4bf80,0x3f6d3f35bec4bf80,0xbdc9bf7bbef13f35,0x3f7f3e48bf62bf35,0xbf553ec43f7ba554,0x3f55bec4bf7b248d,0x3f623f0ebf46bf35,0x3ef1bf55bf223f35
.quad 0x3f803f803f803f80,0x3f803f803f803f80,0xbdc9be48be95bec4,0x3f7f3f7b3f753f6d,0xbf7bbf6dbf55bf35,0x3f7b3f6d3f553f35,0x3e953f0e3f463f6d,0x3f753f553f223ec4
.quad 0x3f6d3f353ec4a554,0x3f6d3f353ec4a554,0xbef1bf55bf7fbf6d,0x3f623f0e3dc9bec4,0xbf55bec43e483f35,0x3f553ec4be48bf35,0x3f223f7b3f623ec4,0x3f463e48bef1bf6d
.quad 0x3f35a554bf35bf80,0x3f35a554bf35bf80,0xbf46bf7bbef13ec4,0x3f22be48bf62bf6d,0xbf0e3ec43f7b3f35,0x3f0ebec4bf7bbf35,0x3f623f55bdc9bf6d,0x3ef1bf0ebf7fbec4
.quad 0x3ec4bf35bf6d248d,0x3ec4bf35bf6d248d,0xbf75bf0e3f223f6d,0x3e95bf55bf463ec4,0xbe483f6d3f0ebf35,0x3e48bf6dbf0e3f35,0x3f7f3e48bf75bec4,0x3dc9bf7bbe953f6d
.quad 0x8000800080008000,0x8000800080008000,0xbe95be48bdc98000,0xbf75bf7bbf7fbf80,0xbf0ebec4be488000,0x3f0e3ec43e48a50d,0xbf46bf0ebe958000,0x3f223f553f753f80
.quad 0xbf6dbf35bec48000,0xbf6dbf35bec48000,0xbf7fbf55bef18000,0xbdc9bf0ebf62bf80,0xbf7bbf6dbf0e8000,0x3f7b3f6d3f0ea50d,0xbf62bf7bbf228000,0xbef13e483f463f80
.quad 0xbf35bf80bf358000,0xbf35bf80bf358000,0xbef1bf7bbf468000,0x3f623e48bf22bf80,0xbe48bf6dbf558000,0x3e483f6d3f55a50d,0x3dc9bf55bf628000,0xbf7fbf0e3ef13f80
.quad 0x3ec4bf35bf6d8000,0x3ec4bf35bf6d8000,0x3f22bf0ebf758000,0x3f463f55be95bf80,0x3f55bec4bf7b8000,0xbf553ec43f7ba50d,0x3f75be48bf7f8000,0xbe95bf7b3dc93f80
.quad 0x8000800080008000,0x8000800080008000,0xbf22bf0ebef1bec4,0xbf46bf55bf62bf6d,0xbf7bbf6dbf55bf35,0x3f7b3f6d3f553f35,0xbf62bf7bbf7fbf6d,0xbef1be483dc93ec4
.quad 0xbec4bf35bf6dbf80,0xbec4bf35bf6dbf80,0x3e95be48bf22bf6d,0x3f753f7b3f463ec4,0x3f553ec4be48bf35,0xbf55bec43e483f35,0x3f7f3f553e95bec4,0x3dc9bf0ebf75bf6d
.quad 0x3f353f803f35a50d,0x3f353f803f35a50d,0x3dc93f553f753ec4,0xbf7fbf0e3e953f6d,0xbf0e3ec43f7b3f35,0x3f0ebec4bf7bbf35,0xbf75be483f463f6d,0x3e953f7b3f22bec4
.quad 0xbf6dbf353ec43f80,0xbf6dbf353ec43f80,0xbef1bf7bbdc93f6d,0x3f62be48bf7fbec4,0x3e48bf6dbf0e3f35,0xbe483f6d3f0ebf35,0x3f46bf0ebf623ec4,0xbf22bf553ef13f6d
.quad 0x8000800080008000,0x8000800080008000,0xbf62bf55bf46bf35,0xbef1bf0ebf22bf35,0xbf55bf6dbf7bbf80,0x3f553f6d3f7b3f80,0x3dc9be48bef1bf35,0xbf7fbf7bbf62bf35
.quad 0x3f6d3f353ec4a50d,0x3f6d3f353ec4a50d,0x3f463f7b3f753f35,0xbf22be483e953f35,0xbe483ec43f553f80,0x3e48bec4bf55bf80,0xbf75bf0e3dc93f35,0x3e953f553f7f3f35
.quad 0xbf35bf80bf358000,0xbf35bf80bf358000,0x3e95bf0ebf7fbf35,0x3f753f553dc9bf35,0x3f7b3ec4bf0ebf80,0xbf7bbec43f0e3f80,0x3f223f7b3e95bf35,0x3f46be48bf75bf35
.quad 0xbec43f353f6da50d,0xbec43f353f6da50d,0xbf7fbe483f623f35,0xbdc9bf7bbef13f35,0xbf0ebf6d3e483f80,0x3f0e3f6dbe48bf80,0x3ef1bf55bf223f35,0xbf62bf0e3f463f35
.quad 0x8000800080008000,0x8000800080008000,0xbf7fbf7bbf75bf6d,0xbdc9be48be95bec4,0xbe48bec4bf0ebf35,0x3e483ec43f0e3f35,0x3f753f553f223ec4,0xbe95bf0ebf46bf6d
.quad 0x3ec43f353f6d3f80,0x3ec43f353f6d3f80,0xbf62bf0ebdc93ec4,0xbef1bf55bf7fbf6d,0xbf0ebf6dbf7bbf35,0x3f0e3f6d3f7b3f35,0x3f463e48bef1bf6d,0xbf22bf7bbf62bec4
.quad 0x3f353f803f35a50d,0x3f353f803f35a50d,0xbf223e483f623f6d,0xbf46bf7bbef13ec4,0xbf55bf6dbe483f35,0x3f553f6d3e48bf35,0x3ef1bf0ebf7fbec4,0xbf62bf553dc93f6d
.quad 0x3f6d3f35bec4bf80,0x3f6d3f35bec4bf80,0xbe953f553f46bec4,0xbf75bf0e3f223f6d,0xbf7bbec43f553f35,0x3f7b3ec4bf55bf35,0x3dc9bf7bbe953f6d,0xbf7fbe483f753ec4
.quad 0x8000800080008000,0x8000800080008000,0x3e953e483dc9a50d,0x3f753f7b3f7f3f80,0xbf0ebec4be488000,0x3f0e3ec43e48a50d,0x3f463f0e3e95a50d,0xbf22bf55bf75bf80
.quad 0xbf6dbf35bec48000,0xbf6dbf35bec48000,0x3f7f3f553ef1a50d,0x3dc93f0e3f623f80,0xbf7bbf6dbf0e8000,0x3f7b3f6d3f0ea50d,0x3f623f7b3f22a50d,0x3ef1be48bf46bf80
.quad 0xbf35bf80bf358000,0xbf35bf80bf358000,0x3ef13f7b3f46a50d,0xbf62be483f223f80,0xbe48bf6dbf558000,0x3e483f6d3f55a50d,0xbdc93f553f62a50d,0x3f7f3f0ebef1bf80
.quad 0x3ec4bf35bf6d8000,0x3ec4bf35bf6d8000,0xbf223f0e3f75a50d,0xbf46bf553e953f80,0x3f55bec4bf7b8000,0xbf553ec43f7ba50d,0xbf753e483f7fa50d,0x3e953f7bbdc9bf80
.quad 0x8000800080008000,0x8000800080008000,0x3f223f0e3ef13ec4,0x3f463f553f623f6d,0xbf7bbf6dbf55bf35,0x3f7b3f6d3f553f35,0x3f623f7b3f7f3f6d,0x3ef13e48bdc9bec4
.quad 0xbec4bf35bf6dbf80,0xbec4bf35bf6dbf80,0xbe953e483f223f6d,0xbf75bf7bbf46bec4,0x3f553ec4be48bf35,0xbf55bec43e483f35,0xbf7fbf55be953ec4,0xbdc93f0e3f753f6d
.quad 0x3f353f803f35a50d,0x3f353f803f35a50d,0xbdc9bf55bf75bec4,0x3f7f3f0ebe95bf6d,0xbf0e3ec43f7b3f35,0x3f0ebec4bf7bbf35,0x3f753e48bf46bf6d,0xbe95bf7bbf223ec4
.quad 0xbf6dbf353ec43f80,0xbf6dbf353ec43f80,0x3ef13f7b3dc9bf6d,0xbf623e483f7f3ec4,0x3e48bf6dbf0e3f35,0xbe483f6d3f0ebf35,0xbf463f0e3f62bec4,0x3f223f55bef1bf6d
.quad 0x8000800080008000,0x8000800080008000,0x3f623f553f463f35,0x3ef13f0e3f223f35,0xbf55bf6dbf7bbf80,0x3f553f6d3f7b3f80,0xbdc93e483ef13f35,0x3f7f3f7b3f623f35
.quad 0x3f6d3f353ec4a50d,0x3f6d3f353ec4a50d,0xbf46bf7bbf75bf35,0x3f223e48be95bf35,0xbe483ec43f553f80,0x3e48bec4bf55bf80,0x3f753f0ebdc9bf35,0xbe95bf55bf7fbf35
.quad 0xbf35bf80bf358000,0xbf35bf80bf358000,0xbe953f0e3f7f3f35,0xbf75bf55bdc93f35,0x3f7b3ec4bf0ebf80,0xbf7bbec43f0e3f80,0xbf22bf7bbe953f35,0xbf463e483f753f35
.quad 0xbec43f353f6da50d,0xbec43f353f6da50d,0x3f7f3e48bf62bf35,0x3dc93f7b3ef1bf35,0xbf0ebf6d3e483f80,0x3f0e3f6dbe48bf80,0xbef13f553f22bf35,0x3f623f0ebf46bf35
.quad 0x8000800080008000,0x8000800080008000,0x3f7f3f7b3f753f6d,0x3dc93e483e953ec4,0xbe48bec4bf0ebf35,0x3e483ec43f0e3f35,0xbf75bf55bf22bec4,0x3e953f0e3f463f6d
.quad 0x3ec43f353f6d3f80,0x3ec43f353f6d3f80,0x3f623f0e3dc9bec4,0x3ef13f553f7f3f6d,0xbf0ebf6dbf7bbf35,0x3f0e3f6d3f7b3f35,0xbf46be483ef13f6d,0x3f223f7b3f623ec4
.quad 0x3f353f803f35a50d,0x3f353f803f35a50d,0x3f22be48bf62bf6d,0x3f463f7b3ef1bec4,0xbf55bf6dbe483f35,0x3f553f6d3e48bf35,0xbef13f0e3f7f3ec4,0x3f623f55bdc9bf6d
.quad 0x3f6d3f35bec4bf80,0x3f6d3f35bec4bf80,0x3e95bf55bf463ec4,0x3f753f0ebf22bf6d,0xbf7bbec43f553f35,0x3f7b3ec4bf55bf35,0xbdc93f7b3e95bf6d,0x3f7f3e48bf75bec4
.quad 0x3f8000003f800000,0x3f8000003f800000,0x3f7fffb13f800000,0x3f7ffd393f7ffec4,0x3f7ffec43f800000,0x3f7ff4e63f7ffb11,0x3f7ffd393f800000,0x3f7fe7053f7ff4e6
.quad 0x3f7ffb113f800000,0x3f7fd3973f7fec43,0x3f7ff84a3f800000,0x3f7fba9e3f7fe129,0x3f7ff4e63f800000,0x3f7f9c183f7fd397,0x3f7ff0e33f800000,0x3f7f78083f7fc38f
.quad 0x3f7fec433f800000,0x3f7f4e6d3f7fb10f,0x3f7fe7053f800000,0x3f7f1f493f7f9c18,0x3f7fe1293f800000,0x3f7eea9d3f7f84ab,0x3f7fdaaf3f800000,0x3f7eb0693f7f6ac7
.quad 0x3f7fd3973f800000,0x3f7e70b03f7f4e6d,0x3f7fcbe23f800000,0x3f7e2b723f7f2f9d,0x3f7fc38f3f800000,0x3f7de0b13f7f0e58,0x3f7fba9e3f800000,0x3f7d906e3f7eea9d
.quad 0x3f8000003f800000,0x3f8000003f800000,0x3f7ff84a3f7ffb11,0x3f7ff0e33f7ff4e6,0x3f7fe1293f7fec43,0x3f7fc38f3f7fd397,0x3f7fba9e3f7fd397,0x3f7f78083f7f9c18
.quad 0x3f7f84ab3f7fb10f,0x3f7f0e583f7f4e6d,0x3f7f3f543f7f84ab,0x3f7e868b3f7eea9d,0x3f7eea9d3f7f4e6d,0x3f7de0b13f7e70b0,0x3f7e868b3f7f0e58,0x3f7d1cdd3f7de0b1
.quad 0x3f7e13243f7ec46d,0x3f7c3b283f7d3aac,0x3f7d906e3f7e70b0,0x3f7b3bab3f7c7eb0,0x3f7cfe733f7e1324,0x3f7a1e843f7baccd,0x3f7c5d3a3f7dabcc,0x3f78e3d63f7ac516
.quad 0x3f7baccd3f7d3aac,0x3f778bc53f79c79d,0x3f7aed373f7cbfc9,0x3f76167a3f78b47b,0x3f7a1e843f7c3b28,0x3f7484223f778bc5,0x3f7940c03f7baccd,0x3f72d4eb3f764d97
.quad 0x3f8000003f800000,0x3f8000003f800000,0x3f7fe7053f7fec43,0x3f7fdaaf3f7fe129,0x3f7f9c183f7fb10f,0x3f7f6ac73f7f84ab,0x3f7f1f493f7f4e6d,0x3f7eb0693f7eea9d
.quad 0x3f7e70b03f7ec46d,0x3f7dabcc3f7e1324,0x3f7d906e3f7e1324,0x3f7c5d3a3f7cfe73,0x3f7c7eb03f7d3aac,0x3f7ac5163f7baccd,0x3f7b3bab3f7c3b28,0x3f78e3d63f7a1e84
.quad 0x3f79c79d3f7b14be,0x3f76ba073f7853f8,0x3f7822d13f79c79d,0x3f74484b3f764d97,0x3f764d973f7853f8,0x3f718f573f740bdd,0x3f74484b3f76ba07,0x3f6e8ff83f718f57
.quad 0x3f7213523f74fa0b,0x3f6b4b0c3f6ed89e,0x3f6faf1b3f731447,0x3f67c1873f6be858,0x3f6d1c1d3f710908,0x3f63f4733f68bf3c,0x3f6a5ad93f6ed89e,0x3f5fe4e93f655e0b
.quad 0x3f8000003f800000,0x3f8000003f800000,0x3f7fcbe23f7fd397,0x3f7fba9e3f7fc38f,0x3f7f2f9d3f7f4e6d,0x3f7eea9d3f7f0e58,0x3f7e2b723f7e70b0,0x3f7d906e3f7de0b1
.quad 0x3f7cbfc93f7d3aac,0x3f7baccd3f7c3b28,0x3f7aed373f7baccd,0x3f7940c03f7a1e84,0x3f78b47b3f79c79d,0x3f764d973f778bc5,0x3f76167a3f778bc5,0x3f72d4eb3f748422
.quad 0x3f7314473f74fa0b,0x3f6ed89e3f710908,0x3f6faf1b3f721352,0x3f6a5ad93f6d1c1d,0x3f6be8583f6ed89e,0x3f655e0b3f68bf3c,0x3f67c1873f6b4b0c,0x3f5fe4e93f63f473
.quad 0x3f633c5a3f676bd8,0x3f59f26a3f5ebe05,0x3f5e5aa63f633c5a,0x3f5389c73f591e6a,0x3f591e6a3f5ebe05,0x3f4cae793f531849,0x3f5389c73f59f26a,0x3f4564393f4cae79
.quad 0x3f8000003f800000,0x3f8000003f800000,0x3f7fa6e33f7fb10f,0x3f7f90b13f7f9c18,0x3f7e9bc93f7ec46d,0x3f7e43233f7e70b0,0x3f7cdf6c3f7d3aac,0x3f7c187a3f7c7eb0
.quad 0x3f7a73023f7b14be,0x3f7912983f79c79d,0x3f77583a3f7853f8,0x3f75341d3f764d97,0x3f73913f3f74fa0b,0x3f7080663f721352,0x3f6f20b03f710908,0x3f6afb8c3f6d1c1d
.quad 0x3f6a09a73f6c835e,0x3f64aa593f676bd8,0x3f644fac3f676bd8,0x3f5d924d3f6106f2,0x3f5df6be3f61c598,0x3f55b9933f59f26a,0x3f5703483f5b941a,0x3f4d26fd3f5233c6
.quad 0x3f4f7a1f3f54db31,0x3f43e2003f49d112,0x3f4760853f4d9f02,0x3f39f2ac3f40d0da,0x3f3ebc1b3f45e403,0x3f2f61a53f373a23,0x3f3592e73f3daef9,0x3f24381a3f2d1469
.quad 0x3f8000003f800000,0x3f8000003f800000,0x3f7f78083f7f84ab,0x3f7f5ce93f7f6ac7,0x3f7de0b13f7e1324,0x3f7d74743f7dabcc,0x3f7b3bab3f7baccd,0x3f7a49103f7ac516
.quad 0x3f778bc53f7853f8,0x3f75dec63f76ba07,0x3f72d4eb3f740bdd,0x3f703b373f718f57,0x3f6d1c1d3f6ed89e,0x3f6965913f6b4b0c,0x3f6667713f68bf3c,0x3f61668a3f63f473
.quad 0x3f5ebe053f61c598,0x3f5848533f5b941a,0x3f5627fe3f59f26a,0x3f4e16893f5233c6,0x3f4cae793f514d3d,0x3f42de293f47de65,0x3f425b893f47de65,0x3f36ad7f3f3ca003
.quad 0x3f373a233f3daef9,0x3f2994153f3085bb,0x3f2b561b3f32c8c9,0x3f1ba2993f239da9,0x3f1ebc123f273656,0x3f0cead03f15f6d9,0x3f11796b3f1b02c6,0x3efafef73f07a136
.quad 0x3f8000003f800000,0x3f8000003f800000,0x3f7f3f543f7f4e6d,0x3f7f1f493f7f2f9d,0x3f7cfe733f7d3aac,0x3f7c7eb03f7cbfc9,0x3f7940c03f79c79d,0x3f7822d13f78b47b
.quad 0x3f740bdd3f74fa0b,0x3f7213523f731447,0x3f6d67a13f6ed89e,0x3f6a5ad93f6be858,0x3f655e0b3f676bd8,0x3f6106f23f633c5a,0x3f5bfb343f5ebe05,0x3f5627fe3f591e6a
.quad 0x3f514d3d3f54db31,0x3f49d1123f4d9f02,0x3f4564393f49d112,0x3f3c17d93f40d0da,0x3f3852163f3daef9,0x3f2d14693f32c8c9,0x3f2a2a803f3085bb,0x3f1ce11f3f239da9
.quad 0x3f1b02c63f226799,0x3f0b9a6b3f13682a,0x3f0af1b73f13682a,0x3ef2bd433f0242b1,0x3ef41f073f039c3d,0x3ecc9b8b3ee0924f,0x3ed0eb2a3ee63375,0x3ea5129f3ebb31a0
.quad 0x3f8000003f800000,0x3f8000003f800000,0x3f7efcc93f7f0e58,0x3f7ed7d43f7eea9d,0x3f7bf5313f7c3b28,0x3f7b61fc3f7baccd,0x3f76ef5b3f778bc5,0x3f75a67b3f764d97
.quad 0x3f6ff5733f710908,0x3f6db2933f6ed89e,0x3f6715993f68bf3c,0x3f6398ac3f655e0b,0x3f5c61c73f5ebe05,0x3f5770263f59f26a,0x3f4fefa83f531849,0x3f4955213f4cae79
.quad 0x3f41d8703f45e403,0x3f3968423f3daef9,0x3f3238aa3f373a23,0x3f27ce613f2d1469,0x3f212ff93f273656,0x3f14b0393f1b02c6,0x3f0ee0db3f15f6d9,0x3f003a063f07a136
.quad 0x3ef6e0cb3f039c3d,0x3ed536413ee63375,0x3ece0bea3ee0924f,0x3ea80b1f3ebb31a0,0x3ea395c53eb8442a,0x3e72b6513e8e9a22,0x3e6fa8b23e8e9a22,0x3e1324ca3e419b37
.quad 0x8000000080000000,0x8000000080000000,0xbb490fc680000000,0xbc16cb58bbc90f88,0xbbc90f8880000000,0xbc96c9b6bc490e90,0xbc16cb5880000000,0xbce22a7abc96c9b6
.quad 0xbc490e9080000000,0xbd16c32cbcc90ab0,0xbc7b514b80000000,0xbd3c6dd5bcfb49ba,0xbc96c9b680000000,0xbd621469bd16c32c,0xbcafea6980000000,0xbd83db0abd2fe007
.quad 0xbcc90ab080000000,0xbd96a905bd48fb30,0xbce22a7a80000000,0xbda973babd621469,0xbcfb49ba80000000,0xbdbc3ac3bd7b2b74,0xbd0a342f80000000,0xbdcefdb7bd8a200a
.quad 0xbd16c32c80000000,0xbde1bc2ebd96a905,0xbd2351cb80000000,0xbdf475c0bda3308c,0xbd2fe00780000000,0xbe039502bdafb680,0xbd3c6dd580000000,0xbe0cec4abdbc3ac3
.quad 0x8000000080000000,0x8000000080000000,0xbc7b514bbc490e90,0xbcafea69bc96c9b6,0xbcfb49babcc90ab0,0xbd2fe007bd16c32c,0xbd3c6dd5bd16c32c,0xbd83db0abd621469
.quad 0xbd7b2b74bd48fb30,0xbdafb680bd96a905,0xbd9cecf9bd7b2b74,0xbddb7d37bdbc3ac3,0xbdbc3ac3bd96a905,0xbe039502bde1bc2e,0xbddb7d37bdafb680,0xbe195be0be039502
.quad 0xbdfab273bdc8bd36,0xbe2f10a2be164083,0xbe0cec4abde1bc2e,0xbe44b0b9be28defc,0xbe1c76debdfab273,0xbe5a3997be3b6ecf,0xbe2bf804be09cf86,0xbe6fa8b2be4dee60
.quad 0xbe3b6ecfbe164083,0xbe827dc0be605c13,0xbe4ada4fbe22abb6,0xbe8d17c0be72b651,0xbe5a3997be2f10a2,0xbe97a117be827dc0,0xbe698bbabe3b6ecf,0xbea21887be8b9507
.quad 0x8000000080000000,0x8000000080000000,0xbce22a7abcc90ab0,0xbd0a342fbcfb49ba,0xbd621469bd48fb30,0xbd8a200abd7b2b74,0xbda973babd96a905,0xbdcefdb7bdbc3ac3
.quad 0xbde1bc2ebdc8bd36,0xbe09cf86bdfab273,0xbe0cec4abdfab273,0xbe2bf804be1c76de,0xbe28defcbe164083,0xbe4dee60be3b6ecf,0xbe44b0b9be2f10a2,0xbe6fa8b2be5a3997
.quad 0xbe605c13be47c5c2,0xbe888e93be78cfcc,0xbe7bdba4be605c13,0xbe9920febe8b9507,0xbe8b9507be78cfcc,0xbea986c4be9aa086,0xbe9920febe888e93,0xbeb9bb1ebea986c4
.quad 0xbea68f12be94a031,0xbec9b953beb8442a,0xbeb3dca5bea09ae5,0xbed97cb9bec6d529,0xbec1071ebeac7cd4,0xbee900b7bed53641,0xbece0beabeb8442a,0xbef840c8bee363fa
.quad 0x8000000080000000,0x8000000080000000,0xbd2351cbbd16c32c,0xbd3c6dd5bd2fe007,0xbda3308cbd96a905,0xbdbc3ac3bdafb680,0xbdf475c0bde1bc2e,0xbe0cec4abe039502
.quad 0xbe22abb6be164083,0xbe3b6ecfbe2f10a2,0xbe4ada4fbe3b6ecf,0xbe698bbabe5a3997,0xbe72b651be605c13,0xbe8b9507be827dc0,0xbe8d17c0be827dc0,0xbea21887be97a117
.quad 0xbea09ae5be94a031,0xbeb8442abeac7cd4,0xbeb3dca5bea68f12,0xbece0beabec1071e,0xbec6d529beb8442a,0xbee363fabed53641,0xbed97cb9bec9b953,0xbef840c8bee900b7
.quad 0xbeebcbbbbedae880,0xbf064b82befc5d27,0xbefdbabbbeebcbbb,0xbf102dd5bf07a136,0xbf07a136befc5d27,0xbf19c200bf10d3cd,0xbf102dd5bf064b82,0xbf2302d3bf19c200
.quad 0x8000000080000000,0x8000000080000000,0xbd55880ebd48fb30,0xbd6ea038bd621469,0xbdd53db9bdc8bd36,0xbdee3876bde1bc2e,0xbe1f917bbe164083,0xbe3228d4be28defc
.quad 0xbe541501be47c5c2,0xbe6c9a7fbe605c13,0xbe840270be78cfcc,0xbe931f35be8b9507,0xbe9d9e78be94a031,0xbeaf713abea68f12,0xbeb6ccc3beac7cd4,0xbecb2aaebec1071e
.quad 0xbecf7bcabec3ef15,0xbee63375bedae880,0xbee79a5dbedae880,0xbf003a06bef41f07,0xbeff17b2bef15aea,0xbf0cead0bf064b82,0xbf0af1b7bf039c3d,0xbf19210fbf121eb0
.quad 0xbf15f6d9bf0e39da,0xbf24d225bf1d7fd1,0xbf209393bf187fc0,0xbf2ff3e6bf286605,0xbf2ac082bf226799,0xbf3a7ca4bf32c8c9,0xbf34768fbf2beb4a,0xbf446337bf3ca003
.quad 0x8000000080000000,0x8000000080000000,0xbd83db0abd7b2b74,0xbd9064b4bd8a200a,0xbe039502bdfab273,0xbe1008b7be09cf86,0xbe44b0b9be3b6ecf,0xbe57278fbe4dee60
.quad 0xbe827dc0be78cfcc,0xbe8e9a22be888e93,0xbea21887be9aa086,0xbeb0eacbbea986c4,0xbec1071ebeb8442a,0xbed25a09bec9b953,0xbedf28a9bed53641,0xbef2bd43bee900b7
.quad 0xbefc5d27bef15aea,0xbf08f59bbf039c3d,0xbf0c42c9bf064b82,0xbf17de12bf121eb0,0xbf19c200bf13682a,0xbf26050abf1ff6cb,0xbf269de3bf1ff6cb,0xbf33587abf2d1469
.quad 0xbf32c8c9bf2beb4a,0xbf3fc767bf396842,0xbf3e35c5bf373a23,0xbf4b41fabf44e3f5,0xbf48d8b3bf41d870,0xbf55b993bf4f7a1f,0xbf52a649bf4bbbf8,0xbf5f20dbbf591e6a
.quad 0x8000000080000000,0x8000000080000000,0xbd9cecf9bd96a905,0xbda973babda3308c,0xbe1c76debe164083,0xbe28defcbe22abb6,0xbe698bbabe605c13,0xbe7bdba4be72b651
.quad 0xbe9aa086be94a031,0xbea68f12bea09ae5,0xbebf926fbeb8442a,0xbece0beabec6d529,0xbee363fabedae880,0xbef41f07beebcbbb,0xbf02ef9fbefc5d27,0xbf0c42c9bf07a136
.quad 0xbf13682abf0e39da,0xbf1d7fd1bf187fc0,0xbf2302d3bf1d7fd1,0xbf2da859bf286605,0xbf31a81dbf2beb4a,0xbf3ca003bf373a23,0xbf3f41fcbf396842,0xbf4a4c87bf44e3f5
.quad 0xbf4bbbf8bf45e403,0xbf5695e5bf514d3d,0xbf570348bf514d3d,0xbf61668abf5c61c7,0xbf6106f2bf5b941a,0xbf6aab7bbf660f88,0xbf69b7e4bf64aa59,0xbf725470bf6e46be
.quad 0x8000000080000000,0x8000000080000000,0xbdb5f8dabdafb680,0xbdc27c39bdbc3ac3,0xbe354098be2f10a2,0xbe419b37be3b6ecf,0xbe870adabe827dc0,0xbe901c2cbe8b9507
.quad 0xbeb263efbeac7cd4,0xbebe1d4abeb8442a,0xbedc53c1bed53641,0xbeea6681bee363fa,0xbf0242b1befc5d27,0xbf0a48adbf064b82,0xbf1553b7bf10d3cd,0xbf1e1e22bf19c200
.quad 0xbf273656bf226799,0xbf3085bbbf2beb4a,0xbf37c655bf32c8c9,0xbf4154e1bf3ca003,0xbf46e22abf41d870,0xbf5064afbf4bbbf8,0xbf546b3bbf4f7a1f,0xbf5d924dbf591e6a
.quad 0xbf604621bf5b941a,0xbf68bf3cbf64aa59,0xbf6a5ad9bf660f88,0xbf71d19fbf6e46be,0xbf7294f8bf6ed89e,0xbf78b47bbf75dec6,0xbf78e3d6bf75dec6,0xbf7d57debf7b61fc
.quad 0xa554bf80248d3f80,0xa554bf80248d3f80,0x3e95bf7bbdc93f80,0x3f753e48bf7f248d,0x3f0ebf6dbe483f80,0xbf0e3f6d3e48bf80,0x3f46bf55be953f80,0xbf22bf0e3f75a554
.quad 0x3f6dbf35bec43f80,0x3f6dbf35bec43f80,0x3f7fbf0ebef13f80,0x3dc93f55bf62248d,0x3f7bbec4bf0e3f80,0xbf7b3ec43f0ebf80,0x3f62be48bf223f80,0x3ef1bf7b3f46a554
.quad 0x3f35a554bf353f80,0x3f35a554bf353f80,0x3ef13e48bf463f80,0xbf623f7bbf22248d,0x3e483ec4bf553f80,0xbe48bec43f55bf80,0xbdc93f0ebf623f80,0x3f7fbf553ef1a554
.quad 0xbec43f35bf6d3f80,0xbec43f35bf6d3f80,0xbf223f55bf753f80,0xbf463f0ebe95248d,0xbf553f6dbf7b3f80,0x3f55bf6d3f7bbf80,0xbf753f7bbf7f3f80,0x3e95be483dc9a554
.quad 0xa554bf80248d3f80,0xa554bf80248d3f80,0x3f22bf55bef13f6d,0x3f463f0ebf62bec4,0x3f7bbec4bf553f35,0xbf7b3ec43f55bf35,0x3f623e48bf7f3ec4,0x3ef1bf7b3dc93f6d
.quad 0x3ec43f35bf6d248d,0x3ec43f35bf6d248d,0xbe953f7bbf22bec4,0xbf753e483f46bf6d,0xbf553f6dbe48bf35,0x3f55bf6d3e483f35,0xbf7f3f0e3e95bf6d,0xbdc93f55bf753ec4
.quad 0xbf35248d3f35bf80,0xbf35248d3f35bf80,0xbdc9bf0e3f75bf6d,0x3f7fbf553e953ec4,0x3f0ebf6d3f7bbf35,0xbf0e3f6dbf7b3f35,0x3f75bf7b3f46bec4,0xbe95be483f22bf6d
.quad 0x3f6dbf353ec4a554,0x3f6dbf353ec4a554,0x3ef1be48bdc93ec4,0xbf623f7bbf7f3f6d,0xbe483ec4bf0e3f35,0x3e48bec43f0ebf35,0xbf463f55bf623f6d,0x3f22bf0e3ef1bec4
.quad 0xa554bf80248d3f80,0xa554bf80248d3f80,0x3f62bf0ebf463f35,0x3ef13f55bf22bf35,0x3f553ec4bf7b248d,0xbf55bec43f7ba554,0xbdc93f7bbef1bf35,0x3f7fbe48bf623f35
.quad 0xbf6d3f353ec4bf80,0xbf6d3f353ec4bf80,0xbf46be483f75bf35,0x3f22bf7b3e953f35,0x3e48bf6d3f55a554,0xbe483f6dbf55248d,0x3f75bf553dc93f35,0xbe95bf0e3f7fbf35
.quad 0x3f35a554bf353f80,0x3f35a554bf353f80,0xbe953f55bf7f3f35,0xbf753f0e3dc9bf35,0xbf7b3f6dbf0e248d,0x3f7bbf6d3f0ea554,0xbf223e483e95bf35,0xbf463f7bbf753f35
.quad 0x3ec4bf353f6dbf80,0x3ec4bf353f6dbf80,0x3f7fbf7b3f62bf35,0x3dc93e48bef13f35,0x3f0ebec43e48a554,0xbf0e3ec4be48248d,0xbef13f0ebf223f35,0x3f62bf553f46bf35
.quad 0xa554bf80248d3f80,0xa554bf80248d3f80,0x3f7fbe48bf753ec4,0x3dc93f7bbe95bf6d,0x3e483f6dbf0ebf35,0xbe48bf6d3f0e3f35,0xbf753f0e3f22bf6d,0x3e953f55bf46bec4
.quad 0xbec4bf353f6da554,0xbec4bf353f6da554,0x3f62bf55bdc93f6d,0x3ef13f0ebf7f3ec4,0x3f0e3ec4bf7b3f35,0xbf0ebec43f7bbf35,0xbf463f7bbef1bec4,0x3f223e48bf623f6d
.quad 0xbf35248d3f35bf80,0xbf35248d3f35bf80,0x3f22bf7b3f62bec4,0x3f46be48bef13f6d,0x3f55bec4be483f35,0xbf553ec43e48bf35,0xbef13f55bf7f3f6d,0x3f62bf0e3dc93ec4
.quad 0xbf6d3f35bec4248d,0xbf6d3f35bec4248d,0x3e95bf0e3f46bf6d,0x3f75bf553f22bec4,0x3f7bbf6d3f55bf35,0xbf7b3f6dbf553f35,0xbdc93e48be953ec4,0x3f7fbf7b3f75bf6d
.quad 0xa554bf80248d3f80,0xa554bf80248d3f80,0xbe953f7b3dc9bf80,0xbf75be483f7fa554,0x3f0ebf6dbe483f80,0xbf0e3f6d3e48bf80,0xbf463f553e95bf80,0x3f223f0ebf75248d
.quad 0x3f6dbf35bec43f80,0x3f6dbf35bec43f80,0xbf7f3f0e3ef1bf80,0xbdc9bf553f62a554,0x3f7bbec4bf0e3f80,0xbf7b3ec43f0ebf80,0xbf623e483f22bf80,0xbef13f7bbf46248d
.quad 0x3f35a554bf353f80,0x3f35a554bf353f80,0xbef1be483f46bf80,0x3f62bf7b3f22a554,0x3e483ec4bf553f80,0xbe48bec43f55bf80,0x3dc9bf0e3f62bf80,0xbf7f3f55bef1248d
.quad 0xbec43f35bf6d3f80,0xbec43f35bf6d3f80,0x3f22bf553f75bf80,0x3f46bf0e3e95a554,0xbf553f6dbf7b3f80,0x3f55bf6d3f7bbf80,0x3f75bf7b3f7fbf80,0xbe953e48bdc9248d
.quad 0xa554bf80248d3f80,0xa554bf80248d3f80,0xbf223f553ef1bf6d,0xbf46bf0e3f623ec4,0x3f7bbec4bf553f35,0xbf7b3ec43f55bf35,0xbf62be483f7fbec4,0xbef13f7bbdc9bf6d
.quad 0x3ec43f35bf6d248d,0x3ec43f35bf6d248d,0x3e95bf7b3f223ec4,0x3f75be48bf463f6d,0xbf553f6dbe48bf35,0x3f55bf6d3e483f35,0x3f7fbf0ebe953f6d,0x3dc9bf553f75bec4
.quad 0xbf35248d3f35bf80,0xbf35248d3f35bf80,0x3dc93f0ebf753f6d,0xbf7f3f55be95bec4,0x3f0ebf6d3f7bbf35,0xbf0e3f6dbf7b3f35,0xbf753f7bbf463ec4,0x3e953e48bf223f6d
.quad 0x3f6dbf353ec4a554,0x3f6dbf353ec4a554,0xbef13e483dc9bec4,0x3f62bf7b3f7fbf6d,0xbe483ec4bf0e3f35,0x3e48bec43f0ebf35,0x3f46bf553f62bf6d,0xbf223f0ebef13ec4
.quad 0xa554bf80248d3f80,0xa554bf80248d3f80,0xbf623f0e3f46bf35,0xbef1bf553f223f35,0x3f553ec4bf7b248d,0xbf55bec43f7ba554,0x3dc9bf7b3ef13f35,0xbf7f3e483f62bf35
.quad 0xbf6d3f353ec4bf80,0xbf6d3f353ec4bf80,0x3f463e48bf753f35,0xbf223f7bbe95bf35,0x3e48bf6d3f55a554,0xbe483f6dbf55248d,0xbf753f55bdc9bf35,0x3e953f0ebf7f3f35
.quad 0x3f35a554bf353f80,0x3f35a554bf353f80,0x3e95bf553f7fbf35,0x3f75bf0ebdc93f35,0xbf7b3f6dbf0e248d,0x3f7bbf6d3f0ea554,0x3f22be48be953f35,0x3f46bf7b3f75bf35
.quad 0x3ec4bf353f6dbf80,0x3ec4bf353f6dbf80,0xbf7f3f7bbf623f35,0xbdc9be483ef1bf35,0x3f0ebec43e48a554,0xbf0e3ec4be48248d,0x3ef1bf0e3f22bf35,0xbf623f55bf463f35
.quad 0xa554bf80248d3f80,0xa554bf80248d3f80,0xbf7f3e483f75bec4,0xbdc9bf7b3e953f6d,0x3e483f6dbf0ebf35,0xbe48bf6d3f0e3f35,0x3f75bf0ebf223f6d,0xbe95bf553f463ec4
.quad 0xbec4bf353f6da554,0xbec4bf353f6da554,0xbf623f553dc9bf6d,0xbef1bf0e3f7fbec4,0x3f0e3ec4bf7b3f35,0xbf0ebec43f7bbf35,0x3f46bf7b3ef13ec4,0xbf22be483f62bf6d
.quad 0xbf35248d3f35bf80,0xbf35248d3f35bf80,0xbf223f7bbf623ec4,0xbf463e483ef1bf6d,0x3f55bec4be483f35,0xbf553ec43e48bf35,0x3ef1bf553f7fbf6d,0xbf623f0ebdc9bec4
.quad 0xbf6d3f35bec4248d,0xbf6d3f35bec4248d,0xbe953f0ebf463f6d,0xbf753f55bf223ec4,0x3f7bbf6d3f55bf35,0xbf7b3f6dbf553f35,0x3dc9be483e95bec4,0xbf7f3f7bbf753f6d
.quad 0x3f80a50dbf808000,0x3f80a50dbf808000,0x3f753e48bf7f8000,0xbe953f7b3dc9bf80,0x3f553ec4bf7b8000,0xbf55bec43f7ba50d,0x3f223f0ebf758000,0x3f46bf55be953f80
.quad 0x3ec43f35bf6d8000,0x3ec43f35bf6d8000,0x3dc93f55bf628000,0xbf7f3f0e3ef1bf80,0xbe483f6dbf558000,0x3e48bf6d3f55a50d,0xbef13f7bbf468000,0x3f62be48bf223f80
.quad 0xbf353f80bf358000,0xbf353f80bf358000,0xbf623f7bbf228000,0xbef1be483f46bf80,0xbf7b3f6dbf0e8000,0x3f7bbf6d3f0ea50d,0xbf7f3f55bef18000,0xbdc93f0ebf623f80
.quad 0xbf6d3f35bec48000,0xbf6d3f35bec48000,0xbf463f0ebe958000,0x3f22bf553f75bf80,0xbf0e3ec4be488000,0x3f0ebec43e48a50d,0xbe953e48bdc98000,0xbf753f7bbf7f3f80
.quad 0x3f80a50dbf808000,0x3f80a50dbf808000,0x3f463f0ebf62bec4,0xbf223f553ef1bf6d,0x3e483f6dbf0ebf35,0xbe48bf6d3f0e3f35,0xbef13f7bbdc9bf6d,0x3f623e48bf7f3ec4
.quad 0xbf6d3f353ec4bf80,0xbf6d3f353ec4bf80,0xbf753e483f46bf6d,0x3e95bf7b3f223ec4,0xbf0ebec43f7bbf35,0x3f0e3ec4bf7b3f35,0x3dc9bf553f75bec4,0xbf7f3f0e3e95bf6d
.quad 0x3f35bf803f35a50d,0x3f35bf803f35a50d,0x3f7fbf553e953ec4,0x3dc93f0ebf753f6d,0x3f55bec4be483f35,0xbf553ec43e48bf35,0x3e953e48bf223f6d,0x3f75bf7b3f46bec4
.quad 0xbec43f35bf6d3f80,0xbec43f35bf6d3f80,0xbf623f7bbf7f3f6d,0xbef13e483dc9bec4,0xbf7b3f6dbf553f35,0x3f7bbf6d3f55bf35,0xbf223f0ebef13ec4,0xbf463f55bf623f6d
.quad 0x3f80a50dbf808000,0x3f80a50dbf808000,0x3ef13f55bf22bf35,0xbf623f0e3f46bf35,0xbf0e3f6d3e48bf80,0x3f0ebf6dbe483f80,0xbf7f3e483f62bf35,0xbdc93f7bbef1bf35
.quad 0xbec4bf353f6da50d,0xbec4bf353f6da50d,0x3f22bf7b3e953f35,0x3f463e48bf753f35,0x3f7bbec4bf0e3f80,0xbf7b3ec43f0ebf80,0x3e953f0ebf7f3f35,0x3f75bf553dc93f35
.quad 0xbf353f80bf358000,0xbf353f80bf358000,0xbf753f0e3dc9bf35,0x3e95bf553f7fbf35,0xbe48bec43f55bf80,0x3e483ec4bf553f80,0x3f46bf7b3f75bf35,0xbf223e483e95bf35
.quad 0x3f6dbf353ec4a50d,0x3f6dbf353ec4a50d,0x3dc93e48bef13f35,0xbf7f3f7bbf623f35,0xbf553f6dbf7b3f80,0x3f55bf6d3f7bbf80,0xbf623f55bf463f35,0xbef13f0ebf223f35
.quad 0x3f80a50dbf808000,0x3f80a50dbf808000,0x3dc93f7bbe95bf6d,0xbf7f3e483f75bec4,0xbf7b3ec43f55bf35,0x3f7bbec4bf553f35,0xbe95bf553f463ec4,0xbf753f0e3f22bf6d
.quad 0x3f6dbf35bec43f80,0x3f6dbf35bec43f80,0x3ef13f0ebf7f3ec4,0xbf623f553dc9bf6d,0xbf553f6dbe48bf35,0x3f55bf6d3e483f35,0xbf22be483f62bf6d,0xbf463f7bbef1bec4
.quad 0x3f35bf803f35a50d,0x3f35bf803f35a50d,0x3f46be48bef13f6d,0xbf223f7bbf623ec4,0xbf0e3f6dbf7b3f35,0x3f0ebf6d3f7bbf35,0xbf623f0ebdc9bec4,0xbef13f55bf7f3f6d
.quad 0x3ec4bf353f6dbf80,0x3ec4bf353f6dbf80,0x3f75bf553f22bec4,0xbe953f0ebf463f6d,0xbe483ec4bf0e3f35,0x3e48bec43f0ebf35,0xbf7f3f7bbf753f6d,0xbdc93e48be953ec4
.quad 0x3f80a50dbf808000,0x3f80a50dbf808000,0xbf75be483f7fa50d,0x3e95bf7bbdc93f80,0x3f553ec4bf7b8000,0xbf55bec43f7ba50d,0xbf22bf0e3f75a50d,0xbf463f553e95bf80
.quad 0x3ec43f35bf6d8000,0x3ec43f35bf6d8000,0xbdc9bf553f62a50d,0x3f7fbf0ebef13f80,0xbe483f6dbf558000,0x3e48bf6d3f55a50d,0x3ef1bf7b3f46a50d,0xbf623e483f22bf80
.quad 0xbf353f80bf358000,0xbf353f80bf358000,0x3f62bf7b3f22a50d,0x3ef13e48bf463f80,0xbf7b3f6dbf0e8000,0x3f7bbf6d3f0ea50d,0x3f7fbf553ef1a50d,0x3dc9bf0e3f62bf80
.quad 0xbf6d3f35bec48000,0xbf6d3f35bec48000,0x3f46bf0e3e95a50d,0xbf223f55bf753f80,0xbf0e3ec4be488000,0x3f0ebec43e48a50d,0x3e95be483dc9a50d,0x3f75bf7b3f7fbf80
.quad 0x3f80a50dbf808000,0x3f80a50dbf808000,0xbf46bf0e3f623ec4,0x3f22bf55bef13f6d,0x3e483f6dbf0ebf35,0xbe48bf6d3f0e3f35,0x3ef1bf7b3dc93f6d,0xbf62be483f7fbec4
.quad 0xbf6d3f353ec4bf80,0xbf6d3f353ec4bf80,0x3f75be48bf463f6d,0xbe953f7bbf22bec4,0xbf0ebec43f7bbf35,0x3f0e3ec4bf7b3f35,0xbdc93f55bf753ec4,0x3f7fbf0ebe953f6d
.quad 0x3f35bf803f35a50d,0x3f35bf803f35a50d,0xbf7f3f55be95bec4,0xbdc9bf0e3f75bf6d,0x3f55bec4be483f35,0xbf553ec43e48bf35,0xbe95be483f22bf6d,0xbf753f7bbf463ec4
.quad 0xbec43f35bf6d3f80,0xbec43f35bf6d3f80,0x3f62bf7b3f7fbf6d,0x3ef1be48bdc93ec4,0xbf7b3f6dbf553f35,0x3f7bbf6d3f55bf35,0x3f22bf0e3ef1bec4,0x3f46bf553f62bf6d
.quad 0x3f80a50dbf808000,0x3f80a50dbf808000,0xbef1bf553f223f35,0x3f62bf0ebf463f35,0xbf0e3f6d3e48bf80,0x3f0ebf6dbe483f80,0x3f7fbe48bf623f35,0x3dc9bf7b3ef13f35
.quad 0xbec4bf353f6da50d,0xbec4bf353f6da50d,0xbf223f7bbe95bf35,0xbf46be483f75bf35,0x3f7bbec4bf0e3f80,0xbf7b3ec43f0ebf80,0xbe95bf0e3f7fbf35,0xbf753f55bdc9bf35
.quad 0xbf353f80bf358000,0xbf353f80bf358000,0x3f75bf0ebdc93f35,0xbe953f55bf7f3f35,0xbe48bec43f55bf80,0x3e483ec4bf553f80,0xbf463f7bbf753f35,0x3f22be48be953f35
.quad 0x3f6dbf353ec4a50d,0x3f6dbf353ec4a50d,0xbdc9be483ef1bf35,0x3f7fbf7b3f62bf35,0xbf553f6dbf7b3f80,0x3f55bf6d3f7bbf80,0x3f62bf553f46bf35,0x3ef1bf0e3f22bf35
.quad 0x3f80a50dbf808000,0x3f80a50dbf808000,0xbdc9bf7b3e953f6d,0x3f7fbe48bf753ec4,0xbf7b3ec43f55bf35,0x3f7bbec4bf553f35,0x3e953f55bf46bec4,0x3f75bf0ebf223f6d
.quad 0x3f6dbf35bec43f80,0x3f6dbf35bec43f80,0xbef1bf0e3f7fbec4,0x3f62bf55bdc93f6d,0xbf553f6dbe48bf35,0x3f55bf6d3e483f35,0x3f223e48bf623f6d,0x3f46bf7b3ef13ec4
.quad 0x3f35bf803f35a50d,0x3f35bf803f35a50d,0xbf463e483ef1bf6d,0x3f22bf7b3f62bec4,0xbf0e3f6dbf7b3f35,0x3f0ebf6d3f7bbf35,0x3f62bf0e3dc93ec4,0x3ef1bf553f7fbf6d
.quad 0x3ec4bf353f6dbf80,0x3ec4bf353f6dbf80,0xbf753f55bf223ec4,0x3e95bf0e3f46bf6d,0xbe483ec4bf0e3f35,0x3e48bec43f0ebf35,0x3f7fbf7b3f75bf6d,0x3dc9be483e95bec4
.quad 0x3f7fb10f3f800000,0x3f7d3aac3f7ec46d,0x3f7fa6e33f800000,0x3f7cdf6c3f7e9bc9,0x3f7f9c183f800000,0x3f7c7eb03f7e70b0,0x3f7f90b13f800000,0x3f7c187a3f7e4323
.quad 0x3f7f84ab3f800000,0x3f7baccd3f7e1324,0x3f7f78083f800000,0x3f7b3bab3f7de0b1,0x3f7f6ac73f800000,0x3f7ac5163f7dabcc,0x3f7f5ce93f800000,0x3f7a49103f7d7474
.quad 0x3f7f4e6d3f800000,0x3f79c79d3f7d3aac,0x3f7f3f543f800000,0x3f7940c03f7cfe73,0x3f7f2f9d3f800000,0x3f78b47b3f7cbfc9,0x3f7f1f493f800000,0x3f7822d13f7c7eb0
.quad 0x3f7f0e583f800000,0x3f778bc53f7c3b28,0x3f7efcc93f800000,0x3f76ef5b3f7bf531,0x3f7eea9d3f800000,0x3f764d973f7baccd,0x3f7ed7d43f800000,0x3f75a67b3f7b61fc
.quad 0x3f7853f83f7b14be,0x3f7109083f74fa0b,0x3f77583a3f7a7302,0x3f6f20b03f73913f,0x3f764d973f79c79d,0x3f6d1c1d3f721352,0x3f75341d3f791298,0x3f6afb8c3f708066
.quad 0x3f740bdd3f7853f8,0x3f68bf3c3f6ed89e,0x3f72d4eb3f778bc5,0x3f6667713f6d1c1d,0x3f718f573f76ba07,0x3f63f4733f6b4b0c,0x3f703b373f75dec6,0x3f61668a3f696591
.quad 0x3f6ed89e3f74fa0b,0x3f5ebe053f676bd8,0x3f6d67a13f740bdd,0x3f5bfb343f655e0b,0x3f6be8583f731447,0x3f591e6a3f633c5a,0x3f6a5ad93f721352,0x3f5627fe3f6106f2
.quad 0x3f68bf3c3f710908,0x3f5318493f5ebe05,0x3f6715993f6ff573,0x3f4fefa83f5c61c7,0x3f655e0b3f6ed89e,0x3f4cae793f59f26a,0x3f6398ac3f6db293,0x3f4955213f577026
.quad 0x3f676bd83f6c835e,0x3f5b941a3f61c598,0x3f644fac3f6a09a7,0x3f5703483f5df6be,0x3f6106f23f676bd8,0x3f5233c63f59f26a,0x3f5d924d3f64aa59,0x3f4d26fd3f55b993
.quad 0x3f59f26a3f61c598,0x3f47de653f514d3d,0x3f5627fe3f5ebe05,0x3f425b893f4cae79,0x3f5233c63f5b941a,0x3f3ca0033f47de65,0x3f4e16893f584853,0x3f36ad7f3f42de29
.quad 0x3f49d1123f54db31,0x3f3085bb3f3daef9,0x3f4564393f514d3d,0x3f2a2a803f385216,0x3f40d0da3f4d9f02,0x3f239da93f32c8c9,0x3f3c17d93f49d112,0x3f1ce11f3f2d1469
.quad 0x3f373a233f45e403,0x3f15f6d93f273656,0x3f3238aa3f41d870,0x3f0ee0db3f212ff9,0x3f2d14693f3daef9,0x3f07a1363f1b02c6,0x3f27ce613f396842,0x3f003a063f14b039
.quad 0x3f4d9f023f54db31,0x3f3daef93f45e403,0x3f4760853f4f7a1f,0x3f3592e73f3ebc1b,0x3f40d0da3f49d112,0x3f2d14693f373a23,0x3f39f2ac3f43e200,0x3f24381a3f2f61a5
.quad 0x3f32c8c93f3daef9,0x3f1b02c63f273656,0x3f2b561b3f373a23,0x3f11796b3f1ebc12,0x3f239da93f3085bb,0x3f07a1363f15f6d9,0x3f1ba2993f299415,0x3efafef73f0cead0
.quad 0x3f13682a3f226799,0x3ee633753f039c3d,0x3f0af1b73f1b02c6,0x3ed0eb2a3ef41f07,0x3f0242b13f13682a,0x3ebb31a03ee0924f,0x3ef2bd433f0b9a6b,0x3ea5129f3ecc9b8b
.quad 0x3ee0924f3f039c3d,0x3e8e9a223eb8442a,0x3ece0bea3ef6e0cb,0x3e6fa8b23ea395c5,0x3ebb31a03ee63375,0x3e419b373e8e9a22,0x3ea80b1f3ed53641,0x3e1324ca3e72b651
.quad 0x3f2beb4a3f3504f3,0x3f187fc03f226799,0x3f21cbfb3f2beb4a,0x3f0c42c93f173c07,0x3f173c073f226799,0x3eff17b23f0b9a6b,0x3f0c42c93f187fc0,0x3ee4cbfe3eff17b2
.quad 0x3f00e7e43f0e39da,0x3ec9b9533ee63375,0x3eea66813f039c3d,0x3eadf73c3ecc9b8b,0x3ed25a093ef15aea,0x3e919ddd3eb263ef,0x3eb9bb1e3edae880,0x3e698bba3e97a117
.quad 0x3ea09ae53ec3ef15,0x3e2f10a23e78cfcc,0x3e870ada3eac7cd4,0x3de7fa9a3e419b37,0x3e5a39973e94a031,0x3d6214693e09cf86,0x3e25c58c3e78cfcc,0xbb490fc63da3308c
.quad 0x3de1bc2e3e47c5c2,0xbd7b2b743cc90ab0,0x3d6ea0383e164083,0xbdf475c0bcfb49ba,0x3bc90f883dc8bd36,0xbe354098bdafb680,0xbd3c6dd53d48fb30,0xbe6fa8b2be1008b7
.quad 0x3f039c3d3f0e39da,0x3edae8803ef15aea,0x3eea66813f00e7e4,0x3eb9bb1e3ed25a09,0x3ecc9b8b3ee63375,0x3e97a1173eb263ef,0x3eadf73c3ec9b953,0x3e698bba3e919ddd
.quad 0x3e8e9a223eac7cd4,0x3e22abb63e605c13,0x3e5d4b1a3e8e9a22,0x3db5f8da3e1c76de,0x3e1c76de3e605c13,0x3c96c9b63dafb680,0x3db5f8da3e22abb6,0xbd55880e3c96c9b6
.quad 0x3cc90ab03dc8bd36,0xbdfab273bd48fb30,0xbd2351cb3d16c32c,0xbe44b0b9bdee3876,0xbdd53db9bcc90ab0,0xbe8586cebe3b6ecf,0xbe2bf804bdafb680,0xbea80b1fbe7ee6e1
.quad 0xbe6c9a7fbe164083,0xbec9b953bea09ae5,0xbe9620d2be541501,0xbeea6681bec1071e,0xbeb554ecbe888e93,0xbf04f484bee0924f,0xbed3c867bea68f12,0xbf140c5fbeff17b2
.quad 0x3eac7cd43ec3ef15,0x3e78cfcc3e94a031,0x3e870ada3ea09ae5,0x3e25c58c3e5a3997,0x3e419b373e78cfcc,0x3da3308c3e09cf86,0x3de7fa9a3e2f10a2,0xbb490fc63d621469
.quad 0x3d16c32c3dc8bd36,0xbdafb680bcc90ab0,0xbd2351cb3cc90ab0,0xbe2bf804bdd53db9,0xbdee3876bd48fb30,0xbe7ee6e1be3b6ecf,0xbe44b0b9bdfab273,0xbea80b1fbe8586ce
.quad 0xbe888e93be47c5c2,0xbecf7bcabeac7cd4,0xbeadf73cbe888e93,0xbef58035bed25a09,0xbed25a09beac7cd4,0xbf0cead0bef6e0cb,0xbef58035becf7bca,0xbf1e1e22bf0cead0
.quad 0xbf0b9a6bbef15aea,0xbf2e3bdebf1d7fd1,0xbf1ba299bf08f59b,0xbf3d27b8bf2d1469,0xbf2ac082bf187fc0,0xbf4ac77fbf3b8f3b,0xbf38dd65bf273656,0xbf570348bf48d8b3
.quad 0x3e1640833e47c5c2,0x3d48fb303dc8bd36,0x3d6ea0383de1bc2e,0xbd3c6dd53bc90f88,0xbcfb49ba3cc90ab0,0xbe1008b7bdafb680,0xbdf475c0bd7b2b74,0xbe6fa8b2be354098
.quad 0xbe541501be164083,0xbea68f12be888e93,0xbe9620d2be6c9a7f,0xbed3c867beb554ec,0xbec1071ebea09ae5,0xbeff17b2bee0924f,0xbeea6681bec9b953,0xbf140c5fbf04f484
.quad 0xbf08f59bbef15aea,0xbf273656bf187fc0,0xbf1ba299bf0b9a6b,0xbf38dd65bf2ac082,0xbf2d1469bf1d7fd1,0xbf48d8b3bf3b8f3b,0xbf3d27b8bf2e3bde,0xbf570348bf4ac77f
.quad 0xbf4bbbf8bf3daef9,0xbf633c5abf584853,0xbf58b3a1bf4bbbf8,0xbf6d67a1bf63f473,0xbf63f473bf584853,0xbf756d97bf6db293,0xbf6d67a1bf633c5a,0xbf7b3babbf756d97
.quad 0xbd48fb3080000000,0xbe164083bdc8bd36,0xbd55880e80000000,0xbe1f917bbdd53db9,0xbd62146980000000,0xbe28defcbde1bc2e,0xbd6ea03880000000,0xbe3228d4bdee3876
.quad 0xbd7b2b7480000000,0xbe3b6ecfbdfab273,0xbd83db0a80000000,0xbe44b0b9be039502,0xbd8a200a80000000,0xbe4dee60be09cf86,0xbd9064b480000000,0xbe57278fbe1008b7
.quad 0xbd96a90580000000,0xbe605c13be164083,0xbd9cecf980000000,0xbe698bbabe1c76de,0xbda3308c80000000,0xbe72b651be22abb6,0xbda973ba80000000,0xbe7bdba4be28defc
.quad 0xbdafb68080000000,0xbe827dc0be2f10a2,0xbdb5f8da80000000,0xbe870adabe354098,0xbdbc3ac380000000,0xbe8b9507be3b6ecf,0xbdc27c3980000000,0xbe901c2cbe419b37
.quad 0xbe78cfccbe47c5c2,0xbeac7cd4be94a031,0xbe840270be541501,0xbeb6ccc3be9d9e78,0xbe8b9507be605c13,0xbec1071ebea68f12,0xbe931f35be6c9a7f,0xbecb2aaebeaf713a
.quad 0xbe9aa086be78cfcc,0xbed53641beb8442a,0xbea21887be827dc0,0xbedf28a9bec1071e,0xbea986c4be888e93,0xbee900b7bec9b953,0xbeb0eacbbe8e9a22,0xbef2bd43bed25a09
.quad 0xbeb8442abe94a031,0xbefc5d27bedae880,0xbebf926fbe9aa086,0xbf02ef9fbee363fa,0xbec6d529bea09ae5,0xbf07a136beebcbbb,0xbece0beabea68f12,0xbf0c42c9bef41f07
.quad 0xbed53641beac7cd4,0xbf10d3cdbefc5d27,0xbedc53c1beb263ef,0xbf1553b7bf0242b1,0xbee363fabeb8442a,0xbf19c200bf064b82,0xbeea6681bebe1d4a,0xbf1e1e22bf0a48ad
.quad 0xbedae880bec3ef15,0xbf039c3dbef15aea,0xbee79a5dbecf7bca,0xbf0af1b7beff17b2,0xbef41f07bedae880,0xbf121eb0bf064b82,0xbf003a06bee63375,0xbf19210fbf0cead0
.quad 0xbf064b82bef15aea,0xbf1ff6cbbf13682a,0xbf0c42c9befc5d27,0xbf269de3bf19c200,0xbf121eb0bf039c3d,0xbf2d1469bf1ff6cb,0xbf17de12bf08f59b,0xbf33587abf26050a
.quad 0xbf1d7fd1bf0e39da,0xbf396842bf2beb4a,0xbf2302d3bf13682a,0xbf3f41fcbf31a81d,0xbf286605bf187fc0,0xbf44e3f5bf373a23,0xbf2da859bf1d7fd1,0xbf4a4c87bf3ca003
.quad 0xbf32c8c9bf226799,0xbf4f7a1fbf41d870,0xbf37c655bf273656,0xbf546b3bbf46e22a,0xbf3ca003bf2beb4a,0xbf591e6abf4bbbf8,0xbf4154e1bf3085bb,0xbf5d924dbf5064af
.quad 0xbf187fc0bf0e39da,0xbf2beb4abf226799,0xbf209393bf15f6d9,0xbf34768fbf2ac082,0xbf286605bf1d7fd1,0xbf3ca003bf32c8c9,0xbf2ff3e6bf24d225,0xbf446337bf3a7ca4
.quad 0xbf373a23bf2beb4a,0xbf4bbbf8bf41d870,0xbf3e35c5bf32c8c9,0xbf52a649bf48d8b3,0xbf44e3f5bf396842,0xbf591e6abf4f7a1f,0xbf4b41fabf3fc767,0xbf5f20dbbf55b993
.quad 0xbf514d3dbf45e403,0xbf64aa59bf5b941a,0xbf570348bf4bbbf8,0xbf69b7e4bf6106f2,0xbf5c61c7bf514d3d,0xbf6e46bebf660f88,0xbf61668abf5695e5,0xbf725470bf6aab7b
.quad 0xbf660f88bf5b941a,0xbf75dec6bf6ed89e,0xbf6a5ad9bf604621,0xbf78e3d6bf7294f8,0xbf6e46bebf64aa59,0xbf7b61fcbf75dec6,0xbf71d19fbf68bf3c,0xbf7d57debf78b47b
.quad 0xbf3daef9bf3504f3,0xbf4d9f02bf45e403,0xbf466354bf3daef9,0xbf5627febf4e8d90,0xbf4e8d90bf45e403,0xbf5df6bebf5695e5,0xbf5627febf4d9f02,0xbf650479bf5df6be
.quad 0xbf5d2d53bf54db31,0xbf6b4b0cbf64aa59,0xbf6398acbf5b941a,0xbf70c501bf6aab7b,0xbf696591bf61c598,0xbf756d97bf6ff573,0xbf6e8ff8bf676bd8,0xbf7940c0bf748422
.quad 0xbf731447bf6c835e,0xbf7c3b28bf7853f8,0xbf76ef5bbf710908,0xbf7e5a38bf7b61fc,0xbf7a1e84bf74fa0b,0xbf7f9c18bf7dabcc,0xbf7c9f8abf7853f8,0xbf7fffb1bf7f2f9d
.quad 0xbf7e70b0bf7b14be,0xbf7f84abbf7fec43,0xbf7f90b1bf7d3aac,0xbf7e2b72bf7fe129,0xbf7ffec4bf7ec46d,0xbf7bf531bf7f0e58,0xbf7fba9ebf7fb10f,0xbf78e3d6bf7d7474
.quad 0xbf5b941abf54db31,0xbf676bd8bf61c598,0xbf6398acbf5d2d53,0xbf6e8ff8bf696591,0xbf6aab7bbf64aa59,0xbf748422bf6ff573,0xbf70c501bf6b4b0c,0xbf7940c0bf756d97
.quad 0xbf75dec6bf710908,0xbf7cbfc9bf79c79d,0xbf79f35ebf75dec6,0xbf7efcc9bf7cfe73,0xbf7cfe73bf79c79d,0xbf7ff4e6bf7f0e58,0xbf7efcc9bf7cbfc9,0xbf7fa6e3bf7ff4e6
.quad 0xbf7fec43bf7ec46d,0xbf7e1324bf7fb10f,0xbf7fcbe2bf7fd397,0xbf7b3babbf7e4323,0xbf7e9bc9bf7fec43,0xbf772417bf7baccd,0xbf7c5d3abf7f0e58,0xbf71d19fbf77f110
.quad 0xbf791298bf7d3aac,0xbf6b4b0cbf731447,0xbf74bf62bf7a7302,0xbf6398acbf6d1c1d,0xbf6f6830bf76ba07,0xbf5ac450bf660f88,0xbf6912aebf721352,0xbf50d937bf5df6be
.quad 0xbf710908bf6c835e,0xbf7853f8bf74fa0b,0xbf76ef5bbf731447,0xbf7c9f8abf7a1e84,0xbf7b61fcbf7853f8,0xbf7f2f9dbf7dabcc,0xbf7e5a38bf7c3b28,0xbf7fffb1bf7f9c18
.quad 0xbf7fd397bf7ec46d,0xbf7f0e58bf7fec43,0xbf7fcbe2bf7fec43,0xbf7c5d3abf7e9bc9,0xbf7e4323bf7fb10f,0xbf77f110bf7baccd,0xbf7b3babbf7e1324,0xbf71d19fbf772417
.quad 0xbf76ba07bf7b14be,0xbf6a09a7bf710908,0xbf70c501bf76ba07,0xbf60a6cfbf696591,0xbf696591bf710908,0xbf55b993bf604621,0xbf60a6cfbf6a09a7,0xbf495521bf55b993
.quad 0xbf5695e5bf61c598,0xbf3b8f3bbf49d112,0xbf4b41fabf584853,0xbf2c800fbf3ca003,0xbf3ebc1bbf4d9f02,0xbf1c420cbf2e3bde,0xbf311722bf41d870,0xbf0af1b7bf1ebc12
.quad 0xbf7d3aacbf7b14be,0xbf7fb10fbf7ec46d,0xbf7f90b1bf7e70b0,0xbf7fba9ebf7ffec4,0xbf7fe129bf7fec43,0xbf7d7474bf7f0e58,0xbf7e2b72bf7f84ab,0xbf78e3d6bf7bf531
.quad 0xbf7a7302bf7d3aac,0xbf721352bf76ba07,0xbf74bf62bf791298,0xbf6912aebf6f6830,0xbf6d1c1dbf731447,0xbf5df6bebf660f88,0xbf6398acbf6b4b0c,0xbf50d937bf5ac450
.quad 0xbf584853bf61c598,0xbf41d870bf4d9f02,0xbf4b41fabf5695e5,0xbf311722bf3ebc1b,0xbf3ca003bf49d112,0xbf1ebc12bf2e3bde,0xbf2c800fbf3b8f3b,0xbf0af1b7bf1c420c
.quad 0xbf1b02c6bf2beb4a,0xbeebcbbbbf08f59b,0xbf084b92bf1b02c6,0xbebf926fbee900b7,0xbee900b7bf08f59b,0xbe919dddbebe1d4a,0xbebf926fbeebcbbb,0xbe44b0b9be919ddd
.quad 0xbf803f80bf803f80,0xbf803f80bf803f80,0xbf753f7bbf7f3f80,0x3e95be483dc9248d,0xbf553f6dbf7b3f80,0x3f55bf6d3f7bbf80,0xbf223f55bf753f80,0xbf463f0ebe95a554
.quad 0xbec43f35bf6d3f80,0xbec43f35bf6d3f80,0xbdc93f0ebf623f80,0x3f7fbf553ef1248d,0x3e483ec4bf553f80,0xbe48bec43f55bf80,0x3ef13e48bf463f80,0xbf623f7bbf22a554
.quad 0x3f35248dbf353f80,0x3f35248dbf353f80,0x3f62be48bf223f80,0x3ef1bf7b3f46248d,0x3f7bbec4bf0e3f80,0xbf7b3ec43f0ebf80,0x3f7fbf0ebef13f80,0x3dc93f55bf62a554
.quad 0x3f6dbf35bec43f80,0x3f6dbf35bec43f80,0x3f46bf55be953f80,0xbf22bf0e3f75248d,0x3f0ebf6dbe483f80,0xbf0e3f6d3e48bf80,0x3e95bf7bbdc93f80,0x3f753e48bf7fa554
.quad 0xbf803f80bf803f80,0xbf803f80bf803f80,0xbf463f55bf623f6d,0x3f22bf0e3ef1bec4,0xbe483ec4bf0e3f35,0x3e48bec43f0ebf35,0x3ef1be48bdc93ec4,0xbf623f7bbf7f3f6d
.quad 0x3f6dbf353ec4248d,0x3f6dbf353ec4248d,0x3f75bf7b3f46bec4,0xbe95be483f22bf6d,0x3f0ebf6d3f7bbf35,0xbf0e3f6dbf7b3f35,0xbdc9bf0e3f75bf6d,0x3f7fbf553e953ec4
.quad 0xbf35a5543f35bf80,0xbf35a5543f35bf80,0xbf7f3f0e3e95bf6d,0xbdc93f55bf753ec4,0xbf553f6dbe48bf35,0x3f55bf6d3e483f35,0xbe953f7bbf22bec4,0xbf753e483f46bf6d
.quad 0x3ec43f35bf6da554,0x3ec43f35bf6da554,0x3f623e48bf7f3ec4,0x3ef1bf7b3dc93f6d,0x3f7bbec4bf553f35,0xbf7b3ec43f55bf35,0x3f22bf55bef13f6d,0x3f463f0ebf62bec4
.quad 0xbf803f80bf803f80,0xbf803f80bf803f80,0xbef13f0ebf223f35,0x3f62bf553f46bf35,0x3f0ebec43e48248d,0xbf0e3ec4be48a554,0x3f7fbf7b3f62bf35,0x3dc93e48bef13f35
.quad 0x3ec4bf353f6dbf80,0x3ec4bf353f6dbf80,0xbf223e483e95bf35,0xbf463f7bbf753f35,0xbf7b3f6dbf0ea554,0x3f7bbf6d3f0e248d,0xbe953f55bf7f3f35,0xbf753f0e3dc9bf35
.quad 0x3f35248dbf353f80,0x3f35248dbf353f80,0x3f75bf553dc93f35,0xbe95bf0e3f7fbf35,0x3e48bf6d3f55248d,0xbe483f6dbf55a554,0xbf46be483f75bf35,0x3f22bf7b3e953f35
.quad 0xbf6d3f353ec4bf80,0xbf6d3f353ec4bf80,0xbdc93f7bbef1bf35,0x3f7fbe48bf623f35,0x3f553ec4bf7ba554,0xbf55bec43f7b248d,0x3f62bf0ebf463f35,0x3ef13f55bf22bf35
.quad 0xbf803f80bf803f80,0xbf803f80bf803f80,0xbdc93e48be953ec4,0x3f7fbf7b3f75bf6d,0x3f7bbf6d3f55bf35,0xbf7b3f6dbf553f35,0x3e95bf0e3f46bf6d,0x3f75bf553f22bec4
.quad 0xbf6d3f35bec4a554,0xbf6d3f35bec4a554,0xbef13f55bf7f3f6d,0x3f62bf0e3dc93ec4,0x3f55bec4be483f35,0xbf553ec43e48bf35,0x3f22bf7b3f62bec4,0x3f46be48bef13f6d
.quad 0xbf35a5543f35bf80,0xbf35a5543f35bf80,0xbf463f7bbef1bec4,0x3f223e48bf623f6d,0x3f0e3ec4bf7b3f35,0xbf0ebec43f7bbf35,0x3f62bf55bdc93f6d,0x3ef13f0ebf7f3ec4
.quad 0xbec4bf353f6d248d,0xbec4bf353f6d248d,0xbf753f0e3f22bf6d,0x3e953f55bf46bec4,0x3e483f6dbf0ebf35,0xbe48bf6d3f0e3f35,0x3f7fbe48bf753ec4,0x3dc93f7bbe95bf6d
.quad 0xbf803f80bf803f80,0xbf803f80bf803f80,0x3f75bf7b3f7fbf80,0xbe953e48bdc9a554,0xbf553f6dbf7b3f80,0x3f55bf6d3f7bbf80,0x3f22bf553f75bf80,0x3f46bf0e3e95248d
.quad 0xbec43f35bf6d3f80,0xbec43f35bf6d3f80,0x3dc9bf0e3f62bf80,0xbf7f3f55bef1a554,0x3e483ec4bf553f80,0xbe48bec43f55bf80,0xbef1be483f46bf80,0x3f62bf7b3f22248d
.quad 0x3f35248dbf353f80,0x3f35248dbf353f80,0xbf623e483f22bf80,0xbef13f7bbf46a554,0x3f7bbec4bf0e3f80,0xbf7b3ec43f0ebf80,0xbf7f3f0e3ef1bf80,0xbdc9bf553f62248d
.quad 0x3f6dbf35bec43f80,0x3f6dbf35bec43f80,0xbf463f553e95bf80,0x3f223f0ebf75a554,0x3f0ebf6dbe483f80,0xbf0e3f6d3e48bf80,0xbe953f7b3dc9bf80,0xbf75be483f7f248d
.quad 0xbf803f80bf803f80,0xbf803f80bf803f80,0x3f46bf553f62bf6d,0xbf223f0ebef13ec4,0xbe483ec4bf0e3f35,0x3e48bec43f0ebf35,0xbef13e483dc9bec4,0x3f62bf7b3f7fbf6d
.quad 0x3f6dbf353ec4248d,0x3f6dbf353ec4248d,0xbf753f7bbf463ec4,0x3e953e48bf223f6d,0x3f0ebf6d3f7bbf35,0xbf0e3f6dbf7b3f35,0x3dc93f0ebf753f6d,0xbf7f3f55be95bec4
.quad 0xbf35a5543f35bf80,0xbf35a5543f35bf80,0x3f7fbf0ebe953f6d,0x3dc9bf553f75bec4,0xbf553f6dbe48bf35,0x3f55bf6d3e483f35,0x3e95bf7b3f223ec4,0x3f75be48bf463f6d
.quad 0x3ec43f35bf6da554,0x3ec43f35bf6da554,0xbf62be483f7fbec4,0xbef13f7bbdc9bf6d,0x3f7bbec4bf553f35,0xbf7b3ec43f55bf35,0xbf223f553ef1bf6d,0xbf46bf0e3f623ec4
.quad 0xbf803f80bf803f80,0xbf803f80bf803f80,0x3ef1bf0e3f22bf35,0xbf623f55bf463f35,0x3f0ebec43e48248d,0xbf0e3ec4be48a554,0xbf7f3f7bbf623f35,0xbdc9be483ef1bf35
.quad 0x3ec4bf353f6dbf80,0x3ec4bf353f6dbf80,0x3f22be48be953f35,0x3f46bf7b3f75bf35,0xbf7b3f6dbf0ea554,0x3f7bbf6d3f0e248d,0x3e95bf553f7fbf35,0x3f75bf0ebdc93f35
.quad 0x3f35248dbf353f80,0x3f35248dbf353f80,0xbf753f55bdc9bf35,0x3e953f0ebf7f3f35,0x3e48bf6d3f55248d,0xbe483f6dbf55a554,0x3f463e48bf753f35,0xbf223f7bbe95bf35
.quad 0xbf6d3f353ec4bf80,0xbf6d3f353ec4bf80,0x3dc9bf7b3ef13f35,0xbf7f3e483f62bf35,0x3f553ec4bf7ba554,0xbf55bec43f7b248d,0xbf623f0e3f46bf35,0xbef1bf553f223f35
.quad 0xbf803f80bf803f80,0xbf803f80bf803f80,0x3dc9be483e95bec4,0xbf7f3f7bbf753f6d,0x3f7bbf6d3f55bf35,0xbf7b3f6dbf553f35,0xbe953f0ebf463f6d,0xbf753f55bf223ec4
.quad 0xbf6d3f35bec4a554,0xbf6d3f35bec4a554,0x3ef1bf553f7fbf6d,0xbf623f0ebdc9bec4,0x3f55bec4be483f35,0xbf553ec43e48bf35,0xbf223f7bbf623ec4,0xbf463e483ef1bf6d
.quad 0xbf35a5543f35bf80,0xbf35a5543f35bf80,0x3f46bf7b3ef13ec4,0xbf22be483f62bf6d,0x3f0e3ec4bf7b3f35,0xbf0ebec43f7bbf35,0xbf623f553dc9bf6d,0xbef1bf0e3f7fbec4
.quad 0xbec4bf353f6d248d,0xbec4bf353f6d248d,0x3f75bf0ebf223f6d,0xbe95bf553f463ec4,0x3e483f6dbf0ebf35,0xbe48bf6d3f0e3f35,0xbf7f3e483f75bec4,0xbdc9bf7b3e953f6d
.quad 0xa50d8000a50d8000,0xa50d8000a50d8000,0x3e95be483dc98000,0x3f75bf7b3f7fbf80,0x3f0ebec43e488000,0xbf0e3ec4be48a50d,0x3f46bf0e3e958000,0xbf223f55bf753f80
.quad 0x3f6dbf353ec48000,0x3f6dbf353ec48000,0x3f7fbf553ef18000,0x3dc9bf0e3f62bf80,0x3f7bbf6d3f0e8000,0xbf7b3f6dbf0ea50d,0x3f62bf7b3f228000,0x3ef13e48bf463f80
.quad 0x3f35bf803f358000,0x3f35bf803f358000,0x3ef1bf7b3f468000,0xbf623e483f22bf80,0x3e48bf6d3f558000,0xbe483f6dbf55a50d,0xbdc9bf553f628000,0x3f7fbf0ebef13f80
.quad 0xbec4bf353f6d8000,0xbec4bf353f6d8000,0xbf22bf0e3f758000,0xbf463f553e95bf80,0xbf55bec43f7b8000,0x3f553ec4bf7ba50d,0xbf75be483f7f8000,0x3e95bf7bbdc93f80
.quad 0xa50d8000a50d8000,0xa50d8000a50d8000,0x3f22bf0e3ef1bec4,0x3f46bf553f62bf6d,0x3f7bbf6d3f55bf35,0xbf7b3f6dbf553f35,0x3f62bf7b3f7fbf6d,0x3ef1be48bdc93ec4
.quad 0x3ec4bf353f6dbf80,0x3ec4bf353f6dbf80,0xbe95be483f22bf6d,0xbf753f7bbf463ec4,0xbf553ec43e48bf35,0x3f55bec4be483f35,0xbf7f3f55be95bec4,0xbdc9bf0e3f75bf6d
.quad 0xbf353f80bf35a50d,0xbf353f80bf35a50d,0xbdc93f55bf753ec4,0x3f7fbf0ebe953f6d,0x3f0e3ec4bf7b3f35,0xbf0ebec43f7bbf35,0x3f75be48bf463f6d,0xbe953f7bbf22bec4
.quad 0x3f6dbf35bec43f80,0x3f6dbf35bec43f80,0x3ef1bf7b3dc93f6d,0xbf62be483f7fbec4,0xbe48bf6d3f0e3f35,0x3e483f6dbf0ebf35,0xbf46bf0e3f623ec4,0x3f22bf55bef13f6d
.quad 0xa50d8000a50d8000,0xa50d8000a50d8000,0x3f62bf553f46bf35,0x3ef1bf0e3f22bf35,0x3f55bf6d3f7bbf80,0xbf553f6dbf7b3f80,0xbdc9be483ef1bf35,0x3f7fbf7b3f62bf35
.quad 0xbf6d3f35bec4a50d,0xbf6d3f35bec4a50d,0xbf463f7bbf753f35,0x3f22be48be953f35,0x3e483ec4bf553f80,0xbe48bec43f55bf80,0x3f75bf0ebdc93f35,0xbe953f55bf7f3f35
.quad 0x3f35bf803f358000,0x3f35bf803f358000,0xbe95bf0e3f7fbf35,0xbf753f55bdc9bf35,0xbf7b3ec43f0ebf80,0x3f7bbec4bf0e3f80,0xbf223f7bbe95bf35,0xbf46be483f75bf35
.quad 0x3ec43f35bf6da50d,0x3ec43f35bf6da50d,0x3f7fbe48bf623f35,0x3dc9bf7b3ef13f35,0x3f0ebf6dbe483f80,0xbf0e3f6d3e48bf80,0xbef1bf553f223f35,0x3f62bf0ebf463f35
.quad 0xa50d8000a50d8000,0xa50d8000a50d8000,0x3f7fbf7b3f75bf6d,0x3dc9be483e95bec4,0x3e48bec43f0ebf35,0xbe483ec4bf0e3f35,0xbf753f55bf223ec4,0x3e95bf0e3f46bf6d
.quad 0xbec43f35bf6d3f80,0xbec43f35bf6d3f80,0x3f62bf0e3dc93ec4,0x3ef1bf553f7fbf6d,0x3f0ebf6d3f7bbf35,0xbf0e3f6dbf7b3f35,0xbf463e483ef1bf6d,0x3f22bf7b3f62bec4
.quad 0xbf353f80bf35a50d,0xbf353f80bf35a50d,0x3f223e48bf623f6d,0x3f46bf7b3ef13ec4,0x3f55bf6d3e483f35,0xbf553f6dbe48bf35,0xbef1bf0e3f7fbec4,0x3f62bf55bdc93f6d
.quad 0xbf6d3f353ec4bf80,0xbf6d3f353ec4bf80,0x3e953f55bf46bec4,0x3f75bf0ebf223f6d,0x3f7bbec4bf553f35,0xbf7b3ec43f55bf35,0xbdc9bf7b3e953f6d,0x3f7fbe48bf753ec4
.quad 0xa50d8000a50d8000,0xa50d8000a50d8000,0xbe953e48bdc9a50d,0xbf753f7bbf7f3f80,0x3f0ebec43e488000,0xbf0e3ec4be48a50d,0xbf463f0ebe95a50d,0x3f22bf553f75bf80
.quad 0x3f6dbf353ec48000,0x3f6dbf353ec48000,0xbf7f3f55bef1a50d,0xbdc93f0ebf623f80,0x3f7bbf6d3f0e8000,0xbf7b3f6dbf0ea50d,0xbf623f7bbf22a50d,0xbef1be483f46bf80
.quad 0x3f35bf803f358000,0x3f35bf803f358000,0xbef13f7bbf46a50d,0x3f62be48bf223f80,0x3e48bf6d3f558000,0xbe483f6dbf55a50d,0x3dc93f55bf62a50d,0xbf7f3f0e3ef1bf80
.quad 0xbec4bf353f6d8000,0xbec4bf353f6d8000,0x3f223f0ebf75a50d,0x3f46bf55be953f80,0xbf55bec43f7b8000,0x3f553ec4bf7ba50d,0x3f753e48bf7fa50d,0xbe953f7b3dc9bf80
.quad 0xa50d8000a50d8000,0xa50d8000a50d8000,0xbf223f0ebef13ec4,0xbf463f55bf623f6d,0x3f7bbf6d3f55bf35,0xbf7b3f6dbf553f35,0xbf623f7bbf7f3f6d,0xbef13e483dc9bec4
.quad 0x3ec4bf353f6dbf80,0x3ec4bf353f6dbf80,0x3e953e48bf223f6d,0x3f75bf7b3f46bec4,0xbf553ec43e48bf35,0x3f55bec4be483f35,0x3f7fbf553e953ec4,0x3dc93f0ebf753f6d
.quad 0xbf353f80bf35a50d,0xbf353f80bf35a50d,0x3dc9bf553f75bec4,0xbf7f3f0e3e95bf6d,0x3f0e3ec4bf7b3f35,0xbf0ebec43f7bbf35,0xbf753e483f46bf6d,0x3e95bf7b3f223ec4
.quad 0x3f6dbf35bec43f80,0x3f6dbf35bec43f80,0xbef13f7bbdc9bf6d,0x3f623e48bf7f3ec4,0xbe48bf6d3f0e3f35,0x3e483f6dbf0ebf35,0x3f463f0ebf62bec4,0xbf223f553ef1bf6d
.quad 0xa50d8000a50d8000,0xa50d8000a50d8000,0xbf623f55bf463f35,0xbef13f0ebf223f35,0x3f55bf6d3f7bbf80,0xbf553f6dbf7b3f80,0x3dc93e48bef13f35,0xbf7f3f7bbf623f35
.quad 0xbf6d3f35bec4a50d,0xbf6d3f35bec4a50d,0x3f46bf7b3f75bf35,0xbf223e483e95bf35,0x3e483ec4bf553f80,0xbe48bec43f55bf80,0xbf753f0e3dc9bf35,0x3e95bf553f7fbf35
.quad 0x3f35bf803f358000,0x3f35bf803f358000,0x3e953f0ebf7f3f35,0x3f75bf553dc93f35,0xbf7b3ec43f0ebf80,0x3f7bbec4bf0e3f80,0x3f22bf7b3e953f35,0x3f463e48bf753f35
.quad 0x3ec43f35bf6da50d,0x3ec43f35bf6da50d,0xbf7f3e483f62bf35,0xbdc93f7bbef1bf35,0x3f0ebf6dbe483f80,0xbf0e3f6d3e48bf80,0x3ef13f55bf22bf35,0xbf623f0e3f46bf35
.quad 0xa50d8000a50d8000,0xa50d8000a50d8000,0xbf7f3f7bbf753f6d,0xbdc93e48be953ec4,0x3e48bec43f0ebf35,0xbe483ec4bf0e3f35,0x3f75bf553f22bec4,0xbe953f0ebf463f6d
.quad 0xbec43f35bf6d3f80,0xbec43f35bf6d3f80,0xbf623f0ebdc9bec4,0xbef13f55bf7f3f6d,0x3f0ebf6d3f7bbf35,0xbf0e3f6dbf7b3f35,0x3f46be48bef13f6d,0xbf223f7bbf623ec4
.quad 0xbf353f80bf35a50d,0xbf353f80bf35a50d,0xbf22be483f62bf6d,0xbf463f7bbef1bec4,0x3f55bf6d3e483f35,0xbf553f6dbe48bf35,0x3ef13f0ebf7f3ec4,0xbf623f553dc9bf6d
.quad 0xbf6d3f353ec4bf80,0xbf6d3f353ec4bf80,0xbe95bf553f463ec4,0xbf753f0e3f22bf6d,0x3f7bbec4bf553f35,0xbf7b3ec43f55bf35,0x3dc93f7bbe95bf6d,0xbf7f3e483f75bec4
.quad 0x3f7ec46d3f800000,0x3f74fa0b3f7b14be,0x3f7eb0693f800000,0x3f74484b3f7ac516,0x3f7e9bc93f800000,0x3f73913f3f7a7302,0x3f7e868b3f800000,0x3f72d4eb3f7a1e84
.quad 0x3f7e70b03f800000,0x3f7213523f79c79d,0x3f7e5a383f800000,0x3f714c7a3f796e4e,0x3f7e43233f800000,0x3f7080663f791298,0x3f7e2b723f800000,0x3f6faf1b3f78b47b
.quad 0x3f7e13243f800000,0x3f6ed89e3f7853f8,0x3f7dfa383f800000,0x3f6dfcf23f77f110,0x3f7de0b13f800000,0x3f6d1c1d3f778bc5,0x3f7dc68c3f800000,0x3f6c36243f772417
.quad 0x3f7dabcc3f800000,0x3f6b4b0c3f76ba07,0x3f7d906e3f800000,0x3f6a5ad93f764d97,0x3f7d74743f800000,0x3f6965913f75dec6,0x3f7d57de3f800000,0x3f686b393f756d97
.quad 0x3f61c5983f6c835e,0x3f45e4033f54db31,0x3f5fe4e93f6b4b0c,0x3f425b893f5233c6,0x3f5df6be3f6a09a7,0x3f3ebc1b3f4f7a1f,0x3f5bfb343f68bf3c,0x3f3b06293f4cae79
.quad 0x3f59f26a3f676bd8,0x3f373a233f49d112,0x3f57dc7f3f660f88,0x3f33587a3f46e22a,0x3f55b9933f64aa59,0x3f2f61a53f43e200,0x3f5389c73f633c5a,0x3f2b561b3f40d0da
.quad 0x3f514d3d3f61c598,0x3f2736563f3daef9,0x3f4f04173f604621,0x3f2302d33f3a7ca4,0x3f4cae793f5ebe05,0x3f1ebc123f373a23,0x3f4a4c873f5d2d53,0x3f1a62933f33e7bc
.quad 0x3f47de653f5b941a,0x3f15f6d93f3085bb,0x3f4564393f59f26a,0x3f11796b3f2d1469,0x3f42de293f584853,0x3f0cead03f299415,0x3f404c5c3f5695e5,0x3f084b923f26050a
.quad 0x3f2267993f3504f3,0x3ef15aea3f0e39da,0x3f1ce11f3f3085bb,0x3ee1fb6a3f07a136,0x3f173c073f2beb4a,0x3ed25a093f00e7e4,0x3f11796b3f273656,0x3ec27b553ef41f07
.quad 0x3f0b9a6b3f226799,0x3eb263ef3ee63375,0x3f05a02c3f1d7fd1,0x3ea218873ed8106b,0x3eff17b23f187fc0,0x3e919ddd3ec9b953,0x3ef2bd433f13682a,0x3e80f8c03ebb31a0
.quad 0x3ee633753f0e39da,0x3e605c133eac7cd4,0x3ed97cb93f08f59b,0x3e3e853e3e9d9e78,0x3ecc9b8b3f039c3d,0x3e1c76de3e8e9a22,0x3ebf926f3efc5d27,0x3df475c03e7ee6e1
.quad 0x3eb263ef3ef15aea,0x3dafb6803e605c13,0x3ea5129f3ee63375,0x3d55880e3e419b37,0x3e97a1173edae880,0x3c96c9b63e22abb6,0x3e8a11f73ecf7bca,0xbc7b514b3e039502
.quad 0x3e94a0313ec3ef15,0x3dc8bd363e47c5c2,0x3e80f8c03eb263ef,0x3d55880e3e1c76de,0x3e5a39973ea09ae5,0x3bc90f883de1bc2e,0x3e3228d43e8e9a22,0xbd2351cb3d8a200a
.quad 0x3e09cf863e78cfcc,0xbdafb6803cc90ab0,0x3dc27c393e541501,0xbe06b26ebc96c9b6,0x3d6214693e2f10a2,0xbe354098bd7b2b74,0x3c7b514b3e09cf86,0xbe636c83bdd53db9
.quad 0xbcc90ab03dc8bd36,0xbe888e93be164083,0xbd83db0a3d7b2b74,0xbe9f1cdfbe419b37,0xbdd53db93cc90ab0,0xbeb554ecbe6c9a7f,0xbe1324cabc490e90,0xbecb2aaebe8b9507
.quad 0xbe3b6ecfbd48fb30,0xbee0924fbea09ae5,0xbe636c83bdafb680,0xbef58035beb554ec,0xbe8586cebdfab273,0xbf04f484bec9b953,0xbe9920febe22abb6,0xbf0ee0dbbeddbe79
.quad 0xbdc8bd36248d3132,0xbe94a031be47c5c2,0xbe195be0bd48fb30,0xbeb0eacbbe7ee6e1,0xbe4dee60bdc8bd36,0xbecc9b8bbe9aa086,0xbe80f8c0be164083,0xbee79a5dbeb554ec
.quad 0xbe9aa086be47c5c2,0xbf00e7e4becf7bca,0xbeb3dca5be78cfcc,0xbf0d9281bee900b7,0xbecc9b8bbe94a031,0xbf19c200bf00e7e4,0xbee4cbfebeac7cd4,0xbf256bcbbf0cead0
.quad 0xbefc5d27bec3ef15,0xbf3085bbbf187fc0,0xbf099f4ebedae880,0xbf3b0629bf239da9,0xbf14b039bef15aea,0xbf44e3f5bf2e3bde,0xbf1f599fbf039c3d,0xbf4e1689bf385216
.quad 0xbf299415bf0e39da,0xbf5695e5bf41d870,0xbf33587abf187fc0,0xbf5e5aa6bf4ac77f,0xbf3ca003bf226799,0xbf655e0bbf531849,0xbf456439bf2beb4a,0xbf6b99fbbf5ac450
.quad 0xbef15aeabec3ef15,0xbf226799bf0e39da,0xbf06f686bee0924f,0xbf2ff3e6bf1c420c,0xbf14b039befc5d27,0xbf3ca003bf299415,0xbf21cbfbbf0b9a6b,0xbf485bcabf36206c
.quad 0xbf2e3bdebf187fc0,0xbf531849bf41d870,0xbf39f2acbf24d225,0xbf5cc7d1bf4cae79,0xbf44e3f5bf3085bb,0xbf655e0bbf5695e5,0xbf4f0417bf3b8f3b,0xbf6cd007bf5f8327
.quad 0xbf584853bf45e403,0xbf731447bf676bd8,0xbf60a6cfbf4f7a1f,0xbf7822d1bf6e46be,0xbf6816a8bf584853,0xbf7bf531bf740bdd,0xbf6e8ff8bf604621,0xbf7e868bbf78b47b
.quad 0xbf740bddbf676bd8,0xbf7fd397bf7c3b28,0xbf788486bf6db293,0xbf7fdaafbf7e9bc9,0xbf7bf531bf731447,0xbf7e9bc9bf7fd397,0xbf7e5a38bf778bc5,0xbf7c187abf7fe129
.quad 0xbf45e403bf3504f3,0xbf61c598bf54db31,0xbf51c0c2bf41d870,0xbf6afb8cbf5f8327,0xbf5c61c7bf4d9f02,0xbf7294f8bf68bf3c,0xbf65b710bf584853,0xbf788486bf708066
.quad 0xbf6db293bf61c598,0xbf7cbfc9bf76ba07,0xbf74484bbf6a09a7,0xbf7f3f54bf7b61fc,0xbf796e4ebf710908,0xbf7ffec4bf7e70b0,0xbf7d1cddbf76ba07,0xbf7efcc9bf7fe129
.quad 0xbf7f4e6dbf7b14be,0xbf7c3b28bf7fb10f,0xbf7fffb1bf7e1324,0xbf77beb7bf7de0b1,0xbf7f2f9dbf7fb10f,0xbf718f57bf7a7302,0xbf7cdf6cbf7fec43,0xbf69b7e4bf756d97
.quad 0xbf791298bf7ec46d,0xbf604621bf6ed89e,0xbf73ced9bf7c3b28,0xbf554aa4bf66becc,0xbf6d1c1dbf7853f8,0xbf48d8b3bf5d2d53,0xbf650479bf731447,0xbf3b0629bf5233c6
.quad 0xbf74fa0bbf6c835e,0xbf7ec46dbf7b14be,0xbf7a9c59bf740bdd,0xbf7fffb1bf7e9bc9,0xbf7e4323bf79c79d,0xbf7eea9dbf7ffb11,0xbf7fe705bf7dabcc,0xbf7b87b2bf7f2f9d
.quad 0xbf7f84abbf7fb10f,0xbf75dec6bf7c3b28,0xbf7d1cddbf7fd397,0xbf6dfcf2bf772417,0xbf78b47bbf7e1324,0xbf63f473bf6ff573,0xbf725470bf7a7302,0xbf57dc7fbf66becc
.quad 0xbf6a09a7bf74fa0b,0xbf49d112bf5b941a,0xbf5fe4e9bf6db293,0xbf39f2acbf4e8d90,0xbf53fac3bf64aa59,0xbf286605bf3fc767,0xbf466354bf59f26a,0xbf1553b7bf2f61a5
.quad 0xbf373a23bf4d9f02,0xbf00e7e4bf1d7fd1,0xbf269de3bf3fc767,0xbed6a399bf0a48ad,0xbf14b039bf3085bb,0xbea986c4beebcbbb,0xbf019573bf1ff6cb,0xbe75c35abec1071e
.quad 0xbdc8bd3680000000,0xbe94a031be47c5c2,0xbdcefdb780000000,0xbe9920febe4dee60,0xbdd53db980000000,0xbe9d9e78be541501,0xbddb7d3780000000,0xbea21887be5a3997
.quad 0xbde1bc2e80000000,0xbea68f12be605c13,0xbde7fa9a80000000,0xbeab0201be667c66,0xbdee387680000000,0xbeaf713abe6c9a7f,0xbdf475c080000000,0xbeb3dca5be72b651
.quad 0xbdfab27380000000,0xbeb8442abe78cfcc,0xbe00774580000000,0xbebca7afbe7ee6e1,0xbe03950280000000,0xbec1071ebe827dc0,0xbe06b26e80000000,0xbec5625cbe8586ce
.quad 0xbe09cf8680000000,0xbec9b953be888e93,0xbe0cec4a80000000,0xbece0beabe8b9507,0xbe1008b780000000,0xbed25a09be8e9a22,0xbe1324ca80000000,0xbed6a399be919ddd
.quad 0xbef15aeabec3ef15,0xbf226799bf0e39da,0xbef840c8bec9b953,0xbf269de3bf121eb0,0xbeff17b2becf7bca,0xbf2ac082bf15f6d9,0xbf02ef9fbed53641,0xbf2ecef7bf19c200
.quad 0xbf064b82bedae880,0xbf32c8c9bf1d7fd1,0xbf099f4ebee0924f,0xbf36ad7fbf212ff9,0xbf0cead0bee63375,0xbf3a7ca4bf24d225,0xbf102dd5beebcbbb,0xbf3e35c5bf286605
.quad 0xbf13682abef15aea,0xbf41d870bf2beb4a,0xbf16999fbef6e0cb,0xbf456439bf2f61a5,0xbf19c200befc5d27,0xbf48d8b3bf32c8c9,0xbf1ce11fbf00e7e4,0xbf4c3578bf36206c
.quad 0xbf1ff6cbbf039c3d,0xbf4f7a1fbf396842,0xbf2302d3bf064b82,0xbf52a649bf3ca003,0xbf26050abf08f59b,0xbf55b993bf3fc767,0xbf28fd41bf0b9a6b,0xbf58b3a1bf42de29
.quad 0xbf45e403bf3504f3,0xbf61c598bf54db31,0xbf4a4c87bf396842,0xbf65b710bf591e6a,0xbf4e8d90bf3daef9,0xbf696591bf5d2d53,0xbf52a649bf41d870,0xbf6cd007bf6106f2
.quad 0xbf5695e5bf45e403,0xbf6ff573bf64aa59,0xbf5a5ba0bf49d112,0xbf72d4ebbf6816a8,0xbf5df6bebf4d9f02,0xbf756d97bf6b4b0c,0xbf61668abf514d3d,0xbf77beb7bf6e46be
.quad 0xbf64aa59bf54db31,0xbf79c79dbf710908,0xbf67c187bf584853,0xbf7b87b2bf73913f,0xbf6aab7bbf5b941a,0xbf7cfe73bf75dec6,0xbf6d67a1bf5ebe05,0xbf7e2b72bf77f110
.quad 0xbf6ff573bf61c598,0xbf7f0e58bf79c79d,0xbf725470bf64aa59,0xbf7fa6e3bf7b61fc,0xbf748422bf676bd8,0xbf7ff4e6bf7cbfc9,0xbf76841bbf6a09a7,0xbf7ff84abf7de0b1
.quad 0xbf74fa0bbf6c835e,0xbf7ec46dbf7b14be,0xbf77beb7bf6ff573,0xbf7fa6e3bf7cfe73,0xbf7a1e84bf731447,0xbf7ffec4bf7e70b0,0xbf7c187abf75dec6,0xbf7fcbe2bf7f6ac7
.quad 0xbf7dabccbf7853f8,0xbf7f0e58bf7fec43,0xbf7ed7d4bf7a7302,0xbf7dc68cbf7ff4e6,0xbf7f9c18bf7c3b28,0xbf7bf531bf7f84ab,0xbf7ff84abf7dabcc,0xbf799b43bf7e9bc9
.quad 0xbf7fec43bf7ec46d,0xbf76ba07bf7d3aac,0xbf7f7808bf7f84ab,0xbf73530ebf7b61fc,0xbf7e9bc9bf7fec43,0xbf6f6830bf791298,0xbf7d57debf7ffb11,0xbf6afb8cbf764d97
.quad 0xbf7baccdbf7fb10f,0xbf660f88bf731447,0xbf799b43bf7f0e58,0xbf60a6cfbf6f6830,0xbf772417bf7e1324,0xbf5ac450bf6b4b0c,0xbf74484bbf7cbfc9,0xbf546b3bbf66becc
.quad 0xbf7ec46dbf800000,0xbf74fa0bbf7b14be,0xbf7d1cddbf7fb10f,0xbf703b37bf77f110,0xbf7ac516bf7ec46d,0xbf6aab7bbf740bdd,0xbf77beb7bf7d3aac,0xbf644facbf6f6830
.quad 0xbf740bddbf7b14be,0xbf5d2d53bf6a09a7,0xbf6faf1bbf7853f8,0xbf554aa4bf63f473,0xbf6aab7bbf74fa0b,0xbf4cae79bf5d2d53,0xbf650479bf710908,0xbf436051bf55b993
.quad 0xbf5ebe05bf6c835e,0xbf396842bf4d9f02,0xbf57dc7fbf676bd8,0xbf2ecef7bf44e3f5,0xbf5064afbf61c598,0xbf239da9bf3b8f3b,0xbf485bcabf5b941a,0xbf17de12bf31a81d
.quad 0xbf3fc767bf54db31,0xbf0b9a6bbf273656,0xbf36ad7fbf4d9f02,0xbefdbabbbf1c420c,0xbf2d1469bf45e403,0xbee363fabf10d3cd,0xbf2302d3bf3daef9,0xbec8477cbf04f484
.quad 0xbf61c598bf6c835e,0xbf45e403bf54db31,0xbf5988adbf660f88,0xbf39f2acbf4ac77f,0xbf5064afbf5ebe05,0xbf2d1469bf3fc767,0xbf466354bf5695e5,0xbf1f599fbf33e7bc
.quad 0xbf3b8f3bbf4d9f02,0xbf10d3cdbf273656,0xbf2ff3e6bf43e200,0xbf019573bf19c200,0xbf239da9bf396842,0xbee363fabf0b9a6b,0xbf16999fbf2e3bde,0xbec27b55bef9a02d
.quad 0xbf08f59bbf226799,0xbea09ae5bedae880,0xbef58035bf15f6d9,0xbe7bdba4bebb31a0,0xbed8106bbf08f59b,0xbe354098be9aa086,0xbeb9bb1ebef6e0cb,0xbddb7d37be72b651
.quad 0xbe9aa086bedae880,0xbd16c32cbe2f10a2,0xbe75c35abebe1d4a,0x3d0a342fbdd53db9,0xbe354098bea09ae5,0x3dd53db9bd16c32c,0xbde7fa9abe827dc0,0x3e3228d43cfb49ba
.quad 0xbf226799bf3504f3,0xbef15aeabf0e39da,0xbf12c39abf273656,0xbecb2aaebef9a02d,0xbf0242b1bf187fc0,0xbea395c5bed53641,0xbee1fb6abf08f59b,0xbe75c35abeaf713a
.quad 0xbebe1d4abef15aea,0xbe22abb6be888e93,0xbe9920febecf7bca,0xbd9cecf9be419b37,0xbe667c66beac7cd4,0x3bc90f88bde1bc2e,0xbe195be0be888e93,0x3db5f8dabcfb49ba
.quad 0xbd96a905be47c5c2,0x3e2f10a23d48fb30,0x3b490fc6bdfab273,0x3e80f8c03e039502,0x3da3308cbd48fb30,0x3ea986c43e541501,0x3e1f917b3cc90ab0,0x3ed0eb2a3e919ddd
.quad 0x3e6c9a7f3dc8bd36,0x3ef6e0cb3eb8442a,0x3e9c1faf3e2f10a2,0x3f0d92813eddbe79,0x3ec1071e3e78cfcc,0x3f1ebc123f00e7e4,0x3ee4cbfe3ea09ae5,0x3f2ecef73f121eb0
.quad 0xbe94a031bec3ef15,0xbdc8bd36be47c5c2,0xbe5101f1be9aa086,0xbb490fc6bdd53db9,0xbdee3876be605c13,0x3dbc3ac3bc490e90,0xbce22a7abe09cf86,0x3e3e853e3da3308c
.quad 0x3d7b2b74bd48fb30,0x3e8e9a223e2f10a2,0x3e195be03d16c32c,0x3ebca7af3e8586ce,0x3e72b6513dfab273,0x3ee900b73eb263ef,0x3ea5129f3e541501,0x3f099f4e3eddbe79
.quad 0x3ecf7bca3e94a031,0x3f1d7fd13f039c3d,0x3ef840c83ebe1d4a,0x3f2ff3e63f173c07,0x3f0f87843ee63375,0x3f40d0da3f299415,0x3f21cbfb3f064b82,0x3f4fefa83f3a7ca4
.quad 0x3f32c8c93f187fc0,0x3f5d2d533f49d112,0x3f425b893f299415,0x3f686b393f577026,0x3f5064af3f396842,0x3f718f573f633c5a,0x3f5cc7d13f47de65,0x3f7884863f6d1c1d
.quad 0x248dbf80a5543f80,0x248dbf80a5543f80,0xbe95bf7b3dc93f80,0xbf753e483f7f248d,0xbf0ebf6d3e483f80,0x3f0e3f6dbe48bf80,0xbf46bf553e953f80,0x3f22bf0ebf75a554
.quad 0xbf6dbf353ec43f80,0xbf6dbf353ec43f80,0xbf7fbf0e3ef13f80,0xbdc93f553f62248d,0xbf7bbec43f0e3f80,0x3f7b3ec4bf0ebf80,0xbf62be483f223f80,0xbef1bf7bbf46a554
.quad 0xbf35a5543f353f80,0xbf35a5543f353f80,0xbef13e483f463f80,0x3f623f7b3f22248d,0xbe483ec43f553f80,0x3e48bec4bf55bf80,0x3dc93f0e3f623f80,0xbf7fbf55bef1a554
.quad 0x3ec43f353f6d3f80,0x3ec43f353f6d3f80,0x3f223f553f753f80,0x3f463f0e3e95248d,0x3f553f6d3f7b3f80,0xbf55bf6dbf7bbf80,0x3f753f7b3f7f3f80,0xbe95be48bdc9a554
.quad 0x248dbf80a5543f80,0x248dbf80a5543f80,0xbf22bf553ef13f6d,0xbf463f0e3f62bec4,0xbf7bbec43f553f35,0x3f7b3ec4bf55bf35,0xbf623e483f7f3ec4,0xbef1bf7bbdc93f6d
.quad 0xbec43f353f6d248d,0xbec43f353f6d248d,0x3e953f7b3f22bec4,0x3f753e48bf46bf6d,0x3f553f6d3e48bf35,0xbf55bf6dbe483f35,0x3f7f3f0ebe95bf6d,0x3dc93f553f753ec4
.quad 0x3f35248dbf35bf80,0x3f35248dbf35bf80,0x3dc9bf0ebf75bf6d,0xbf7fbf55be953ec4,0xbf0ebf6dbf7bbf35,0x3f0e3f6d3f7b3f35,0xbf75bf7bbf46bec4,0x3e95be48bf22bf6d
.quad 0xbf6dbf35bec4a554,0xbf6dbf35bec4a554,0xbef1be483dc93ec4,0x3f623f7b3f7f3f6d,0x3e483ec43f0e3f35,0xbe48bec4bf0ebf35,0x3f463f553f623f6d,0xbf22bf0ebef1bec4
.quad 0x248dbf80a5543f80,0x248dbf80a5543f80,0xbf62bf0e3f463f35,0xbef13f553f22bf35,0xbf553ec43f7b248d,0x3f55bec4bf7ba554,0x3dc93f7b3ef1bf35,0xbf7fbe483f623f35
.quad 0x3f6d3f35bec4bf80,0x3f6d3f35bec4bf80,0x3f46be48bf75bf35,0xbf22bf7bbe953f35,0xbe48bf6dbf55a554,0x3e483f6d3f55248d,0xbf75bf55bdc93f35,0x3e95bf0ebf7fbf35
.quad 0xbf35a5543f353f80,0xbf35a5543f353f80,0x3e953f553f7f3f35,0x3f753f0ebdc9bf35,0x3f7b3f6d3f0e248d,0xbf7bbf6dbf0ea554,0x3f223e48be95bf35,0x3f463f7b3f753f35
.quad 0xbec4bf35bf6dbf80,0xbec4bf35bf6dbf80,0xbf7fbf7bbf62bf35,0xbdc93e483ef13f35,0xbf0ebec4be48a554,0x3f0e3ec43e48248d,0x3ef13f0e3f223f35,0xbf62bf55bf46bf35
.quad 0x248dbf80a5543f80,0x248dbf80a5543f80,0xbf7fbe483f753ec4,0xbdc93f7b3e95bf6d,0xbe483f6d3f0ebf35,0x3e48bf6dbf0e3f35,0x3f753f0ebf22bf6d,0xbe953f553f46bec4
.quad 0x3ec4bf35bf6da554,0x3ec4bf35bf6da554,0xbf62bf553dc93f6d,0xbef13f0e3f7f3ec4,0xbf0e3ec43f7b3f35,0x3f0ebec4bf7bbf35,0x3f463f7b3ef1bec4,0xbf223e483f623f6d
.quad 0x3f35248dbf35bf80,0x3f35248dbf35bf80,0xbf22bf7bbf62bec4,0xbf46be483ef13f6d,0xbf55bec43e483f35,0x3f553ec4be48bf35,0x3ef13f553f7f3f6d,0xbf62bf0ebdc93ec4
.quad 0x3f6d3f353ec4248d,0x3f6d3f353ec4248d,0xbe95bf0ebf46bf6d,0xbf75bf55bf22bec4,0xbf7bbf6dbf55bf35,0x3f7b3f6d3f553f35,0x3dc93e483e953ec4,0xbf7fbf7bbf75bf6d
.quad 0x248dbf80a5543f80,0x248dbf80a5543f80,0x3e953f7bbdc9bf80,0x3f75be48bf7fa554,0xbf0ebf6d3e483f80,0x3f0e3f6dbe48bf80,0x3f463f55be95bf80,0xbf223f0e3f75248d
.quad 0xbf6dbf353ec43f80,0xbf6dbf353ec43f80,0x3f7f3f0ebef1bf80,0x3dc9bf55bf62a554,0xbf7bbec43f0e3f80,0x3f7b3ec4bf0ebf80,0x3f623e48bf22bf80,0x3ef13f7b3f46248d
.quad 0xbf35a5543f353f80,0xbf35a5543f353f80,0x3ef1be48bf46bf80,0xbf62bf7bbf22a554,0xbe483ec43f553f80,0x3e48bec4bf55bf80,0xbdc9bf0ebf62bf80,0x3f7f3f553ef1248d
.quad 0x3ec43f353f6d3f80,0x3ec43f353f6d3f80,0xbf22bf55bf75bf80,0xbf46bf0ebe95a554,0x3f553f6d3f7b3f80,0xbf55bf6dbf7bbf80,0xbf75bf7bbf7fbf80,0x3e953e483dc9248d
.quad 0x248dbf80a5543f80,0x248dbf80a5543f80,0x3f223f55bef1bf6d,0x3f46bf0ebf623ec4,0xbf7bbec43f553f35,0x3f7b3ec4bf55bf35,0x3f62be48bf7fbec4,0x3ef13f7b3dc9bf6d
.quad 0xbec43f353f6d248d,0xbec43f353f6d248d,0xbe95bf7bbf223ec4,0xbf75be483f463f6d,0x3f553f6d3e48bf35,0xbf55bf6dbe483f35,0xbf7fbf0e3e953f6d,0xbdc9bf55bf75bec4
.quad 0x3f35248dbf35bf80,0x3f35248dbf35bf80,0xbdc93f0e3f753f6d,0x3f7f3f553e95bec4,0xbf0ebf6dbf7bbf35,0x3f0e3f6d3f7b3f35,0x3f753f7b3f463ec4,0xbe953e483f223f6d
.quad 0xbf6dbf35bec4a554,0xbf6dbf35bec4a554,0x3ef13e48bdc9bec4,0xbf62bf7bbf7fbf6d,0x3e483ec43f0e3f35,0xbe48bec4bf0ebf35,0xbf46bf55bf62bf6d,0x3f223f0e3ef13ec4
.quad 0x248dbf80a5543f80,0x248dbf80a5543f80,0x3f623f0ebf46bf35,0x3ef1bf55bf223f35,0xbf553ec43f7b248d,0x3f55bec4bf7ba554,0xbdc9bf7bbef13f35,0x3f7f3e48bf62bf35
.quad 0x3f6d3f35bec4bf80,0x3f6d3f35bec4bf80,0xbf463e483f753f35,0x3f223f7b3e95bf35,0xbe48bf6dbf55a554,0x3e483f6d3f55248d,0x3f753f553dc9bf35,0xbe953f0e3f7f3f35
.quad 0xbf35a5543f353f80,0xbf35a5543f353f80,0xbe95bf55bf7fbf35,0xbf75bf0e3dc93f35,0x3f7b3f6d3f0e248d,0xbf7bbf6dbf0ea554,0xbf22be483e953f35,0xbf46bf7bbf75bf35
.quad 0xbec4bf35bf6dbf80,0xbec4bf35bf6dbf80,0x3f7f3f7b3f623f35,0x3dc9be48bef1bf35,0xbf0ebec4be48a554,0x3f0e3ec43e48248d,0xbef1bf0ebf22bf35,0x3f623f553f463f35
.quad 0x248dbf80a5543f80,0x248dbf80a5543f80,0x3f7f3e48bf75bec4,0x3dc9bf7bbe953f6d,0xbe483f6d3f0ebf35,0x3e48bf6dbf0e3f35,0xbf75bf0e3f223f6d,0x3e95bf55bf463ec4
.quad 0x3ec4bf35bf6da554,0x3ec4bf35bf6da554,0x3f623f55bdc9bf6d,0x3ef1bf0ebf7fbec4,0xbf0e3ec43f7b3f35,0x3f0ebec4bf7bbf35,0xbf46bf7bbef13ec4,0x3f22be48bf62bf6d
.quad 0x3f35248dbf35bf80,0x3f35248dbf35bf80,0x3f223f7b3f623ec4,0x3f463e48bef1bf6d,0xbf55bec43e483f35,0x3f553ec4be48bf35,0xbef1bf55bf7fbf6d,0x3f623f0e3dc9bec4
.quad 0x3f6d3f353ec4248d,0x3f6d3f353ec4248d,0x3e953f0e3f463f6d,0x3f753f553f223ec4,0xbf7bbf6dbf55bf35,0x3f7b3f6d3f553f35,0xbdc9be48be95bec4,0x3f7f3f7b3f753f6d
.quad 0xbf80a50d3f808000,0xbf80a50d3f808000,0xbf753e483f7f8000,0x3e953f7bbdc9bf80,0xbf553ec43f7b8000,0x3f55bec4bf7ba50d,0xbf223f0e3f758000,0xbf46bf553e953f80
.quad 0xbec43f353f6d8000,0xbec43f353f6d8000,0xbdc93f553f628000,0x3f7f3f0ebef1bf80,0x3e483f6d3f558000,0xbe48bf6dbf55a50d,0x3ef13f7b3f468000,0xbf62be483f223f80
.quad 0x3f353f803f358000,0x3f353f803f358000,0x3f623f7b3f228000,0x3ef1be48bf46bf80,0x3f7b3f6d3f0e8000,0xbf7bbf6dbf0ea50d,0x3f7f3f553ef18000,0x3dc93f0e3f623f80
.quad 0x3f6d3f353ec48000,0x3f6d3f353ec48000,0x3f463f0e3e958000,0xbf22bf55bf75bf80,0x3f0e3ec43e488000,0xbf0ebec4be48a50d,0x3e953e483dc98000,0x3f753f7b3f7f3f80
.quad 0xbf80a50d3f808000,0xbf80a50d3f808000,0xbf463f0e3f62bec4,0x3f223f55bef1bf6d,0xbe483f6d3f0ebf35,0x3e48bf6dbf0e3f35,0x3ef13f7b3dc9bf6d,0xbf623e483f7f3ec4
.quad 0x3f6d3f35bec4bf80,0x3f6d3f35bec4bf80,0x3f753e48bf46bf6d,0xbe95bf7bbf223ec4,0x3f0ebec4bf7bbf35,0xbf0e3ec43f7b3f35,0xbdc9bf55bf75bec4,0x3f7f3f0ebe95bf6d
.quad 0xbf35bf80bf35a50d,0xbf35bf80bf35a50d,0xbf7fbf55be953ec4,0xbdc93f0e3f753f6d,0xbf55bec43e483f35,0x3f553ec4be48bf35,0xbe953e483f223f6d,0xbf75bf7bbf46bec4
.quad 0x3ec43f353f6d3f80,0x3ec43f353f6d3f80,0x3f623f7b3f7f3f6d,0x3ef13e48bdc9bec4,0x3f7b3f6d3f553f35,0xbf7bbf6dbf55bf35,0x3f223f0e3ef13ec4,0x3f463f553f623f6d
.quad 0xbf80a50d3f808000,0xbf80a50d3f808000,0xbef13f553f22bf35,0x3f623f0ebf46bf35,0x3f0e3f6dbe48bf80,0xbf0ebf6d3e483f80,0x3f7f3e48bf62bf35,0x3dc93f7b3ef1bf35
.quad 0x3ec4bf35bf6da50d,0x3ec4bf35bf6da50d,0xbf22bf7bbe953f35,0xbf463e483f753f35,0xbf7bbec43f0e3f80,0x3f7b3ec4bf0ebf80,0xbe953f0e3f7f3f35,0xbf75bf55bdc93f35
.quad 0x3f353f803f358000,0x3f353f803f358000,0x3f753f0ebdc9bf35,0xbe95bf55bf7fbf35,0x3e48bec4bf55bf80,0xbe483ec43f553f80,0xbf46bf7bbf75bf35,0x3f223e48be95bf35
.quad 0xbf6dbf35bec4a50d,0xbf6dbf35bec4a50d,0xbdc93e483ef13f35,0x3f7f3f7b3f623f35,0x3f553f6d3f7b3f80,0xbf55bf6dbf7bbf80,0x3f623f553f463f35,0x3ef13f0e3f223f35
.quad 0xbf80a50d3f808000,0xbf80a50d3f808000,0xbdc93f7b3e95bf6d,0x3f7f3e48bf75bec4,0x3f7b3ec4bf55bf35,0xbf7bbec43f553f35,0x3e95bf55bf463ec4,0x3f753f0ebf22bf6d
.quad 0xbf6dbf353ec43f80,0xbf6dbf353ec43f80,0xbef13f0e3f7f3ec4,0x3f623f55bdc9bf6d,0x3f553f6d3e48bf35,0xbf55bf6dbe483f35,0x3f22be48bf62bf6d,0x3f463f7b3ef1bec4
.quad 0xbf35bf80bf35a50d,0xbf35bf80bf35a50d,0xbf46be483ef13f6d,0x3f223f7b3f623ec4,0x3f0e3f6d3f7b3f35,0xbf0ebf6dbf7bbf35,0x3f623f0e3dc9bec4,0x3ef13f553f7f3f6d
.quad 0xbec4bf35bf6dbf80,0xbec4bf35bf6dbf80,0xbf75bf55bf22bec4,0x3e953f0e3f463f6d,0x3e483ec43f0e3f35,0xbe48bec4bf0ebf35,0x3f7f3f7b3f753f6d,0x3dc93e483e953ec4
.quad 0xbf80a50d3f808000,0xbf80a50d3f808000,0x3f75be48bf7fa50d,0xbe95bf7b3dc93f80,0xbf553ec43f7b8000,0x3f55bec4bf7ba50d,0x3f22bf0ebf75a50d,0x3f463f55be95bf80
.quad 0xbec43f353f6d8000,0xbec43f353f6d8000,0x3dc9bf55bf62a50d,0xbf7fbf0e3ef13f80,0x3e483f6d3f558000,0xbe48bf6dbf55a50d,0xbef1bf7bbf46a50d,0x3f623e48bf22bf80
.quad 0x3f353f803f358000,0x3f353f803f358000,0xbf62bf7bbf22a50d,0xbef13e483f463f80,0x3f7b3f6d3f0e8000,0xbf7bbf6dbf0ea50d,0xbf7fbf55bef1a50d,0xbdc9bf0ebf62bf80
.quad 0x3f6d3f353ec48000,0x3f6d3f353ec48000,0xbf46bf0ebe95a50d,0x3f223f553f753f80,0x3f0e3ec43e488000,0xbf0ebec4be48a50d,0xbe95be48bdc9a50d,0xbf75bf7bbf7fbf80
.quad 0xbf80a50d3f808000,0xbf80a50d3f808000,0x3f46bf0ebf623ec4,0xbf22bf553ef13f6d,0xbe483f6d3f0ebf35,0x3e48bf6dbf0e3f35,0xbef1bf7bbdc93f6d,0x3f62be48bf7fbec4
.quad 0x3f6d3f35bec4bf80,0x3f6d3f35bec4bf80,0xbf75be483f463f6d,0x3e953f7b3f22bec4,0x3f0ebec4bf7bbf35,0xbf0e3ec43f7b3f35,0x3dc93f553f753ec4,0xbf7fbf0e3e953f6d
.quad 0xbf35bf80bf35a50d,0xbf35bf80bf35a50d,0x3f7f3f553e95bec4,0x3dc9bf0ebf75bf6d,0xbf55bec43e483f35,0x3f553ec4be48bf35,0x3e95be48bf22bf6d,0x3f753f7b3f463ec4
.quad 0x3ec43f353f6d3f80,0x3ec43f353f6d3f80,0xbf62bf7bbf7fbf6d,0xbef1be483dc93ec4,0x3f7b3f6d3f553f35,0xbf7bbf6dbf55bf35,0xbf22bf0ebef1bec4,0xbf46bf55bf62bf6d
.quad 0xbf80a50d3f808000,0xbf80a50d3f808000,0x3ef1bf55bf223f35,0xbf62bf0e3f463f35,0x3f0e3f6dbe48bf80,0xbf0ebf6d3e483f80,0xbf7fbe483f623f35,0xbdc9bf7bbef13f35
.quad 0x3ec4bf35bf6da50d,0x3ec4bf35bf6da50d,0x3f223f7b3e95bf35,0x3f46be48bf75bf35,0xbf7bbec43f0e3f80,0x3f7b3ec4bf0ebf80,0x3e95bf0ebf7fbf35,0x3f753f553dc9bf35
.quad 0x3f353f803f358000,0x3f353f803f358000,0xbf75bf0e3dc93f35,0x3e953f553f7f3f35,0x3e48bec4bf55bf80,0xbe483ec43f553f80,0x3f463f7b3f753f35,0xbf22be483e953f35
.quad 0xbf6dbf35bec4a50d,0xbf6dbf35bec4a50d,0x3dc9be48bef1bf35,0xbf7fbf7bbf62bf35,0x3f553f6d3f7b3f80,0xbf55bf6dbf7bbf80,0xbf62bf55bf46bf35,0xbef1bf0ebf22bf35
.quad 0xbf80a50d3f808000,0xbf80a50d3f808000,0x3dc9bf7bbe953f6d,0xbf7fbe483f753ec4,0x3f7b3ec4bf55bf35,0xbf7bbec43f553f35,0xbe953f553f46bec4,0xbf75bf0e3f223f6d
.quad 0xbf6dbf353ec43f80,0xbf6dbf353ec43f80,0x3ef1bf0ebf7fbec4,0xbf62bf553dc93f6d,0x3f553f6d3e48bf35,0xbf55bf6dbe483f35,0xbf223e483f623f6d,0xbf46bf7bbef13ec4
.quad 0xbf35bf80bf35a50d,0xbf35bf80bf35a50d,0x3f463e48bef1bf6d,0xbf22bf7bbf62bec4,0x3f0e3f6d3f7b3f35,0xbf0ebf6dbf7bbf35,0xbf62bf0ebdc93ec4,0xbef1bf55bf7fbf6d
.quad 0xbec4bf35bf6dbf80,0xbec4bf35bf6dbf80,0x3f753f553f223ec4,0xbe95bf0ebf46bf6d,0x3e483ec43f0e3f35,0xbe48bec4bf0ebf35,0xbf7fbf7bbf75bf6d,0xbdc9be48be95bec4
.quad 0x3f7d3aac3f800000,0x3f676bd83f74fa0b,0x3f7d1cdd3f800000,0x3f6667713f748422,0x3f7cfe733f800000,0x3f655e0b3f740bdd,0x3f7cdf6c3f800000,0x3f644fac3f73913f
.quad 0x3f7cbfc93f800000,0x3f633c5a3f731447,0x3f7c9f8a3f800000,0x3f62241a3f7294f8,0x3f7c7eb03f800000,0x3f6106f23f721352,0x3f7c5d3a3f800000,0x3f5fe4e93f718f57
.quad 0x3f7c3b283f800000,0x3f5ebe053f710908,0x3f7c187a3f800000,0x3f5d924d3f708066,0x3f7bf5313f800000,0x3f5c61c73f6ff573,0x3f7bd14d3f800000,0x3f5b2c793f6f6830
.quad 0x3f7baccd3f800000,0x3f59f26a3f6ed89e,0x3f7b87b23f800000,0x3f58b3a13f6e46be,0x3f7b61fc3f800000,0x3f5770263f6db293,0x3f7b3bab3f800000,0x3f5627fe3f6d1c1d
.quad 0x3f3daef93f54db31,0x3f039c3d3f226799,0x3f3b06293f531849,0x3efdbabb3f1ebc12,0x3f3852163f514d3d,0x3ef41f073f1b02c6,0x3f3592e73f4f7a1f,0x3eea66813f173c07
.quad 0x3f32c8c93f4d9f02,0x3ee0924f3f13682a,0x3f2ff3e63f4bbbf8,0x3ed6a3993f0f8784,0x3f2d14693f49d112,0x3ecc9b8b3f0b9a6b,0x3f2a2a803f47de65,0x3ec27b553f07a136
.quad 0x3f2736563f45e403,0x3eb8442a3f039c3d,0x3f24381a3f43e200,0x3eadf73c3eff17b2,0x3f212ff93f41d870,0x3ea395c53ef6e0cb,0x3f1e1e223f3fc767,0x3e9920fe3eee9479
.quad 0x3f1b02c63f3daef9,0x3e8e9a223ee63375,0x3f17de123f3b8f3b,0x3e8402703eddbe79,0x3f14b0393f396842,0x3e72b6513ed53641,0x3f11796b3f373a23,0x3e5d4b1a3ecc9b8b
.quad 0x3e78cfcc3ec3ef15,0xbd48fb303dc8bd36,0x3e5d4b1a3eb8442a,0xbda973ba3d8a200a,0x3e419b373eac7cd4,0xbdee38763d16c32c,0x3e25c58c3ea09ae5,0xbe195be03bc90f88
.quad 0x3e09cf863e94a031,0xbe3b6ecfbcc90ab0,0x3ddb7d373e888e93,0xbe5d4b1abd621469,0x3da3308c3e78cfcc,0xbe7ee6e1bdafb680,0x3d55880e3e605c13,0xbe901c2cbdee3876
.quad 0x3cc90ab03e47c5c2,0xbea09ae5be164083,0xbb490fc63e2f10a2,0xbeb0eacbbe354098,0xbcfb49ba3e164083,0xbec1071ebe541501,0xbd6ea0383dfab273,0xbed0eb2abe72b651
.quad 0xbdafb6803dc8bd36,0xbee0924fbe888e93,0xbde7fa9a3d96a905,0xbeeff7fbbe97a117,0xbe1008b73d48fb30,0xbeff17b2bea68f12,0xbe2bf8043cc90ab0,0xbf06f686beb554ec
.quad 0xbeac7cd4be47c5c2,0xbf187fc0bef15aea,0xbebf926fbe6c9a7f,0xbf21cbfbbf0242b1,0xbed25a09be888e93,0xbf2ac082bf0b9a6b,0xbee4cbfebe9aa086,0xbf33587abf14b039
.quad 0xbef6e0cbbeac7cd4,0xbf3b8f3bbf1d7fd1,0xbf044889bebe1d4a,0xbf436051bf26050a,0xbf0cead0becf7bca,0xbf4ac77fbf2e3bde,0xbf1553b7bee0924f,0xbf51c0c2bf36206c
.quad 0xbf1d7fd1bef15aea,0xbf584853bf3daef9,0xbf256bcbbf00e7e4,0xbf5e5aa6bf44e3f5,0xbf2d1469bf08f59b,0xbf63f473bf4bbbf8,0xbf34768fbf10d3cd,0xbf6912aebf5233c6
.quad 0xbf3b8f3bbf187fc0,0xbf6db293bf584853,0xbf425b89bf1ff6cb,0xbf71d19fbf5df6be,0xbf48d8b3bf273656,0xbf756d97bf633c5a,0xbf4f0417bf2e3bde,0xbf788486bf6816a8
.quad 0xbf4d9f02bf3504f3,0xbf710908bf61c598,0xbf554aa4bf3daef9,0xbf75a67bbf6816a8,0xbf5c61c7bf45e403,0xbf796e4ebf6db293,0xbf62df7bbf4d9f02,0xbf7c5d3abf7294f8
.quad 0xbf68bf3cbf54db31,0xbf7e70b0bf76ba07,0xbf6dfcf2bf5b941a,0xbf7fa6e3bf7a1e84,0xbf7294f8bf61c598,0xbf7ffec4bf7cbfc9,0xbf76841bbf676bd8,0xbf7f7808bf7e9bc9
.quad 0xbf79c79dbf6c835e,0xbf7e1324bf7fb10f,0xbf7c5d3abf710908,0xbf7bd14dbf7ffec4,0xbf7e4323bf74fa0b,0xbf78b47bbf7f84ab,0xbf7f7808bf7853f8,0xbf74bf62bf7e4323
.quad 0xbf7ffb11bf7b14be,0xbf6ff573bf7c3b28,0xbf7fcbe2bf7d3aac,0xbf6a5ad9bf796e4e,0xbf7eea9dbf7ec46d,0xbf63f473bf75dec6,0xbf7d57debf7fb10f,0xbf5cc7d1bf718f57
.quad 0xbf7fb10fbf7b14be,0xbf7853f8bf7ec46d,0xbf7ff84abf7dabcc,0xbf73530ebf7c7eb0,0xbf7f2f9dbf7f4e6d,0xbf6d1c1dbf791298,0xbf7d57debf7ffb11,0xbf65b710bf748422
.quad 0xbf7a7302bf7fb10f,0xbf5d2d53bf6ed89e,0xbf76841bbf7e70b0,0xbf5389c7bf6816a8,0xbf718f57bf7c3b28,0xbf48d8b3bf604621,0xbf6b99fbbf791298,0xbf3d27b8bf577026
.quad 0xbf64aa59bf74fa0b,0xbf3085bbbf4d9f02,0xbf5cc7d1bf6ff573,0xbf2302d3bf42de29,0xbf53fac3bf6a09a7,0xbf14b039bf373a23,0xbf4a4c87bf633c5a,0xbf05a02cbf2ac082
.quad 0xbf3fc767bf5b941a,0xbeebcbbbbf1d7fd1,0xbf34768fbf531849,0xbecb2aaebf0f8784,0xbf286605bf49d112,0xbea986c4bf00e7e4,0xbf1ba299bf3fc767,0xbe870adabee363fa
.quad 0xbf5b941abf6c835e,0xbf2beb4abf45e403,0xbf50d937bf64aa59,0xbf1ba299bf385216,0xbf44e3f5bf5b941a,0xbf0a48adbf299415,0xbf37c655bf514d3d,0xbeeff7fbbf19c200
.quad 0xbf299415bf45e403,0xbec9b953bf08f59b,0xbf1a6293bf396842,0xbea21887beee9479,0xbf0a48adbf2beb4a,0xbe72b651bec9b953,0xbef2bd43bf1d7fd1,0xbe1f917bbea395c5
.quad 0xbecf7bcabf0e39da,0xbd96a905be78cfcc,0xbeab0201befc5d27,0x3c16cb58be28defc,0xbe8586cebedae880,0x3dbc3ac3bdafb680,0xbe3e853ebeb8442a,0x3e3228d4bbc90f88
.quad 0xbde1bc2ebe94a031,0x3e827dc03d96a905,0xbd0a342fbe605c13,0x3eab02013e1c76de,0x3d2fe007be164083,0x3ed25a093e6c9a7f,0x3df475c0bd96a905,0x3ef840c83e9d9e78
.quad 0xbedae880bf0e39da,0xbe164083be94a031,0xbeb0eacbbef6e0cb,0xbd55880ebe4dee60,0xbe8586cebecf7bca,0x3d2fe007bde1bc2e,0xbe3228d4bea68f12,0x3e0cec4abc96c9b6
.quad 0xbdafb680be78cfcc,0x3e6c9a7f3d96a905,0x3b490fc6be22abb6,0x3ea5129f3e28defc,0x3dbc3ac3bd96a905,0x3ed25a093e827dc0,0x3e3857ec3c490e90,0x3efdbabb3eaf713a
.quad 0x3e888e933dc8bd36,0x3f13682a3edae880,0x3eb3dca53e3b6ecf,0x3f269de33f0242b1,0x3eddbe793e888e93,0x3f3852163f15f6d9,0x3f02ef9f3eb263ef,0x3f485bca3f286605
.quad 0x3f15f6d93edae880,0x3f5695e53f396842,0x3f27ce613f00e7e4,0x3f62df7b3f48d8b3,0x3f3852163f13682a,0x3f6d1c1d3f5695e5,0x3f4760853f24d225,0x3f75341d3f628210
.quad 0xbe16408380000000,0xbedae880be94a031,0xbe195be080000000,0xbedf28a9be97a117,0xbe1c76de80000000,0xbee363fabe9aa086,0xbe1f917b80000000,0xbee79a5dbe9d9e78
.quad 0xbe22abb680000000,0xbeebcbbbbea09ae5,0xbe25c58c80000000,0xbeeff7fbbea395c5,0xbe28defc80000000,0xbef41f07bea68f12,0xbe2bf80480000000,0xbef840c8bea986c4
.quad 0xbe2f10a280000000,0xbefc5d27beac7cd4,0xbe3228d480000000,0xbf003a06beaf713a,0xbe35409880000000,0xbf0242b1beb263ef,0xbe3857ec80000000,0xbf044889beb554ec
.quad 0xbe3b6ecf80000000,0xbf064b82beb8442a,0xbe3e853e80000000,0xbf084b92bebb31a0,0xbe419b3780000000,0xbf0a48adbebe1d4a,0xbe44b0b980000000,0xbf0c42c9bec1071e
.quad 0xbf2beb4abf0e39da,0xbf5b941abf45e403,0xbf2ecef7bf10d3cd,0xbf5e5aa6bf48d8b3,0xbf31a81dbf13682a,0xbf6106f2bf4bbbf8,0xbf34768fbf15f6d9,0xbf6398acbf4e8d90
.quad 0xbf373a23bf187fc0,0xbf660f88bf514d3d,0xbf39f2acbf1b02c6,0xbf686b39bf53fac3,0xbf3ca003bf1d7fd1,0xbf6aab7bbf5695e5,0xbf3f41fcbf1ff6cb,0xbf6cd007bf591e6a
.quad 0xbf41d870bf226799,0xbf6ed89ebf5b941a,0xbf446337bf24d225,0xbf70c501bf5df6be,0xbf46e22abf273656,0xbf7294f8bf604621,0xbf495521bf299415,0xbf74484bbf628210
.quad 0xbf4bbbf8bf2beb4a,0xbf75dec6bf64aa59,0xbf4e1689bf2e3bde,0xbf77583abf66becc,0xbf5064afbf3085bb,0xbf78b47bbf68bf3c,0xbf52a649bf32c8c9,0xbf79f35ebf6aab7b
.quad 0xbf7853f8bf6c835e,0xbf7fb10fbf7ec46d,0xbf79f35ebf6ed89e,0xbf7f1f49bf7f6ac7,0xbf7b61fcbf710908,0xbf7e4323bf7fd397,0xbf7c9f8abf731447,0xbf7d1cddbf7ffec4
.quad 0xbf7dabccbf74fa0b,0xbf7baccdbf7fec43,0xbf7e868bbf76ba07,0xbf79f35ebf7f9c18,0xbf7f2f9dbf7853f8,0xbf77f110bf7f0e58,0xbf7fa6e3bf79c79d,0xbf75a67bbf7e4323
.quad 0xbf7fec43bf7b14be,0xbf731447bf7d3aac,0xbf7fffb1bf7c3b28,0xbf703b37bf7bf531,0xbf7fe129bf7d3aac,0xbf6d1c1dbf7a7302,0xbf7f90b1bf7e1324,0xbf69b7e4bf78b47b
.quad 0xbf7f0e58bf7ec46d,0xbf660f88bf76ba07,0xbf7e5a38bf7f4e6d,0xbf62241abf748422,0xbf7d7474bf7fb10f,0xbf5df6bebf721352,0xbf7c5d3abf7fec43,0xbf5988adbf6f6830
.quad 0xbf710908bf7b14be,0xbf4d9f02bf61c598,0xbf6d67a1bf791298,0xbf466354bf5c61c7,0xbf696591bf76ba07,0xbf3ebc1bbf5695e5,0xbf650479bf740bdd,0xbf36ad7fbf5064af
.quad 0xbf604621bf710908,0xbf2e3bdebf49d112,0xbf5b2c79bf6db293,0xbf256bcbbf42de29,0xbf55b993bf6a09a7,0xbf1c420cbf3b8f3b,0xbf4fefa8bf660f88,0xbf12c39abf33e7bc
.quad 0xbf49d112bf61c598,0xbf08f59bbf2beb4a,0xbf436051bf5d2d53,0xbefdbabbbf239da9,0xbf3ca003bf584853,0xbee900b7bf1b02c6,0xbf3592e7bf531849,0xbed3c867bf121eb0
.quad 0xbf2e3bdebf4d9f02,0xbebe1d4abf08f59b,0xbf269de3bf47de65,0xbea80b1fbeff17b2,0xbf1ebc12bf41d870,0xbe919dddbeebcbbb,0xbf16999fbf3b8f3b,0xbe75c35abed8106b
.quad 0xbf187fc0bf3504f3,0xbeac7cd4bef15aea,0xbf0d9281bf2beb4a,0xbe901c2cbed8106b,0xbf0242b1bf226799,0xbe667c66bebe1d4a,0xbeed3063bf187fc0,0xbe2bf804bea395c5
.quad 0xbed53641bf0e39da,0xbde1bc2ebe888e93,0xbebca7afbf039c3d,0xbd55880ebe5a3997,0xbea395c5bef15aea,0x3bc90f88be22abb6,0xbe8a11f7bedae880,0x3d83db0abdd53db9
.quad 0xbe605c13bec3ef15,0x3dfab273bd48fb30,0xbe2bf804beac7cd4,0x3e3857ec3bc90f88,0xbdee3876be94a031,0x3e72b6513d7b2b74,0xbd83db0abe78cfcc,0x3e9620d23dee3876
.quad 0xbc490e90be47c5c2,0x3eb263ef3e2f10a2,0x3d2351cbbe164083,0x3ece0bea3e667c66,0x3dbc3ac3bdc8bd36,0x3ee900b73e8e9a22,0x3e1324cabd48fb30,0x3f0195733ea986c4
.quad 0xbd48fb30be47c5c2,0x3e78cfcc3dc8bd36,0x3c7b514bbe09cf86,0x3e9f1cdf3e28defc,0x3da3308cbd96a905,0x3ec1071e3e6c9a7f,0x3e1324cabc490e90,0x3ee1fb6a3e97a117
.quad 0x3e5415013d48fb30,0x3f00e7e43eb8442a,0x3e8a11f73de1bc2e,0x3f102dd53ed8106b,0x3ea986c43e2f10a2,0x3f1ebc123ef6e0cb,0x3ec8477c3e6c9a7f,0x3f2c800f3f0a48ad
.quad 0x3ee633753e94a031,0x3f3968423f187fc0,0x3f0195733eb263ef,0x3f4564393f26050a,0x3f0f87843ecf7bca,0x3f5064af3f32c8c9,0x3f1ce11f3eebcbbb,0x3f5a5ba03f3ebc1b
.quad 0x3f2994153f039c3d,0x3f633c5a3f49d112,0x3f3592e73f10d3cd,0x3f6afb8c3f53fac3,0x3f40d0da3f1d7fd1,0x3f718f573f5d2d53,0x3f4b41fa3f299415,0x3f76ef5b3f655e0b
.quad 0x3f039c3d3ec3ef15,0x3f3daef93f226799,0x3f140c5f3ee63375,0x3f4b41fa3f31a81d,0x3f239da93f039c3d,0x3f5770263f3fc767,0x3f3238aa3f13682a,0x3f62241a3f4cae79
.quad 0x3f3fc7673f226799,0x3f6b4b0c3f584853,0x3f4c35783f3085bb,0x3f72d4eb3f628210,0x3f5770263f3daef9,0x3f78b47b3f6b4b0c,0x3f61668a3f49d112,0x3f7cdf6c3f7294f8
.quad 0x3f6a09a73f54db31,0x3f7f4e6d3f7853f8,0x3f714c7a3f5ebe05,0x3f7ffd393f7c7eb0,0x3f7724173f676bd8,0x3f7eea9d3f7f0e58,0x3f7b87b23f6ed89e,0x3f7c187a3f7ffec4
.quad 0x3f7e70b03f74fa0b,0x3f778bc53f7f4e6d,0x3f7fdaaf3f79c79d,0x3f714c7a3f7cfe73,0x3f7fc38f3f7d3aac,0x3f6965913f791298,0x3f7e2b723f7f4e6d,0x3f5fe4e93f73913f
.quad 0x3f676bd83f54db31,0x3f7d3aac3f74fa0b,0x3f703b373f604621,0x3f7fa6e33f7ac516,0x3f7724173f6a09a7,0x3f7fc38f3f7e70b0,0x3f7c187a3f721352,0x3f7d906e3f7ff4e6
.quad 0x3f7f0e583f7853f8,0x3f7912983f7f4e6d,0x3f7fffb13f7cbfc9,0x3f7254703f7c7eb0,0x3f7eea9d3f7f4e6d,0x3f6965913f778bc5,0x3f7bd14d3f7ffb11,0x3f5e5aa63f708066
.quad 0x3f76ba073f7ec46d,0x3f514d3d3f676bd8,0x3f6faf1b3f7baccd,0x3f425b893f5c61c7,0x3f66becc3f76ba07,0x3f31a81d3f4f7a1f,0x3f5bfb343f6ff573,0x3f1f599f3f40d0da
.quad 0x3f4f7a1f3f676bd8,0x3f0b9a6b3f3085bb,0x3f4154e13f5d2d53,0x3eed30633f1ebc12,0x3f31a81d3f514d3d,0x3ec1071e3f0b9a6b,0x3f2093933f43e200,0x3e931f353eee9479
.quad 0x3f803f803f803f80,0x3f803f803f803f80,0x3f553f6d3f7b3f80,0xbf55bf6dbf7bbf80,0x3ec43f353f6d3f80,0x3ec43f353f6d3f80,0xbe483ec43f553f80,0x3e48bec4bf55bf80
.quad 0xbf35248d3f353f80,0xbf35248d3f353f80,0xbf7bbec43f0e3f80,0x3f7b3ec4bf0ebf80,0xbf6dbf353ec43f80,0xbf6dbf353ec43f80,0xbf0ebf6d3e483f80,0x3f0e3f6dbe48bf80
.quad 0xa554bf80248d3f80,0xa554bf80248d3f80,0x3f0ebf6dbe483f80,0xbf0e3f6d3e48bf80,0x3f6dbf35bec43f80,0x3f6dbf35bec43f80,0x3f7bbec4bf0e3f80,0xbf7b3ec43f0ebf80
.quad 0x3f35a554bf353f80,0x3f35a554bf353f80,0x3e483ec4bf553f80,0xbe48bec43f55bf80,0xbec43f35bf6d3f80,0xbec43f35bf6d3f80,0xbf553f6dbf7b3f80,0x3f55bf6d3f7bbf80
.quad 0x3f803f803f803f80,0x3f803f803f803f80,0x3e483ec43f0e3f35,0xbe48bec4bf0ebf35,0xbf6dbf35bec4248d,0xbf6dbf35bec4248d,0xbf0ebf6dbf7bbf35,0x3f0e3f6d3f7b3f35
.quad 0x3f35a554bf35bf80,0x3f35a554bf35bf80,0x3f553f6d3e48bf35,0xbf55bf6dbe483f35,0xbec43f353f6da554,0xbec43f353f6da554,0xbf7bbec43f553f35,0x3f7b3ec4bf55bf35
.quad 0xa554bf80248d3f80,0xa554bf80248d3f80,0x3f7bbec4bf553f35,0xbf7b3ec43f55bf35,0x3ec43f35bf6d248d,0x3ec43f35bf6d248d,0xbf553f6dbe48bf35,0x3f55bf6d3e483f35
.quad 0xbf35248d3f35bf80,0xbf35248d3f35bf80,0x3f0ebf6d3f7bbf35,0xbf0e3f6dbf7b3f35,0x3f6dbf353ec4a554,0x3f6dbf353ec4a554,0xbe483ec4bf0e3f35,0x3e48bec43f0ebf35
.quad 0x3f803f803f803f80,0x3f803f803f803f80,0xbf0ebec4be48248d,0x3f0e3ec43e48a554,0xbec4bf35bf6dbf80,0xbec4bf35bf6dbf80,0x3f7b3f6d3f0ea554,0xbf7bbf6dbf0e248d
.quad 0xbf35248d3f353f80,0xbf35248d3f353f80,0xbe48bf6dbf55248d,0x3e483f6d3f55a554,0x3f6d3f35bec4bf80,0x3f6d3f35bec4bf80,0xbf553ec43f7ba554,0x3f55bec4bf7b248d
.quad 0xa554bf80248d3f80,0xa554bf80248d3f80,0x3f553ec4bf7b248d,0xbf55bec43f7ba554,0xbf6d3f353ec4bf80,0xbf6d3f353ec4bf80,0x3e48bf6d3f55a554,0xbe483f6dbf55248d
.quad 0x3f35a554bf353f80,0x3f35a554bf353f80,0xbf7b3f6dbf0e248d,0x3f7bbf6d3f0ea554,0x3ec4bf353f6dbf80,0x3ec4bf353f6dbf80,0x3f0ebec43e48a554,0xbf0e3ec4be48248d
.quad 0x3f803f803f803f80,0x3f803f803f803f80,0xbf7bbf6dbf55bf35,0x3f7b3f6d3f553f35,0x3f6d3f353ec4a554,0x3f6d3f353ec4a554,0xbf55bec43e483f35,0x3f553ec4be48bf35
.quad 0x3f35a554bf35bf80,0x3f35a554bf35bf80,0xbf0e3ec43f7b3f35,0x3f0ebec4bf7bbf35,0x3ec4bf35bf6d248d,0x3ec4bf35bf6d248d,0xbe483f6d3f0ebf35,0x3e48bf6dbf0e3f35
.quad 0xa554bf80248d3f80,0xa554bf80248d3f80,0x3e483f6dbf0ebf35,0xbe48bf6d3f0e3f35,0xbec4bf353f6da554,0xbec4bf353f6da554,0x3f0e3ec4bf7b3f35,0xbf0ebec43f7bbf35
.quad 0xbf35248d3f35bf80,0xbf35248d3f35bf80,0x3f55bec4be483f35,0xbf553ec43e48bf35,0xbf6d3f35bec4248d,0xbf6d3f35bec4248d,0x3f7bbf6d3f55bf35,0xbf7b3f6dbf553f35
.quad 0xbf803f80bf803f80,0xbf803f80bf803f80,0xbf553f6dbf7b3f80,0x3f55bf6d3f7bbf80,0xbec43f35bf6d3f80,0xbec43f35bf6d3f80,0x3e483ec4bf553f80,0xbe48bec43f55bf80
.quad 0x3f35248dbf353f80,0x3f35248dbf353f80,0x3f7bbec4bf0e3f80,0xbf7b3ec43f0ebf80,0x3f6dbf35bec43f80,0x3f6dbf35bec43f80,0x3f0ebf6dbe483f80,0xbf0e3f6d3e48bf80
.quad 0x248dbf80a5543f80,0x248dbf80a5543f80,0xbf0ebf6d3e483f80,0x3f0e3f6dbe48bf80,0xbf6dbf353ec43f80,0xbf6dbf353ec43f80,0xbf7bbec43f0e3f80,0x3f7b3ec4bf0ebf80
.quad 0xbf35a5543f353f80,0xbf35a5543f353f80,0xbe483ec43f553f80,0x3e48bec4bf55bf80,0x3ec43f353f6d3f80,0x3ec43f353f6d3f80,0x3f553f6d3f7b3f80,0xbf55bf6dbf7bbf80
.quad 0xbf803f80bf803f80,0xbf803f80bf803f80,0xbe483ec4bf0e3f35,0x3e48bec43f0ebf35,0x3f6dbf353ec4248d,0x3f6dbf353ec4248d,0x3f0ebf6d3f7bbf35,0xbf0e3f6dbf7b3f35
.quad 0xbf35a5543f35bf80,0xbf35a5543f35bf80,0xbf553f6dbe48bf35,0x3f55bf6d3e483f35,0x3ec43f35bf6da554,0x3ec43f35bf6da554,0x3f7bbec4bf553f35,0xbf7b3ec43f55bf35
.quad 0x248dbf80a5543f80,0x248dbf80a5543f80,0xbf7bbec43f553f35,0x3f7b3ec4bf55bf35,0xbec43f353f6d248d,0xbec43f353f6d248d,0x3f553f6d3e48bf35,0xbf55bf6dbe483f35
.quad 0x3f35248dbf35bf80,0x3f35248dbf35bf80,0xbf0ebf6dbf7bbf35,0x3f0e3f6d3f7b3f35,0xbf6dbf35bec4a554,0xbf6dbf35bec4a554,0x3e483ec43f0e3f35,0xbe48bec4bf0ebf35
.quad 0xbf803f80bf803f80,0xbf803f80bf803f80,0x3f0ebec43e48248d,0xbf0e3ec4be48a554,0x3ec4bf353f6dbf80,0x3ec4bf353f6dbf80,0xbf7b3f6dbf0ea554,0x3f7bbf6d3f0e248d
.quad 0x3f35248dbf353f80,0x3f35248dbf353f80,0x3e48bf6d3f55248d,0xbe483f6dbf55a554,0xbf6d3f353ec4bf80,0xbf6d3f353ec4bf80,0x3f553ec4bf7ba554,0xbf55bec43f7b248d
.quad 0x248dbf80a5543f80,0x248dbf80a5543f80,0xbf553ec43f7b248d,0x3f55bec4bf7ba554,0x3f6d3f35bec4bf80,0x3f6d3f35bec4bf80,0xbe48bf6dbf55a554,0x3e483f6d3f55248d
.quad 0xbf35a5543f353f80,0xbf35a5543f353f80,0x3f7b3f6d3f0e248d,0xbf7bbf6dbf0ea554,0xbec4bf35bf6dbf80,0xbec4bf35bf6dbf80,0xbf0ebec4be48a554,0x3f0e3ec43e48248d
.quad 0xbf803f80bf803f80,0xbf803f80bf803f80,0x3f7bbf6d3f55bf35,0xbf7b3f6dbf553f35,0xbf6d3f35bec4a554,0xbf6d3f35bec4a554,0x3f55bec4be483f35,0xbf553ec43e48bf35
.quad 0xbf35a5543f35bf80,0xbf35a5543f35bf80,0x3f0e3ec4bf7b3f35,0xbf0ebec43f7bbf35,0xbec4bf353f6d248d,0xbec4bf353f6d248d,0x3e483f6dbf0ebf35,0xbe48bf6d3f0e3f35
.quad 0x248dbf80a5543f80,0x248dbf80a5543f80,0xbe483f6d3f0ebf35,0x3e48bf6dbf0e3f35,0x3ec4bf35bf6da554,0x3ec4bf35bf6da554,0xbf0e3ec43f7b3f35,0x3f0ebec4bf7bbf35
.quad 0x3f35248dbf35bf80,0x3f35248dbf35bf80,0xbf55bec43e483f35,0x3f553ec4be48bf35,0x3f6d3f353ec4248d,0x3f6d3f353ec4248d,0xbf7bbf6dbf55bf35,0x3f7b3f6d3f553f35
.quad 0x8000800080008000,0x8000800080008000,0xbf0ebec4be488000,0x3f0e3ec43e48a50d,0xbf6dbf35bec48000,0xbf6dbf35bec48000,0xbf7bbf6dbf0e8000,0x3f7b3f6d3f0ea50d
.quad 0xbf35bf80bf358000,0xbf35bf80bf358000,0xbe48bf6dbf558000,0x3e483f6d3f55a50d,0x3ec4bf35bf6d8000,0x3ec4bf35bf6d8000,0x3f55bec4bf7b8000,0xbf553ec43f7ba50d
.quad 0x3f80a50dbf808000,0x3f80a50dbf808000,0x3f553ec4bf7b8000,0xbf55bec43f7ba50d,0x3ec43f35bf6d8000,0x3ec43f35bf6d8000,0xbe483f6dbf558000,0x3e48bf6d3f55a50d
.quad 0xbf353f80bf358000,0xbf353f80bf358000,0xbf7b3f6dbf0e8000,0x3f7bbf6d3f0ea50d,0xbf6d3f35bec48000,0xbf6d3f35bec48000,0xbf0e3ec4be488000,0x3f0ebec43e48a50d
.quad 0x8000800080008000,0x8000800080008000,0xbf7bbf6dbf55bf35,0x3f7b3f6d3f553f35,0xbec4bf35bf6dbf80,0xbec4bf35bf6dbf80,0x3f553ec4be48bf35,0xbf55bec43e483f35
.quad 0x3f353f803f35a50d,0x3f353f803f35a50d,0xbf0e3ec43f7b3f35,0x3f0ebec4bf7bbf35,0xbf6dbf353ec43f80,0xbf6dbf353ec43f80,0x3e48bf6dbf0e3f35,0xbe483f6d3f0ebf35
.quad 0x3f80a50dbf808000,0x3f80a50dbf808000,0x3e483f6dbf0ebf35,0xbe48bf6d3f0e3f35,0xbf6d3f353ec4bf80,0xbf6d3f353ec4bf80,0xbf0ebec43f7bbf35,0x3f0e3ec4bf7b3f35
.quad 0x3f35bf803f35a50d,0x3f35bf803f35a50d,0x3f55bec4be483f35,0xbf553ec43e48bf35,0xbec43f35bf6d3f80,0xbec43f35bf6d3f80,0xbf7b3f6dbf553f35,0x3f7bbf6d3f55bf35
.quad 0x8000800080008000,0x8000800080008000,0xbf55bf6dbf7bbf80,0x3f553f6d3f7b3f80,0x3f6d3f353ec4a50d,0x3f6d3f353ec4a50d,0xbe483ec43f553f80,0x3e48bec4bf55bf80
.quad 0xbf35bf80bf358000,0xbf35bf80bf358000,0x3f7b3ec4bf0ebf80,0xbf7bbec43f0e3f80,0xbec43f353f6da50d,0xbec43f353f6da50d,0xbf0ebf6d3e483f80,0x3f0e3f6dbe48bf80
.quad 0x3f80a50dbf808000,0x3f80a50dbf808000,0xbf0e3f6d3e48bf80,0x3f0ebf6dbe483f80,0xbec4bf353f6da50d,0xbec4bf353f6da50d,0x3f7bbec4bf0e3f80,0xbf7b3ec43f0ebf80
.quad 0xbf353f80bf358000,0xbf353f80bf358000,0xbe48bec43f55bf80,0x3e483ec4bf553f80,0x3f6dbf353ec4a50d,0x3f6dbf353ec4a50d,0xbf553f6dbf7b3f80,0x3f55bf6d3f7bbf80
.quad 0x8000800080008000,0x8000800080008000,0xbe48bec4bf0ebf35,0x3e483ec43f0e3f35,0x3ec43f353f6d3f80,0x3ec43f353f6d3f80,0xbf0ebf6dbf7bbf35,0x3f0e3f6d3f7b3f35
.quad 0x3f353f803f35a50d,0x3f353f803f35a50d,0xbf55bf6dbe483f35,0x3f553f6d3e48bf35,0x3f6d3f35bec4bf80,0x3f6d3f35bec4bf80,0xbf7bbec43f553f35,0x3f7b3ec4bf55bf35
.quad 0x3f80a50dbf808000,0x3f80a50dbf808000,0xbf7b3ec43f55bf35,0x3f7bbec4bf553f35,0x3f6dbf35bec43f80,0x3f6dbf35bec43f80,0xbf553f6dbe48bf35,0x3f55bf6d3e483f35
.quad 0x3f35bf803f35a50d,0x3f35bf803f35a50d,0xbf0e3f6dbf7b3f35,0x3f0ebf6d3f7bbf35,0x3ec4bf353f6dbf80,0x3ec4bf353f6dbf80,0xbe483ec4bf0e3f35,0x3e48bec43f0ebf35
.quad 0xa50d8000a50d8000,0xa50d8000a50d8000,0x3f0ebec43e488000,0xbf0e3ec4be48a50d,0x3f6dbf353ec48000,0x3f6dbf353ec48000,0x3f7bbf6d3f0e8000,0xbf7b3f6dbf0ea50d
.quad 0x3f35bf803f358000,0x3f35bf803f358000,0x3e48bf6d3f558000,0xbe483f6dbf55a50d,0xbec4bf353f6d8000,0xbec4bf353f6d8000,0xbf55bec43f7b8000,0x3f553ec4bf7ba50d
.quad 0xbf80a50d3f808000,0xbf80a50d3f808000,0xbf553ec43f7b8000,0x3f55bec4bf7ba50d,0xbec43f353f6d8000,0xbec43f353f6d8000,0x3e483f6d3f558000,0xbe48bf6dbf55a50d
.quad 0x3f353f803f358000,0x3f353f803f358000,0x3f7b3f6d3f0e8000,0xbf7bbf6dbf0ea50d,0x3f6d3f353ec48000,0x3f6d3f353ec48000,0x3f0e3ec43e488000,0xbf0ebec4be48a50d
.quad 0xa50d8000a50d8000,0xa50d8000a50d8000,0x3f7bbf6d3f55bf35,0xbf7b3f6dbf553f35,0x3ec4bf353f6dbf80,0x3ec4bf353f6dbf80,0xbf553ec43e48bf35,0x3f55bec4be483f35
.quad 0xbf353f80bf35a50d,0xbf353f80bf35a50d,0x3f0e3ec4bf7b3f35,0xbf0ebec43f7bbf35,0x3f6dbf35bec43f80,0x3f6dbf35bec43f80,0xbe48bf6d3f0e3f35,0x3e483f6dbf0ebf35
.quad 0xbf80a50d3f808000,0xbf80a50d3f808000,0xbe483f6d3f0ebf35,0x3e48bf6dbf0e3f35,0x3f6d3f35bec4bf80,0x3f6d3f35bec4bf80,0x3f0ebec4bf7bbf35,0xbf0e3ec43f7b3f35
.quad 0xbf35bf80bf35a50d,0xbf35bf80bf35a50d,0xbf55bec43e483f35,0x3f553ec4be48bf35,0x3ec43f353f6d3f80,0x3ec43f353f6d3f80,0x3f7b3f6d3f553f35,0xbf7bbf6dbf55bf35
.quad 0xa50d8000a50d8000,0xa50d8000a50d8000,0x3f55bf6d3f7bbf80,0xbf553f6dbf7b3f80,0xbf6d3f35bec4a50d,0xbf6d3f35bec4a50d,0x3e483ec4bf553f80,0xbe48bec43f55bf80
.quad 0x3f35bf803f358000,0x3f35bf803f358000,0xbf7b3ec43f0ebf80,0x3f7bbec4bf0e3f80,0x3ec43f35bf6da50d,0x3ec43f35bf6da50d,0x3f0ebf6dbe483f80,0xbf0e3f6d3e48bf80
.quad 0xbf80a50d3f808000,0xbf80a50d3f808000,0x3f0e3f6dbe48bf80,0xbf0ebf6d3e483f80,0x3ec4bf35bf6da50d,0x3ec4bf35bf6da50d,0xbf7bbec43f0e3f80,0x3f7b3ec4bf0ebf80
.quad 0x3f353f803f358000,0x3f353f803f358000,0x3e48bec4bf55bf80,0xbe483ec43f553f80,0xbf6dbf35bec4a50d,0xbf6dbf35bec4a50d,0x3f553f6d3f7b3f80,0xbf55bf6dbf7bbf80
.quad 0xa50d8000a50d8000,0xa50d8000a50d8000,0x3e48bec43f0ebf35,0xbe483ec4bf0e3f35,0xbec43f35bf6d3f80,0xbec43f35bf6d3f80,0x3f0ebf6d3f7bbf35,0xbf0e3f6dbf7b3f35
.quad 0xbf353f80bf35a50d,0xbf353f80bf35a50d,0x3f55bf6d3e483f35,0xbf553f6dbe48bf35,0xbf6d3f353ec4bf80,0xbf6d3f353ec4bf80,0x3f7bbec4bf553f35,0xbf7b3ec43f55bf35
.quad 0xbf80a50d3f808000,0xbf80a50d3f808000,0x3f7b3ec4bf55bf35,0xbf7bbec43f553f35,0xbf6dbf353ec43f80,0xbf6dbf353ec43f80,0x3f553f6d3e48bf35,0xbf55bf6dbe483f35
.quad 0xbf35bf80bf35a50d,0xbf35bf80bf35a50d,0x3f0e3f6d3f7b3f35,0xbf0ebf6dbf7bbf35,0xbec4bf35bf6dbf80,0xbec4bf35bf6dbf80,0x3e483ec43f0e3f35,0xbe48bec4bf0ebf35
.size Ltab, 36864
.section .rodata,"a"
.p2align 6
.amdhsa_kernel interleave_layers__spectral_gfnet__glu_gated_reglu__prompt_kernel
  .amdhsa_next_free_vgpr 512
  .amdhsa_next_free_sgpr 102
  .amdhsa_accum_offset 256
  .amdhsa_group_segment_fixed_size 0
  .amdhsa_kernarg_size 80
  .amdhsa_user_sgpr_count 2
  .amdhsa_user_sgpr_kernarg_segment_ptr 1
  .amdhsa_system_sgpr_workgroup_id_x 1
  .amdhsa_float_denorm_mode_32 3
.end_amdhsa_kernel
```
